```python
import torch

def _softmax(x, axis=-1):
    return torch.softmax(x, dim=axis)
def _gelu(x):
    return torch.nn.functional.gelu(x, approximate="tanh")
def _silu(x):
    return torch.nn.functional.silu(x)
def _sigmoid(x):
    return torch.sigmoid(x)
def _layernorm(x, axis=-1, eps=1e-5):
    m = x.mean(dim=axis, keepdim=True)
    v = x.var(dim=axis, keepdim=True, unbiased=False)
    return (x - m) / torch.sqrt(v + eps)
def _scatter_add(tgt, idx, src, axis=0):
    return tgt.clone().index_add_(axis, idx, src)
def _segment_sum(src, seg, n):
    out = torch.zeros((n,) + src.shape[1:], dtype=src.dtype)
    return out.index_add_(0, seg, src)
def _pad(x, pw):
    flat = tuple(v for pair in reversed(pw) for v in pair)
    return torch.nn.functional.pad(x, flat)

kernel_name = 'concat_heads__compressed_kv_cla__softmax_full_mha__prompt'

def setup_inputs():

    _w = (lambda a: (lambda t: t.to(torch.bfloat16) if t.is_floating_point() else t)(torch.as_tensor(a)))
    def _A_setup():
        B, H, Sq, Sk, D, M = 1, 32, 2048, 2048, 128, 576
        Dc = 4 * D
        return {
            "x": _w((lambda *s: torch.randn(*s, dtype=torch.bfloat16) * 0.4)(B, Sq, M)),
            "c_kv": _w((lambda *s: torch.randn(*s, dtype=torch.bfloat16) * 1.6)(B, Sk, Dc)),
            "w_q": _w((lambda *s: torch.randn(*s, dtype=torch.bfloat16) * 6.4)(M, H, D) * (M ** -0.5)),
            "w_uk": _w((lambda *s: torch.randn(*s, dtype=torch.bfloat16) * 6.4)(Dc, H, D) * (Dc ** -0.5)),
            "w_uv": _w((lambda *s: torch.randn(*s, dtype=torch.bfloat16) * 1.6)(Dc, H, D) * (Dc ** -0.5)),
            "w_o": _w((lambda *s: torch.randn(*s, dtype=torch.bfloat16) * 1.6)(H, D, M) * ((H * D) ** -0.5)),
        }
    _A_in = _A_setup()

    def _B_setup():
        B, S, D = 1, 2048, 576
        return {
            "x": _w((lambda *s: torch.randn(*s, dtype=torch.bfloat16) * 0.4)(B, S, D)),
            "wqkv": _w((lambda *s: torch.randn(*s, dtype=torch.bfloat16) * 0.4)(D, 3 * D)),
            "wo": _w((lambda *s: torch.randn(*s, dtype=torch.bfloat16) * 0.05)(D, D)),
        }
    _B_in = _B_setup()

    return {
        "A_x": _A_in["x"],
        "A_c_kv": _A_in["c_kv"],
        "A_w_q": _A_in["w_q"],
        "A_w_uk": _A_in["w_uk"],
        "A_w_uv": _A_in["w_uv"],
        "A_w_o": _A_in["w_o"],
        "B_x": _B_in["x"],
        "B_wqkv": _B_in["wqkv"],
        "B_wo": _B_in["wo"],
    }

def reference(A_x, A_c_kv, A_w_q, A_w_uk, A_w_uv, A_w_o, B_x, B_wqkv, B_wo):
    def _A_ref(x, c_kv, w_q, w_uk, w_uv, w_o):
        B, Sq, M = x.shape[0], x.shape[1], x.shape[2]
        Sk = c_kv.shape[1]
        H, D = w_q.shape[1], w_q.shape[2]
        q = torch.einsum("bqm,mhd->bhqd", x, w_q)
        k = torch.einsum("bkc,chd->bhkd", c_kv, w_uk)
        v = torch.einsum("bkc,chd->bhkd", c_kv, w_uv)
        scores = torch.einsum("bhqd,bhkd->bhqk", q, k) * (D ** -0.5)
        off = Sk - Sq
        qi = torch.arange(Sq)[:, None]
        kj = torch.arange(Sk)[None, :]
        cmask = kj <= (qi + off)
        scores = torch.where(cmask[None, None], scores, -1e9)
        p = _softmax(scores, axis=-1)
        ctx = torch.einsum("bhqk,bhkd->bhqd", p, v)
        return torch.einsum("bhqd,hdm->bqm", ctx, w_o)

    def _B_ref(x, wqkv, wo):
        B, S, D = x.shape
        H = 32; Dh = D // H
        qkv = (lambda x, *d: x.permute(*d))((x @ wqkv).reshape(B, S, 3, H, Dh), 2, 0, 3, 1, 4)
        q, k, v = qkv[0], qkv[1], qkv[2]
        scale = Dh ** -0.5
        scores = torch.einsum("bhqd,bhkd->bhqk", q, k) * scale
        p = _softmax(scores, axis=-1)
        o = torch.einsum("bhqk,bhkd->bhqd", p, v)
        return (lambda x, *d: x.permute(*d))(o, 0, 2, 1, 3).reshape(B, S, D) @ wo

    a = _A_ref(A_x, A_c_kv, A_w_q, A_w_uk, A_w_uv, A_w_o)
    b = _B_ref(B_x, B_wqkv, B_wo)
    return torch.concatenate([a, b], axis=-1)
```

```asm
; @launch kernel=main_kernel grid=(256,1,1) block=(256,1,1) lds=163840
; @launch kernel=k3_kernel grid=(512,1,1) block=(256,1,1) lds=81920
.amdgcn_target "amdgcn-amd-amdhsa--gfx950"
.text
.globl main_kernel
.p2align 8
.type main_kernel,@function
main_kernel:
    s_cmp_ge_u32 s2, 256
    s_cbranch_scc1 L_proj_exit
    s_load_dwordx4 s[60:63], s[0:1], 0
    s_load_dwordx4 s[64:67], s[0:1], 16
    s_load_dwordx4 s[68:71], s[0:1], 32
    s_load_dwordx4 s[72:75], s[0:1], 48
    s_load_dwordx2 s[76:77], s[0:1], 64
    s_load_dwordx2 s[78:79], s[0:1], 88
    v_and_b32 v244, 63, v0
    v_lshrrev_b32 v237, 6, v0
    v_lshlrev_b32 v236, 4, v244
    v_readfirstlane_b32 s3, v237
    v_lshrrev_b32 v246, 5, v244
    v_and_b32 v245, 0x13, v244
    v_and_b32 v237, 4, v244
    v_lshl_or_b32 v245, v237, 1, v245
    v_bfe_u32 v237, v244, 3, 1
    v_lshl_or_b32 v245, v237, 2, v245
    s_getpc_b64 s[4:5]
L_proj_pc:
    s_sub_u32 s4, s4, L_proj_pc-main_kernel
    s_subb_u32 s5, s5, 0
    s_lshr_b32 s6, s2, 3
    s_lshl_b32 s6, s6, 2
    s_add_u32 s6, s6, s3
    s_cmp_ge_u32 s6, (L_text_end-main_kernel)>>10
    s_cbranch_scc1 L_proj_nocode
    s_lshl_b32 s6, s6, 10
    v_add_u32 v253, s6, v236
    global_load_dwordx4 v[248:251], v253, s[4:5]
L_proj_nocode:
    v_lshrrev_b32 v237, 3, v244
    v_mul_u32_u24 v237, 1024, v237
    v_and_b32 v238, 7, v244
    v_lshrrev_b32 v239, 4, v244
    v_xor_b32 v238, v238, v239
    v_lshl_add_u32 v232, v238, 4, v237
    v_xor_b32 v233, 64, v232
    v_lshrrev_b32 v237, 5, v244
    v_and_b32 v238, 31, v244
    v_lshlrev_b32 v239, 2, v237
    v_xor_b32 v238, v238, v239
    v_mul_u32_u24 v237, 8192, v237
    v_lshl_add_u32 v234, v238, 4, v237
    v_xor_b32 v235, 128, v234
    s_and_b32 s50, s2, 7
    s_lshr_b32 s51, s2, 3
    s_and_b32 s49, s51, 7
    s_lshr_b32 s52, s51, 3
    s_and_b32 s44, s52, 1
    s_lshl_b32 s53, s50, 1
    s_add_u32 s53, s53, s44
    s_lshl_b32 s44, s49, 2
    s_add_u32 s44, s44, s3
    s_lshl_b32 s40, s44, 16
    s_lshl_b32 s42, s3, 16
    s_lshl_b32 s44, s53, 9
    s_add_u32 s42, s42, s44
    s_lshl_b32 s41, s3, 13
    s_add_u32 s41, s41, 65536
    s_lshl_b32 s43, s3, 12
    s_waitcnt lgkmcnt(0)
    s_mov_b32 s8, s62
    s_mov_b32 s9, s63
    s_mov_b32 s10, 0x200000
    s_mov_b32 s11, 0x00020000
    s_cmp_lt_u32 s52, 2
    s_cselect_b32 s12, s66, s68
    s_cselect_b32 s13, s67, s69
    s_mov_b32 s14, 0x400000
    s_mov_b32 s15, 0x00020000
    s_add_u32 s40, s40, 256
    s_add_u32 s41, s41, 65536
    s_add_u32 s42, s42, 1048576
    s_add_u32 m0, s41, 4294901760
    s_add_u32 s44, s40, 4294967040
    buffer_load_dwordx4 v232, s[8:11], s44 offen lds
    s_add_u32 m0, s41, 4294902784
    s_add_u32 s44, s40, 7936
    buffer_load_dwordx4 v233, s[8:11], s44 offen lds
    s_add_u32 m0, s41, 4294903808
    s_add_u32 s44, s40, 16128
    buffer_load_dwordx4 v232, s[8:11], s44 offen lds
    s_add_u32 m0, s41, 4294904832
    s_add_u32 s44, s40, 24320
    buffer_load_dwordx4 v233, s[8:11], s44 offen lds
    s_add_u32 m0, s43, 0
    s_add_u32 s44, s42, 4293918720
    buffer_load_dwordx4 v234, s[12:15], s44 offen lds
    s_add_u32 m0, s43, 1024
    s_add_u32 s44, s42, 4293935104
    buffer_load_dwordx4 v235, s[12:15], s44 offen lds
    s_add_u32 m0, s43, 2048
    s_add_u32 s44, s42, 4293951488
    buffer_load_dwordx4 v234, s[12:15], s44 offen lds
    s_add_u32 m0, s43, 3072
    s_add_u32 s44, s42, 4293967872
    buffer_load_dwordx4 v235, s[12:15], s44 offen lds
    s_add_u32 m0, s41, 4294905856
    s_add_u32 s44, s40, 32512
    buffer_load_dwordx4 v232, s[8:11], s44 offen lds
    s_add_u32 m0, s41, 4294906880
    s_add_u32 s44, s40, 40704
    buffer_load_dwordx4 v233, s[8:11], s44 offen lds
    s_add_u32 m0, s41, 4294907904
    s_add_u32 s44, s40, 48896
    buffer_load_dwordx4 v232, s[8:11], s44 offen lds
    s_add_u32 m0, s41, 4294908928
    s_add_u32 s44, s40, 57088
    buffer_load_dwordx4 v233, s[8:11], s44 offen lds
    s_add_u32 m0, s43, 16384
    s_add_u32 s44, s42, 4294180864
    buffer_load_dwordx4 v234, s[12:15], s44 offen lds
    s_add_u32 m0, s43, 17408
    s_add_u32 s44, s42, 4294197248
    buffer_load_dwordx4 v235, s[12:15], s44 offen lds
    s_add_u32 m0, s43, 18432
    s_add_u32 s44, s42, 4294213632
    buffer_load_dwordx4 v234, s[12:15], s44 offen lds
    s_add_u32 m0, s43, 19456
    s_add_u32 s44, s42, 4294230016
    buffer_load_dwordx4 v235, s[12:15], s44 offen lds
    s_mov_b32 s16, s60
    s_mov_b32 s17, s61
    s_mov_b32 s18, 0x240000
    s_mov_b32 s19, 0x00020000
    s_mov_b32 s20, s64
    s_mov_b32 s21, s65
    s_mov_b32 s22, 0x480000
    s_mov_b32 s23, 0x00020000
    s_mov_b32 s24, s72
    s_mov_b32 s25, s73
    s_mov_b32 s26, 0x240000
    s_mov_b32 s27, 0x00020000
    s_mov_b32 s28, s74
    s_mov_b32 s29, s75
    s_mov_b32 s30, 0x1e6000
    s_mov_b32 s31, 0x00020000
    s_mov_b32 s32, s78
    s_mov_b32 s33, s79
    s_mov_b32 s34, 0x10000000
    s_mov_b32 s35, 0x00020000
    s_lshl_b32 s6, s2, 7
    s_add_u32 s6, s6, 92340224
    v_mov_b32 v237, 0
    buffer_load_dword a250, v237, s[32:35], s6 offen sc1
    v_and_b32 v237, 7, v244
    v_lshlrev_b32 v237, 3, v237
    v_bfe_u32 v238, v244, 3, 1
    v_lshl_add_u32 v237, v238, 7, v237
    s_bfe_u32 s6, s2, 0x10004
    s_lshl_b32 s6, s6, 6
    s_and_b32 s7, s2, 7
    s_add_u32 s6, s6, s7
    v_add_u32 v237, s6, v237
    v_lshlrev_b32 v237, 7, v237
    s_mov_b32 s6, 92340224
    buffer_load_dword a251, v237, s[32:35], s6 offen sc1
    s_mov_b32 s36, s70
    s_mov_b32 s37, s71
    s_mov_b32 s38, 0x480000
    s_mov_b32 s39, 0x00020000
    s_mov_b32 s4, s76
    s_mov_b32 s5, s77
    s_mov_b32 s6, 0xa2000
    s_mov_b32 s7, 0x00020000
    s_mov_b32 s47, 65536
    s_and_b32 s45, s3, 1
    s_lshl_b32 s45, s45, 7
    s_lshr_b32 s51, s3, 1
    s_lshl_b32 s51, s51, 2
    s_mov_b32 s46, 0
    v_add_u32 v237, s45, v245
    v_bfe_u32 v238, v237, 1, 3
    v_xor_b32 v238, v238, v246
    v_lshlrev_b32 v238, 4, v238
    v_lshl_add_u32 v237, v237, 7, v238
    v_add_u32 v237, s47, v237
    v_mov_b32 v224, v237
    v_xor_b32 v225, 32, v237
    v_xor_b32 v226, 64, v237
    v_xor_b32 v227, 96, v237
    v_bfe_u32 v237, v244, 2, 2
    v_lshl_add_u32 v238, v246, 3, v237
    v_mul_u32_u24 v238, 512, v238
    v_bfe_u32 v239, v244, 4, 1
    v_and_b32 v240, 1, v244
    v_lshl_or_b32 v239, v239, 1, v240
    v_lshlrev_b32 v240, 2, v237
    v_bfe_u32 v241, v244, 1, 1
    v_lshl_add_u32 v238, v241, 3, v238
    v_add_u32 v238, s46, v238
    s_add_u32 s44, s51, 0
    s_lshl_b32 s44, s44, 2
    v_or_b32 v241, s44, v239
    v_xor_b32 v241, v241, v240
    v_lshl_add_u32 v228, v241, 4, v238
    s_add_u32 s44, s51, 1
    s_lshl_b32 s44, s44, 2
    v_or_b32 v241, s44, v239
    v_xor_b32 v241, v241, v240
    v_lshl_add_u32 v229, v241, 4, v238
    s_add_u32 s44, s51, 2
    s_lshl_b32 s44, s44, 2
    v_or_b32 v241, s44, v239
    v_xor_b32 v241, v241, v240
    v_lshl_add_u32 v230, v241, 4, v238
    s_add_u32 s44, s51, 3
    s_lshl_b32 s44, s44, 2
    v_or_b32 v241, s44, v239
    v_xor_b32 v241, v241, v240
    v_lshl_add_u32 v231, v241, 4, v238
    s_lshr_b32 s51, s2, 3
    s_min_u32 s51, s51, 26
    s_lshl_b32 s44, s50, 2
    s_add_u32 s44, s44, s3
    s_mul_i32 s56, s44, 73728
    s_mul_i32 s57, s3, 27648
    s_lshl_b32 s44, s51, 7
    s_add_u32 s57, s57, s44
    s_lshl_b32 s44, s53, 1
    s_lshr_b32 s45, s3, 1
    s_add_u32 s44, s44, s45
    s_lshl_b32 s44, s44, 6
    s_lshl_b32 s45, s49, 3
    s_add_u32 s44, s44, s45
    s_and_b32 s45, s3, 1
    s_lshl_b32 s45, s45, 2
    s_add_u32 s44, s44, s45
    s_lshl_b32 s54, s44, 14
    s_add_u32 s54, s54, 16777216
    s_lshl_b32 s58, s2, 2
    s_add_u32 s58, s58, s3
    s_lshl_b32 s58, s58, 10
    s_cmp_ge_u32 s52, 2
    s_cbranch_scc1 L_proj_V
    s_waitcnt vmcnt(6)
    s_barrier
    ds_read_b64_tr_b16 a[16:17], v228 offset:0
    ds_read_b128 a[0:3], v224 offset:0
    ds_read_b64_tr_b16 a[18:19], v228 offset:2048
    ds_read_b64_tr_b16 a[20:21], v229 offset:0
    ds_read_b128 a[4:7], v224 offset:4096
    ds_read_b64_tr_b16 a[22:23], v229 offset:2048
    ds_read_b64_tr_b16 a[24:25], v230 offset:0
    ds_read_b128 a[8:11], v224 offset:8192
    ds_read_b64_tr_b16 a[26:27], v230 offset:2048
    ds_read_b64_tr_b16 a[28:29], v231 offset:0
    ds_read_b128 a[12:15], v224 offset:12288
    ds_read_b64_tr_b16 a[30:31], v231 offset:2048
    s_waitcnt lgkmcnt(0)
    v_mfma_f32_32x32x16_bf16 v[0:15], a[16:19], a[0:3], 0
    s_add_u32 s47, s47, 32768
    s_mov_b32 s55, 32768
    s_cmp_eq_u32 s47, 163840
    s_cselect_b32 s55, -65536, s55
    s_cselect_b32 s47, 65536, s47
    s_add_u32 m0, s41, 4294934528
    s_add_u32 s44, s40, 4294967168
    buffer_load_dwordx4 v232, s[8:11], s44 offen lds
    v_mfma_f32_32x32x16_bf16 v[64:79], a[20:23], a[0:3], 0
    ds_read_b64_tr_b16 a[48:49], v228 offset:8192
    s_add_u32 m0, s41, 4294935552
    s_add_u32 s44, s40, 8064
    buffer_load_dwordx4 v233, s[8:11], s44 offen lds
    v_mfma_f32_32x32x16_bf16 v[128:143], a[24:27], a[0:3], 0
    ds_read_b128 a[32:35], v225 offset:0
    s_add_u32 m0, s41, 4294936576
    s_add_u32 s44, s40, 16256
    buffer_load_dwordx4 v232, s[8:11], s44 offen lds
    v_mfma_f32_32x32x16_bf16 v[192:207], a[28:31], a[0:3], 0
    ds_read_b64_tr_b16 a[50:51], v228 offset:10240
    v_mfma_f32_32x32x16_bf16 v[16:31], a[16:19], a[4:7], 0
    s_add_u32 m0, s41, 4294937600
    s_add_u32 s44, s40, 24448
    buffer_load_dwordx4 v233, s[8:11], s44 offen lds
    ds_read_b64_tr_b16 a[52:53], v229 offset:8192
    v_mfma_f32_32x32x16_bf16 v[80:95], a[20:23], a[4:7], 0
    s_add_u32 m0, s43, 32768
    s_add_u32 s44, s42, 4294443008
    buffer_load_dwordx4 v234, s[12:15], s44 offen lds
    ds_read_b128 a[36:39], v225 offset:4096
    v_mfma_f32_32x32x16_bf16 v[144:159], a[24:27], a[4:7], 0
    s_add_u32 m0, s43, 33792
    s_add_u32 s44, s42, 4294459392
    buffer_load_dwordx4 v235, s[12:15], s44 offen lds
    ds_read_b64_tr_b16 a[54:55], v229 offset:10240
    v_mfma_f32_32x32x16_bf16 v[208:223], a[28:31], a[4:7], 0
    s_add_u32 m0, s43, 34816
    s_add_u32 s44, s42, 4294475776
    buffer_load_dwordx4 v234, s[12:15], s44 offen lds
    v_mfma_f32_32x32x16_bf16 v[32:47], a[16:19], a[8:11], 0
    ds_read_b64_tr_b16 a[56:57], v230 offset:8192
    s_add_u32 m0, s43, 35840
    s_add_u32 s44, s42, 4294492160
    buffer_load_dwordx4 v235, s[12:15], s44 offen lds
    v_mfma_f32_32x32x16_bf16 v[96:111], a[20:23], a[8:11], 0
    ds_read_b128 a[40:43], v225 offset:8192
    s_add_u32 m0, s41, 0
    s_add_u32 s44, s40, 0
    buffer_load_dwordx4 v232, s[8:11], s44 offen lds
    v_mfma_f32_32x32x16_bf16 v[160:175], a[24:27], a[8:11], 0
    ds_read_b64_tr_b16 a[58:59], v230 offset:10240
    s_add_u32 m0, s41, 1024
    s_add_u32 s44, s40, 8192
    buffer_load_dwordx4 v233, s[8:11], s44 offen lds
    v_mfma_f32_32x32x16_bf16 a[64:79], a[28:31], a[8:11], 0
    ds_read_b64_tr_b16 a[60:61], v231 offset:8192
    v_mfma_f32_32x32x16_bf16 v[48:63], a[16:19], a[12:15], 0
    s_add_u32 m0, s41, 2048
    s_add_u32 s44, s40, 16384
    buffer_load_dwordx4 v232, s[8:11], s44 offen lds
    ds_read_b128 a[44:47], v225 offset:12288
    v_mfma_f32_32x32x16_bf16 v[112:127], a[20:23], a[12:15], 0
    s_add_u32 m0, s41, 3072
    s_add_u32 s44, s40, 24576
    buffer_load_dwordx4 v233, s[8:11], s44 offen lds
    ds_read_b64_tr_b16 a[62:63], v231 offset:10240
    v_mfma_f32_32x32x16_bf16 v[176:191], a[24:27], a[12:15], 0
    v_add_u32 v225, s55, v225
    v_mfma_f32_32x32x16_bf16 a[80:95], a[28:31], a[12:15], 0
    s_waitcnt vmcnt(14) lgkmcnt(0)
    s_barrier
    v_mfma_f32_32x32x16_bf16 v[0:15], a[48:51], a[32:35], v[0:15]
    ds_read_b64_tr_b16 a[16:17], v228 offset:16384
    s_add_u32 m0, s41, 4294938624
    s_add_u32 s44, s40, 32640
    buffer_load_dwordx4 v232, s[8:11], s44 offen lds
    v_mfma_f32_32x32x16_bf16 v[64:79], a[52:55], a[32:35], v[64:79]
    ds_read_b128 a[0:3], v226 offset:0
    v_mfma_f32_32x32x16_bf16 v[128:143], a[56:59], a[32:35], v[128:143]
    s_add_u32 m0, s41, 4294939648
    s_add_u32 s44, s40, 40832
    buffer_load_dwordx4 v233, s[8:11], s44 offen lds
    v_mfma_f32_32x32x16_bf16 v[192:207], a[60:63], a[32:35], v[192:207]
    ds_read_b64_tr_b16 a[18:19], v228 offset:18432
    ds_read_b64_tr_b16 a[20:21], v229 offset:16384
    v_mfma_f32_32x32x16_bf16 v[16:31], a[48:51], a[36:39], v[16:31]
    s_add_u32 m0, s41, 4294940672
    s_add_u32 s44, s40, 49024
    buffer_load_dwordx4 v232, s[8:11], s44 offen lds
    v_mfma_f32_32x32x16_bf16 v[80:95], a[52:55], a[36:39], v[80:95]
    ds_read_b128 a[4:7], v226 offset:4096
    v_mfma_f32_32x32x16_bf16 v[144:159], a[56:59], a[36:39], v[144:159]
    s_add_u32 m0, s41, 4294941696
    s_add_u32 s44, s40, 57216
    buffer_load_dwordx4 v233, s[8:11], s44 offen lds
    ds_read_b64_tr_b16 a[22:23], v229 offset:18432
    v_mfma_f32_32x32x16_bf16 v[208:223], a[60:63], a[36:39], v[208:223]
    ds_read_b64_tr_b16 a[24:25], v230 offset:16384
    v_mfma_f32_32x32x16_bf16 v[32:47], a[48:51], a[40:43], v[32:47]
    s_add_u32 m0, s43, 0
    s_add_u32 s44, s42, 0
    buffer_load_dwordx4 v234, s[12:15], s44 offen lds
    v_mfma_f32_32x32x16_bf16 v[96:111], a[52:55], a[40:43], v[96:111]
    ds_read_b128 a[8:11], v226 offset:8192
    s_add_u32 m0, s43, 1024
    s_add_u32 s44, s42, 16384
    buffer_load_dwordx4 v235, s[12:15], s44 offen lds
    v_mfma_f32_32x32x16_bf16 v[160:175], a[56:59], a[40:43], v[160:175]
    ds_read_b64_tr_b16 a[26:27], v230 offset:18432
    v_mfma_f32_32x32x16_bf16 a[64:79], a[60:63], a[40:43], a[64:79]
    ds_read_b64_tr_b16 a[28:29], v231 offset:16384
    v_mfma_f32_32x32x16_bf16 v[48:63], a[48:51], a[44:47], v[48:63]
    s_add_u32 m0, s43, 2048
    s_add_u32 s44, s42, 32768
    buffer_load_dwordx4 v234, s[12:15], s44 offen lds
    ds_read_b128 a[12:15], v226 offset:12288
    v_mfma_f32_32x32x16_bf16 v[112:127], a[52:55], a[44:47], v[112:127]
    s_add_u32 m0, s43, 3072
    s_add_u32 s44, s42, 49152
    buffer_load_dwordx4 v235, s[12:15], s44 offen lds
    v_mfma_f32_32x32x16_bf16 v[176:191], a[56:59], a[44:47], v[176:191]
    ds_read_b64_tr_b16 a[30:31], v231 offset:18432
    v_mfma_f32_32x32x16_bf16 a[80:95], a[60:63], a[44:47], a[80:95]
    v_add_u32 v226, s55, v226
    s_waitcnt lgkmcnt(0)
    v_mfma_f32_32x32x16_bf16 v[0:15], a[16:19], a[0:3], v[0:15]
    ds_read_b64_tr_b16 a[48:49], v228 offset:24576
    s_add_u32 m0, s43, 49152
    s_add_u32 s44, s42, 4294705152
    buffer_load_dwordx4 v234, s[12:15], s44 offen lds
    v_mfma_f32_32x32x16_bf16 v[64:79], a[20:23], a[0:3], v[64:79]
    ds_read_b128 a[32:35], v227 offset:0
    s_add_u32 m0, s43, 50176
    s_add_u32 s44, s42, 4294721536
    buffer_load_dwordx4 v235, s[12:15], s44 offen lds
    v_mfma_f32_32x32x16_bf16 v[128:143], a[24:27], a[0:3], v[128:143]
    ds_read_b64_tr_b16 a[50:51], v228 offset:26624
    ds_read_b64_tr_b16 a[52:53], v229 offset:24576
    v_mfma_f32_32x32x16_bf16 v[192:207], a[28:31], a[0:3], v[192:207]
    s_add_u32 m0, s43, 51200
    s_add_u32 s44, s42, 4294737920
    buffer_load_dwordx4 v234, s[12:15], s44 offen lds
    v_mfma_f32_32x32x16_bf16 v[16:31], a[16:19], a[4:7], v[16:31]
    ds_read_b128 a[36:39], v227 offset:4096
    s_add_u32 m0, s43, 52224
    s_add_u32 s44, s42, 4294754304
    buffer_load_dwordx4 v235, s[12:15], s44 offen lds
    v_mfma_f32_32x32x16_bf16 v[80:95], a[20:23], a[4:7], v[80:95]
    ds_read_b64_tr_b16 a[54:55], v229 offset:26624
    ds_read_b64_tr_b16 a[56:57], v230 offset:24576
    v_mfma_f32_32x32x16_bf16 v[144:159], a[24:27], a[4:7], v[144:159]
    s_add_u32 m0, s41, 4096
    s_add_u32 s44, s40, 32768
    buffer_load_dwordx4 v232, s[8:11], s44 offen lds
    ds_read_b128 a[40:43], v227 offset:8192
    v_mfma_f32_32x32x16_bf16 v[208:223], a[28:31], a[4:7], v[208:223]
    s_add_u32 m0, s41, 5120
    s_add_u32 s44, s40, 40960
    buffer_load_dwordx4 v233, s[8:11], s44 offen lds
    v_mfma_f32_32x32x16_bf16 v[32:47], a[16:19], a[8:11], v[32:47]
    ds_read_b64_tr_b16 a[58:59], v230 offset:26624
    ds_read_b64_tr_b16 a[60:61], v231 offset:24576
    v_mfma_f32_32x32x16_bf16 v[96:111], a[20:23], a[8:11], v[96:111]
    s_add_u32 m0, s41, 6144
    s_add_u32 s44, s40, 49152
    buffer_load_dwordx4 v232, s[8:11], s44 offen lds
    ds_read_b128 a[44:47], v227 offset:12288
    v_mfma_f32_32x32x16_bf16 v[160:175], a[24:27], a[8:11], v[160:175]
    s_add_u32 m0, s41, 7168
    s_add_u32 s44, s40, 57344
    buffer_load_dwordx4 v233, s[8:11], s44 offen lds
    ds_read_b64_tr_b16 a[62:63], v231 offset:26624
    v_mfma_f32_32x32x16_bf16 a[64:79], a[28:31], a[8:11], a[64:79]
    v_add_u32 v227, s55, v227
    v_mfma_f32_32x32x16_bf16 v[48:63], a[16:19], a[12:15], v[48:63]
    v_add_u32 v224, s55, v224
    v_xor_b32 v228, 32768, v228
    v_mfma_f32_32x32x16_bf16 v[112:127], a[20:23], a[12:15], v[112:127]
    v_xor_b32 v229, 32768, v229
    v_xor_b32 v230, 32768, v230
    v_mfma_f32_32x32x16_bf16 v[176:191], a[24:27], a[12:15], v[176:191]
    v_xor_b32 v231, 32768, v231
    v_mfma_f32_32x32x16_bf16 a[80:95], a[28:31], a[12:15], a[80:95]
    s_waitcnt vmcnt(12) lgkmcnt(0)
    s_barrier
    v_mfma_f32_32x32x16_bf16 v[0:15], a[48:51], a[32:35], v[0:15]
    ds_read_b64_tr_b16 a[16:17], v228 offset:0
    s_add_u32 m0, s43, 16384
    s_add_u32 s44, s42, 262144
    buffer_load_dwordx4 v234, s[12:15], s44 offen lds
    v_mfma_f32_32x32x16_bf16 v[64:79], a[52:55], a[32:35], v[64:79]
    ds_read_b128 a[0:3], v224 offset:0
    v_mfma_f32_32x32x16_bf16 v[128:143], a[56:59], a[32:35], v[128:143]
    ds_read_b64_tr_b16 a[18:19], v228 offset:2048
    v_mfma_f32_32x32x16_bf16 v[192:207], a[60:63], a[32:35], v[192:207]
    ds_read_b64_tr_b16 a[20:21], v229 offset:0
    v_mfma_f32_32x32x16_bf16 v[16:31], a[48:51], a[36:39], v[16:31]
    s_add_u32 m0, s43, 17408
    s_add_u32 s44, s42, 278528
    buffer_load_dwordx4 v235, s[12:15], s44 offen lds
    v_mfma_f32_32x32x16_bf16 v[80:95], a[52:55], a[36:39], v[80:95]
    ds_read_b128 a[4:7], v224 offset:4096
    v_mfma_f32_32x32x16_bf16 v[144:159], a[56:59], a[36:39], v[144:159]
    ds_read_b64_tr_b16 a[22:23], v229 offset:2048
    v_mfma_f32_32x32x16_bf16 v[208:223], a[60:63], a[36:39], v[208:223]
    ds_read_b64_tr_b16 a[24:25], v230 offset:0
    v_mfma_f32_32x32x16_bf16 v[32:47], a[48:51], a[40:43], v[32:47]
    s_add_u32 m0, s43, 18432
    s_add_u32 s44, s42, 294912
    buffer_load_dwordx4 v234, s[12:15], s44 offen lds
    ds_read_b128 a[8:11], v224 offset:8192
    v_mfma_f32_32x32x16_bf16 v[96:111], a[52:55], a[40:43], v[96:111]
    ds_read_b64_tr_b16 a[26:27], v230 offset:2048
    v_mfma_f32_32x32x16_bf16 v[160:175], a[56:59], a[40:43], v[160:175]
    ds_read_b64_tr_b16 a[28:29], v231 offset:0
    v_mfma_f32_32x32x16_bf16 a[64:79], a[60:63], a[40:43], a[64:79]
    s_add_u32 m0, s43, 19456
    s_add_u32 s44, s42, 311296
    buffer_load_dwordx4 v235, s[12:15], s44 offen lds
    v_mfma_f32_32x32x16_bf16 v[48:63], a[48:51], a[44:47], v[48:63]
    ds_read_b128 a[12:15], v224 offset:12288
    v_mfma_f32_32x32x16_bf16 v[112:127], a[52:55], a[44:47], v[112:127]
    ds_read_b64_tr_b16 a[30:31], v231 offset:2048
    v_mfma_f32_32x32x16_bf16 v[176:191], a[56:59], a[44:47], v[176:191]
    s_add_u32 s42, s42, 524288
    s_xor_b32 s43, s43, 32768
    v_mfma_f32_32x32x16_bf16 a[80:95], a[60:63], a[44:47], a[80:95]
    s_add_u32 s40, s40, 128
    s_add_u32 s41, s41, 32768
    s_cmp_ge_u32 s41, 163840
    s_cselect_b32 s45, 98304, 0
    s_sub_u32 s41, s41, s45
    s_waitcnt lgkmcnt(0)
    v_mfma_f32_32x32x16_bf16 v[0:15], a[16:19], a[0:3], v[0:15]
    s_add_u32 s47, s47, 32768
    s_mov_b32 s55, 32768
    s_cmp_eq_u32 s47, 163840
    s_cselect_b32 s55, -65536, s55
    s_cselect_b32 s47, 65536, s47
    ds_read_b64_tr_b16 a[48:49], v228 offset:8192
    v_mfma_f32_32x32x16_bf16 v[64:79], a[20:23], a[0:3], v[64:79]
    s_add_u32 m0, s41, 0
    s_add_u32 s44, s40, 0
    buffer_load_dwordx4 v232, s[8:11], s44 offen lds
    v_mfma_f32_32x32x16_bf16 v[128:143], a[24:27], a[0:3], v[128:143]
    ds_read_b128 a[32:35], v225 offset:0
    v_mfma_f32_32x32x16_bf16 v[192:207], a[28:31], a[0:3], v[192:207]
    ds_read_b64_tr_b16 a[50:51], v228 offset:10240
    v_mfma_f32_32x32x16_bf16 v[16:31], a[16:19], a[4:7], v[16:31]
    ds_read_b64_tr_b16 a[52:53], v229 offset:8192
    v_mfma_f32_32x32x16_bf16 v[80:95], a[20:23], a[4:7], v[80:95]
    s_add_u32 m0, s41, 1024
    s_add_u32 s44, s40, 8192
    buffer_load_dwordx4 v233, s[8:11], s44 offen lds
    ds_read_b128 a[36:39], v225 offset:4096
    v_mfma_f32_32x32x16_bf16 v[144:159], a[24:27], a[4:7], v[144:159]
    ds_read_b64_tr_b16 a[54:55], v229 offset:10240
    v_mfma_f32_32x32x16_bf16 v[208:223], a[28:31], a[4:7], v[208:223]
    ds_read_b64_tr_b16 a[56:57], v230 offset:8192
    v_mfma_f32_32x32x16_bf16 v[32:47], a[16:19], a[8:11], v[32:47]
    s_add_u32 m0, s41, 2048
    s_add_u32 s44, s40, 16384
    buffer_load_dwordx4 v232, s[8:11], s44 offen lds
    v_mfma_f32_32x32x16_bf16 v[96:111], a[20:23], a[8:11], v[96:111]
    ds_read_b128 a[40:43], v225 offset:8192
    v_mfma_f32_32x32x16_bf16 v[160:175], a[24:27], a[8:11], v[160:175]
    ds_read_b64_tr_b16 a[58:59], v230 offset:10240
    ds_read_b64_tr_b16 a[60:61], v231 offset:8192
    v_mfma_f32_32x32x16_bf16 a[64:79], a[28:31], a[8:11], a[64:79]
    s_add_u32 m0, s41, 3072
    s_add_u32 s44, s40, 24576
    buffer_load_dwordx4 v233, s[8:11], s44 offen lds
    v_mfma_f32_32x32x16_bf16 v[48:63], a[16:19], a[12:15], v[48:63]
    ds_read_b128 a[44:47], v225 offset:12288
    v_mfma_f32_32x32x16_bf16 v[112:127], a[20:23], a[12:15], v[112:127]
    ds_read_b64_tr_b16 a[62:63], v231 offset:10240
    v_mfma_f32_32x32x16_bf16 v[176:191], a[24:27], a[12:15], v[176:191]
    v_add_u32 v225, s55, v225
    v_mfma_f32_32x32x16_bf16 a[80:95], a[28:31], a[12:15], a[80:95]
    s_waitcnt vmcnt(12) lgkmcnt(0)
    s_barrier
    v_mfma_f32_32x32x16_bf16 v[0:15], a[48:51], a[32:35], v[0:15]
    ds_read_b64_tr_b16 a[16:17], v228 offset:16384
    s_add_u32 m0, s43, 0
    s_add_u32 s44, s42, 0
    buffer_load_dwordx4 v234, s[12:15], s44 offen lds
    v_mfma_f32_32x32x16_bf16 v[64:79], a[52:55], a[32:35], v[64:79]
    ds_read_b128 a[0:3], v226 offset:0
    v_mfma_f32_32x32x16_bf16 v[128:143], a[56:59], a[32:35], v[128:143]
    ds_read_b64_tr_b16 a[18:19], v228 offset:18432
    v_mfma_f32_32x32x16_bf16 v[192:207], a[60:63], a[32:35], v[192:207]
    ds_read_b64_tr_b16 a[20:21], v229 offset:16384
    v_mfma_f32_32x32x16_bf16 v[16:31], a[48:51], a[36:39], v[16:31]
    s_add_u32 m0, s43, 1024
    s_add_u32 s44, s42, 16384
    buffer_load_dwordx4 v235, s[12:15], s44 offen lds
    v_mfma_f32_32x32x16_bf16 v[80:95], a[52:55], a[36:39], v[80:95]
    ds_read_b128 a[4:7], v226 offset:4096
    v_mfma_f32_32x32x16_bf16 v[144:159], a[56:59], a[36:39], v[144:159]
    ds_read_b64_tr_b16 a[22:23], v229 offset:18432
    v_mfma_f32_32x32x16_bf16 v[208:223], a[60:63], a[36:39], v[208:223]
    s_add_u32 m0, s43, 2048
    s_add_u32 s44, s42, 32768
    buffer_load_dwordx4 v234, s[12:15], s44 offen lds
    v_mfma_f32_32x32x16_bf16 v[32:47], a[48:51], a[40:43], v[32:47]
    ds_read_b64_tr_b16 a[24:25], v230 offset:16384
    ds_read_b128 a[8:11], v226 offset:8192
    v_mfma_f32_32x32x16_bf16 v[96:111], a[52:55], a[40:43], v[96:111]
    s_add_u32 m0, s43, 3072
    s_add_u32 s44, s42, 49152
    buffer_load_dwordx4 v235, s[12:15], s44 offen lds
    v_mfma_f32_32x32x16_bf16 v[160:175], a[56:59], a[40:43], v[160:175]
    ds_read_b64_tr_b16 a[26:27], v230 offset:18432
    v_mfma_f32_32x32x16_bf16 a[64:79], a[60:63], a[40:43], a[64:79]
    ds_read_b64_tr_b16 a[28:29], v231 offset:16384
    v_mfma_f32_32x32x16_bf16 v[48:63], a[48:51], a[44:47], v[48:63]
    ds_read_b128 a[12:15], v226 offset:12288
    v_mfma_f32_32x32x16_bf16 v[112:127], a[52:55], a[44:47], v[112:127]
    s_add_u32 s45, s58, 0
    buffer_load_dwordx4 v[252:255], v236, s[24:27], s45 offen
    v_mfma_f32_32x32x16_bf16 v[176:191], a[56:59], a[44:47], v[176:191]
    ds_read_b64_tr_b16 a[30:31], v231 offset:18432
    v_mfma_f32_32x32x16_bf16 a[80:95], a[60:63], a[44:47], a[80:95]
    v_add_u32 v226, s55, v226
    s_waitcnt lgkmcnt(0)
    v_mfma_f32_32x32x16_bf16 v[0:15], a[16:19], a[0:3], v[0:15]
    ds_read_b64_tr_b16 a[48:49], v228 offset:24576
    s_add_u32 m0, s41, 4096
    s_add_u32 s44, s40, 32768
    buffer_load_dwordx4 v232, s[8:11], s44 offen lds
    v_mfma_f32_32x32x16_bf16 v[64:79], a[20:23], a[0:3], v[64:79]
    ds_read_b128 a[32:35], v227 offset:0
    v_mfma_f32_32x32x16_bf16 v[128:143], a[24:27], a[0:3], v[128:143]
    ds_read_b64_tr_b16 a[50:51], v228 offset:26624
    ds_read_b64_tr_b16 a[52:53], v229 offset:24576
    v_mfma_f32_32x32x16_bf16 v[192:207], a[28:31], a[0:3], v[192:207]
    s_add_u32 m0, s41, 5120
    s_add_u32 s44, s40, 40960
    buffer_load_dwordx4 v233, s[8:11], s44 offen lds
    v_mfma_f32_32x32x16_bf16 v[16:31], a[16:19], a[4:7], v[16:31]
    ds_read_b128 a[36:39], v227 offset:4096
    ds_read_b64_tr_b16 a[54:55], v229 offset:26624
    v_mfma_f32_32x32x16_bf16 v[80:95], a[20:23], a[4:7], v[80:95]
    ds_read_b64_tr_b16 a[56:57], v230 offset:24576
    v_mfma_f32_32x32x16_bf16 v[144:159], a[24:27], a[4:7], v[144:159]
    s_add_u32 m0, s41, 6144
    s_add_u32 s44, s40, 49152
    buffer_load_dwordx4 v232, s[8:11], s44 offen lds
    ds_read_b128 a[40:43], v227 offset:8192
    v_mfma_f32_32x32x16_bf16 v[208:223], a[28:31], a[4:7], v[208:223]
    ds_read_b64_tr_b16 a[58:59], v230 offset:26624
    v_mfma_f32_32x32x16_bf16 v[32:47], a[16:19], a[8:11], v[32:47]
    ds_read_b64_tr_b16 a[60:61], v231 offset:24576
    s_add_u32 m0, s41, 7168
    s_add_u32 s44, s40, 57344
    buffer_load_dwordx4 v233, s[8:11], s44 offen lds
    v_mfma_f32_32x32x16_bf16 v[96:111], a[20:23], a[8:11], v[96:111]
    ds_read_b128 a[44:47], v227 offset:12288
    v_mfma_f32_32x32x16_bf16 v[160:175], a[24:27], a[8:11], v[160:175]
    ds_read_b64_tr_b16 a[62:63], v231 offset:26624
    v_add_u32 v227, s55, v227
    v_mfma_f32_32x32x16_bf16 a[64:79], a[28:31], a[8:11], a[64:79]
    v_add_u32 v224, s55, v224
    v_mfma_f32_32x32x16_bf16 v[48:63], a[16:19], a[12:15], v[48:63]
    v_xor_b32 v228, 32768, v228
    v_xor_b32 v229, 32768, v229
    v_mfma_f32_32x32x16_bf16 v[112:127], a[20:23], a[12:15], v[112:127]
    v_xor_b32 v230, 32768, v230
    v_mfma_f32_32x32x16_bf16 v[176:191], a[24:27], a[12:15], v[176:191]
    v_xor_b32 v231, 32768, v231
    v_mfma_f32_32x32x16_bf16 a[80:95], a[28:31], a[12:15], a[80:95]
    s_waitcnt vmcnt(17) lgkmcnt(0)
    s_barrier
    v_mfma_f32_32x32x16_bf16 v[0:15], a[48:51], a[32:35], v[0:15]
    ds_read_b64_tr_b16 a[16:17], v228 offset:0
    s_add_u32 m0, s43, 16384
    s_add_u32 s44, s42, 262144
    buffer_load_dwordx4 v234, s[12:15], s44 offen lds
    v_mfma_f32_32x32x16_bf16 v[64:79], a[52:55], a[32:35], v[64:79]
    ds_read_b128 a[0:3], v224 offset:0
    v_mfma_f32_32x32x16_bf16 v[128:143], a[56:59], a[32:35], v[128:143]
    ds_read_b64_tr_b16 a[18:19], v228 offset:2048
    v_mfma_f32_32x32x16_bf16 v[192:207], a[60:63], a[32:35], v[192:207]
    ds_read_b64_tr_b16 a[20:21], v229 offset:0
    v_mfma_f32_32x32x16_bf16 v[16:31], a[48:51], a[36:39], v[16:31]
    s_add_u32 m0, s43, 17408
    s_add_u32 s44, s42, 278528
    buffer_load_dwordx4 v235, s[12:15], s44 offen lds
    v_mfma_f32_32x32x16_bf16 v[80:95], a[52:55], a[36:39], v[80:95]
    ds_read_b128 a[4:7], v224 offset:4096
    ds_read_b64_tr_b16 a[22:23], v229 offset:2048
    v_mfma_f32_32x32x16_bf16 v[144:159], a[56:59], a[36:39], v[144:159]
    s_add_u32 m0, s43, 18432
    s_add_u32 s44, s42, 294912
    buffer_load_dwordx4 v234, s[12:15], s44 offen lds
    v_mfma_f32_32x32x16_bf16 v[208:223], a[60:63], a[36:39], v[208:223]
    ds_read_b64_tr_b16 a[24:25], v230 offset:0
    v_mfma_f32_32x32x16_bf16 v[32:47], a[48:51], a[40:43], v[32:47]
    ds_read_b128 a[8:11], v224 offset:8192
    v_mfma_f32_32x32x16_bf16 v[96:111], a[52:55], a[40:43], v[96:111]
    s_add_u32 m0, s43, 19456
    s_add_u32 s44, s42, 311296
    buffer_load_dwordx4 v235, s[12:15], s44 offen lds
    v_mfma_f32_32x32x16_bf16 v[160:175], a[56:59], a[40:43], v[160:175]
    ds_read_b64_tr_b16 a[26:27], v230 offset:2048
    ds_read_b64_tr_b16 a[28:29], v231 offset:0
    v_mfma_f32_32x32x16_bf16 a[64:79], a[60:63], a[40:43], a[64:79]
    ds_read_b128 a[12:15], v224 offset:12288
    v_mfma_f32_32x32x16_bf16 v[48:63], a[48:51], a[44:47], v[48:63]
    s_add_u32 s45, s58, 0
    buffer_load_dwordx4 v[252:255], v236, s[28:31], s45 offen
    v_mfma_f32_32x32x16_bf16 v[112:127], a[52:55], a[44:47], v[112:127]
    ds_read_b64_tr_b16 a[30:31], v231 offset:2048
    v_mfma_f32_32x32x16_bf16 v[176:191], a[56:59], a[44:47], v[176:191]
    s_add_u32 s42, s42, 524288
    s_xor_b32 s43, s43, 32768
    v_mfma_f32_32x32x16_bf16 a[80:95], a[60:63], a[44:47], a[80:95]
    s_add_u32 s40, s40, 128
    s_add_u32 s41, s41, 32768
    s_cmp_ge_u32 s41, 163840
    s_cselect_b32 s45, 98304, 0
    s_sub_u32 s41, s41, s45
    s_waitcnt lgkmcnt(0)
    v_mfma_f32_32x32x16_bf16 v[0:15], a[16:19], a[0:3], v[0:15]
    s_add_u32 s47, s47, 32768
    s_mov_b32 s55, 32768
    s_cmp_eq_u32 s47, 163840
    s_cselect_b32 s55, -65536, s55
    s_cselect_b32 s47, 65536, s47
    ds_read_b64_tr_b16 a[48:49], v228 offset:8192
    v_mfma_f32_32x32x16_bf16 v[64:79], a[20:23], a[0:3], v[64:79]
    s_add_u32 m0, s41, 0
    s_add_u32 s44, s40, 0
    buffer_load_dwordx4 v232, s[8:11], s44 offen lds
    v_mfma_f32_32x32x16_bf16 v[128:143], a[24:27], a[0:3], v[128:143]
    ds_read_b128 a[32:35], v225 offset:0
    v_mfma_f32_32x32x16_bf16 v[192:207], a[28:31], a[0:3], v[192:207]
    ds_read_b64_tr_b16 a[50:51], v228 offset:10240
    v_mfma_f32_32x32x16_bf16 v[16:31], a[16:19], a[4:7], v[16:31]
    ds_read_b64_tr_b16 a[52:53], v229 offset:8192
    v_mfma_f32_32x32x16_bf16 v[80:95], a[20:23], a[4:7], v[80:95]
    s_add_u32 m0, s41, 1024
    s_add_u32 s44, s40, 8192
    buffer_load_dwordx4 v233, s[8:11], s44 offen lds
    ds_read_b128 a[36:39], v225 offset:4096
    v_mfma_f32_32x32x16_bf16 v[144:159], a[24:27], a[4:7], v[144:159]
    ds_read_b64_tr_b16 a[54:55], v229 offset:10240
    v_mfma_f32_32x32x16_bf16 v[208:223], a[28:31], a[4:7], v[208:223]
    ds_read_b64_tr_b16 a[56:57], v230 offset:8192
    v_mfma_f32_32x32x16_bf16 v[32:47], a[16:19], a[8:11], v[32:47]
    s_add_u32 m0, s41, 2048
    s_add_u32 s44, s40, 16384
    buffer_load_dwordx4 v232, s[8:11], s44 offen lds
    v_mfma_f32_32x32x16_bf16 v[96:111], a[20:23], a[8:11], v[96:111]
    ds_read_b128 a[40:43], v225 offset:8192
    v_mfma_f32_32x32x16_bf16 v[160:175], a[24:27], a[8:11], v[160:175]
    ds_read_b64_tr_b16 a[58:59], v230 offset:10240
    ds_read_b64_tr_b16 a[60:61], v231 offset:8192
    v_mfma_f32_32x32x16_bf16 a[64:79], a[28:31], a[8:11], a[64:79]
    s_add_u32 m0, s41, 3072
    s_add_u32 s44, s40, 24576
    buffer_load_dwordx4 v233, s[8:11], s44 offen lds
    v_mfma_f32_32x32x16_bf16 v[48:63], a[16:19], a[12:15], v[48:63]
    ds_read_b128 a[44:47], v225 offset:12288
    v_mfma_f32_32x32x16_bf16 v[112:127], a[20:23], a[12:15], v[112:127]
    ds_read_b64_tr_b16 a[62:63], v231 offset:10240
    v_mfma_f32_32x32x16_bf16 v[176:191], a[24:27], a[12:15], v[176:191]
    v_add_u32 v225, s55, v225
    v_mfma_f32_32x32x16_bf16 a[80:95], a[28:31], a[12:15], a[80:95]
    s_waitcnt vmcnt(22) lgkmcnt(0)
    s_barrier
    v_mfma_f32_32x32x16_bf16 v[0:15], a[48:51], a[32:35], v[0:15]
    ds_read_b64_tr_b16 a[16:17], v228 offset:16384
    s_add_u32 m0, s43, 0
    s_add_u32 s44, s42, 0
    buffer_load_dwordx4 v234, s[12:15], s44 offen lds
    v_mfma_f32_32x32x16_bf16 v[64:79], a[52:55], a[32:35], v[64:79]
    ds_read_b128 a[0:3], v226 offset:0
    v_mfma_f32_32x32x16_bf16 v[128:143], a[56:59], a[32:35], v[128:143]
    ds_read_b64_tr_b16 a[18:19], v228 offset:18432
    v_mfma_f32_32x32x16_bf16 v[192:207], a[60:63], a[32:35], v[192:207]
    ds_read_b64_tr_b16 a[20:21], v229 offset:16384
    v_mfma_f32_32x32x16_bf16 v[16:31], a[48:51], a[36:39], v[16:31]
    s_add_u32 m0, s43, 1024
    s_add_u32 s44, s42, 16384
    buffer_load_dwordx4 v235, s[12:15], s44 offen lds
    v_mfma_f32_32x32x16_bf16 v[80:95], a[52:55], a[36:39], v[80:95]
    ds_read_b128 a[4:7], v226 offset:4096
    v_mfma_f32_32x32x16_bf16 v[144:159], a[56:59], a[36:39], v[144:159]
    ds_read_b64_tr_b16 a[22:23], v229 offset:18432
    v_mfma_f32_32x32x16_bf16 v[208:223], a[60:63], a[36:39], v[208:223]
    s_add_u32 m0, s43, 2048
    s_add_u32 s44, s42, 32768
    buffer_load_dwordx4 v234, s[12:15], s44 offen lds
    v_mfma_f32_32x32x16_bf16 v[32:47], a[48:51], a[40:43], v[32:47]
    ds_read_b64_tr_b16 a[24:25], v230 offset:16384
    ds_read_b128 a[8:11], v226 offset:8192
    v_mfma_f32_32x32x16_bf16 v[96:111], a[52:55], a[40:43], v[96:111]
    s_add_u32 m0, s43, 3072
    s_add_u32 s44, s42, 49152
    buffer_load_dwordx4 v235, s[12:15], s44 offen lds
    v_mfma_f32_32x32x16_bf16 v[160:175], a[56:59], a[40:43], v[160:175]
    ds_read_b64_tr_b16 a[26:27], v230 offset:18432
    v_mfma_f32_32x32x16_bf16 a[64:79], a[60:63], a[40:43], a[64:79]
    ds_read_b64_tr_b16 a[28:29], v231 offset:16384
    v_mfma_f32_32x32x16_bf16 v[48:63], a[48:51], a[44:47], v[48:63]
    ds_read_b128 a[12:15], v226 offset:12288
    v_mfma_f32_32x32x16_bf16 v[112:127], a[52:55], a[44:47], v[112:127]
    s_add_u32 s45, s58, 1048576
    buffer_load_dwordx4 v[252:255], v236, s[24:27], s45 offen
    v_mfma_f32_32x32x16_bf16 v[176:191], a[56:59], a[44:47], v[176:191]
    ds_read_b64_tr_b16 a[30:31], v231 offset:18432
    v_mfma_f32_32x32x16_bf16 a[80:95], a[60:63], a[44:47], a[80:95]
    v_add_u32 v226, s55, v226
    s_waitcnt lgkmcnt(0)
    v_mfma_f32_32x32x16_bf16 v[0:15], a[16:19], a[0:3], v[0:15]
    ds_read_b64_tr_b16 a[48:49], v228 offset:24576
    s_add_u32 m0, s41, 4096
    s_add_u32 s44, s40, 32768
    buffer_load_dwordx4 v232, s[8:11], s44 offen lds
    v_mfma_f32_32x32x16_bf16 v[64:79], a[20:23], a[0:3], v[64:79]
    ds_read_b128 a[32:35], v227 offset:0
    v_mfma_f32_32x32x16_bf16 v[128:143], a[24:27], a[0:3], v[128:143]
    ds_read_b64_tr_b16 a[50:51], v228 offset:26624
    ds_read_b64_tr_b16 a[52:53], v229 offset:24576
    v_mfma_f32_32x32x16_bf16 v[192:207], a[28:31], a[0:3], v[192:207]
    s_add_u32 m0, s41, 5120
    s_add_u32 s44, s40, 40960
    buffer_load_dwordx4 v233, s[8:11], s44 offen lds
    v_mfma_f32_32x32x16_bf16 v[16:31], a[16:19], a[4:7], v[16:31]
    ds_read_b128 a[36:39], v227 offset:4096
    ds_read_b64_tr_b16 a[54:55], v229 offset:26624
    v_mfma_f32_32x32x16_bf16 v[80:95], a[20:23], a[4:7], v[80:95]
    ds_read_b64_tr_b16 a[56:57], v230 offset:24576
    v_mfma_f32_32x32x16_bf16 v[144:159], a[24:27], a[4:7], v[144:159]
    s_add_u32 m0, s41, 6144
    s_add_u32 s44, s40, 49152
    buffer_load_dwordx4 v232, s[8:11], s44 offen lds
    ds_read_b128 a[40:43], v227 offset:8192
    v_mfma_f32_32x32x16_bf16 v[208:223], a[28:31], a[4:7], v[208:223]
    ds_read_b64_tr_b16 a[58:59], v230 offset:26624
    v_mfma_f32_32x32x16_bf16 v[32:47], a[16:19], a[8:11], v[32:47]
    ds_read_b64_tr_b16 a[60:61], v231 offset:24576
    s_add_u32 m0, s41, 7168
    s_add_u32 s44, s40, 57344
    buffer_load_dwordx4 v233, s[8:11], s44 offen lds
    v_mfma_f32_32x32x16_bf16 v[96:111], a[20:23], a[8:11], v[96:111]
    ds_read_b128 a[44:47], v227 offset:12288
    v_mfma_f32_32x32x16_bf16 v[160:175], a[24:27], a[8:11], v[160:175]
    ds_read_b64_tr_b16 a[62:63], v231 offset:26624
    v_add_u32 v227, s55, v227
    v_mfma_f32_32x32x16_bf16 a[64:79], a[28:31], a[8:11], a[64:79]
    v_add_u32 v224, s55, v224
    v_mfma_f32_32x32x16_bf16 v[48:63], a[16:19], a[12:15], v[48:63]
    v_xor_b32 v228, 32768, v228
    v_xor_b32 v229, 32768, v229
    v_mfma_f32_32x32x16_bf16 v[112:127], a[20:23], a[12:15], v[112:127]
    v_xor_b32 v230, 32768, v230
    v_mfma_f32_32x32x16_bf16 v[176:191], a[24:27], a[12:15], v[176:191]
    v_xor_b32 v231, 32768, v231
    v_mfma_f32_32x32x16_bf16 a[80:95], a[28:31], a[12:15], a[80:95]
    s_waitcnt vmcnt(18) lgkmcnt(0)
    s_barrier
    v_mfma_f32_32x32x16_bf16 v[0:15], a[48:51], a[32:35], v[0:15]
    ds_read_b64_tr_b16 a[16:17], v228 offset:0
    s_add_u32 m0, s43, 16384
    s_add_u32 s44, s42, 262144
    buffer_load_dwordx4 v234, s[12:15], s44 offen lds
    v_mfma_f32_32x32x16_bf16 v[64:79], a[52:55], a[32:35], v[64:79]
    ds_read_b128 a[0:3], v224 offset:0
    v_mfma_f32_32x32x16_bf16 v[128:143], a[56:59], a[32:35], v[128:143]
    ds_read_b64_tr_b16 a[18:19], v228 offset:2048
    v_mfma_f32_32x32x16_bf16 v[192:207], a[60:63], a[32:35], v[192:207]
    ds_read_b64_tr_b16 a[20:21], v229 offset:0
    v_mfma_f32_32x32x16_bf16 v[16:31], a[48:51], a[36:39], v[16:31]
    s_add_u32 m0, s43, 17408
    s_add_u32 s44, s42, 278528
    buffer_load_dwordx4 v235, s[12:15], s44 offen lds
    v_mfma_f32_32x32x16_bf16 v[80:95], a[52:55], a[36:39], v[80:95]
    ds_read_b128 a[4:7], v224 offset:4096
    ds_read_b64_tr_b16 a[22:23], v229 offset:2048
    v_mfma_f32_32x32x16_bf16 v[144:159], a[56:59], a[36:39], v[144:159]
    s_add_u32 m0, s43, 18432
    s_add_u32 s44, s42, 294912
    buffer_load_dwordx4 v234, s[12:15], s44 offen lds
    v_mfma_f32_32x32x16_bf16 v[208:223], a[60:63], a[36:39], v[208:223]
    ds_read_b64_tr_b16 a[24:25], v230 offset:0
    v_mfma_f32_32x32x16_bf16 v[32:47], a[48:51], a[40:43], v[32:47]
    ds_read_b128 a[8:11], v224 offset:8192
    v_mfma_f32_32x32x16_bf16 v[96:111], a[52:55], a[40:43], v[96:111]
    s_add_u32 m0, s43, 19456
    s_add_u32 s44, s42, 311296
    buffer_load_dwordx4 v235, s[12:15], s44 offen lds
    v_mfma_f32_32x32x16_bf16 v[160:175], a[56:59], a[40:43], v[160:175]
    ds_read_b64_tr_b16 a[26:27], v230 offset:2048
    ds_read_b64_tr_b16 a[28:29], v231 offset:0
    v_mfma_f32_32x32x16_bf16 a[64:79], a[60:63], a[40:43], a[64:79]
    ds_read_b128 a[12:15], v224 offset:12288
    v_mfma_f32_32x32x16_bf16 v[48:63], a[48:51], a[44:47], v[48:63]
    s_add_u32 s45, s58, 1048576
    buffer_load_dwordx4 v[252:255], v236, s[28:31], s45 offen
    v_mfma_f32_32x32x16_bf16 v[112:127], a[52:55], a[44:47], v[112:127]
    ds_read_b64_tr_b16 a[30:31], v231 offset:2048
    v_mfma_f32_32x32x16_bf16 v[176:191], a[56:59], a[44:47], v[176:191]
    s_add_u32 s42, s42, 524288
    s_xor_b32 s43, s43, 32768
    v_mfma_f32_32x32x16_bf16 a[80:95], a[60:63], a[44:47], a[80:95]
    s_add_u32 s40, s40, 128
    s_add_u32 s41, s41, 32768
    s_cmp_ge_u32 s41, 163840
    s_cselect_b32 s45, 98304, 0
    s_sub_u32 s41, s41, s45
    s_waitcnt lgkmcnt(0)
    v_mfma_f32_32x32x16_bf16 v[0:15], a[16:19], a[0:3], v[0:15]
    s_add_u32 s47, s47, 32768
    s_mov_b32 s55, 32768
    s_cmp_eq_u32 s47, 163840
    s_cselect_b32 s55, -65536, s55
    s_cselect_b32 s47, 65536, s47
    ds_read_b64_tr_b16 a[48:49], v228 offset:8192
    v_mfma_f32_32x32x16_bf16 v[64:79], a[20:23], a[0:3], v[64:79]
    s_add_u32 m0, s41, 0
    s_add_u32 s44, s40, 0
    buffer_load_dwordx4 v232, s[8:11], s44 offen lds
    v_mfma_f32_32x32x16_bf16 v[128:143], a[24:27], a[0:3], v[128:143]
    ds_read_b128 a[32:35], v225 offset:0
    v_mfma_f32_32x32x16_bf16 v[192:207], a[28:31], a[0:3], v[192:207]
    ds_read_b64_tr_b16 a[50:51], v228 offset:10240
    v_mfma_f32_32x32x16_bf16 v[16:31], a[16:19], a[4:7], v[16:31]
    ds_read_b64_tr_b16 a[52:53], v229 offset:8192
    v_mfma_f32_32x32x16_bf16 v[80:95], a[20:23], a[4:7], v[80:95]
    s_add_u32 m0, s41, 1024
    s_add_u32 s44, s40, 8192
    buffer_load_dwordx4 v233, s[8:11], s44 offen lds
    ds_read_b128 a[36:39], v225 offset:4096
    v_mfma_f32_32x32x16_bf16 v[144:159], a[24:27], a[4:7], v[144:159]
    ds_read_b64_tr_b16 a[54:55], v229 offset:10240
    v_mfma_f32_32x32x16_bf16 v[208:223], a[28:31], a[4:7], v[208:223]
    ds_read_b64_tr_b16 a[56:57], v230 offset:8192
    v_mfma_f32_32x32x16_bf16 v[32:47], a[16:19], a[8:11], v[32:47]
    s_add_u32 m0, s41, 2048
    s_add_u32 s44, s40, 16384
    buffer_load_dwordx4 v232, s[8:11], s44 offen lds
    v_mfma_f32_32x32x16_bf16 v[96:111], a[20:23], a[8:11], v[96:111]
    ds_read_b128 a[40:43], v225 offset:8192
    v_mfma_f32_32x32x16_bf16 v[160:175], a[24:27], a[8:11], v[160:175]
    ds_read_b64_tr_b16 a[58:59], v230 offset:10240
    ds_read_b64_tr_b16 a[60:61], v231 offset:8192
    v_mfma_f32_32x32x16_bf16 a[64:79], a[28:31], a[8:11], a[64:79]
    s_add_u32 m0, s41, 3072
    s_add_u32 s44, s40, 24576
    buffer_load_dwordx4 v233, s[8:11], s44 offen lds
    v_mfma_f32_32x32x16_bf16 v[48:63], a[16:19], a[12:15], v[48:63]
    ds_read_b128 a[44:47], v225 offset:12288
    v_mfma_f32_32x32x16_bf16 v[112:127], a[20:23], a[12:15], v[112:127]
    ds_read_b64_tr_b16 a[62:63], v231 offset:10240
    v_mfma_f32_32x32x16_bf16 v[176:191], a[24:27], a[12:15], v[176:191]
    v_add_u32 v225, s55, v225
    v_mfma_f32_32x32x16_bf16 a[80:95], a[28:31], a[12:15], a[80:95]
    s_waitcnt vmcnt(23) lgkmcnt(0)
    s_barrier
    v_mfma_f32_32x32x16_bf16 v[0:15], a[48:51], a[32:35], v[0:15]
    ds_read_b64_tr_b16 a[16:17], v228 offset:16384
    s_add_u32 m0, s43, 0
    s_add_u32 s44, s42, 0
    buffer_load_dwordx4 v234, s[12:15], s44 offen lds
    v_mfma_f32_32x32x16_bf16 v[64:79], a[52:55], a[32:35], v[64:79]
    ds_read_b128 a[0:3], v226 offset:0
    v_mfma_f32_32x32x16_bf16 v[128:143], a[56:59], a[32:35], v[128:143]
    ds_read_b64_tr_b16 a[18:19], v228 offset:18432
    v_mfma_f32_32x32x16_bf16 v[192:207], a[60:63], a[32:35], v[192:207]
    ds_read_b64_tr_b16 a[20:21], v229 offset:16384
    v_mfma_f32_32x32x16_bf16 v[16:31], a[48:51], a[36:39], v[16:31]
    s_add_u32 m0, s43, 1024
    s_add_u32 s44, s42, 16384
    buffer_load_dwordx4 v235, s[12:15], s44 offen lds
    v_mfma_f32_32x32x16_bf16 v[80:95], a[52:55], a[36:39], v[80:95]
    ds_read_b128 a[4:7], v226 offset:4096
    v_mfma_f32_32x32x16_bf16 v[144:159], a[56:59], a[36:39], v[144:159]
    ds_read_b64_tr_b16 a[22:23], v229 offset:18432
    v_mfma_f32_32x32x16_bf16 v[208:223], a[60:63], a[36:39], v[208:223]
    s_add_u32 m0, s43, 2048
    s_add_u32 s44, s42, 32768
    buffer_load_dwordx4 v234, s[12:15], s44 offen lds
    v_mfma_f32_32x32x16_bf16 v[32:47], a[48:51], a[40:43], v[32:47]
    ds_read_b64_tr_b16 a[24:25], v230 offset:16384
    ds_read_b128 a[8:11], v226 offset:8192
    v_mfma_f32_32x32x16_bf16 v[96:111], a[52:55], a[40:43], v[96:111]
    s_add_u32 m0, s43, 3072
    s_add_u32 s44, s42, 49152
    buffer_load_dwordx4 v235, s[12:15], s44 offen lds
    v_mfma_f32_32x32x16_bf16 v[160:175], a[56:59], a[40:43], v[160:175]
    ds_read_b64_tr_b16 a[26:27], v230 offset:18432
    v_mfma_f32_32x32x16_bf16 a[64:79], a[60:63], a[40:43], a[64:79]
    ds_read_b64_tr_b16 a[28:29], v231 offset:16384
    v_mfma_f32_32x32x16_bf16 v[48:63], a[48:51], a[44:47], v[48:63]
    ds_read_b128 a[12:15], v226 offset:12288
    v_mfma_f32_32x32x16_bf16 v[112:127], a[52:55], a[44:47], v[112:127]
    s_add_u32 s45, s58, 2097152
    buffer_load_dwordx4 v[252:255], v236, s[24:27], s45 offen
    v_mfma_f32_32x32x16_bf16 v[176:191], a[56:59], a[44:47], v[176:191]
    ds_read_b64_tr_b16 a[30:31], v231 offset:18432
    v_mfma_f32_32x32x16_bf16 a[80:95], a[60:63], a[44:47], a[80:95]
    v_add_u32 v226, s55, v226
    s_waitcnt lgkmcnt(0)
    v_mfma_f32_32x32x16_bf16 v[0:15], a[16:19], a[0:3], v[0:15]
    ds_read_b64_tr_b16 a[48:49], v228 offset:24576
    s_add_u32 m0, s41, 4096
    s_add_u32 s44, s40, 32768
    buffer_load_dwordx4 v232, s[8:11], s44 offen lds
    v_mfma_f32_32x32x16_bf16 v[64:79], a[20:23], a[0:3], v[64:79]
    ds_read_b128 a[32:35], v227 offset:0
    v_mfma_f32_32x32x16_bf16 v[128:143], a[24:27], a[0:3], v[128:143]
    ds_read_b64_tr_b16 a[50:51], v228 offset:26624
    ds_read_b64_tr_b16 a[52:53], v229 offset:24576
    v_mfma_f32_32x32x16_bf16 v[192:207], a[28:31], a[0:3], v[192:207]
    s_add_u32 m0, s41, 5120
    s_add_u32 s44, s40, 40960
    buffer_load_dwordx4 v233, s[8:11], s44 offen lds
    v_mfma_f32_32x32x16_bf16 v[16:31], a[16:19], a[4:7], v[16:31]
    ds_read_b128 a[36:39], v227 offset:4096
    ds_read_b64_tr_b16 a[54:55], v229 offset:26624
    v_mfma_f32_32x32x16_bf16 v[80:95], a[20:23], a[4:7], v[80:95]
    ds_read_b64_tr_b16 a[56:57], v230 offset:24576
    v_mfma_f32_32x32x16_bf16 v[144:159], a[24:27], a[4:7], v[144:159]
    s_add_u32 m0, s41, 6144
    s_add_u32 s44, s40, 49152
    buffer_load_dwordx4 v232, s[8:11], s44 offen lds
    ds_read_b128 a[40:43], v227 offset:8192
    v_mfma_f32_32x32x16_bf16 v[208:223], a[28:31], a[4:7], v[208:223]
    ds_read_b64_tr_b16 a[58:59], v230 offset:26624
    v_mfma_f32_32x32x16_bf16 v[32:47], a[16:19], a[8:11], v[32:47]
    ds_read_b64_tr_b16 a[60:61], v231 offset:24576
    s_add_u32 m0, s41, 7168
    s_add_u32 s44, s40, 57344
    buffer_load_dwordx4 v233, s[8:11], s44 offen lds
    v_mfma_f32_32x32x16_bf16 v[96:111], a[20:23], a[8:11], v[96:111]
    ds_read_b128 a[44:47], v227 offset:12288
    v_mfma_f32_32x32x16_bf16 v[160:175], a[24:27], a[8:11], v[160:175]
    ds_read_b64_tr_b16 a[62:63], v231 offset:26624
    v_add_u32 v227, s55, v227
    v_mfma_f32_32x32x16_bf16 a[64:79], a[28:31], a[8:11], a[64:79]
    v_add_u32 v224, s55, v224
    v_mfma_f32_32x32x16_bf16 v[48:63], a[16:19], a[12:15], v[48:63]
    v_xor_b32 v228, 32768, v228
    v_xor_b32 v229, 32768, v229
    v_mfma_f32_32x32x16_bf16 v[112:127], a[20:23], a[12:15], v[112:127]
    v_xor_b32 v230, 32768, v230
    v_mfma_f32_32x32x16_bf16 v[176:191], a[24:27], a[12:15], v[176:191]
    v_xor_b32 v231, 32768, v231
    v_mfma_f32_32x32x16_bf16 a[80:95], a[28:31], a[12:15], a[80:95]
    s_waitcnt vmcnt(18) lgkmcnt(0)
    s_barrier
    v_mfma_f32_32x32x16_bf16 v[0:15], a[48:51], a[32:35], v[0:15]
    ds_read_b64_tr_b16 a[16:17], v228 offset:0
    s_add_u32 m0, s43, 16384
    s_add_u32 s44, s42, 262144
    buffer_load_dwordx4 v234, s[12:15], s44 offen lds
    v_mfma_f32_32x32x16_bf16 v[64:79], a[52:55], a[32:35], v[64:79]
    ds_read_b128 a[0:3], v224 offset:0
    v_mfma_f32_32x32x16_bf16 v[128:143], a[56:59], a[32:35], v[128:143]
    ds_read_b64_tr_b16 a[18:19], v228 offset:2048
    v_mfma_f32_32x32x16_bf16 v[192:207], a[60:63], a[32:35], v[192:207]
    ds_read_b64_tr_b16 a[20:21], v229 offset:0
    v_mfma_f32_32x32x16_bf16 v[16:31], a[48:51], a[36:39], v[16:31]
    s_add_u32 m0, s43, 17408
    s_add_u32 s44, s42, 278528
    buffer_load_dwordx4 v235, s[12:15], s44 offen lds
    v_mfma_f32_32x32x16_bf16 v[80:95], a[52:55], a[36:39], v[80:95]
    ds_read_b128 a[4:7], v224 offset:4096
    ds_read_b64_tr_b16 a[22:23], v229 offset:2048
    v_mfma_f32_32x32x16_bf16 v[144:159], a[56:59], a[36:39], v[144:159]
    s_add_u32 m0, s43, 18432
    s_add_u32 s44, s42, 294912
    buffer_load_dwordx4 v234, s[12:15], s44 offen lds
    v_mfma_f32_32x32x16_bf16 v[208:223], a[60:63], a[36:39], v[208:223]
    ds_read_b64_tr_b16 a[24:25], v230 offset:0
    v_mfma_f32_32x32x16_bf16 v[32:47], a[48:51], a[40:43], v[32:47]
    ds_read_b128 a[8:11], v224 offset:8192
    v_mfma_f32_32x32x16_bf16 v[96:111], a[52:55], a[40:43], v[96:111]
    s_add_u32 m0, s43, 19456
    s_add_u32 s44, s42, 311296
    buffer_load_dwordx4 v235, s[12:15], s44 offen lds
    v_mfma_f32_32x32x16_bf16 v[160:175], a[56:59], a[40:43], v[160:175]
    ds_read_b64_tr_b16 a[26:27], v230 offset:2048
    ds_read_b64_tr_b16 a[28:29], v231 offset:0
    v_mfma_f32_32x32x16_bf16 a[64:79], a[60:63], a[40:43], a[64:79]
    ds_read_b128 a[12:15], v224 offset:12288
    v_mfma_f32_32x32x16_bf16 v[48:63], a[48:51], a[44:47], v[48:63]
    s_add_u32 s45, s58, 0
    buffer_load_dwordx4 v[252:255], v236, s[16:19], s45 offen
    v_mfma_f32_32x32x16_bf16 v[112:127], a[52:55], a[44:47], v[112:127]
    ds_read_b64_tr_b16 a[30:31], v231 offset:2048
    v_mfma_f32_32x32x16_bf16 v[176:191], a[56:59], a[44:47], v[176:191]
    s_add_u32 s42, s42, 524288
    s_xor_b32 s43, s43, 32768
    v_mfma_f32_32x32x16_bf16 a[80:95], a[60:63], a[44:47], a[80:95]
    s_add_u32 s40, s40, 128
    s_add_u32 s41, s41, 32768
    s_cmp_ge_u32 s41, 163840
    s_cselect_b32 s45, 98304, 0
    s_sub_u32 s41, s41, s45
    s_waitcnt lgkmcnt(0)
    v_mfma_f32_32x32x16_bf16 v[0:15], a[16:19], a[0:3], v[0:15]
    s_add_u32 s47, s47, 32768
    s_mov_b32 s55, 32768
    s_cmp_eq_u32 s47, 163840
    s_cselect_b32 s55, -65536, s55
    s_cselect_b32 s47, 65536, s47
    ds_read_b64_tr_b16 a[48:49], v228 offset:8192
    v_mfma_f32_32x32x16_bf16 v[64:79], a[20:23], a[0:3], v[64:79]
    s_add_u32 m0, s41, 0
    s_add_u32 s44, s40, 0
    buffer_load_dwordx4 v232, s[8:11], s44 offen lds
    v_mfma_f32_32x32x16_bf16 v[128:143], a[24:27], a[0:3], v[128:143]
    ds_read_b128 a[32:35], v225 offset:0
    v_mfma_f32_32x32x16_bf16 v[192:207], a[28:31], a[0:3], v[192:207]
    ds_read_b64_tr_b16 a[50:51], v228 offset:10240
    v_mfma_f32_32x32x16_bf16 v[16:31], a[16:19], a[4:7], v[16:31]
    ds_read_b64_tr_b16 a[52:53], v229 offset:8192
    v_mfma_f32_32x32x16_bf16 v[80:95], a[20:23], a[4:7], v[80:95]
    s_add_u32 m0, s41, 1024
    s_add_u32 s44, s40, 8192
    buffer_load_dwordx4 v233, s[8:11], s44 offen lds
    ds_read_b128 a[36:39], v225 offset:4096
    v_mfma_f32_32x32x16_bf16 v[144:159], a[24:27], a[4:7], v[144:159]
    ds_read_b64_tr_b16 a[54:55], v229 offset:10240
    v_mfma_f32_32x32x16_bf16 v[208:223], a[28:31], a[4:7], v[208:223]
    ds_read_b64_tr_b16 a[56:57], v230 offset:8192
    v_mfma_f32_32x32x16_bf16 v[32:47], a[16:19], a[8:11], v[32:47]
    s_add_u32 m0, s41, 2048
    s_add_u32 s44, s40, 16384
    buffer_load_dwordx4 v232, s[8:11], s44 offen lds
    v_mfma_f32_32x32x16_bf16 v[96:111], a[20:23], a[8:11], v[96:111]
    ds_read_b128 a[40:43], v225 offset:8192
    v_mfma_f32_32x32x16_bf16 v[160:175], a[24:27], a[8:11], v[160:175]
    ds_read_b64_tr_b16 a[58:59], v230 offset:10240
    ds_read_b64_tr_b16 a[60:61], v231 offset:8192
    v_mfma_f32_32x32x16_bf16 a[64:79], a[28:31], a[8:11], a[64:79]
    s_add_u32 m0, s41, 3072
    s_add_u32 s44, s40, 24576
    buffer_load_dwordx4 v233, s[8:11], s44 offen lds
    v_mfma_f32_32x32x16_bf16 v[48:63], a[16:19], a[12:15], v[48:63]
    ds_read_b128 a[44:47], v225 offset:12288
    v_mfma_f32_32x32x16_bf16 v[112:127], a[20:23], a[12:15], v[112:127]
    ds_read_b64_tr_b16 a[62:63], v231 offset:10240
    v_mfma_f32_32x32x16_bf16 v[176:191], a[24:27], a[12:15], v[176:191]
    v_add_u32 v225, s55, v225
    v_mfma_f32_32x32x16_bf16 a[80:95], a[28:31], a[12:15], a[80:95]
    s_waitcnt vmcnt(23) lgkmcnt(0)
    s_barrier
    v_mfma_f32_32x32x16_bf16 v[0:15], a[48:51], a[32:35], v[0:15]
    ds_read_b64_tr_b16 a[16:17], v228 offset:16384
    s_add_u32 m0, s43, 0
    s_add_u32 s44, s42, 0
    buffer_load_dwordx4 v234, s[12:15], s44 offen lds
    v_mfma_f32_32x32x16_bf16 v[64:79], a[52:55], a[32:35], v[64:79]
    ds_read_b128 a[0:3], v226 offset:0
    v_mfma_f32_32x32x16_bf16 v[128:143], a[56:59], a[32:35], v[128:143]
    ds_read_b64_tr_b16 a[18:19], v228 offset:18432
    v_mfma_f32_32x32x16_bf16 v[192:207], a[60:63], a[32:35], v[192:207]
    ds_read_b64_tr_b16 a[20:21], v229 offset:16384
    v_mfma_f32_32x32x16_bf16 v[16:31], a[48:51], a[36:39], v[16:31]
    s_add_u32 m0, s43, 1024
    s_add_u32 s44, s42, 16384
    buffer_load_dwordx4 v235, s[12:15], s44 offen lds
    v_mfma_f32_32x32x16_bf16 v[80:95], a[52:55], a[36:39], v[80:95]
    ds_read_b128 a[4:7], v226 offset:4096
    v_mfma_f32_32x32x16_bf16 v[144:159], a[56:59], a[36:39], v[144:159]
    ds_read_b64_tr_b16 a[22:23], v229 offset:18432
    v_mfma_f32_32x32x16_bf16 v[208:223], a[60:63], a[36:39], v[208:223]
    s_add_u32 m0, s43, 2048
    s_add_u32 s44, s42, 32768
    buffer_load_dwordx4 v234, s[12:15], s44 offen lds
    v_mfma_f32_32x32x16_bf16 v[32:47], a[48:51], a[40:43], v[32:47]
    ds_read_b64_tr_b16 a[24:25], v230 offset:16384
    ds_read_b128 a[8:11], v226 offset:8192
    v_mfma_f32_32x32x16_bf16 v[96:111], a[52:55], a[40:43], v[96:111]
    s_add_u32 m0, s43, 3072
    s_add_u32 s44, s42, 49152
    buffer_load_dwordx4 v235, s[12:15], s44 offen lds
    v_mfma_f32_32x32x16_bf16 v[160:175], a[56:59], a[40:43], v[160:175]
    ds_read_b64_tr_b16 a[26:27], v230 offset:18432
    v_mfma_f32_32x32x16_bf16 a[64:79], a[60:63], a[40:43], a[64:79]
    ds_read_b64_tr_b16 a[28:29], v231 offset:16384
    v_mfma_f32_32x32x16_bf16 v[48:63], a[48:51], a[44:47], v[48:63]
    ds_read_b128 a[12:15], v226 offset:12288
    v_mfma_f32_32x32x16_bf16 v[112:127], a[52:55], a[44:47], v[112:127]
    s_add_u32 s45, s58, 1048576
    buffer_load_dwordx4 v[252:255], v236, s[16:19], s45 offen
    v_mfma_f32_32x32x16_bf16 v[176:191], a[56:59], a[44:47], v[176:191]
    ds_read_b64_tr_b16 a[30:31], v231 offset:18432
    v_mfma_f32_32x32x16_bf16 a[80:95], a[60:63], a[44:47], a[80:95]
    v_add_u32 v226, s55, v226
    s_waitcnt lgkmcnt(0)
    v_mfma_f32_32x32x16_bf16 v[0:15], a[16:19], a[0:3], v[0:15]
    ds_read_b64_tr_b16 a[48:49], v228 offset:24576
    s_add_u32 m0, s41, 4096
    s_add_u32 s44, s40, 32768
    buffer_load_dwordx4 v232, s[8:11], s44 offen lds
    v_mfma_f32_32x32x16_bf16 v[64:79], a[20:23], a[0:3], v[64:79]
    ds_read_b128 a[32:35], v227 offset:0
    v_mfma_f32_32x32x16_bf16 v[128:143], a[24:27], a[0:3], v[128:143]
    ds_read_b64_tr_b16 a[50:51], v228 offset:26624
    ds_read_b64_tr_b16 a[52:53], v229 offset:24576
    v_mfma_f32_32x32x16_bf16 v[192:207], a[28:31], a[0:3], v[192:207]
    s_add_u32 m0, s41, 5120
    s_add_u32 s44, s40, 40960
    buffer_load_dwordx4 v233, s[8:11], s44 offen lds
    v_mfma_f32_32x32x16_bf16 v[16:31], a[16:19], a[4:7], v[16:31]
    ds_read_b128 a[36:39], v227 offset:4096
    ds_read_b64_tr_b16 a[54:55], v229 offset:26624
    v_mfma_f32_32x32x16_bf16 v[80:95], a[20:23], a[4:7], v[80:95]
    ds_read_b64_tr_b16 a[56:57], v230 offset:24576
    v_mfma_f32_32x32x16_bf16 v[144:159], a[24:27], a[4:7], v[144:159]
    s_add_u32 m0, s41, 6144
    s_add_u32 s44, s40, 49152
    buffer_load_dwordx4 v232, s[8:11], s44 offen lds
    ds_read_b128 a[40:43], v227 offset:8192
    v_mfma_f32_32x32x16_bf16 v[208:223], a[28:31], a[4:7], v[208:223]
    ds_read_b64_tr_b16 a[58:59], v230 offset:26624
    v_mfma_f32_32x32x16_bf16 v[32:47], a[16:19], a[8:11], v[32:47]
    ds_read_b64_tr_b16 a[60:61], v231 offset:24576
    s_add_u32 m0, s41, 7168
    s_add_u32 s44, s40, 57344
    buffer_load_dwordx4 v233, s[8:11], s44 offen lds
    v_mfma_f32_32x32x16_bf16 v[96:111], a[20:23], a[8:11], v[96:111]
    ds_read_b128 a[44:47], v227 offset:12288
    v_mfma_f32_32x32x16_bf16 v[160:175], a[24:27], a[8:11], v[160:175]
    ds_read_b64_tr_b16 a[62:63], v231 offset:26624
    v_add_u32 v227, s55, v227
    v_mfma_f32_32x32x16_bf16 a[64:79], a[28:31], a[8:11], a[64:79]
    v_add_u32 v224, s55, v224
    v_mfma_f32_32x32x16_bf16 v[48:63], a[16:19], a[12:15], v[48:63]
    v_xor_b32 v228, 32768, v228
    v_xor_b32 v229, 32768, v229
    v_mfma_f32_32x32x16_bf16 v[112:127], a[20:23], a[12:15], v[112:127]
    v_xor_b32 v230, 32768, v230
    v_mfma_f32_32x32x16_bf16 v[176:191], a[24:27], a[12:15], v[176:191]
    v_xor_b32 v231, 32768, v231
    v_mfma_f32_32x32x16_bf16 a[80:95], a[28:31], a[12:15], a[80:95]
    s_waitcnt vmcnt(18) lgkmcnt(0)
    s_barrier
    v_mfma_f32_32x32x16_bf16 v[0:15], a[48:51], a[32:35], v[0:15]
    ds_read_b64_tr_b16 a[16:17], v228 offset:0
    s_add_u32 m0, s43, 16384
    s_add_u32 s44, s42, 262144
    buffer_load_dwordx4 v234, s[12:15], s44 offen lds
    v_mfma_f32_32x32x16_bf16 v[64:79], a[52:55], a[32:35], v[64:79]
    ds_read_b128 a[0:3], v224 offset:0
    v_mfma_f32_32x32x16_bf16 v[128:143], a[56:59], a[32:35], v[128:143]
    ds_read_b64_tr_b16 a[18:19], v228 offset:2048
    v_mfma_f32_32x32x16_bf16 v[192:207], a[60:63], a[32:35], v[192:207]
    ds_read_b64_tr_b16 a[20:21], v229 offset:0
    v_mfma_f32_32x32x16_bf16 v[16:31], a[48:51], a[36:39], v[16:31]
    s_add_u32 m0, s43, 17408
    s_add_u32 s44, s42, 278528
    buffer_load_dwordx4 v235, s[12:15], s44 offen lds
    v_mfma_f32_32x32x16_bf16 v[80:95], a[52:55], a[36:39], v[80:95]
    ds_read_b128 a[4:7], v224 offset:4096
    ds_read_b64_tr_b16 a[22:23], v229 offset:2048
    v_mfma_f32_32x32x16_bf16 v[144:159], a[56:59], a[36:39], v[144:159]
    s_add_u32 m0, s43, 18432
    s_add_u32 s44, s42, 294912
    buffer_load_dwordx4 v234, s[12:15], s44 offen lds
    v_mfma_f32_32x32x16_bf16 v[208:223], a[60:63], a[36:39], v[208:223]
    ds_read_b64_tr_b16 a[24:25], v230 offset:0
    v_mfma_f32_32x32x16_bf16 v[32:47], a[48:51], a[40:43], v[32:47]
    ds_read_b128 a[8:11], v224 offset:8192
    v_mfma_f32_32x32x16_bf16 v[96:111], a[52:55], a[40:43], v[96:111]
    s_add_u32 m0, s43, 19456
    s_add_u32 s44, s42, 311296
    buffer_load_dwordx4 v235, s[12:15], s44 offen lds
    v_mfma_f32_32x32x16_bf16 v[160:175], a[56:59], a[40:43], v[160:175]
    ds_read_b64_tr_b16 a[26:27], v230 offset:2048
    ds_read_b64_tr_b16 a[28:29], v231 offset:0
    v_mfma_f32_32x32x16_bf16 a[64:79], a[60:63], a[40:43], a[64:79]
    ds_read_b128 a[12:15], v224 offset:12288
    v_mfma_f32_32x32x16_bf16 v[48:63], a[48:51], a[44:47], v[48:63]
    s_add_u32 s45, s58, 0
    buffer_load_dwordx4 v[252:255], v236, s[20:23], s45 offen
    v_mfma_f32_32x32x16_bf16 v[112:127], a[52:55], a[44:47], v[112:127]
    ds_read_b64_tr_b16 a[30:31], v231 offset:2048
    v_mfma_f32_32x32x16_bf16 v[176:191], a[56:59], a[44:47], v[176:191]
    s_add_u32 s42, s42, 524288
    s_xor_b32 s43, s43, 32768
    v_mfma_f32_32x32x16_bf16 a[80:95], a[60:63], a[44:47], a[80:95]
    s_add_u32 s40, s40, 128
    s_add_u32 s41, s41, 32768
    s_cmp_ge_u32 s41, 163840
    s_cselect_b32 s45, 98304, 0
    s_sub_u32 s41, s41, s45
    s_waitcnt lgkmcnt(0)
    v_mfma_f32_32x32x16_bf16 v[0:15], a[16:19], a[0:3], v[0:15]
    s_add_u32 s47, s47, 32768
    s_mov_b32 s55, 32768
    s_cmp_eq_u32 s47, 163840
    s_cselect_b32 s55, -65536, s55
    s_cselect_b32 s47, 65536, s47
    ds_read_b64_tr_b16 a[48:49], v228 offset:8192
    v_mfma_f32_32x32x16_bf16 v[64:79], a[20:23], a[0:3], v[64:79]
    s_add_u32 m0, s41, 0
    s_add_u32 s44, s40, 0
    buffer_load_dwordx4 v232, s[8:11], s44 offen lds
    v_mfma_f32_32x32x16_bf16 v[128:143], a[24:27], a[0:3], v[128:143]
    ds_read_b128 a[32:35], v225 offset:0
    v_mfma_f32_32x32x16_bf16 v[192:207], a[28:31], a[0:3], v[192:207]
    ds_read_b64_tr_b16 a[50:51], v228 offset:10240
    v_mfma_f32_32x32x16_bf16 v[16:31], a[16:19], a[4:7], v[16:31]
    ds_read_b64_tr_b16 a[52:53], v229 offset:8192
    v_mfma_f32_32x32x16_bf16 v[80:95], a[20:23], a[4:7], v[80:95]
    s_add_u32 m0, s41, 1024
    s_add_u32 s44, s40, 8192
    buffer_load_dwordx4 v233, s[8:11], s44 offen lds
    ds_read_b128 a[36:39], v225 offset:4096
    v_mfma_f32_32x32x16_bf16 v[144:159], a[24:27], a[4:7], v[144:159]
    ds_read_b64_tr_b16 a[54:55], v229 offset:10240
    v_mfma_f32_32x32x16_bf16 v[208:223], a[28:31], a[4:7], v[208:223]
    ds_read_b64_tr_b16 a[56:57], v230 offset:8192
    v_mfma_f32_32x32x16_bf16 v[32:47], a[16:19], a[8:11], v[32:47]
    s_add_u32 m0, s41, 2048
    s_add_u32 s44, s40, 16384
    buffer_load_dwordx4 v232, s[8:11], s44 offen lds
    v_mfma_f32_32x32x16_bf16 v[96:111], a[20:23], a[8:11], v[96:111]
    ds_read_b128 a[40:43], v225 offset:8192
    v_mfma_f32_32x32x16_bf16 v[160:175], a[24:27], a[8:11], v[160:175]
    ds_read_b64_tr_b16 a[58:59], v230 offset:10240
    ds_read_b64_tr_b16 a[60:61], v231 offset:8192
    v_mfma_f32_32x32x16_bf16 a[64:79], a[28:31], a[8:11], a[64:79]
    s_add_u32 m0, s41, 3072
    s_add_u32 s44, s40, 24576
    buffer_load_dwordx4 v233, s[8:11], s44 offen lds
    v_mfma_f32_32x32x16_bf16 v[48:63], a[16:19], a[12:15], v[48:63]
    ds_read_b128 a[44:47], v225 offset:12288
    v_mfma_f32_32x32x16_bf16 v[112:127], a[20:23], a[12:15], v[112:127]
    ds_read_b64_tr_b16 a[62:63], v231 offset:10240
    v_mfma_f32_32x32x16_bf16 v[176:191], a[24:27], a[12:15], v[176:191]
    v_add_u32 v225, s55, v225
    v_mfma_f32_32x32x16_bf16 a[80:95], a[28:31], a[12:15], a[80:95]
    s_waitcnt vmcnt(23) lgkmcnt(0)
    s_barrier
    v_mfma_f32_32x32x16_bf16 v[0:15], a[48:51], a[32:35], v[0:15]
    ds_read_b64_tr_b16 a[16:17], v228 offset:16384
    s_add_u32 m0, s43, 0
    s_add_u32 s44, s42, 0
    buffer_load_dwordx4 v234, s[12:15], s44 offen lds
    v_mfma_f32_32x32x16_bf16 v[64:79], a[52:55], a[32:35], v[64:79]
    ds_read_b128 a[0:3], v226 offset:0
    v_mfma_f32_32x32x16_bf16 v[128:143], a[56:59], a[32:35], v[128:143]
    ds_read_b64_tr_b16 a[18:19], v228 offset:18432
    v_mfma_f32_32x32x16_bf16 v[192:207], a[60:63], a[32:35], v[192:207]
    ds_read_b64_tr_b16 a[20:21], v229 offset:16384
    v_mfma_f32_32x32x16_bf16 v[16:31], a[48:51], a[36:39], v[16:31]
    s_add_u32 m0, s43, 1024
    s_add_u32 s44, s42, 16384
    buffer_load_dwordx4 v235, s[12:15], s44 offen lds
    v_mfma_f32_32x32x16_bf16 v[80:95], a[52:55], a[36:39], v[80:95]
    ds_read_b128 a[4:7], v226 offset:4096
    v_mfma_f32_32x32x16_bf16 v[144:159], a[56:59], a[36:39], v[144:159]
    ds_read_b64_tr_b16 a[22:23], v229 offset:18432
    v_mfma_f32_32x32x16_bf16 v[208:223], a[60:63], a[36:39], v[208:223]
    s_add_u32 m0, s43, 2048
    s_add_u32 s44, s42, 32768
    buffer_load_dwordx4 v234, s[12:15], s44 offen lds
    v_mfma_f32_32x32x16_bf16 v[32:47], a[48:51], a[40:43], v[32:47]
    ds_read_b64_tr_b16 a[24:25], v230 offset:16384
    ds_read_b128 a[8:11], v226 offset:8192
    v_mfma_f32_32x32x16_bf16 v[96:111], a[52:55], a[40:43], v[96:111]
    s_add_u32 m0, s43, 3072
    s_add_u32 s44, s42, 49152
    buffer_load_dwordx4 v235, s[12:15], s44 offen lds
    v_mfma_f32_32x32x16_bf16 v[160:175], a[56:59], a[40:43], v[160:175]
    ds_read_b64_tr_b16 a[26:27], v230 offset:18432
    v_mfma_f32_32x32x16_bf16 a[64:79], a[60:63], a[40:43], a[64:79]
    ds_read_b64_tr_b16 a[28:29], v231 offset:16384
    v_mfma_f32_32x32x16_bf16 v[48:63], a[48:51], a[44:47], v[48:63]
    ds_read_b128 a[12:15], v226 offset:12288
    v_mfma_f32_32x32x16_bf16 v[112:127], a[52:55], a[44:47], v[112:127]
    s_add_u32 s45, s58, 2097152
    buffer_load_dwordx4 v[252:255], v236, s[16:19], s45 offen
    v_mfma_f32_32x32x16_bf16 v[176:191], a[56:59], a[44:47], v[176:191]
    ds_read_b64_tr_b16 a[30:31], v231 offset:18432
    v_mfma_f32_32x32x16_bf16 a[80:95], a[60:63], a[44:47], a[80:95]
    v_add_u32 v226, s55, v226
    s_waitcnt lgkmcnt(0)
    v_mfma_f32_32x32x16_bf16 v[0:15], a[16:19], a[0:3], v[0:15]
    ds_read_b64_tr_b16 a[48:49], v228 offset:24576
    s_add_u32 m0, s41, 4096
    s_add_u32 s44, s40, 32768
    buffer_load_dwordx4 v232, s[8:11], s44 offen lds
    v_mfma_f32_32x32x16_bf16 v[64:79], a[20:23], a[0:3], v[64:79]
    ds_read_b128 a[32:35], v227 offset:0
    v_mfma_f32_32x32x16_bf16 v[128:143], a[24:27], a[0:3], v[128:143]
    ds_read_b64_tr_b16 a[50:51], v228 offset:26624
    ds_read_b64_tr_b16 a[52:53], v229 offset:24576
    v_mfma_f32_32x32x16_bf16 v[192:207], a[28:31], a[0:3], v[192:207]
    s_add_u32 m0, s41, 5120
    s_add_u32 s44, s40, 40960
    buffer_load_dwordx4 v233, s[8:11], s44 offen lds
    v_mfma_f32_32x32x16_bf16 v[16:31], a[16:19], a[4:7], v[16:31]
    ds_read_b128 a[36:39], v227 offset:4096
    ds_read_b64_tr_b16 a[54:55], v229 offset:26624
    v_mfma_f32_32x32x16_bf16 v[80:95], a[20:23], a[4:7], v[80:95]
    ds_read_b64_tr_b16 a[56:57], v230 offset:24576
    v_mfma_f32_32x32x16_bf16 v[144:159], a[24:27], a[4:7], v[144:159]
    s_add_u32 m0, s41, 6144
    s_add_u32 s44, s40, 49152
    buffer_load_dwordx4 v232, s[8:11], s44 offen lds
    ds_read_b128 a[40:43], v227 offset:8192
    v_mfma_f32_32x32x16_bf16 v[208:223], a[28:31], a[4:7], v[208:223]
    ds_read_b64_tr_b16 a[58:59], v230 offset:26624
    v_mfma_f32_32x32x16_bf16 v[32:47], a[16:19], a[8:11], v[32:47]
    ds_read_b64_tr_b16 a[60:61], v231 offset:24576
    s_add_u32 m0, s41, 7168
    s_add_u32 s44, s40, 57344
    buffer_load_dwordx4 v233, s[8:11], s44 offen lds
    v_mfma_f32_32x32x16_bf16 v[96:111], a[20:23], a[8:11], v[96:111]
    ds_read_b128 a[44:47], v227 offset:12288
    v_mfma_f32_32x32x16_bf16 v[160:175], a[24:27], a[8:11], v[160:175]
    ds_read_b64_tr_b16 a[62:63], v231 offset:26624
    v_add_u32 v227, s55, v227
    v_mfma_f32_32x32x16_bf16 a[64:79], a[28:31], a[8:11], a[64:79]
    v_add_u32 v224, s55, v224
    v_mfma_f32_32x32x16_bf16 v[48:63], a[16:19], a[12:15], v[48:63]
    v_xor_b32 v228, 32768, v228
    v_xor_b32 v229, 32768, v229
    v_mfma_f32_32x32x16_bf16 v[112:127], a[20:23], a[12:15], v[112:127]
    v_xor_b32 v230, 32768, v230
    v_mfma_f32_32x32x16_bf16 v[176:191], a[24:27], a[12:15], v[176:191]
    v_xor_b32 v231, 32768, v231
    v_mfma_f32_32x32x16_bf16 a[80:95], a[28:31], a[12:15], a[80:95]
    s_waitcnt vmcnt(18) lgkmcnt(0)
    s_barrier
    v_mfma_f32_32x32x16_bf16 v[0:15], a[48:51], a[32:35], v[0:15]
    ds_read_b64_tr_b16 a[16:17], v228 offset:0
    s_add_u32 m0, s43, 16384
    s_add_u32 s44, s42, 262144
    buffer_load_dwordx4 v234, s[12:15], s44 offen lds
    v_mfma_f32_32x32x16_bf16 v[64:79], a[52:55], a[32:35], v[64:79]
    ds_read_b128 a[0:3], v224 offset:0
    v_mfma_f32_32x32x16_bf16 v[128:143], a[56:59], a[32:35], v[128:143]
    ds_read_b64_tr_b16 a[18:19], v228 offset:2048
    v_mfma_f32_32x32x16_bf16 v[192:207], a[60:63], a[32:35], v[192:207]
    ds_read_b64_tr_b16 a[20:21], v229 offset:0
    v_mfma_f32_32x32x16_bf16 v[16:31], a[48:51], a[36:39], v[16:31]
    s_add_u32 m0, s43, 17408
    s_add_u32 s44, s42, 278528
    buffer_load_dwordx4 v235, s[12:15], s44 offen lds
    v_mfma_f32_32x32x16_bf16 v[80:95], a[52:55], a[36:39], v[80:95]
    ds_read_b128 a[4:7], v224 offset:4096
    ds_read_b64_tr_b16 a[22:23], v229 offset:2048
    v_mfma_f32_32x32x16_bf16 v[144:159], a[56:59], a[36:39], v[144:159]
    s_add_u32 m0, s43, 18432
    s_add_u32 s44, s42, 294912
    buffer_load_dwordx4 v234, s[12:15], s44 offen lds
    v_mfma_f32_32x32x16_bf16 v[208:223], a[60:63], a[36:39], v[208:223]
    ds_read_b64_tr_b16 a[24:25], v230 offset:0
    v_mfma_f32_32x32x16_bf16 v[32:47], a[48:51], a[40:43], v[32:47]
    ds_read_b128 a[8:11], v224 offset:8192
    v_mfma_f32_32x32x16_bf16 v[96:111], a[52:55], a[40:43], v[96:111]
    s_add_u32 m0, s43, 19456
    s_add_u32 s44, s42, 311296
    buffer_load_dwordx4 v235, s[12:15], s44 offen lds
    v_mfma_f32_32x32x16_bf16 v[160:175], a[56:59], a[40:43], v[160:175]
    ds_read_b64_tr_b16 a[26:27], v230 offset:2048
    ds_read_b64_tr_b16 a[28:29], v231 offset:0
    v_mfma_f32_32x32x16_bf16 a[64:79], a[60:63], a[40:43], a[64:79]
    ds_read_b128 a[12:15], v224 offset:12288
    v_mfma_f32_32x32x16_bf16 v[48:63], a[48:51], a[44:47], v[48:63]
    s_add_u32 s45, s58, 1048576
    buffer_load_dwordx4 v[252:255], v236, s[20:23], s45 offen
    v_mfma_f32_32x32x16_bf16 v[112:127], a[52:55], a[44:47], v[112:127]
    ds_read_b64_tr_b16 a[30:31], v231 offset:2048
    v_mfma_f32_32x32x16_bf16 v[176:191], a[56:59], a[44:47], v[176:191]
    s_add_u32 s42, s42, 524288
    s_xor_b32 s43, s43, 32768
    v_mfma_f32_32x32x16_bf16 a[80:95], a[60:63], a[44:47], a[80:95]
    s_add_u32 s40, s40, 128
    s_add_u32 s41, s41, 32768
    s_cmp_ge_u32 s41, 163840
    s_cselect_b32 s45, 98304, 0
    s_sub_u32 s41, s41, s45
    s_waitcnt lgkmcnt(0)
    v_lshrrev_b32 v237, 3, v244
    v_mul_u32_u24 v237, 1152, v237
    v_and_b32 v238, 7, v244
    v_lshrrev_b32 v239, 4, v244
    v_xor_b32 v238, v238, v239
    v_lshl_add_u32 v232, v238, 4, v237
    v_xor_b32 v233, 64, v232
    v_lshrrev_b32 v237, 3, v244
    v_and_b32 v238, 7, v244
    v_bfe_u32 v239, v237, 1, 1
    v_lshlrev_b32 v239, 2, v239
    v_xor_b32 v238, v238, v239
    v_mul_u32_u24 v237, 3456, v237
    v_lshl_add_u32 v234, v238, 4, v237
    s_and_b32 s43, s43, 32768
    s_mul_i32 s44, s3, 1024
    s_add_u32 s43, s43, s44
    v_mfma_f32_32x32x16_bf16 v[0:15], a[16:19], a[0:3], v[0:15]
    s_add_u32 s47, s47, 32768
    s_mov_b32 s55, 32768
    s_cmp_eq_u32 s47, 163840
    s_cselect_b32 s55, -65536, s55
    s_cselect_b32 s47, 65536, s47
    ds_read_b64_tr_b16 a[48:49], v228 offset:8192
    v_mfma_f32_32x32x16_bf16 v[64:79], a[20:23], a[0:3], v[64:79]
    s_add_u32 m0, s41, 0
    s_add_u32 s44, s56, 0
    buffer_load_dwordx4 v232, s[24:27], s44 offen lds
    v_mfma_f32_32x32x16_bf16 v[128:143], a[24:27], a[0:3], v[128:143]
    ds_read_b128 a[32:35], v225 offset:0
    v_mfma_f32_32x32x16_bf16 v[192:207], a[28:31], a[0:3], v[192:207]
    ds_read_b64_tr_b16 a[50:51], v228 offset:10240
    v_mfma_f32_32x32x16_bf16 v[16:31], a[16:19], a[4:7], v[16:31]
    ds_read_b64_tr_b16 a[52:53], v229 offset:8192
    v_mfma_f32_32x32x16_bf16 v[80:95], a[20:23], a[4:7], v[80:95]
    s_add_u32 m0, s41, 1024
    s_add_u32 s44, s56, 9216
    buffer_load_dwordx4 v233, s[24:27], s44 offen lds
    ds_read_b128 a[36:39], v225 offset:4096
    v_mfma_f32_32x32x16_bf16 v[144:159], a[24:27], a[4:7], v[144:159]
    ds_read_b64_tr_b16 a[54:55], v229 offset:10240
    v_mfma_f32_32x32x16_bf16 v[208:223], a[28:31], a[4:7], v[208:223]
    ds_read_b64_tr_b16 a[56:57], v230 offset:8192
    v_mfma_f32_32x32x16_bf16 v[32:47], a[16:19], a[8:11], v[32:47]
    s_add_u32 m0, s41, 2048
    s_add_u32 s44, s56, 18432
    buffer_load_dwordx4 v232, s[24:27], s44 offen lds
    v_mfma_f32_32x32x16_bf16 v[96:111], a[20:23], a[8:11], v[96:111]
    ds_read_b128 a[40:43], v225 offset:8192
    v_mfma_f32_32x32x16_bf16 v[160:175], a[24:27], a[8:11], v[160:175]
    ds_read_b64_tr_b16 a[58:59], v230 offset:10240
    ds_read_b64_tr_b16 a[60:61], v231 offset:8192
    v_mfma_f32_32x32x16_bf16 a[64:79], a[28:31], a[8:11], a[64:79]
    s_add_u32 m0, s41, 3072
    s_add_u32 s44, s56, 27648
    buffer_load_dwordx4 v233, s[24:27], s44 offen lds
    v_mfma_f32_32x32x16_bf16 v[48:63], a[16:19], a[12:15], v[48:63]
    ds_read_b128 a[44:47], v225 offset:12288
    v_mfma_f32_32x32x16_bf16 v[112:127], a[20:23], a[12:15], v[112:127]
    ds_read_b64_tr_b16 a[62:63], v231 offset:10240
    v_mfma_f32_32x32x16_bf16 v[176:191], a[24:27], a[12:15], v[176:191]
    v_add_u32 v225, s55, v225
    v_mfma_f32_32x32x16_bf16 a[80:95], a[28:31], a[12:15], a[80:95]
    s_waitcnt vmcnt(23) lgkmcnt(0)
    s_barrier
    v_mfma_f32_32x32x16_bf16 v[0:15], a[48:51], a[32:35], v[0:15]
    ds_read_b64_tr_b16 a[16:17], v228 offset:16384
    v_mfma_f32_32x32x16_bf16 v[64:79], a[52:55], a[32:35], v[64:79]
    ds_read_b128 a[0:3], v226 offset:0
    v_mfma_f32_32x32x16_bf16 v[128:143], a[56:59], a[32:35], v[128:143]
    ds_read_b64_tr_b16 a[18:19], v228 offset:18432
    v_mfma_f32_32x32x16_bf16 v[192:207], a[60:63], a[32:35], v[192:207]
    s_add_u32 m0, s43, 0
    s_add_u32 s44, s57, 0
    buffer_load_dwordx4 v234, s[28:31], s44 offen lds
    v_mfma_f32_32x32x16_bf16 v[16:31], a[48:51], a[36:39], v[16:31]
    ds_read_b64_tr_b16 a[20:21], v229 offset:16384
    v_mfma_f32_32x32x16_bf16 v[80:95], a[52:55], a[36:39], v[80:95]
    ds_read_b128 a[4:7], v226 offset:4096
    v_mfma_f32_32x32x16_bf16 v[144:159], a[56:59], a[36:39], v[144:159]
    ds_read_b64_tr_b16 a[22:23], v229 offset:18432
    v_mfma_f32_32x32x16_bf16 v[208:223], a[60:63], a[36:39], v[208:223]
    ds_read_b64_tr_b16 a[24:25], v230 offset:16384
    v_mfma_f32_32x32x16_bf16 v[32:47], a[48:51], a[40:43], v[32:47]
    ds_read_b128 a[8:11], v226 offset:8192
    v_mfma_f32_32x32x16_bf16 v[96:111], a[52:55], a[40:43], v[96:111]
    ds_read_b64_tr_b16 a[26:27], v230 offset:18432
    v_mfma_f32_32x32x16_bf16 v[160:175], a[56:59], a[40:43], v[160:175]
    s_add_u32 s45, s58, 2097152
    buffer_load_dwordx4 v[252:255], v236, s[20:23], s45 offen
    v_mfma_f32_32x32x16_bf16 a[64:79], a[60:63], a[40:43], a[64:79]
    ds_read_b64_tr_b16 a[28:29], v231 offset:16384
    v_mfma_f32_32x32x16_bf16 v[48:63], a[48:51], a[44:47], v[48:63]
    ds_read_b128 a[12:15], v226 offset:12288
    v_mfma_f32_32x32x16_bf16 v[112:127], a[52:55], a[44:47], v[112:127]
    ds_read_b64_tr_b16 a[30:31], v231 offset:18432
    v_mfma_f32_32x32x16_bf16 v[176:191], a[56:59], a[44:47], v[176:191]
    v_add_u32 v226, s55, v226
    v_mfma_f32_32x32x16_bf16 a[80:95], a[60:63], a[44:47], a[80:95]
    s_waitcnt lgkmcnt(0)
    v_mfma_f32_32x32x16_bf16 v[0:15], a[16:19], a[0:3], v[0:15]
    ds_read_b64_tr_b16 a[48:49], v228 offset:24576
    s_add_u32 m0, s41, 4096
    s_add_u32 s44, s56, 36864
    buffer_load_dwordx4 v232, s[24:27], s44 offen lds
    v_mfma_f32_32x32x16_bf16 v[64:79], a[20:23], a[0:3], v[64:79]
    ds_read_b128 a[32:35], v227 offset:0
    v_mfma_f32_32x32x16_bf16 v[128:143], a[24:27], a[0:3], v[128:143]
    ds_read_b64_tr_b16 a[50:51], v228 offset:26624
    ds_read_b64_tr_b16 a[52:53], v229 offset:24576
    v_mfma_f32_32x32x16_bf16 v[192:207], a[28:31], a[0:3], v[192:207]
    s_add_u32 m0, s41, 5120
    s_add_u32 s44, s56, 46080
    buffer_load_dwordx4 v233, s[24:27], s44 offen lds
    v_mfma_f32_32x32x16_bf16 v[16:31], a[16:19], a[4:7], v[16:31]
    ds_read_b128 a[36:39], v227 offset:4096
    ds_read_b64_tr_b16 a[54:55], v229 offset:26624
    v_mfma_f32_32x32x16_bf16 v[80:95], a[20:23], a[4:7], v[80:95]
    ds_read_b64_tr_b16 a[56:57], v230 offset:24576
    v_mfma_f32_32x32x16_bf16 v[144:159], a[24:27], a[4:7], v[144:159]
    s_add_u32 m0, s41, 6144
    s_add_u32 s44, s56, 55296
    buffer_load_dwordx4 v232, s[24:27], s44 offen lds
    ds_read_b128 a[40:43], v227 offset:8192
    v_mfma_f32_32x32x16_bf16 v[208:223], a[28:31], a[4:7], v[208:223]
    ds_read_b64_tr_b16 a[58:59], v230 offset:26624
    v_mfma_f32_32x32x16_bf16 v[32:47], a[16:19], a[8:11], v[32:47]
    ds_read_b64_tr_b16 a[60:61], v231 offset:24576
    s_add_u32 m0, s41, 7168
    s_add_u32 s44, s56, 64512
    buffer_load_dwordx4 v233, s[24:27], s44 offen lds
    v_mfma_f32_32x32x16_bf16 v[96:111], a[20:23], a[8:11], v[96:111]
    ds_read_b128 a[44:47], v227 offset:12288
    v_mfma_f32_32x32x16_bf16 v[160:175], a[24:27], a[8:11], v[160:175]
    ds_read_b64_tr_b16 a[62:63], v231 offset:26624
    v_add_u32 v227, s55, v227
    v_mfma_f32_32x32x16_bf16 a[64:79], a[28:31], a[8:11], a[64:79]
    v_add_u32 v224, s55, v224
    v_mfma_f32_32x32x16_bf16 v[48:63], a[16:19], a[12:15], v[48:63]
    v_xor_b32 v228, 32768, v228
    v_xor_b32 v229, 32768, v229
    v_mfma_f32_32x32x16_bf16 v[112:127], a[20:23], a[12:15], v[112:127]
    v_xor_b32 v230, 32768, v230
    v_mfma_f32_32x32x16_bf16 v[176:191], a[24:27], a[12:15], v[176:191]
    v_xor_b32 v231, 32768, v231
    v_mfma_f32_32x32x16_bf16 a[80:95], a[28:31], a[12:15], a[80:95]
    s_waitcnt vmcnt(15) lgkmcnt(0)
    s_barrier
    v_mfma_f32_32x32x16_bf16 v[0:15], a[48:51], a[32:35], v[0:15]
    ds_read_b64_tr_b16 a[16:17], v228 offset:0
    v_mfma_f32_32x32x16_bf16 v[64:79], a[52:55], a[32:35], v[64:79]
    ds_read_b128 a[0:3], v224 offset:0
    v_mfma_f32_32x32x16_bf16 v[128:143], a[56:59], a[32:35], v[128:143]
    ds_read_b64_tr_b16 a[18:19], v228 offset:2048
    v_mfma_f32_32x32x16_bf16 v[192:207], a[60:63], a[32:35], v[192:207]
    s_add_u32 m0, s43, 16384
    s_add_u32 s44, s57, 110592
    buffer_load_dwordx4 v234, s[28:31], s44 offen lds
    v_mfma_f32_32x32x16_bf16 v[16:31], a[48:51], a[36:39], v[16:31]
    ds_read_b64_tr_b16 a[20:21], v229 offset:0
    v_mfma_f32_32x32x16_bf16 v[80:95], a[52:55], a[36:39], v[80:95]
    ds_read_b128 a[4:7], v224 offset:4096
    v_mfma_f32_32x32x16_bf16 v[144:159], a[56:59], a[36:39], v[144:159]
    ds_read_b64_tr_b16 a[22:23], v229 offset:2048
    v_mfma_f32_32x32x16_bf16 v[208:223], a[60:63], a[36:39], v[208:223]
    ds_read_b64_tr_b16 a[24:25], v230 offset:0
    v_mfma_f32_32x32x16_bf16 v[32:47], a[48:51], a[40:43], v[32:47]
    ds_read_b128 a[8:11], v224 offset:8192
    v_mfma_f32_32x32x16_bf16 v[96:111], a[52:55], a[40:43], v[96:111]
    ds_read_b64_tr_b16 a[26:27], v230 offset:2048
    v_mfma_f32_32x32x16_bf16 v[160:175], a[56:59], a[40:43], v[160:175]
    s_add_u32 s45, s58, 3145728
    buffer_load_dwordx4 v[252:255], v236, s[20:23], s45 offen
    v_mfma_f32_32x32x16_bf16 a[64:79], a[60:63], a[40:43], a[64:79]
    ds_read_b64_tr_b16 a[28:29], v231 offset:0
    v_mfma_f32_32x32x16_bf16 v[48:63], a[48:51], a[44:47], v[48:63]
    ds_read_b128 a[12:15], v224 offset:12288
    v_mfma_f32_32x32x16_bf16 v[112:127], a[52:55], a[44:47], v[112:127]
    ds_read_b64_tr_b16 a[30:31], v231 offset:2048
    v_mfma_f32_32x32x16_bf16 v[176:191], a[56:59], a[44:47], v[176:191]
    s_add_u32 s57, s57, 221184
    s_xor_b32 s43, s43, 32768
    v_mfma_f32_32x32x16_bf16 a[80:95], a[60:63], a[44:47], a[80:95]
    s_add_u32 s56, s56, 128
    s_add_u32 s41, s41, 32768
    s_cmp_ge_u32 s41, 163840
    s_cselect_b32 s45, 98304, 0
    s_sub_u32 s41, s41, s45
    s_waitcnt lgkmcnt(0)
    v_mfma_f32_32x32x16_bf16 v[0:15], a[16:19], a[0:3], v[0:15]
    s_add_u32 s47, s47, 32768
    s_mov_b32 s55, 32768
    s_cmp_eq_u32 s47, 163840
    s_cselect_b32 s55, -65536, s55
    s_cselect_b32 s47, 65536, s47
    ds_read_b64_tr_b16 a[48:49], v228 offset:8192
    v_mfma_f32_32x32x16_bf16 v[64:79], a[20:23], a[0:3], v[64:79]
    s_add_u32 m0, s41, 0
    s_add_u32 s44, s56, 0
    buffer_load_dwordx4 v232, s[24:27], s44 offen lds
    v_mfma_f32_32x32x16_bf16 v[128:143], a[24:27], a[0:3], v[128:143]
    ds_read_b128 a[32:35], v225 offset:0
    v_mfma_f32_32x32x16_bf16 v[192:207], a[28:31], a[0:3], v[192:207]
    ds_read_b64_tr_b16 a[50:51], v228 offset:10240
    v_mfma_f32_32x32x16_bf16 v[16:31], a[16:19], a[4:7], v[16:31]
    ds_read_b64_tr_b16 a[52:53], v229 offset:8192
    v_mfma_f32_32x32x16_bf16 v[80:95], a[20:23], a[4:7], v[80:95]
    s_add_u32 m0, s41, 1024
    s_add_u32 s44, s56, 9216
    buffer_load_dwordx4 v233, s[24:27], s44 offen lds
    ds_read_b128 a[36:39], v225 offset:4096
    v_mfma_f32_32x32x16_bf16 v[144:159], a[24:27], a[4:7], v[144:159]
    ds_read_b64_tr_b16 a[54:55], v229 offset:10240
    v_mfma_f32_32x32x16_bf16 v[208:223], a[28:31], a[4:7], v[208:223]
    ds_read_b64_tr_b16 a[56:57], v230 offset:8192
    v_mfma_f32_32x32x16_bf16 v[32:47], a[16:19], a[8:11], v[32:47]
    s_add_u32 m0, s41, 2048
    s_add_u32 s44, s56, 18432
    buffer_load_dwordx4 v232, s[24:27], s44 offen lds
    v_mfma_f32_32x32x16_bf16 v[96:111], a[20:23], a[8:11], v[96:111]
    ds_read_b128 a[40:43], v225 offset:8192
    v_mfma_f32_32x32x16_bf16 v[160:175], a[24:27], a[8:11], v[160:175]
    ds_read_b64_tr_b16 a[58:59], v230 offset:10240
    ds_read_b64_tr_b16 a[60:61], v231 offset:8192
    v_mfma_f32_32x32x16_bf16 a[64:79], a[28:31], a[8:11], a[64:79]
    s_add_u32 m0, s41, 3072
    s_add_u32 s44, s56, 27648
    buffer_load_dwordx4 v233, s[24:27], s44 offen lds
    v_mfma_f32_32x32x16_bf16 v[48:63], a[16:19], a[12:15], v[48:63]
    ds_read_b128 a[44:47], v225 offset:12288
    v_mfma_f32_32x32x16_bf16 v[112:127], a[20:23], a[12:15], v[112:127]
    ds_read_b64_tr_b16 a[62:63], v231 offset:10240
    v_mfma_f32_32x32x16_bf16 v[176:191], a[24:27], a[12:15], v[176:191]
    v_add_u32 v225, s55, v225
    v_mfma_f32_32x32x16_bf16 a[80:95], a[28:31], a[12:15], a[80:95]
    s_waitcnt vmcnt(17) lgkmcnt(0)
    s_barrier
    v_mfma_f32_32x32x16_bf16 v[0:15], a[48:51], a[32:35], v[0:15]
    ds_read_b64_tr_b16 a[16:17], v228 offset:16384
    v_mfma_f32_32x32x16_bf16 v[64:79], a[52:55], a[32:35], v[64:79]
    ds_read_b128 a[0:3], v226 offset:0
    v_mfma_f32_32x32x16_bf16 v[128:143], a[56:59], a[32:35], v[128:143]
    ds_read_b64_tr_b16 a[18:19], v228 offset:18432
    v_mfma_f32_32x32x16_bf16 v[192:207], a[60:63], a[32:35], v[192:207]
    s_add_u32 m0, s43, 0
    s_add_u32 s44, s57, 0
    buffer_load_dwordx4 v234, s[28:31], s44 offen lds
    v_mfma_f32_32x32x16_bf16 v[16:31], a[48:51], a[36:39], v[16:31]
    ds_read_b64_tr_b16 a[20:21], v229 offset:16384
    v_mfma_f32_32x32x16_bf16 v[80:95], a[52:55], a[36:39], v[80:95]
    ds_read_b128 a[4:7], v226 offset:4096
    v_mfma_f32_32x32x16_bf16 v[144:159], a[56:59], a[36:39], v[144:159]
    ds_read_b64_tr_b16 a[22:23], v229 offset:18432
    v_mfma_f32_32x32x16_bf16 v[208:223], a[60:63], a[36:39], v[208:223]
    ds_read_b64_tr_b16 a[24:25], v230 offset:16384
    v_mfma_f32_32x32x16_bf16 v[32:47], a[48:51], a[40:43], v[32:47]
    ds_read_b128 a[8:11], v226 offset:8192
    v_mfma_f32_32x32x16_bf16 v[96:111], a[52:55], a[40:43], v[96:111]
    ds_read_b64_tr_b16 a[26:27], v230 offset:18432
    v_mfma_f32_32x32x16_bf16 v[160:175], a[56:59], a[40:43], v[160:175]
    s_add_u32 s45, s58, 4194304
    buffer_load_dwordx4 v[252:255], v236, s[20:23], s45 offen
    v_mfma_f32_32x32x16_bf16 a[64:79], a[60:63], a[40:43], a[64:79]
    ds_read_b64_tr_b16 a[28:29], v231 offset:16384
    v_mfma_f32_32x32x16_bf16 v[48:63], a[48:51], a[44:47], v[48:63]
    ds_read_b128 a[12:15], v226 offset:12288
    v_mfma_f32_32x32x16_bf16 v[112:127], a[52:55], a[44:47], v[112:127]
    ds_read_b64_tr_b16 a[30:31], v231 offset:18432
    v_mfma_f32_32x32x16_bf16 v[176:191], a[56:59], a[44:47], v[176:191]
    v_add_u32 v226, s55, v226
    v_mfma_f32_32x32x16_bf16 a[80:95], a[60:63], a[44:47], a[80:95]
    s_waitcnt lgkmcnt(0)
    v_mfma_f32_32x32x16_bf16 v[0:15], a[16:19], a[0:3], v[0:15]
    ds_read_b64_tr_b16 a[48:49], v228 offset:24576
    s_add_u32 m0, s41, 4096
    s_add_u32 s44, s56, 36864
    buffer_load_dwordx4 v232, s[24:27], s44 offen lds
    v_mfma_f32_32x32x16_bf16 v[64:79], a[20:23], a[0:3], v[64:79]
    ds_read_b128 a[32:35], v227 offset:0
    v_mfma_f32_32x32x16_bf16 v[128:143], a[24:27], a[0:3], v[128:143]
    ds_read_b64_tr_b16 a[50:51], v228 offset:26624
    ds_read_b64_tr_b16 a[52:53], v229 offset:24576
    v_mfma_f32_32x32x16_bf16 v[192:207], a[28:31], a[0:3], v[192:207]
    s_add_u32 m0, s41, 5120
    s_add_u32 s44, s56, 46080
    buffer_load_dwordx4 v233, s[24:27], s44 offen lds
    v_mfma_f32_32x32x16_bf16 v[16:31], a[16:19], a[4:7], v[16:31]
    ds_read_b128 a[36:39], v227 offset:4096
    ds_read_b64_tr_b16 a[54:55], v229 offset:26624
    v_mfma_f32_32x32x16_bf16 v[80:95], a[20:23], a[4:7], v[80:95]
    ds_read_b64_tr_b16 a[56:57], v230 offset:24576
    v_mfma_f32_32x32x16_bf16 v[144:159], a[24:27], a[4:7], v[144:159]
    s_add_u32 m0, s41, 6144
    s_add_u32 s44, s56, 55296
    buffer_load_dwordx4 v232, s[24:27], s44 offen lds
    ds_read_b128 a[40:43], v227 offset:8192
    v_mfma_f32_32x32x16_bf16 v[208:223], a[28:31], a[4:7], v[208:223]
    ds_read_b64_tr_b16 a[58:59], v230 offset:26624
    v_mfma_f32_32x32x16_bf16 v[32:47], a[16:19], a[8:11], v[32:47]
    ds_read_b64_tr_b16 a[60:61], v231 offset:24576
    s_add_u32 m0, s41, 7168
    s_add_u32 s44, s56, 64512
    buffer_load_dwordx4 v233, s[24:27], s44 offen lds
    v_mfma_f32_32x32x16_bf16 v[96:111], a[20:23], a[8:11], v[96:111]
    ds_read_b128 a[44:47], v227 offset:12288
    v_mfma_f32_32x32x16_bf16 v[160:175], a[24:27], a[8:11], v[160:175]
    ds_read_b64_tr_b16 a[62:63], v231 offset:26624
    v_add_u32 v227, s55, v227
    v_mfma_f32_32x32x16_bf16 a[64:79], a[28:31], a[8:11], a[64:79]
    v_add_u32 v224, s55, v224
    v_mfma_f32_32x32x16_bf16 v[48:63], a[16:19], a[12:15], v[48:63]
    v_xor_b32 v228, 32768, v228
    v_xor_b32 v229, 32768, v229
    v_mfma_f32_32x32x16_bf16 v[112:127], a[20:23], a[12:15], v[112:127]
    v_xor_b32 v230, 32768, v230
    v_mfma_f32_32x32x16_bf16 v[176:191], a[24:27], a[12:15], v[176:191]
    v_xor_b32 v231, 32768, v231
    v_mfma_f32_32x32x16_bf16 a[80:95], a[28:31], a[12:15], a[80:95]
    s_waitcnt lgkmcnt(0)
    s_barrier
    v_mfma_f32_32x32x16_bf16 v[0:15], a[48:51], a[32:35], v[0:15]
    s_add_u32 m0, s43, 16384
    s_add_u32 s44, s57, 110592
    buffer_load_dwordx4 v234, s[28:31], s44 offen lds
    v_mfma_f32_32x32x16_bf16 v[64:79], a[52:55], a[32:35], v[64:79]
    v_mfma_f32_32x32x16_bf16 v[128:143], a[56:59], a[32:35], v[128:143]
    v_mfma_f32_32x32x16_bf16 v[192:207], a[60:63], a[32:35], v[192:207]
    v_mfma_f32_32x32x16_bf16 v[16:31], a[48:51], a[36:39], v[16:31]
    v_mfma_f32_32x32x16_bf16 v[80:95], a[52:55], a[36:39], v[80:95]
    s_add_u32 s57, s57, 221184
    s_xor_b32 s43, s43, 32768
    v_mfma_f32_32x32x16_bf16 v[144:159], a[56:59], a[36:39], v[144:159]
    v_mfma_f32_32x32x16_bf16 v[208:223], a[60:63], a[36:39], v[208:223]
    v_mfma_f32_32x32x16_bf16 v[32:47], a[48:51], a[40:43], v[32:47]
    v_mfma_f32_32x32x16_bf16 v[96:111], a[52:55], a[40:43], v[96:111]
    v_mfma_f32_32x32x16_bf16 v[160:175], a[56:59], a[40:43], v[160:175]
    s_add_u32 s56, s56, 128
    s_add_u32 s41, s41, 32768
    s_cmp_ge_u32 s41, 163840
    s_cselect_b32 s45, 98304, 0
    s_sub_u32 s41, s41, s45
    v_mfma_f32_32x32x16_bf16 a[64:79], a[60:63], a[40:43], a[64:79]
    v_mfma_f32_32x32x16_bf16 v[48:63], a[48:51], a[44:47], v[48:63]
    v_mfma_f32_32x32x16_bf16 v[112:127], a[52:55], a[44:47], v[112:127]
    v_mfma_f32_32x32x16_bf16 v[176:191], a[56:59], a[44:47], v[176:191]
    v_mfma_f32_32x32x16_bf16 a[80:95], a[60:63], a[44:47], a[80:95]
    s_add_u32 s60, s54, 0
    s_add_u32 s61, s54, 1024
    s_add_u32 s62, s54, 2048
    s_add_u32 s63, s54, 3072
    s_add_u32 s64, s54, 4096
    s_add_u32 s65, s54, 5120
    s_add_u32 s66, s54, 6144
    s_add_u32 s67, s54, 7168
    s_branch L_proj_B
L_proj_V:
    s_waitcnt vmcnt(6)
    s_barrier
    ds_read_b64_tr_b16 a[16:17], v228 offset:0
    ds_read_b128 a[0:3], v224 offset:0
    ds_read_b64_tr_b16 a[18:19], v228 offset:2048
    ds_read_b64_tr_b16 a[20:21], v229 offset:0
    ds_read_b128 a[4:7], v224 offset:4096
    ds_read_b64_tr_b16 a[22:23], v229 offset:2048
    ds_read_b64_tr_b16 a[24:25], v230 offset:0
    ds_read_b128 a[8:11], v224 offset:8192
    ds_read_b64_tr_b16 a[26:27], v230 offset:2048
    ds_read_b64_tr_b16 a[28:29], v231 offset:0
    ds_read_b128 a[12:15], v224 offset:12288
    ds_read_b64_tr_b16 a[30:31], v231 offset:2048
    s_waitcnt lgkmcnt(0)
    v_mfma_f32_32x32x16_bf16 v[0:15], a[0:3], a[16:19], 0
    s_add_u32 s47, s47, 32768
    s_mov_b32 s55, 32768
    s_cmp_eq_u32 s47, 163840
    s_cselect_b32 s55, -65536, s55
    s_cselect_b32 s47, 65536, s47
    s_add_u32 m0, s41, 4294934528
    s_add_u32 s44, s40, 4294967168
    buffer_load_dwordx4 v232, s[8:11], s44 offen lds
    v_mfma_f32_32x32x16_bf16 v[64:79], a[0:3], a[20:23], 0
    ds_read_b64_tr_b16 a[48:49], v228 offset:8192
    s_add_u32 m0, s41, 4294935552
    s_add_u32 s44, s40, 8064
    buffer_load_dwordx4 v233, s[8:11], s44 offen lds
    v_mfma_f32_32x32x16_bf16 v[128:143], a[0:3], a[24:27], 0
    ds_read_b128 a[32:35], v225 offset:0
    s_add_u32 m0, s41, 4294936576
    s_add_u32 s44, s40, 16256
    buffer_load_dwordx4 v232, s[8:11], s44 offen lds
    v_mfma_f32_32x32x16_bf16 v[192:207], a[0:3], a[28:31], 0
    ds_read_b64_tr_b16 a[50:51], v228 offset:10240
    v_mfma_f32_32x32x16_bf16 v[16:31], a[4:7], a[16:19], 0
    s_add_u32 m0, s41, 4294937600
    s_add_u32 s44, s40, 24448
    buffer_load_dwordx4 v233, s[8:11], s44 offen lds
    ds_read_b64_tr_b16 a[52:53], v229 offset:8192
    v_mfma_f32_32x32x16_bf16 v[80:95], a[4:7], a[20:23], 0
    s_add_u32 m0, s43, 32768
    s_add_u32 s44, s42, 4294443008
    buffer_load_dwordx4 v234, s[12:15], s44 offen lds
    ds_read_b128 a[36:39], v225 offset:4096
    v_mfma_f32_32x32x16_bf16 v[144:159], a[4:7], a[24:27], 0
    s_add_u32 m0, s43, 33792
    s_add_u32 s44, s42, 4294459392
    buffer_load_dwordx4 v235, s[12:15], s44 offen lds
    ds_read_b64_tr_b16 a[54:55], v229 offset:10240
    v_mfma_f32_32x32x16_bf16 v[208:223], a[4:7], a[28:31], 0
    s_add_u32 m0, s43, 34816
    s_add_u32 s44, s42, 4294475776
    buffer_load_dwordx4 v234, s[12:15], s44 offen lds
    v_mfma_f32_32x32x16_bf16 v[32:47], a[8:11], a[16:19], 0
    ds_read_b64_tr_b16 a[56:57], v230 offset:8192
    s_add_u32 m0, s43, 35840
    s_add_u32 s44, s42, 4294492160
    buffer_load_dwordx4 v235, s[12:15], s44 offen lds
    v_mfma_f32_32x32x16_bf16 v[96:111], a[8:11], a[20:23], 0
    ds_read_b128 a[40:43], v225 offset:8192
    s_add_u32 m0, s41, 0
    s_add_u32 s44, s40, 0
    buffer_load_dwordx4 v232, s[8:11], s44 offen lds
    v_mfma_f32_32x32x16_bf16 v[160:175], a[8:11], a[24:27], 0
    ds_read_b64_tr_b16 a[58:59], v230 offset:10240
    s_add_u32 m0, s41, 1024
    s_add_u32 s44, s40, 8192
    buffer_load_dwordx4 v233, s[8:11], s44 offen lds
    v_mfma_f32_32x32x16_bf16 a[64:79], a[8:11], a[28:31], 0
    ds_read_b64_tr_b16 a[60:61], v231 offset:8192
    v_mfma_f32_32x32x16_bf16 v[48:63], a[12:15], a[16:19], 0
    s_add_u32 m0, s41, 2048
    s_add_u32 s44, s40, 16384
    buffer_load_dwordx4 v232, s[8:11], s44 offen lds
    ds_read_b128 a[44:47], v225 offset:12288
    v_mfma_f32_32x32x16_bf16 v[112:127], a[12:15], a[20:23], 0
    s_add_u32 m0, s41, 3072
    s_add_u32 s44, s40, 24576
    buffer_load_dwordx4 v233, s[8:11], s44 offen lds
    ds_read_b64_tr_b16 a[62:63], v231 offset:10240
    v_mfma_f32_32x32x16_bf16 v[176:191], a[12:15], a[24:27], 0
    v_add_u32 v225, s55, v225
    v_mfma_f32_32x32x16_bf16 a[80:95], a[12:15], a[28:31], 0
    s_waitcnt vmcnt(14) lgkmcnt(0)
    s_barrier
    v_mfma_f32_32x32x16_bf16 v[0:15], a[32:35], a[48:51], v[0:15]
    ds_read_b64_tr_b16 a[16:17], v228 offset:16384
    s_add_u32 m0, s41, 4294938624
    s_add_u32 s44, s40, 32640
    buffer_load_dwordx4 v232, s[8:11], s44 offen lds
    v_mfma_f32_32x32x16_bf16 v[64:79], a[32:35], a[52:55], v[64:79]
    ds_read_b128 a[0:3], v226 offset:0
    v_mfma_f32_32x32x16_bf16 v[128:143], a[32:35], a[56:59], v[128:143]
    s_add_u32 m0, s41, 4294939648
    s_add_u32 s44, s40, 40832
    buffer_load_dwordx4 v233, s[8:11], s44 offen lds
    v_mfma_f32_32x32x16_bf16 v[192:207], a[32:35], a[60:63], v[192:207]
    ds_read_b64_tr_b16 a[18:19], v228 offset:18432
    ds_read_b64_tr_b16 a[20:21], v229 offset:16384
    v_mfma_f32_32x32x16_bf16 v[16:31], a[36:39], a[48:51], v[16:31]
    s_add_u32 m0, s41, 4294940672
    s_add_u32 s44, s40, 49024
    buffer_load_dwordx4 v232, s[8:11], s44 offen lds
    v_mfma_f32_32x32x16_bf16 v[80:95], a[36:39], a[52:55], v[80:95]
    ds_read_b128 a[4:7], v226 offset:4096
    v_mfma_f32_32x32x16_bf16 v[144:159], a[36:39], a[56:59], v[144:159]
    s_add_u32 m0, s41, 4294941696
    s_add_u32 s44, s40, 57216
    buffer_load_dwordx4 v233, s[8:11], s44 offen lds
    ds_read_b64_tr_b16 a[22:23], v229 offset:18432
    v_mfma_f32_32x32x16_bf16 v[208:223], a[36:39], a[60:63], v[208:223]
    ds_read_b64_tr_b16 a[24:25], v230 offset:16384
    v_mfma_f32_32x32x16_bf16 v[32:47], a[40:43], a[48:51], v[32:47]
    s_add_u32 m0, s43, 0
    s_add_u32 s44, s42, 0
    buffer_load_dwordx4 v234, s[12:15], s44 offen lds
    v_mfma_f32_32x32x16_bf16 v[96:111], a[40:43], a[52:55], v[96:111]
    ds_read_b128 a[8:11], v226 offset:8192
    s_add_u32 m0, s43, 1024
    s_add_u32 s44, s42, 16384
    buffer_load_dwordx4 v235, s[12:15], s44 offen lds
    v_mfma_f32_32x32x16_bf16 v[160:175], a[40:43], a[56:59], v[160:175]
    ds_read_b64_tr_b16 a[26:27], v230 offset:18432
    v_mfma_f32_32x32x16_bf16 a[64:79], a[40:43], a[60:63], a[64:79]
    ds_read_b64_tr_b16 a[28:29], v231 offset:16384
    v_mfma_f32_32x32x16_bf16 v[48:63], a[44:47], a[48:51], v[48:63]
    s_add_u32 m0, s43, 2048
    s_add_u32 s44, s42, 32768
    buffer_load_dwordx4 v234, s[12:15], s44 offen lds
    ds_read_b128 a[12:15], v226 offset:12288
    v_mfma_f32_32x32x16_bf16 v[112:127], a[44:47], a[52:55], v[112:127]
    s_add_u32 m0, s43, 3072
    s_add_u32 s44, s42, 49152
    buffer_load_dwordx4 v235, s[12:15], s44 offen lds
    v_mfma_f32_32x32x16_bf16 v[176:191], a[44:47], a[56:59], v[176:191]
    ds_read_b64_tr_b16 a[30:31], v231 offset:18432
    v_mfma_f32_32x32x16_bf16 a[80:95], a[44:47], a[60:63], a[80:95]
    v_add_u32 v226, s55, v226
    s_waitcnt lgkmcnt(0)
    v_mfma_f32_32x32x16_bf16 v[0:15], a[0:3], a[16:19], v[0:15]
    ds_read_b64_tr_b16 a[48:49], v228 offset:24576
    s_add_u32 m0, s43, 49152
    s_add_u32 s44, s42, 4294705152
    buffer_load_dwordx4 v234, s[12:15], s44 offen lds
    v_mfma_f32_32x32x16_bf16 v[64:79], a[0:3], a[20:23], v[64:79]
    ds_read_b128 a[32:35], v227 offset:0
    s_add_u32 m0, s43, 50176
    s_add_u32 s44, s42, 4294721536
    buffer_load_dwordx4 v235, s[12:15], s44 offen lds
    v_mfma_f32_32x32x16_bf16 v[128:143], a[0:3], a[24:27], v[128:143]
    ds_read_b64_tr_b16 a[50:51], v228 offset:26624
    ds_read_b64_tr_b16 a[52:53], v229 offset:24576
    v_mfma_f32_32x32x16_bf16 v[192:207], a[0:3], a[28:31], v[192:207]
    s_add_u32 m0, s43, 51200
    s_add_u32 s44, s42, 4294737920
    buffer_load_dwordx4 v234, s[12:15], s44 offen lds
    v_mfma_f32_32x32x16_bf16 v[16:31], a[4:7], a[16:19], v[16:31]
    ds_read_b128 a[36:39], v227 offset:4096
    s_add_u32 m0, s43, 52224
    s_add_u32 s44, s42, 4294754304
    buffer_load_dwordx4 v235, s[12:15], s44 offen lds
    v_mfma_f32_32x32x16_bf16 v[80:95], a[4:7], a[20:23], v[80:95]
    ds_read_b64_tr_b16 a[54:55], v229 offset:26624
    ds_read_b64_tr_b16 a[56:57], v230 offset:24576
    v_mfma_f32_32x32x16_bf16 v[144:159], a[4:7], a[24:27], v[144:159]
    s_add_u32 m0, s41, 4096
    s_add_u32 s44, s40, 32768
    buffer_load_dwordx4 v232, s[8:11], s44 offen lds
    ds_read_b128 a[40:43], v227 offset:8192
    v_mfma_f32_32x32x16_bf16 v[208:223], a[4:7], a[28:31], v[208:223]
    s_add_u32 m0, s41, 5120
    s_add_u32 s44, s40, 40960
    buffer_load_dwordx4 v233, s[8:11], s44 offen lds
    v_mfma_f32_32x32x16_bf16 v[32:47], a[8:11], a[16:19], v[32:47]
    ds_read_b64_tr_b16 a[58:59], v230 offset:26624
    ds_read_b64_tr_b16 a[60:61], v231 offset:24576
    v_mfma_f32_32x32x16_bf16 v[96:111], a[8:11], a[20:23], v[96:111]
    s_add_u32 m0, s41, 6144
    s_add_u32 s44, s40, 49152
    buffer_load_dwordx4 v232, s[8:11], s44 offen lds
    ds_read_b128 a[44:47], v227 offset:12288
    v_mfma_f32_32x32x16_bf16 v[160:175], a[8:11], a[24:27], v[160:175]
    s_add_u32 m0, s41, 7168
    s_add_u32 s44, s40, 57344
    buffer_load_dwordx4 v233, s[8:11], s44 offen lds
    ds_read_b64_tr_b16 a[62:63], v231 offset:26624
    v_mfma_f32_32x32x16_bf16 a[64:79], a[8:11], a[28:31], a[64:79]
    v_add_u32 v227, s55, v227
    v_mfma_f32_32x32x16_bf16 v[48:63], a[12:15], a[16:19], v[48:63]
    v_add_u32 v224, s55, v224
    v_xor_b32 v228, 32768, v228
    v_mfma_f32_32x32x16_bf16 v[112:127], a[12:15], a[20:23], v[112:127]
    v_xor_b32 v229, 32768, v229
    v_xor_b32 v230, 32768, v230
    v_mfma_f32_32x32x16_bf16 v[176:191], a[12:15], a[24:27], v[176:191]
    v_xor_b32 v231, 32768, v231
    v_mfma_f32_32x32x16_bf16 a[80:95], a[12:15], a[28:31], a[80:95]
    s_waitcnt vmcnt(12) lgkmcnt(0)
    s_barrier
    v_mfma_f32_32x32x16_bf16 v[0:15], a[32:35], a[48:51], v[0:15]
    ds_read_b64_tr_b16 a[16:17], v228 offset:0
    s_add_u32 m0, s43, 16384
    s_add_u32 s44, s42, 262144
    buffer_load_dwordx4 v234, s[12:15], s44 offen lds
    v_mfma_f32_32x32x16_bf16 v[64:79], a[32:35], a[52:55], v[64:79]
    ds_read_b128 a[0:3], v224 offset:0
    v_mfma_f32_32x32x16_bf16 v[128:143], a[32:35], a[56:59], v[128:143]
    ds_read_b64_tr_b16 a[18:19], v228 offset:2048
    v_mfma_f32_32x32x16_bf16 v[192:207], a[32:35], a[60:63], v[192:207]
    ds_read_b64_tr_b16 a[20:21], v229 offset:0
    v_mfma_f32_32x32x16_bf16 v[16:31], a[36:39], a[48:51], v[16:31]
    s_add_u32 m0, s43, 17408
    s_add_u32 s44, s42, 278528
    buffer_load_dwordx4 v235, s[12:15], s44 offen lds
    v_mfma_f32_32x32x16_bf16 v[80:95], a[36:39], a[52:55], v[80:95]
    ds_read_b128 a[4:7], v224 offset:4096
    v_mfma_f32_32x32x16_bf16 v[144:159], a[36:39], a[56:59], v[144:159]
    ds_read_b64_tr_b16 a[22:23], v229 offset:2048
    v_mfma_f32_32x32x16_bf16 v[208:223], a[36:39], a[60:63], v[208:223]
    ds_read_b64_tr_b16 a[24:25], v230 offset:0
    v_mfma_f32_32x32x16_bf16 v[32:47], a[40:43], a[48:51], v[32:47]
    s_add_u32 m0, s43, 18432
    s_add_u32 s44, s42, 294912
    buffer_load_dwordx4 v234, s[12:15], s44 offen lds
    ds_read_b128 a[8:11], v224 offset:8192
    v_mfma_f32_32x32x16_bf16 v[96:111], a[40:43], a[52:55], v[96:111]
    ds_read_b64_tr_b16 a[26:27], v230 offset:2048
    v_mfma_f32_32x32x16_bf16 v[160:175], a[40:43], a[56:59], v[160:175]
    ds_read_b64_tr_b16 a[28:29], v231 offset:0
    v_mfma_f32_32x32x16_bf16 a[64:79], a[40:43], a[60:63], a[64:79]
    s_add_u32 m0, s43, 19456
    s_add_u32 s44, s42, 311296
    buffer_load_dwordx4 v235, s[12:15], s44 offen lds
    v_mfma_f32_32x32x16_bf16 v[48:63], a[44:47], a[48:51], v[48:63]
    ds_read_b128 a[12:15], v224 offset:12288
    v_mfma_f32_32x32x16_bf16 v[112:127], a[44:47], a[52:55], v[112:127]
    ds_read_b64_tr_b16 a[30:31], v231 offset:2048
    v_mfma_f32_32x32x16_bf16 v[176:191], a[44:47], a[56:59], v[176:191]
    s_add_u32 s42, s42, 524288
    s_xor_b32 s43, s43, 32768
    v_mfma_f32_32x32x16_bf16 a[80:95], a[44:47], a[60:63], a[80:95]
    s_add_u32 s40, s40, 128
    s_add_u32 s41, s41, 32768
    s_cmp_ge_u32 s41, 163840
    s_cselect_b32 s45, 98304, 0
    s_sub_u32 s41, s41, s45
    s_waitcnt lgkmcnt(0)
    v_mfma_f32_32x32x16_bf16 v[0:15], a[0:3], a[16:19], v[0:15]
    s_add_u32 s47, s47, 32768
    s_mov_b32 s55, 32768
    s_cmp_eq_u32 s47, 163840
    s_cselect_b32 s55, -65536, s55
    s_cselect_b32 s47, 65536, s47
    ds_read_b64_tr_b16 a[48:49], v228 offset:8192
    v_mfma_f32_32x32x16_bf16 v[64:79], a[0:3], a[20:23], v[64:79]
    s_add_u32 m0, s41, 0
    s_add_u32 s44, s40, 0
    buffer_load_dwordx4 v232, s[8:11], s44 offen lds
    v_mfma_f32_32x32x16_bf16 v[128:143], a[0:3], a[24:27], v[128:143]
    ds_read_b128 a[32:35], v225 offset:0
    v_mfma_f32_32x32x16_bf16 v[192:207], a[0:3], a[28:31], v[192:207]
    ds_read_b64_tr_b16 a[50:51], v228 offset:10240
    v_mfma_f32_32x32x16_bf16 v[16:31], a[4:7], a[16:19], v[16:31]
    ds_read_b64_tr_b16 a[52:53], v229 offset:8192
    v_mfma_f32_32x32x16_bf16 v[80:95], a[4:7], a[20:23], v[80:95]
    s_add_u32 m0, s41, 1024
    s_add_u32 s44, s40, 8192
    buffer_load_dwordx4 v233, s[8:11], s44 offen lds
    ds_read_b128 a[36:39], v225 offset:4096
    v_mfma_f32_32x32x16_bf16 v[144:159], a[4:7], a[24:27], v[144:159]
    ds_read_b64_tr_b16 a[54:55], v229 offset:10240
    v_mfma_f32_32x32x16_bf16 v[208:223], a[4:7], a[28:31], v[208:223]
    ds_read_b64_tr_b16 a[56:57], v230 offset:8192
    v_mfma_f32_32x32x16_bf16 v[32:47], a[8:11], a[16:19], v[32:47]
    s_add_u32 m0, s41, 2048
    s_add_u32 s44, s40, 16384
    buffer_load_dwordx4 v232, s[8:11], s44 offen lds
    v_mfma_f32_32x32x16_bf16 v[96:111], a[8:11], a[20:23], v[96:111]
    ds_read_b128 a[40:43], v225 offset:8192
    v_mfma_f32_32x32x16_bf16 v[160:175], a[8:11], a[24:27], v[160:175]
    ds_read_b64_tr_b16 a[58:59], v230 offset:10240
    ds_read_b64_tr_b16 a[60:61], v231 offset:8192
    v_mfma_f32_32x32x16_bf16 a[64:79], a[8:11], a[28:31], a[64:79]
    s_add_u32 m0, s41, 3072
    s_add_u32 s44, s40, 24576
    buffer_load_dwordx4 v233, s[8:11], s44 offen lds
    v_mfma_f32_32x32x16_bf16 v[48:63], a[12:15], a[16:19], v[48:63]
    ds_read_b128 a[44:47], v225 offset:12288
    v_mfma_f32_32x32x16_bf16 v[112:127], a[12:15], a[20:23], v[112:127]
    ds_read_b64_tr_b16 a[62:63], v231 offset:10240
    v_mfma_f32_32x32x16_bf16 v[176:191], a[12:15], a[24:27], v[176:191]
    v_add_u32 v225, s55, v225
    v_mfma_f32_32x32x16_bf16 a[80:95], a[12:15], a[28:31], a[80:95]
    s_waitcnt vmcnt(12) lgkmcnt(0)
    s_barrier
    v_mfma_f32_32x32x16_bf16 v[0:15], a[32:35], a[48:51], v[0:15]
    ds_read_b64_tr_b16 a[16:17], v228 offset:16384
    s_add_u32 m0, s43, 0
    s_add_u32 s44, s42, 0
    buffer_load_dwordx4 v234, s[12:15], s44 offen lds
    v_mfma_f32_32x32x16_bf16 v[64:79], a[32:35], a[52:55], v[64:79]
    ds_read_b128 a[0:3], v226 offset:0
    v_mfma_f32_32x32x16_bf16 v[128:143], a[32:35], a[56:59], v[128:143]
    ds_read_b64_tr_b16 a[18:19], v228 offset:18432
    v_mfma_f32_32x32x16_bf16 v[192:207], a[32:35], a[60:63], v[192:207]
    ds_read_b64_tr_b16 a[20:21], v229 offset:16384
    v_mfma_f32_32x32x16_bf16 v[16:31], a[36:39], a[48:51], v[16:31]
    s_add_u32 m0, s43, 1024
    s_add_u32 s44, s42, 16384
    buffer_load_dwordx4 v235, s[12:15], s44 offen lds
    v_mfma_f32_32x32x16_bf16 v[80:95], a[36:39], a[52:55], v[80:95]
    ds_read_b128 a[4:7], v226 offset:4096
    v_mfma_f32_32x32x16_bf16 v[144:159], a[36:39], a[56:59], v[144:159]
    ds_read_b64_tr_b16 a[22:23], v229 offset:18432
    v_mfma_f32_32x32x16_bf16 v[208:223], a[36:39], a[60:63], v[208:223]
    s_add_u32 m0, s43, 2048
    s_add_u32 s44, s42, 32768
    buffer_load_dwordx4 v234, s[12:15], s44 offen lds
    v_mfma_f32_32x32x16_bf16 v[32:47], a[40:43], a[48:51], v[32:47]
    ds_read_b64_tr_b16 a[24:25], v230 offset:16384
    ds_read_b128 a[8:11], v226 offset:8192
    v_mfma_f32_32x32x16_bf16 v[96:111], a[40:43], a[52:55], v[96:111]
    s_add_u32 m0, s43, 3072
    s_add_u32 s44, s42, 49152
    buffer_load_dwordx4 v235, s[12:15], s44 offen lds
    v_mfma_f32_32x32x16_bf16 v[160:175], a[40:43], a[56:59], v[160:175]
    ds_read_b64_tr_b16 a[26:27], v230 offset:18432
    v_mfma_f32_32x32x16_bf16 a[64:79], a[40:43], a[60:63], a[64:79]
    ds_read_b64_tr_b16 a[28:29], v231 offset:16384
    v_mfma_f32_32x32x16_bf16 v[48:63], a[44:47], a[48:51], v[48:63]
    ds_read_b128 a[12:15], v226 offset:12288
    v_mfma_f32_32x32x16_bf16 v[112:127], a[44:47], a[52:55], v[112:127]
    s_add_u32 s45, s58, 0
    buffer_load_dwordx4 v[252:255], v236, s[24:27], s45 offen
    v_mfma_f32_32x32x16_bf16 v[176:191], a[44:47], a[56:59], v[176:191]
    ds_read_b64_tr_b16 a[30:31], v231 offset:18432
    v_mfma_f32_32x32x16_bf16 a[80:95], a[44:47], a[60:63], a[80:95]
    v_add_u32 v226, s55, v226
    s_waitcnt lgkmcnt(0)
    v_mfma_f32_32x32x16_bf16 v[0:15], a[0:3], a[16:19], v[0:15]
    ds_read_b64_tr_b16 a[48:49], v228 offset:24576
    s_add_u32 m0, s41, 4096
    s_add_u32 s44, s40, 32768
    buffer_load_dwordx4 v232, s[8:11], s44 offen lds
    v_mfma_f32_32x32x16_bf16 v[64:79], a[0:3], a[20:23], v[64:79]
    ds_read_b128 a[32:35], v227 offset:0
    v_mfma_f32_32x32x16_bf16 v[128:143], a[0:3], a[24:27], v[128:143]
    ds_read_b64_tr_b16 a[50:51], v228 offset:26624
    ds_read_b64_tr_b16 a[52:53], v229 offset:24576
    v_mfma_f32_32x32x16_bf16 v[192:207], a[0:3], a[28:31], v[192:207]
    s_add_u32 m0, s41, 5120
    s_add_u32 s44, s40, 40960
    buffer_load_dwordx4 v233, s[8:11], s44 offen lds
    v_mfma_f32_32x32x16_bf16 v[16:31], a[4:7], a[16:19], v[16:31]
    ds_read_b128 a[36:39], v227 offset:4096
    ds_read_b64_tr_b16 a[54:55], v229 offset:26624
    v_mfma_f32_32x32x16_bf16 v[80:95], a[4:7], a[20:23], v[80:95]
    ds_read_b64_tr_b16 a[56:57], v230 offset:24576
    v_mfma_f32_32x32x16_bf16 v[144:159], a[4:7], a[24:27], v[144:159]
    s_add_u32 m0, s41, 6144
    s_add_u32 s44, s40, 49152
    buffer_load_dwordx4 v232, s[8:11], s44 offen lds
    ds_read_b128 a[40:43], v227 offset:8192
    v_mfma_f32_32x32x16_bf16 v[208:223], a[4:7], a[28:31], v[208:223]
    ds_read_b64_tr_b16 a[58:59], v230 offset:26624
    v_mfma_f32_32x32x16_bf16 v[32:47], a[8:11], a[16:19], v[32:47]
    ds_read_b64_tr_b16 a[60:61], v231 offset:24576
    s_add_u32 m0, s41, 7168
    s_add_u32 s44, s40, 57344
    buffer_load_dwordx4 v233, s[8:11], s44 offen lds
    v_mfma_f32_32x32x16_bf16 v[96:111], a[8:11], a[20:23], v[96:111]
    ds_read_b128 a[44:47], v227 offset:12288
    v_mfma_f32_32x32x16_bf16 v[160:175], a[8:11], a[24:27], v[160:175]
    ds_read_b64_tr_b16 a[62:63], v231 offset:26624
    v_add_u32 v227, s55, v227
    v_mfma_f32_32x32x16_bf16 a[64:79], a[8:11], a[28:31], a[64:79]
    v_add_u32 v224, s55, v224
    v_mfma_f32_32x32x16_bf16 v[48:63], a[12:15], a[16:19], v[48:63]
    v_xor_b32 v228, 32768, v228
    v_xor_b32 v229, 32768, v229
    v_mfma_f32_32x32x16_bf16 v[112:127], a[12:15], a[20:23], v[112:127]
    v_xor_b32 v230, 32768, v230
    v_mfma_f32_32x32x16_bf16 v[176:191], a[12:15], a[24:27], v[176:191]
    v_xor_b32 v231, 32768, v231
    v_mfma_f32_32x32x16_bf16 a[80:95], a[12:15], a[28:31], a[80:95]
    s_waitcnt vmcnt(17) lgkmcnt(0)
    s_barrier
    v_mfma_f32_32x32x16_bf16 v[0:15], a[32:35], a[48:51], v[0:15]
    ds_read_b64_tr_b16 a[16:17], v228 offset:0
    s_add_u32 m0, s43, 16384
    s_add_u32 s44, s42, 262144
    buffer_load_dwordx4 v234, s[12:15], s44 offen lds
    v_mfma_f32_32x32x16_bf16 v[64:79], a[32:35], a[52:55], v[64:79]
    ds_read_b128 a[0:3], v224 offset:0
    v_mfma_f32_32x32x16_bf16 v[128:143], a[32:35], a[56:59], v[128:143]
    ds_read_b64_tr_b16 a[18:19], v228 offset:2048
    v_mfma_f32_32x32x16_bf16 v[192:207], a[32:35], a[60:63], v[192:207]
    ds_read_b64_tr_b16 a[20:21], v229 offset:0
    v_mfma_f32_32x32x16_bf16 v[16:31], a[36:39], a[48:51], v[16:31]
    s_add_u32 m0, s43, 17408
    s_add_u32 s44, s42, 278528
    buffer_load_dwordx4 v235, s[12:15], s44 offen lds
    v_mfma_f32_32x32x16_bf16 v[80:95], a[36:39], a[52:55], v[80:95]
    ds_read_b128 a[4:7], v224 offset:4096
    ds_read_b64_tr_b16 a[22:23], v229 offset:2048
    v_mfma_f32_32x32x16_bf16 v[144:159], a[36:39], a[56:59], v[144:159]
    s_add_u32 m0, s43, 18432
    s_add_u32 s44, s42, 294912
    buffer_load_dwordx4 v234, s[12:15], s44 offen lds
    v_mfma_f32_32x32x16_bf16 v[208:223], a[36:39], a[60:63], v[208:223]
    ds_read_b64_tr_b16 a[24:25], v230 offset:0
    v_mfma_f32_32x32x16_bf16 v[32:47], a[40:43], a[48:51], v[32:47]
    ds_read_b128 a[8:11], v224 offset:8192
    v_mfma_f32_32x32x16_bf16 v[96:111], a[40:43], a[52:55], v[96:111]
    s_add_u32 m0, s43, 19456
    s_add_u32 s44, s42, 311296
    buffer_load_dwordx4 v235, s[12:15], s44 offen lds
    v_mfma_f32_32x32x16_bf16 v[160:175], a[40:43], a[56:59], v[160:175]
    ds_read_b64_tr_b16 a[26:27], v230 offset:2048
    ds_read_b64_tr_b16 a[28:29], v231 offset:0
    v_mfma_f32_32x32x16_bf16 a[64:79], a[40:43], a[60:63], a[64:79]
    ds_read_b128 a[12:15], v224 offset:12288
    v_mfma_f32_32x32x16_bf16 v[48:63], a[44:47], a[48:51], v[48:63]
    s_add_u32 s45, s58, 0
    buffer_load_dwordx4 v[252:255], v236, s[28:31], s45 offen
    v_mfma_f32_32x32x16_bf16 v[112:127], a[44:47], a[52:55], v[112:127]
    ds_read_b64_tr_b16 a[30:31], v231 offset:2048
    v_mfma_f32_32x32x16_bf16 v[176:191], a[44:47], a[56:59], v[176:191]
    s_add_u32 s42, s42, 524288
    s_xor_b32 s43, s43, 32768
    v_mfma_f32_32x32x16_bf16 a[80:95], a[44:47], a[60:63], a[80:95]
    s_add_u32 s40, s40, 128
    s_add_u32 s41, s41, 32768
    s_cmp_ge_u32 s41, 163840
    s_cselect_b32 s45, 98304, 0
    s_sub_u32 s41, s41, s45
    s_waitcnt lgkmcnt(0)
    v_mfma_f32_32x32x16_bf16 v[0:15], a[0:3], a[16:19], v[0:15]
    s_add_u32 s47, s47, 32768
    s_mov_b32 s55, 32768
    s_cmp_eq_u32 s47, 163840
    s_cselect_b32 s55, -65536, s55
    s_cselect_b32 s47, 65536, s47
    ds_read_b64_tr_b16 a[48:49], v228 offset:8192
    v_mfma_f32_32x32x16_bf16 v[64:79], a[0:3], a[20:23], v[64:79]
    s_add_u32 m0, s41, 0
    s_add_u32 s44, s40, 0
    buffer_load_dwordx4 v232, s[8:11], s44 offen lds
    v_mfma_f32_32x32x16_bf16 v[128:143], a[0:3], a[24:27], v[128:143]
    ds_read_b128 a[32:35], v225 offset:0
    v_mfma_f32_32x32x16_bf16 v[192:207], a[0:3], a[28:31], v[192:207]
    ds_read_b64_tr_b16 a[50:51], v228 offset:10240
    v_mfma_f32_32x32x16_bf16 v[16:31], a[4:7], a[16:19], v[16:31]
    ds_read_b64_tr_b16 a[52:53], v229 offset:8192
    v_mfma_f32_32x32x16_bf16 v[80:95], a[4:7], a[20:23], v[80:95]
    s_add_u32 m0, s41, 1024
    s_add_u32 s44, s40, 8192
    buffer_load_dwordx4 v233, s[8:11], s44 offen lds
    ds_read_b128 a[36:39], v225 offset:4096
    v_mfma_f32_32x32x16_bf16 v[144:159], a[4:7], a[24:27], v[144:159]
    ds_read_b64_tr_b16 a[54:55], v229 offset:10240
    v_mfma_f32_32x32x16_bf16 v[208:223], a[4:7], a[28:31], v[208:223]
    ds_read_b64_tr_b16 a[56:57], v230 offset:8192
    v_mfma_f32_32x32x16_bf16 v[32:47], a[8:11], a[16:19], v[32:47]
    s_add_u32 m0, s41, 2048
    s_add_u32 s44, s40, 16384
    buffer_load_dwordx4 v232, s[8:11], s44 offen lds
    v_mfma_f32_32x32x16_bf16 v[96:111], a[8:11], a[20:23], v[96:111]
    ds_read_b128 a[40:43], v225 offset:8192
    v_mfma_f32_32x32x16_bf16 v[160:175], a[8:11], a[24:27], v[160:175]
    ds_read_b64_tr_b16 a[58:59], v230 offset:10240
    ds_read_b64_tr_b16 a[60:61], v231 offset:8192
    v_mfma_f32_32x32x16_bf16 a[64:79], a[8:11], a[28:31], a[64:79]
    s_add_u32 m0, s41, 3072
    s_add_u32 s44, s40, 24576
    buffer_load_dwordx4 v233, s[8:11], s44 offen lds
    v_mfma_f32_32x32x16_bf16 v[48:63], a[12:15], a[16:19], v[48:63]
    ds_read_b128 a[44:47], v225 offset:12288
    v_mfma_f32_32x32x16_bf16 v[112:127], a[12:15], a[20:23], v[112:127]
    ds_read_b64_tr_b16 a[62:63], v231 offset:10240
    v_mfma_f32_32x32x16_bf16 v[176:191], a[12:15], a[24:27], v[176:191]
    v_add_u32 v225, s55, v225
    v_mfma_f32_32x32x16_bf16 a[80:95], a[12:15], a[28:31], a[80:95]
    s_waitcnt vmcnt(22) lgkmcnt(0)
    s_barrier
    v_mfma_f32_32x32x16_bf16 v[0:15], a[32:35], a[48:51], v[0:15]
    ds_read_b64_tr_b16 a[16:17], v228 offset:16384
    s_add_u32 m0, s43, 0
    s_add_u32 s44, s42, 0
    buffer_load_dwordx4 v234, s[12:15], s44 offen lds
    v_mfma_f32_32x32x16_bf16 v[64:79], a[32:35], a[52:55], v[64:79]
    ds_read_b128 a[0:3], v226 offset:0
    v_mfma_f32_32x32x16_bf16 v[128:143], a[32:35], a[56:59], v[128:143]
    ds_read_b64_tr_b16 a[18:19], v228 offset:18432
    v_mfma_f32_32x32x16_bf16 v[192:207], a[32:35], a[60:63], v[192:207]
    ds_read_b64_tr_b16 a[20:21], v229 offset:16384
    v_mfma_f32_32x32x16_bf16 v[16:31], a[36:39], a[48:51], v[16:31]
    s_add_u32 m0, s43, 1024
    s_add_u32 s44, s42, 16384
    buffer_load_dwordx4 v235, s[12:15], s44 offen lds
    v_mfma_f32_32x32x16_bf16 v[80:95], a[36:39], a[52:55], v[80:95]
    ds_read_b128 a[4:7], v226 offset:4096
    v_mfma_f32_32x32x16_bf16 v[144:159], a[36:39], a[56:59], v[144:159]
    ds_read_b64_tr_b16 a[22:23], v229 offset:18432
    v_mfma_f32_32x32x16_bf16 v[208:223], a[36:39], a[60:63], v[208:223]
    s_add_u32 m0, s43, 2048
    s_add_u32 s44, s42, 32768
    buffer_load_dwordx4 v234, s[12:15], s44 offen lds
    v_mfma_f32_32x32x16_bf16 v[32:47], a[40:43], a[48:51], v[32:47]
    ds_read_b64_tr_b16 a[24:25], v230 offset:16384
    ds_read_b128 a[8:11], v226 offset:8192
    v_mfma_f32_32x32x16_bf16 v[96:111], a[40:43], a[52:55], v[96:111]
    s_add_u32 m0, s43, 3072
    s_add_u32 s44, s42, 49152
    buffer_load_dwordx4 v235, s[12:15], s44 offen lds
    v_mfma_f32_32x32x16_bf16 v[160:175], a[40:43], a[56:59], v[160:175]
    ds_read_b64_tr_b16 a[26:27], v230 offset:18432
    v_mfma_f32_32x32x16_bf16 a[64:79], a[40:43], a[60:63], a[64:79]
    ds_read_b64_tr_b16 a[28:29], v231 offset:16384
    v_mfma_f32_32x32x16_bf16 v[48:63], a[44:47], a[48:51], v[48:63]
    ds_read_b128 a[12:15], v226 offset:12288
    v_mfma_f32_32x32x16_bf16 v[112:127], a[44:47], a[52:55], v[112:127]
    s_add_u32 s45, s58, 1048576
    buffer_load_dwordx4 v[252:255], v236, s[24:27], s45 offen
    v_mfma_f32_32x32x16_bf16 v[176:191], a[44:47], a[56:59], v[176:191]
    ds_read_b64_tr_b16 a[30:31], v231 offset:18432
    v_mfma_f32_32x32x16_bf16 a[80:95], a[44:47], a[60:63], a[80:95]
    v_add_u32 v226, s55, v226
    s_waitcnt lgkmcnt(0)
    v_mfma_f32_32x32x16_bf16 v[0:15], a[0:3], a[16:19], v[0:15]
    ds_read_b64_tr_b16 a[48:49], v228 offset:24576
    s_add_u32 m0, s41, 4096
    s_add_u32 s44, s40, 32768
    buffer_load_dwordx4 v232, s[8:11], s44 offen lds
    v_mfma_f32_32x32x16_bf16 v[64:79], a[0:3], a[20:23], v[64:79]
    ds_read_b128 a[32:35], v227 offset:0
    v_mfma_f32_32x32x16_bf16 v[128:143], a[0:3], a[24:27], v[128:143]
    ds_read_b64_tr_b16 a[50:51], v228 offset:26624
    ds_read_b64_tr_b16 a[52:53], v229 offset:24576
    v_mfma_f32_32x32x16_bf16 v[192:207], a[0:3], a[28:31], v[192:207]
    s_add_u32 m0, s41, 5120
    s_add_u32 s44, s40, 40960
    buffer_load_dwordx4 v233, s[8:11], s44 offen lds
    v_mfma_f32_32x32x16_bf16 v[16:31], a[4:7], a[16:19], v[16:31]
    ds_read_b128 a[36:39], v227 offset:4096
    ds_read_b64_tr_b16 a[54:55], v229 offset:26624
    v_mfma_f32_32x32x16_bf16 v[80:95], a[4:7], a[20:23], v[80:95]
    ds_read_b64_tr_b16 a[56:57], v230 offset:24576
    v_mfma_f32_32x32x16_bf16 v[144:159], a[4:7], a[24:27], v[144:159]
    s_add_u32 m0, s41, 6144
    s_add_u32 s44, s40, 49152
    buffer_load_dwordx4 v232, s[8:11], s44 offen lds
    ds_read_b128 a[40:43], v227 offset:8192
    v_mfma_f32_32x32x16_bf16 v[208:223], a[4:7], a[28:31], v[208:223]
    ds_read_b64_tr_b16 a[58:59], v230 offset:26624
    v_mfma_f32_32x32x16_bf16 v[32:47], a[8:11], a[16:19], v[32:47]
    ds_read_b64_tr_b16 a[60:61], v231 offset:24576
    s_add_u32 m0, s41, 7168
    s_add_u32 s44, s40, 57344
    buffer_load_dwordx4 v233, s[8:11], s44 offen lds
    v_mfma_f32_32x32x16_bf16 v[96:111], a[8:11], a[20:23], v[96:111]
    ds_read_b128 a[44:47], v227 offset:12288
    v_mfma_f32_32x32x16_bf16 v[160:175], a[8:11], a[24:27], v[160:175]
    ds_read_b64_tr_b16 a[62:63], v231 offset:26624
    v_add_u32 v227, s55, v227
    v_mfma_f32_32x32x16_bf16 a[64:79], a[8:11], a[28:31], a[64:79]
    v_add_u32 v224, s55, v224
    v_mfma_f32_32x32x16_bf16 v[48:63], a[12:15], a[16:19], v[48:63]
    v_xor_b32 v228, 32768, v228
    v_xor_b32 v229, 32768, v229
    v_mfma_f32_32x32x16_bf16 v[112:127], a[12:15], a[20:23], v[112:127]
    v_xor_b32 v230, 32768, v230
    v_mfma_f32_32x32x16_bf16 v[176:191], a[12:15], a[24:27], v[176:191]
    v_xor_b32 v231, 32768, v231
    v_mfma_f32_32x32x16_bf16 a[80:95], a[12:15], a[28:31], a[80:95]
    s_waitcnt vmcnt(18) lgkmcnt(0)
    s_barrier
    v_mfma_f32_32x32x16_bf16 v[0:15], a[32:35], a[48:51], v[0:15]
    ds_read_b64_tr_b16 a[16:17], v228 offset:0
    s_add_u32 m0, s43, 16384
    s_add_u32 s44, s42, 262144
    buffer_load_dwordx4 v234, s[12:15], s44 offen lds
    v_mfma_f32_32x32x16_bf16 v[64:79], a[32:35], a[52:55], v[64:79]
    ds_read_b128 a[0:3], v224 offset:0
    v_mfma_f32_32x32x16_bf16 v[128:143], a[32:35], a[56:59], v[128:143]
    ds_read_b64_tr_b16 a[18:19], v228 offset:2048
    v_mfma_f32_32x32x16_bf16 v[192:207], a[32:35], a[60:63], v[192:207]
    ds_read_b64_tr_b16 a[20:21], v229 offset:0
    v_mfma_f32_32x32x16_bf16 v[16:31], a[36:39], a[48:51], v[16:31]
    s_add_u32 m0, s43, 17408
    s_add_u32 s44, s42, 278528
    buffer_load_dwordx4 v235, s[12:15], s44 offen lds
    v_mfma_f32_32x32x16_bf16 v[80:95], a[36:39], a[52:55], v[80:95]
    ds_read_b128 a[4:7], v224 offset:4096
    ds_read_b64_tr_b16 a[22:23], v229 offset:2048
    v_mfma_f32_32x32x16_bf16 v[144:159], a[36:39], a[56:59], v[144:159]
    s_add_u32 m0, s43, 18432
    s_add_u32 s44, s42, 294912
    buffer_load_dwordx4 v234, s[12:15], s44 offen lds
    v_mfma_f32_32x32x16_bf16 v[208:223], a[36:39], a[60:63], v[208:223]
    ds_read_b64_tr_b16 a[24:25], v230 offset:0
    v_mfma_f32_32x32x16_bf16 v[32:47], a[40:43], a[48:51], v[32:47]
    ds_read_b128 a[8:11], v224 offset:8192
    v_mfma_f32_32x32x16_bf16 v[96:111], a[40:43], a[52:55], v[96:111]
    s_add_u32 m0, s43, 19456
    s_add_u32 s44, s42, 311296
    buffer_load_dwordx4 v235, s[12:15], s44 offen lds
    v_mfma_f32_32x32x16_bf16 v[160:175], a[40:43], a[56:59], v[160:175]
    ds_read_b64_tr_b16 a[26:27], v230 offset:2048
    ds_read_b64_tr_b16 a[28:29], v231 offset:0
    v_mfma_f32_32x32x16_bf16 a[64:79], a[40:43], a[60:63], a[64:79]
    ds_read_b128 a[12:15], v224 offset:12288
    v_mfma_f32_32x32x16_bf16 v[48:63], a[44:47], a[48:51], v[48:63]
    s_add_u32 s45, s58, 1048576
    buffer_load_dwordx4 v[252:255], v236, s[28:31], s45 offen
    v_mfma_f32_32x32x16_bf16 v[112:127], a[44:47], a[52:55], v[112:127]
    ds_read_b64_tr_b16 a[30:31], v231 offset:2048
    v_mfma_f32_32x32x16_bf16 v[176:191], a[44:47], a[56:59], v[176:191]
    s_add_u32 s42, s42, 524288
    s_xor_b32 s43, s43, 32768
    v_mfma_f32_32x32x16_bf16 a[80:95], a[44:47], a[60:63], a[80:95]
    s_add_u32 s40, s40, 128
    s_add_u32 s41, s41, 32768
    s_cmp_ge_u32 s41, 163840
    s_cselect_b32 s45, 98304, 0
    s_sub_u32 s41, s41, s45
    s_waitcnt lgkmcnt(0)
    v_mfma_f32_32x32x16_bf16 v[0:15], a[0:3], a[16:19], v[0:15]
    s_add_u32 s47, s47, 32768
    s_mov_b32 s55, 32768
    s_cmp_eq_u32 s47, 163840
    s_cselect_b32 s55, -65536, s55
    s_cselect_b32 s47, 65536, s47
    ds_read_b64_tr_b16 a[48:49], v228 offset:8192
    v_mfma_f32_32x32x16_bf16 v[64:79], a[0:3], a[20:23], v[64:79]
    s_add_u32 m0, s41, 0
    s_add_u32 s44, s40, 0
    buffer_load_dwordx4 v232, s[8:11], s44 offen lds
    v_mfma_f32_32x32x16_bf16 v[128:143], a[0:3], a[24:27], v[128:143]
    ds_read_b128 a[32:35], v225 offset:0
    v_mfma_f32_32x32x16_bf16 v[192:207], a[0:3], a[28:31], v[192:207]
    ds_read_b64_tr_b16 a[50:51], v228 offset:10240
    v_mfma_f32_32x32x16_bf16 v[16:31], a[4:7], a[16:19], v[16:31]
    ds_read_b64_tr_b16 a[52:53], v229 offset:8192
    v_mfma_f32_32x32x16_bf16 v[80:95], a[4:7], a[20:23], v[80:95]
    s_add_u32 m0, s41, 1024
    s_add_u32 s44, s40, 8192
    buffer_load_dwordx4 v233, s[8:11], s44 offen lds
    ds_read_b128 a[36:39], v225 offset:4096
    v_mfma_f32_32x32x16_bf16 v[144:159], a[4:7], a[24:27], v[144:159]
    ds_read_b64_tr_b16 a[54:55], v229 offset:10240
    v_mfma_f32_32x32x16_bf16 v[208:223], a[4:7], a[28:31], v[208:223]
    ds_read_b64_tr_b16 a[56:57], v230 offset:8192
    v_mfma_f32_32x32x16_bf16 v[32:47], a[8:11], a[16:19], v[32:47]
    s_add_u32 m0, s41, 2048
    s_add_u32 s44, s40, 16384
    buffer_load_dwordx4 v232, s[8:11], s44 offen lds
    v_mfma_f32_32x32x16_bf16 v[96:111], a[8:11], a[20:23], v[96:111]
    ds_read_b128 a[40:43], v225 offset:8192
    v_mfma_f32_32x32x16_bf16 v[160:175], a[8:11], a[24:27], v[160:175]
    ds_read_b64_tr_b16 a[58:59], v230 offset:10240
    ds_read_b64_tr_b16 a[60:61], v231 offset:8192
    v_mfma_f32_32x32x16_bf16 a[64:79], a[8:11], a[28:31], a[64:79]
    s_add_u32 m0, s41, 3072
    s_add_u32 s44, s40, 24576
    buffer_load_dwordx4 v233, s[8:11], s44 offen lds
    v_mfma_f32_32x32x16_bf16 v[48:63], a[12:15], a[16:19], v[48:63]
    ds_read_b128 a[44:47], v225 offset:12288
    v_mfma_f32_32x32x16_bf16 v[112:127], a[12:15], a[20:23], v[112:127]
    ds_read_b64_tr_b16 a[62:63], v231 offset:10240
    v_mfma_f32_32x32x16_bf16 v[176:191], a[12:15], a[24:27], v[176:191]
    v_add_u32 v225, s55, v225
    v_mfma_f32_32x32x16_bf16 a[80:95], a[12:15], a[28:31], a[80:95]
    s_waitcnt vmcnt(23) lgkmcnt(0)
    s_barrier
    v_mfma_f32_32x32x16_bf16 v[0:15], a[32:35], a[48:51], v[0:15]
    ds_read_b64_tr_b16 a[16:17], v228 offset:16384
    s_add_u32 m0, s43, 0
    s_add_u32 s44, s42, 0
    buffer_load_dwordx4 v234, s[12:15], s44 offen lds
    v_mfma_f32_32x32x16_bf16 v[64:79], a[32:35], a[52:55], v[64:79]
    ds_read_b128 a[0:3], v226 offset:0
    v_mfma_f32_32x32x16_bf16 v[128:143], a[32:35], a[56:59], v[128:143]
    ds_read_b64_tr_b16 a[18:19], v228 offset:18432
    v_mfma_f32_32x32x16_bf16 v[192:207], a[32:35], a[60:63], v[192:207]
    ds_read_b64_tr_b16 a[20:21], v229 offset:16384
    v_mfma_f32_32x32x16_bf16 v[16:31], a[36:39], a[48:51], v[16:31]
    s_add_u32 m0, s43, 1024
    s_add_u32 s44, s42, 16384
    buffer_load_dwordx4 v235, s[12:15], s44 offen lds
    v_mfma_f32_32x32x16_bf16 v[80:95], a[36:39], a[52:55], v[80:95]
    ds_read_b128 a[4:7], v226 offset:4096
    v_mfma_f32_32x32x16_bf16 v[144:159], a[36:39], a[56:59], v[144:159]
    ds_read_b64_tr_b16 a[22:23], v229 offset:18432
    v_mfma_f32_32x32x16_bf16 v[208:223], a[36:39], a[60:63], v[208:223]
    s_add_u32 m0, s43, 2048
    s_add_u32 s44, s42, 32768
    buffer_load_dwordx4 v234, s[12:15], s44 offen lds
    v_mfma_f32_32x32x16_bf16 v[32:47], a[40:43], a[48:51], v[32:47]
    ds_read_b64_tr_b16 a[24:25], v230 offset:16384
    ds_read_b128 a[8:11], v226 offset:8192
    v_mfma_f32_32x32x16_bf16 v[96:111], a[40:43], a[52:55], v[96:111]
    s_add_u32 m0, s43, 3072
    s_add_u32 s44, s42, 49152
    buffer_load_dwordx4 v235, s[12:15], s44 offen lds
    v_mfma_f32_32x32x16_bf16 v[160:175], a[40:43], a[56:59], v[160:175]
    ds_read_b64_tr_b16 a[26:27], v230 offset:18432
    v_mfma_f32_32x32x16_bf16 a[64:79], a[40:43], a[60:63], a[64:79]
    ds_read_b64_tr_b16 a[28:29], v231 offset:16384
    v_mfma_f32_32x32x16_bf16 v[48:63], a[44:47], a[48:51], v[48:63]
    ds_read_b128 a[12:15], v226 offset:12288
    v_mfma_f32_32x32x16_bf16 v[112:127], a[44:47], a[52:55], v[112:127]
    s_add_u32 s45, s58, 2097152
    buffer_load_dwordx4 v[252:255], v236, s[24:27], s45 offen
    v_mfma_f32_32x32x16_bf16 v[176:191], a[44:47], a[56:59], v[176:191]
    ds_read_b64_tr_b16 a[30:31], v231 offset:18432
    v_mfma_f32_32x32x16_bf16 a[80:95], a[44:47], a[60:63], a[80:95]
    v_add_u32 v226, s55, v226
    s_waitcnt lgkmcnt(0)
    v_mfma_f32_32x32x16_bf16 v[0:15], a[0:3], a[16:19], v[0:15]
    ds_read_b64_tr_b16 a[48:49], v228 offset:24576
    s_add_u32 m0, s41, 4096
    s_add_u32 s44, s40, 32768
    buffer_load_dwordx4 v232, s[8:11], s44 offen lds
    v_mfma_f32_32x32x16_bf16 v[64:79], a[0:3], a[20:23], v[64:79]
    ds_read_b128 a[32:35], v227 offset:0
    v_mfma_f32_32x32x16_bf16 v[128:143], a[0:3], a[24:27], v[128:143]
    ds_read_b64_tr_b16 a[50:51], v228 offset:26624
    ds_read_b64_tr_b16 a[52:53], v229 offset:24576
    v_mfma_f32_32x32x16_bf16 v[192:207], a[0:3], a[28:31], v[192:207]
    s_add_u32 m0, s41, 5120
    s_add_u32 s44, s40, 40960
    buffer_load_dwordx4 v233, s[8:11], s44 offen lds
    v_mfma_f32_32x32x16_bf16 v[16:31], a[4:7], a[16:19], v[16:31]
    ds_read_b128 a[36:39], v227 offset:4096
    ds_read_b64_tr_b16 a[54:55], v229 offset:26624
    v_mfma_f32_32x32x16_bf16 v[80:95], a[4:7], a[20:23], v[80:95]
    ds_read_b64_tr_b16 a[56:57], v230 offset:24576
    v_mfma_f32_32x32x16_bf16 v[144:159], a[4:7], a[24:27], v[144:159]
    s_add_u32 m0, s41, 6144
    s_add_u32 s44, s40, 49152
    buffer_load_dwordx4 v232, s[8:11], s44 offen lds
    ds_read_b128 a[40:43], v227 offset:8192
    v_mfma_f32_32x32x16_bf16 v[208:223], a[4:7], a[28:31], v[208:223]
    ds_read_b64_tr_b16 a[58:59], v230 offset:26624
    v_mfma_f32_32x32x16_bf16 v[32:47], a[8:11], a[16:19], v[32:47]
    ds_read_b64_tr_b16 a[60:61], v231 offset:24576
    s_add_u32 m0, s41, 7168
    s_add_u32 s44, s40, 57344
    buffer_load_dwordx4 v233, s[8:11], s44 offen lds
    v_mfma_f32_32x32x16_bf16 v[96:111], a[8:11], a[20:23], v[96:111]
    ds_read_b128 a[44:47], v227 offset:12288
    v_mfma_f32_32x32x16_bf16 v[160:175], a[8:11], a[24:27], v[160:175]
    ds_read_b64_tr_b16 a[62:63], v231 offset:26624
    v_add_u32 v227, s55, v227
    v_mfma_f32_32x32x16_bf16 a[64:79], a[8:11], a[28:31], a[64:79]
    v_add_u32 v224, s55, v224
    v_mfma_f32_32x32x16_bf16 v[48:63], a[12:15], a[16:19], v[48:63]
    v_xor_b32 v228, 32768, v228
    v_xor_b32 v229, 32768, v229
    v_mfma_f32_32x32x16_bf16 v[112:127], a[12:15], a[20:23], v[112:127]
    v_xor_b32 v230, 32768, v230
    v_mfma_f32_32x32x16_bf16 v[176:191], a[12:15], a[24:27], v[176:191]
    v_xor_b32 v231, 32768, v231
    v_mfma_f32_32x32x16_bf16 a[80:95], a[12:15], a[28:31], a[80:95]
    s_waitcnt vmcnt(18) lgkmcnt(0)
    s_barrier
    v_mfma_f32_32x32x16_bf16 v[0:15], a[32:35], a[48:51], v[0:15]
    ds_read_b64_tr_b16 a[16:17], v228 offset:0
    s_add_u32 m0, s43, 16384
    s_add_u32 s44, s42, 262144
    buffer_load_dwordx4 v234, s[12:15], s44 offen lds
    v_mfma_f32_32x32x16_bf16 v[64:79], a[32:35], a[52:55], v[64:79]
    ds_read_b128 a[0:3], v224 offset:0
    v_mfma_f32_32x32x16_bf16 v[128:143], a[32:35], a[56:59], v[128:143]
    ds_read_b64_tr_b16 a[18:19], v228 offset:2048
    v_mfma_f32_32x32x16_bf16 v[192:207], a[32:35], a[60:63], v[192:207]
    ds_read_b64_tr_b16 a[20:21], v229 offset:0
    v_mfma_f32_32x32x16_bf16 v[16:31], a[36:39], a[48:51], v[16:31]
    s_add_u32 m0, s43, 17408
    s_add_u32 s44, s42, 278528
    buffer_load_dwordx4 v235, s[12:15], s44 offen lds
    v_mfma_f32_32x32x16_bf16 v[80:95], a[36:39], a[52:55], v[80:95]
    ds_read_b128 a[4:7], v224 offset:4096
    ds_read_b64_tr_b16 a[22:23], v229 offset:2048
    v_mfma_f32_32x32x16_bf16 v[144:159], a[36:39], a[56:59], v[144:159]
    s_add_u32 m0, s43, 18432
    s_add_u32 s44, s42, 294912
    buffer_load_dwordx4 v234, s[12:15], s44 offen lds
    v_mfma_f32_32x32x16_bf16 v[208:223], a[36:39], a[60:63], v[208:223]
    ds_read_b64_tr_b16 a[24:25], v230 offset:0
    v_mfma_f32_32x32x16_bf16 v[32:47], a[40:43], a[48:51], v[32:47]
    ds_read_b128 a[8:11], v224 offset:8192
    v_mfma_f32_32x32x16_bf16 v[96:111], a[40:43], a[52:55], v[96:111]
    s_add_u32 m0, s43, 19456
    s_add_u32 s44, s42, 311296
    buffer_load_dwordx4 v235, s[12:15], s44 offen lds
    v_mfma_f32_32x32x16_bf16 v[160:175], a[40:43], a[56:59], v[160:175]
    ds_read_b64_tr_b16 a[26:27], v230 offset:2048
    ds_read_b64_tr_b16 a[28:29], v231 offset:0
    v_mfma_f32_32x32x16_bf16 a[64:79], a[40:43], a[60:63], a[64:79]
    ds_read_b128 a[12:15], v224 offset:12288
    v_mfma_f32_32x32x16_bf16 v[48:63], a[44:47], a[48:51], v[48:63]
    s_add_u32 s45, s58, 0
    buffer_load_dwordx4 v[252:255], v236, s[16:19], s45 offen
    v_mfma_f32_32x32x16_bf16 v[112:127], a[44:47], a[52:55], v[112:127]
    ds_read_b64_tr_b16 a[30:31], v231 offset:2048
    v_mfma_f32_32x32x16_bf16 v[176:191], a[44:47], a[56:59], v[176:191]
    s_add_u32 s42, s42, 524288
    s_xor_b32 s43, s43, 32768
    v_mfma_f32_32x32x16_bf16 a[80:95], a[44:47], a[60:63], a[80:95]
    s_add_u32 s40, s40, 128
    s_add_u32 s41, s41, 32768
    s_cmp_ge_u32 s41, 163840
    s_cselect_b32 s45, 98304, 0
    s_sub_u32 s41, s41, s45
    s_waitcnt lgkmcnt(0)
    v_mfma_f32_32x32x16_bf16 v[0:15], a[0:3], a[16:19], v[0:15]
    s_add_u32 s47, s47, 32768
    s_mov_b32 s55, 32768
    s_cmp_eq_u32 s47, 163840
    s_cselect_b32 s55, -65536, s55
    s_cselect_b32 s47, 65536, s47
    ds_read_b64_tr_b16 a[48:49], v228 offset:8192
    v_mfma_f32_32x32x16_bf16 v[64:79], a[0:3], a[20:23], v[64:79]
    s_add_u32 m0, s41, 0
    s_add_u32 s44, s40, 0
    buffer_load_dwordx4 v232, s[8:11], s44 offen lds
    v_mfma_f32_32x32x16_bf16 v[128:143], a[0:3], a[24:27], v[128:143]
    ds_read_b128 a[32:35], v225 offset:0
    v_mfma_f32_32x32x16_bf16 v[192:207], a[0:3], a[28:31], v[192:207]
    ds_read_b64_tr_b16 a[50:51], v228 offset:10240
    v_mfma_f32_32x32x16_bf16 v[16:31], a[4:7], a[16:19], v[16:31]
    ds_read_b64_tr_b16 a[52:53], v229 offset:8192
    v_mfma_f32_32x32x16_bf16 v[80:95], a[4:7], a[20:23], v[80:95]
    s_add_u32 m0, s41, 1024
    s_add_u32 s44, s40, 8192
    buffer_load_dwordx4 v233, s[8:11], s44 offen lds
    ds_read_b128 a[36:39], v225 offset:4096
    v_mfma_f32_32x32x16_bf16 v[144:159], a[4:7], a[24:27], v[144:159]
    ds_read_b64_tr_b16 a[54:55], v229 offset:10240
    v_mfma_f32_32x32x16_bf16 v[208:223], a[4:7], a[28:31], v[208:223]
    ds_read_b64_tr_b16 a[56:57], v230 offset:8192
    v_mfma_f32_32x32x16_bf16 v[32:47], a[8:11], a[16:19], v[32:47]
    s_add_u32 m0, s41, 2048
    s_add_u32 s44, s40, 16384
    buffer_load_dwordx4 v232, s[8:11], s44 offen lds
    v_mfma_f32_32x32x16_bf16 v[96:111], a[8:11], a[20:23], v[96:111]
    ds_read_b128 a[40:43], v225 offset:8192
    v_mfma_f32_32x32x16_bf16 v[160:175], a[8:11], a[24:27], v[160:175]
    ds_read_b64_tr_b16 a[58:59], v230 offset:10240
    ds_read_b64_tr_b16 a[60:61], v231 offset:8192
    v_mfma_f32_32x32x16_bf16 a[64:79], a[8:11], a[28:31], a[64:79]
    s_add_u32 m0, s41, 3072
    s_add_u32 s44, s40, 24576
    buffer_load_dwordx4 v233, s[8:11], s44 offen lds
    v_mfma_f32_32x32x16_bf16 v[48:63], a[12:15], a[16:19], v[48:63]
    ds_read_b128 a[44:47], v225 offset:12288
    v_mfma_f32_32x32x16_bf16 v[112:127], a[12:15], a[20:23], v[112:127]
    ds_read_b64_tr_b16 a[62:63], v231 offset:10240
    v_mfma_f32_32x32x16_bf16 v[176:191], a[12:15], a[24:27], v[176:191]
    v_add_u32 v225, s55, v225
    v_mfma_f32_32x32x16_bf16 a[80:95], a[12:15], a[28:31], a[80:95]
    s_waitcnt vmcnt(23) lgkmcnt(0)
    s_barrier
    v_mfma_f32_32x32x16_bf16 v[0:15], a[32:35], a[48:51], v[0:15]
    ds_read_b64_tr_b16 a[16:17], v228 offset:16384
    s_add_u32 m0, s43, 0
    s_add_u32 s44, s42, 0
    buffer_load_dwordx4 v234, s[12:15], s44 offen lds
    v_mfma_f32_32x32x16_bf16 v[64:79], a[32:35], a[52:55], v[64:79]
    ds_read_b128 a[0:3], v226 offset:0
    v_mfma_f32_32x32x16_bf16 v[128:143], a[32:35], a[56:59], v[128:143]
    ds_read_b64_tr_b16 a[18:19], v228 offset:18432
    v_mfma_f32_32x32x16_bf16 v[192:207], a[32:35], a[60:63], v[192:207]
    ds_read_b64_tr_b16 a[20:21], v229 offset:16384
    v_mfma_f32_32x32x16_bf16 v[16:31], a[36:39], a[48:51], v[16:31]
    s_add_u32 m0, s43, 1024
    s_add_u32 s44, s42, 16384
    buffer_load_dwordx4 v235, s[12:15], s44 offen lds
    v_mfma_f32_32x32x16_bf16 v[80:95], a[36:39], a[52:55], v[80:95]
    ds_read_b128 a[4:7], v226 offset:4096
    v_mfma_f32_32x32x16_bf16 v[144:159], a[36:39], a[56:59], v[144:159]
    ds_read_b64_tr_b16 a[22:23], v229 offset:18432
    v_mfma_f32_32x32x16_bf16 v[208:223], a[36:39], a[60:63], v[208:223]
    s_add_u32 m0, s43, 2048
    s_add_u32 s44, s42, 32768
    buffer_load_dwordx4 v234, s[12:15], s44 offen lds
    v_mfma_f32_32x32x16_bf16 v[32:47], a[40:43], a[48:51], v[32:47]
    ds_read_b64_tr_b16 a[24:25], v230 offset:16384
    ds_read_b128 a[8:11], v226 offset:8192
    v_mfma_f32_32x32x16_bf16 v[96:111], a[40:43], a[52:55], v[96:111]
    s_add_u32 m0, s43, 3072
    s_add_u32 s44, s42, 49152
    buffer_load_dwordx4 v235, s[12:15], s44 offen lds
    v_mfma_f32_32x32x16_bf16 v[160:175], a[40:43], a[56:59], v[160:175]
    ds_read_b64_tr_b16 a[26:27], v230 offset:18432
    v_mfma_f32_32x32x16_bf16 a[64:79], a[40:43], a[60:63], a[64:79]
    ds_read_b64_tr_b16 a[28:29], v231 offset:16384
    v_mfma_f32_32x32x16_bf16 v[48:63], a[44:47], a[48:51], v[48:63]
    ds_read_b128 a[12:15], v226 offset:12288
    v_mfma_f32_32x32x16_bf16 v[112:127], a[44:47], a[52:55], v[112:127]
    s_add_u32 s45, s58, 1048576
    buffer_load_dwordx4 v[252:255], v236, s[16:19], s45 offen
    v_mfma_f32_32x32x16_bf16 v[176:191], a[44:47], a[56:59], v[176:191]
    ds_read_b64_tr_b16 a[30:31], v231 offset:18432
    v_mfma_f32_32x32x16_bf16 a[80:95], a[44:47], a[60:63], a[80:95]
    v_add_u32 v226, s55, v226
    s_waitcnt lgkmcnt(0)
    v_mfma_f32_32x32x16_bf16 v[0:15], a[0:3], a[16:19], v[0:15]
    ds_read_b64_tr_b16 a[48:49], v228 offset:24576
    s_add_u32 m0, s41, 4096
    s_add_u32 s44, s40, 32768
    buffer_load_dwordx4 v232, s[8:11], s44 offen lds
    v_mfma_f32_32x32x16_bf16 v[64:79], a[0:3], a[20:23], v[64:79]
    ds_read_b128 a[32:35], v227 offset:0
    v_mfma_f32_32x32x16_bf16 v[128:143], a[0:3], a[24:27], v[128:143]
    ds_read_b64_tr_b16 a[50:51], v228 offset:26624
    ds_read_b64_tr_b16 a[52:53], v229 offset:24576
    v_mfma_f32_32x32x16_bf16 v[192:207], a[0:3], a[28:31], v[192:207]
    s_add_u32 m0, s41, 5120
    s_add_u32 s44, s40, 40960
    buffer_load_dwordx4 v233, s[8:11], s44 offen lds
    v_mfma_f32_32x32x16_bf16 v[16:31], a[4:7], a[16:19], v[16:31]
    ds_read_b128 a[36:39], v227 offset:4096
    ds_read_b64_tr_b16 a[54:55], v229 offset:26624
    v_mfma_f32_32x32x16_bf16 v[80:95], a[4:7], a[20:23], v[80:95]
    ds_read_b64_tr_b16 a[56:57], v230 offset:24576
    v_mfma_f32_32x32x16_bf16 v[144:159], a[4:7], a[24:27], v[144:159]
    s_add_u32 m0, s41, 6144
    s_add_u32 s44, s40, 49152
    buffer_load_dwordx4 v232, s[8:11], s44 offen lds
    ds_read_b128 a[40:43], v227 offset:8192
    v_mfma_f32_32x32x16_bf16 v[208:223], a[4:7], a[28:31], v[208:223]
    ds_read_b64_tr_b16 a[58:59], v230 offset:26624
    v_mfma_f32_32x32x16_bf16 v[32:47], a[8:11], a[16:19], v[32:47]
    ds_read_b64_tr_b16 a[60:61], v231 offset:24576
    s_add_u32 m0, s41, 7168
    s_add_u32 s44, s40, 57344
    buffer_load_dwordx4 v233, s[8:11], s44 offen lds
    v_mfma_f32_32x32x16_bf16 v[96:111], a[8:11], a[20:23], v[96:111]
    ds_read_b128 a[44:47], v227 offset:12288
    v_mfma_f32_32x32x16_bf16 v[160:175], a[8:11], a[24:27], v[160:175]
    ds_read_b64_tr_b16 a[62:63], v231 offset:26624
    v_add_u32 v227, s55, v227
    v_mfma_f32_32x32x16_bf16 a[64:79], a[8:11], a[28:31], a[64:79]
    v_add_u32 v224, s55, v224
    v_mfma_f32_32x32x16_bf16 v[48:63], a[12:15], a[16:19], v[48:63]
    v_xor_b32 v228, 32768, v228
    v_xor_b32 v229, 32768, v229
    v_mfma_f32_32x32x16_bf16 v[112:127], a[12:15], a[20:23], v[112:127]
    v_xor_b32 v230, 32768, v230
    v_mfma_f32_32x32x16_bf16 v[176:191], a[12:15], a[24:27], v[176:191]
    v_xor_b32 v231, 32768, v231
    v_mfma_f32_32x32x16_bf16 a[80:95], a[12:15], a[28:31], a[80:95]
    s_waitcnt vmcnt(18) lgkmcnt(0)
    s_barrier
    v_mfma_f32_32x32x16_bf16 v[0:15], a[32:35], a[48:51], v[0:15]
    ds_read_b64_tr_b16 a[16:17], v228 offset:0
    s_add_u32 m0, s43, 16384
    s_add_u32 s44, s42, 262144
    buffer_load_dwordx4 v234, s[12:15], s44 offen lds
    v_mfma_f32_32x32x16_bf16 v[64:79], a[32:35], a[52:55], v[64:79]
    ds_read_b128 a[0:3], v224 offset:0
    v_mfma_f32_32x32x16_bf16 v[128:143], a[32:35], a[56:59], v[128:143]
    ds_read_b64_tr_b16 a[18:19], v228 offset:2048
    v_mfma_f32_32x32x16_bf16 v[192:207], a[32:35], a[60:63], v[192:207]
    ds_read_b64_tr_b16 a[20:21], v229 offset:0
    v_mfma_f32_32x32x16_bf16 v[16:31], a[36:39], a[48:51], v[16:31]
    s_add_u32 m0, s43, 17408
    s_add_u32 s44, s42, 278528
    buffer_load_dwordx4 v235, s[12:15], s44 offen lds
    v_mfma_f32_32x32x16_bf16 v[80:95], a[36:39], a[52:55], v[80:95]
    ds_read_b128 a[4:7], v224 offset:4096
    ds_read_b64_tr_b16 a[22:23], v229 offset:2048
    v_mfma_f32_32x32x16_bf16 v[144:159], a[36:39], a[56:59], v[144:159]
    s_add_u32 m0, s43, 18432
    s_add_u32 s44, s42, 294912
    buffer_load_dwordx4 v234, s[12:15], s44 offen lds
    v_mfma_f32_32x32x16_bf16 v[208:223], a[36:39], a[60:63], v[208:223]
    ds_read_b64_tr_b16 a[24:25], v230 offset:0
    v_mfma_f32_32x32x16_bf16 v[32:47], a[40:43], a[48:51], v[32:47]
    ds_read_b128 a[8:11], v224 offset:8192
    v_mfma_f32_32x32x16_bf16 v[96:111], a[40:43], a[52:55], v[96:111]
    s_add_u32 m0, s43, 19456
    s_add_u32 s44, s42, 311296
    buffer_load_dwordx4 v235, s[12:15], s44 offen lds
    v_mfma_f32_32x32x16_bf16 v[160:175], a[40:43], a[56:59], v[160:175]
    ds_read_b64_tr_b16 a[26:27], v230 offset:2048
    ds_read_b64_tr_b16 a[28:29], v231 offset:0
    v_mfma_f32_32x32x16_bf16 a[64:79], a[40:43], a[60:63], a[64:79]
    ds_read_b128 a[12:15], v224 offset:12288
    v_mfma_f32_32x32x16_bf16 v[48:63], a[44:47], a[48:51], v[48:63]
    s_add_u32 s45, s58, 0
    buffer_load_dwordx4 v[252:255], v236, s[20:23], s45 offen
    v_mfma_f32_32x32x16_bf16 v[112:127], a[44:47], a[52:55], v[112:127]
    ds_read_b64_tr_b16 a[30:31], v231 offset:2048
    v_mfma_f32_32x32x16_bf16 v[176:191], a[44:47], a[56:59], v[176:191]
    s_add_u32 s42, s42, 524288
    s_xor_b32 s43, s43, 32768
    v_mfma_f32_32x32x16_bf16 a[80:95], a[44:47], a[60:63], a[80:95]
    s_add_u32 s40, s40, 128
    s_add_u32 s41, s41, 32768
    s_cmp_ge_u32 s41, 163840
    s_cselect_b32 s45, 98304, 0
    s_sub_u32 s41, s41, s45
    s_waitcnt lgkmcnt(0)
    v_mfma_f32_32x32x16_bf16 v[0:15], a[0:3], a[16:19], v[0:15]
    s_add_u32 s47, s47, 32768
    s_mov_b32 s55, 32768
    s_cmp_eq_u32 s47, 163840
    s_cselect_b32 s55, -65536, s55
    s_cselect_b32 s47, 65536, s47
    ds_read_b64_tr_b16 a[48:49], v228 offset:8192
    v_mfma_f32_32x32x16_bf16 v[64:79], a[0:3], a[20:23], v[64:79]
    s_add_u32 m0, s41, 0
    s_add_u32 s44, s40, 0
    buffer_load_dwordx4 v232, s[8:11], s44 offen lds
    v_mfma_f32_32x32x16_bf16 v[128:143], a[0:3], a[24:27], v[128:143]
    ds_read_b128 a[32:35], v225 offset:0
    v_mfma_f32_32x32x16_bf16 v[192:207], a[0:3], a[28:31], v[192:207]
    ds_read_b64_tr_b16 a[50:51], v228 offset:10240
    v_mfma_f32_32x32x16_bf16 v[16:31], a[4:7], a[16:19], v[16:31]
    ds_read_b64_tr_b16 a[52:53], v229 offset:8192
    v_mfma_f32_32x32x16_bf16 v[80:95], a[4:7], a[20:23], v[80:95]
    s_add_u32 m0, s41, 1024
    s_add_u32 s44, s40, 8192
    buffer_load_dwordx4 v233, s[8:11], s44 offen lds
    ds_read_b128 a[36:39], v225 offset:4096
    v_mfma_f32_32x32x16_bf16 v[144:159], a[4:7], a[24:27], v[144:159]
    ds_read_b64_tr_b16 a[54:55], v229 offset:10240
    v_mfma_f32_32x32x16_bf16 v[208:223], a[4:7], a[28:31], v[208:223]
    ds_read_b64_tr_b16 a[56:57], v230 offset:8192
    v_mfma_f32_32x32x16_bf16 v[32:47], a[8:11], a[16:19], v[32:47]
    s_add_u32 m0, s41, 2048
    s_add_u32 s44, s40, 16384
    buffer_load_dwordx4 v232, s[8:11], s44 offen lds
    v_mfma_f32_32x32x16_bf16 v[96:111], a[8:11], a[20:23], v[96:111]
    ds_read_b128 a[40:43], v225 offset:8192
    v_mfma_f32_32x32x16_bf16 v[160:175], a[8:11], a[24:27], v[160:175]
    ds_read_b64_tr_b16 a[58:59], v230 offset:10240
    ds_read_b64_tr_b16 a[60:61], v231 offset:8192
    v_mfma_f32_32x32x16_bf16 a[64:79], a[8:11], a[28:31], a[64:79]
    s_add_u32 m0, s41, 3072
    s_add_u32 s44, s40, 24576
    buffer_load_dwordx4 v233, s[8:11], s44 offen lds
    v_mfma_f32_32x32x16_bf16 v[48:63], a[12:15], a[16:19], v[48:63]
    ds_read_b128 a[44:47], v225 offset:12288
    v_mfma_f32_32x32x16_bf16 v[112:127], a[12:15], a[20:23], v[112:127]
    ds_read_b64_tr_b16 a[62:63], v231 offset:10240
    v_mfma_f32_32x32x16_bf16 v[176:191], a[12:15], a[24:27], v[176:191]
    v_add_u32 v225, s55, v225
    v_mfma_f32_32x32x16_bf16 a[80:95], a[12:15], a[28:31], a[80:95]
    s_waitcnt vmcnt(23) lgkmcnt(0)
    s_barrier
    v_mfma_f32_32x32x16_bf16 v[0:15], a[32:35], a[48:51], v[0:15]
    ds_read_b64_tr_b16 a[16:17], v228 offset:16384
    s_add_u32 m0, s43, 0
    s_add_u32 s44, s42, 0
    buffer_load_dwordx4 v234, s[12:15], s44 offen lds
    v_mfma_f32_32x32x16_bf16 v[64:79], a[32:35], a[52:55], v[64:79]
    ds_read_b128 a[0:3], v226 offset:0
    v_mfma_f32_32x32x16_bf16 v[128:143], a[32:35], a[56:59], v[128:143]
    ds_read_b64_tr_b16 a[18:19], v228 offset:18432
    v_mfma_f32_32x32x16_bf16 v[192:207], a[32:35], a[60:63], v[192:207]
    ds_read_b64_tr_b16 a[20:21], v229 offset:16384
    v_mfma_f32_32x32x16_bf16 v[16:31], a[36:39], a[48:51], v[16:31]
    s_add_u32 m0, s43, 1024
    s_add_u32 s44, s42, 16384
    buffer_load_dwordx4 v235, s[12:15], s44 offen lds
    v_mfma_f32_32x32x16_bf16 v[80:95], a[36:39], a[52:55], v[80:95]
    ds_read_b128 a[4:7], v226 offset:4096
    v_mfma_f32_32x32x16_bf16 v[144:159], a[36:39], a[56:59], v[144:159]
    ds_read_b64_tr_b16 a[22:23], v229 offset:18432
    v_mfma_f32_32x32x16_bf16 v[208:223], a[36:39], a[60:63], v[208:223]
    s_add_u32 m0, s43, 2048
    s_add_u32 s44, s42, 32768
    buffer_load_dwordx4 v234, s[12:15], s44 offen lds
    v_mfma_f32_32x32x16_bf16 v[32:47], a[40:43], a[48:51], v[32:47]
    ds_read_b64_tr_b16 a[24:25], v230 offset:16384
    ds_read_b128 a[8:11], v226 offset:8192
    v_mfma_f32_32x32x16_bf16 v[96:111], a[40:43], a[52:55], v[96:111]
    s_add_u32 m0, s43, 3072
    s_add_u32 s44, s42, 49152
    buffer_load_dwordx4 v235, s[12:15], s44 offen lds
    v_mfma_f32_32x32x16_bf16 v[160:175], a[40:43], a[56:59], v[160:175]
    ds_read_b64_tr_b16 a[26:27], v230 offset:18432
    v_mfma_f32_32x32x16_bf16 a[64:79], a[40:43], a[60:63], a[64:79]
    ds_read_b64_tr_b16 a[28:29], v231 offset:16384
    v_mfma_f32_32x32x16_bf16 v[48:63], a[44:47], a[48:51], v[48:63]
    ds_read_b128 a[12:15], v226 offset:12288
    v_mfma_f32_32x32x16_bf16 v[112:127], a[44:47], a[52:55], v[112:127]
    s_add_u32 s45, s58, 2097152
    buffer_load_dwordx4 v[252:255], v236, s[16:19], s45 offen
    v_mfma_f32_32x32x16_bf16 v[176:191], a[44:47], a[56:59], v[176:191]
    ds_read_b64_tr_b16 a[30:31], v231 offset:18432
    v_mfma_f32_32x32x16_bf16 a[80:95], a[44:47], a[60:63], a[80:95]
    v_add_u32 v226, s55, v226
    s_waitcnt lgkmcnt(0)
    v_mfma_f32_32x32x16_bf16 v[0:15], a[0:3], a[16:19], v[0:15]
    ds_read_b64_tr_b16 a[48:49], v228 offset:24576
    s_add_u32 m0, s41, 4096
    s_add_u32 s44, s40, 32768
    buffer_load_dwordx4 v232, s[8:11], s44 offen lds
    v_mfma_f32_32x32x16_bf16 v[64:79], a[0:3], a[20:23], v[64:79]
    ds_read_b128 a[32:35], v227 offset:0
    v_mfma_f32_32x32x16_bf16 v[128:143], a[0:3], a[24:27], v[128:143]
    ds_read_b64_tr_b16 a[50:51], v228 offset:26624
    ds_read_b64_tr_b16 a[52:53], v229 offset:24576
    v_mfma_f32_32x32x16_bf16 v[192:207], a[0:3], a[28:31], v[192:207]
    s_add_u32 m0, s41, 5120
    s_add_u32 s44, s40, 40960
    buffer_load_dwordx4 v233, s[8:11], s44 offen lds
    v_mfma_f32_32x32x16_bf16 v[16:31], a[4:7], a[16:19], v[16:31]
    ds_read_b128 a[36:39], v227 offset:4096
    ds_read_b64_tr_b16 a[54:55], v229 offset:26624
    v_mfma_f32_32x32x16_bf16 v[80:95], a[4:7], a[20:23], v[80:95]
    ds_read_b64_tr_b16 a[56:57], v230 offset:24576
    v_mfma_f32_32x32x16_bf16 v[144:159], a[4:7], a[24:27], v[144:159]
    s_add_u32 m0, s41, 6144
    s_add_u32 s44, s40, 49152
    buffer_load_dwordx4 v232, s[8:11], s44 offen lds
    ds_read_b128 a[40:43], v227 offset:8192
    v_mfma_f32_32x32x16_bf16 v[208:223], a[4:7], a[28:31], v[208:223]
    ds_read_b64_tr_b16 a[58:59], v230 offset:26624
    v_mfma_f32_32x32x16_bf16 v[32:47], a[8:11], a[16:19], v[32:47]
    ds_read_b64_tr_b16 a[60:61], v231 offset:24576
    s_add_u32 m0, s41, 7168
    s_add_u32 s44, s40, 57344
    buffer_load_dwordx4 v233, s[8:11], s44 offen lds
    v_mfma_f32_32x32x16_bf16 v[96:111], a[8:11], a[20:23], v[96:111]
    ds_read_b128 a[44:47], v227 offset:12288
    v_mfma_f32_32x32x16_bf16 v[160:175], a[8:11], a[24:27], v[160:175]
    ds_read_b64_tr_b16 a[62:63], v231 offset:26624
    v_add_u32 v227, s55, v227
    v_mfma_f32_32x32x16_bf16 a[64:79], a[8:11], a[28:31], a[64:79]
    v_add_u32 v224, s55, v224
    v_mfma_f32_32x32x16_bf16 v[48:63], a[12:15], a[16:19], v[48:63]
    v_xor_b32 v228, 32768, v228
    v_xor_b32 v229, 32768, v229
    v_mfma_f32_32x32x16_bf16 v[112:127], a[12:15], a[20:23], v[112:127]
    v_xor_b32 v230, 32768, v230
    v_mfma_f32_32x32x16_bf16 v[176:191], a[12:15], a[24:27], v[176:191]
    v_xor_b32 v231, 32768, v231
    v_mfma_f32_32x32x16_bf16 a[80:95], a[12:15], a[28:31], a[80:95]
    s_waitcnt vmcnt(18) lgkmcnt(0)
    s_barrier
    v_mfma_f32_32x32x16_bf16 v[0:15], a[32:35], a[48:51], v[0:15]
    ds_read_b64_tr_b16 a[16:17], v228 offset:0
    s_add_u32 m0, s43, 16384
    s_add_u32 s44, s42, 262144
    buffer_load_dwordx4 v234, s[12:15], s44 offen lds
    v_mfma_f32_32x32x16_bf16 v[64:79], a[32:35], a[52:55], v[64:79]
    ds_read_b128 a[0:3], v224 offset:0
    v_mfma_f32_32x32x16_bf16 v[128:143], a[32:35], a[56:59], v[128:143]
    ds_read_b64_tr_b16 a[18:19], v228 offset:2048
    v_mfma_f32_32x32x16_bf16 v[192:207], a[32:35], a[60:63], v[192:207]
    ds_read_b64_tr_b16 a[20:21], v229 offset:0
    v_mfma_f32_32x32x16_bf16 v[16:31], a[36:39], a[48:51], v[16:31]
    s_add_u32 m0, s43, 17408
    s_add_u32 s44, s42, 278528
    buffer_load_dwordx4 v235, s[12:15], s44 offen lds
    v_mfma_f32_32x32x16_bf16 v[80:95], a[36:39], a[52:55], v[80:95]
    ds_read_b128 a[4:7], v224 offset:4096
    ds_read_b64_tr_b16 a[22:23], v229 offset:2048
    v_mfma_f32_32x32x16_bf16 v[144:159], a[36:39], a[56:59], v[144:159]
    s_add_u32 m0, s43, 18432
    s_add_u32 s44, s42, 294912
    buffer_load_dwordx4 v234, s[12:15], s44 offen lds
    v_mfma_f32_32x32x16_bf16 v[208:223], a[36:39], a[60:63], v[208:223]
    ds_read_b64_tr_b16 a[24:25], v230 offset:0
    v_mfma_f32_32x32x16_bf16 v[32:47], a[40:43], a[48:51], v[32:47]
    ds_read_b128 a[8:11], v224 offset:8192
    v_mfma_f32_32x32x16_bf16 v[96:111], a[40:43], a[52:55], v[96:111]
    s_add_u32 m0, s43, 19456
    s_add_u32 s44, s42, 311296
    buffer_load_dwordx4 v235, s[12:15], s44 offen lds
    v_mfma_f32_32x32x16_bf16 v[160:175], a[40:43], a[56:59], v[160:175]
    ds_read_b64_tr_b16 a[26:27], v230 offset:2048
    ds_read_b64_tr_b16 a[28:29], v231 offset:0
    v_mfma_f32_32x32x16_bf16 a[64:79], a[40:43], a[60:63], a[64:79]
    ds_read_b128 a[12:15], v224 offset:12288
    v_mfma_f32_32x32x16_bf16 v[48:63], a[44:47], a[48:51], v[48:63]
    s_add_u32 s45, s58, 1048576
    buffer_load_dwordx4 v[252:255], v236, s[20:23], s45 offen
    v_mfma_f32_32x32x16_bf16 v[112:127], a[44:47], a[52:55], v[112:127]
    ds_read_b64_tr_b16 a[30:31], v231 offset:2048
    v_mfma_f32_32x32x16_bf16 v[176:191], a[44:47], a[56:59], v[176:191]
    s_add_u32 s42, s42, 524288
    s_xor_b32 s43, s43, 32768
    v_mfma_f32_32x32x16_bf16 a[80:95], a[44:47], a[60:63], a[80:95]
    s_add_u32 s40, s40, 128
    s_add_u32 s41, s41, 32768
    s_cmp_ge_u32 s41, 163840
    s_cselect_b32 s45, 98304, 0
    s_sub_u32 s41, s41, s45
    s_waitcnt lgkmcnt(0)
    v_lshrrev_b32 v237, 3, v244
    v_mul_u32_u24 v237, 1152, v237
    v_and_b32 v238, 7, v244
    v_lshrrev_b32 v239, 4, v244
    v_xor_b32 v238, v238, v239
    v_lshl_add_u32 v232, v238, 4, v237
    v_xor_b32 v233, 64, v232
    v_lshrrev_b32 v237, 3, v244
    v_and_b32 v238, 7, v244
    v_bfe_u32 v239, v237, 1, 1
    v_lshlrev_b32 v239, 2, v239
    v_xor_b32 v238, v238, v239
    v_mul_u32_u24 v237, 3456, v237
    v_lshl_add_u32 v234, v238, 4, v237
    s_and_b32 s43, s43, 32768
    s_mul_i32 s44, s3, 1024
    s_add_u32 s43, s43, s44
    v_mfma_f32_32x32x16_bf16 v[0:15], a[0:3], a[16:19], v[0:15]
    s_add_u32 s47, s47, 32768
    s_mov_b32 s55, 32768
    s_cmp_eq_u32 s47, 163840
    s_cselect_b32 s55, -65536, s55
    s_cselect_b32 s47, 65536, s47
    ds_read_b64_tr_b16 a[48:49], v228 offset:8192
    v_mfma_f32_32x32x16_bf16 v[64:79], a[0:3], a[20:23], v[64:79]
    s_add_u32 m0, s41, 0
    s_add_u32 s44, s56, 0
    buffer_load_dwordx4 v232, s[24:27], s44 offen lds
    v_mfma_f32_32x32x16_bf16 v[128:143], a[0:3], a[24:27], v[128:143]
    ds_read_b128 a[32:35], v225 offset:0
    v_mfma_f32_32x32x16_bf16 v[192:207], a[0:3], a[28:31], v[192:207]
    ds_read_b64_tr_b16 a[50:51], v228 offset:10240
    v_mfma_f32_32x32x16_bf16 v[16:31], a[4:7], a[16:19], v[16:31]
    ds_read_b64_tr_b16 a[52:53], v229 offset:8192
    v_mfma_f32_32x32x16_bf16 v[80:95], a[4:7], a[20:23], v[80:95]
    s_add_u32 m0, s41, 1024
    s_add_u32 s44, s56, 9216
    buffer_load_dwordx4 v233, s[24:27], s44 offen lds
    ds_read_b128 a[36:39], v225 offset:4096
    v_mfma_f32_32x32x16_bf16 v[144:159], a[4:7], a[24:27], v[144:159]
    ds_read_b64_tr_b16 a[54:55], v229 offset:10240
    v_mfma_f32_32x32x16_bf16 v[208:223], a[4:7], a[28:31], v[208:223]
    ds_read_b64_tr_b16 a[56:57], v230 offset:8192
    v_mfma_f32_32x32x16_bf16 v[32:47], a[8:11], a[16:19], v[32:47]
    s_add_u32 m0, s41, 2048
    s_add_u32 s44, s56, 18432
    buffer_load_dwordx4 v232, s[24:27], s44 offen lds
    v_mfma_f32_32x32x16_bf16 v[96:111], a[8:11], a[20:23], v[96:111]
    ds_read_b128 a[40:43], v225 offset:8192
    v_mfma_f32_32x32x16_bf16 v[160:175], a[8:11], a[24:27], v[160:175]
    ds_read_b64_tr_b16 a[58:59], v230 offset:10240
    ds_read_b64_tr_b16 a[60:61], v231 offset:8192
    v_mfma_f32_32x32x16_bf16 a[64:79], a[8:11], a[28:31], a[64:79]
    s_add_u32 m0, s41, 3072
    s_add_u32 s44, s56, 27648
    buffer_load_dwordx4 v233, s[24:27], s44 offen lds
    v_mfma_f32_32x32x16_bf16 v[48:63], a[12:15], a[16:19], v[48:63]
    ds_read_b128 a[44:47], v225 offset:12288
    v_mfma_f32_32x32x16_bf16 v[112:127], a[12:15], a[20:23], v[112:127]
    ds_read_b64_tr_b16 a[62:63], v231 offset:10240
    v_mfma_f32_32x32x16_bf16 v[176:191], a[12:15], a[24:27], v[176:191]
    v_add_u32 v225, s55, v225
    v_mfma_f32_32x32x16_bf16 a[80:95], a[12:15], a[28:31], a[80:95]
    s_waitcnt vmcnt(23) lgkmcnt(0)
    s_barrier
    v_mfma_f32_32x32x16_bf16 v[0:15], a[32:35], a[48:51], v[0:15]
    ds_read_b64_tr_b16 a[16:17], v228 offset:16384
    v_mfma_f32_32x32x16_bf16 v[64:79], a[32:35], a[52:55], v[64:79]
    ds_read_b128 a[0:3], v226 offset:0
    v_mfma_f32_32x32x16_bf16 v[128:143], a[32:35], a[56:59], v[128:143]
    ds_read_b64_tr_b16 a[18:19], v228 offset:18432
    v_mfma_f32_32x32x16_bf16 v[192:207], a[32:35], a[60:63], v[192:207]
    s_add_u32 m0, s43, 0
    s_add_u32 s44, s57, 0
    buffer_load_dwordx4 v234, s[28:31], s44 offen lds
    v_mfma_f32_32x32x16_bf16 v[16:31], a[36:39], a[48:51], v[16:31]
    ds_read_b64_tr_b16 a[20:21], v229 offset:16384
    v_mfma_f32_32x32x16_bf16 v[80:95], a[36:39], a[52:55], v[80:95]
    ds_read_b128 a[4:7], v226 offset:4096
    v_mfma_f32_32x32x16_bf16 v[144:159], a[36:39], a[56:59], v[144:159]
    ds_read_b64_tr_b16 a[22:23], v229 offset:18432
    v_mfma_f32_32x32x16_bf16 v[208:223], a[36:39], a[60:63], v[208:223]
    ds_read_b64_tr_b16 a[24:25], v230 offset:16384
    v_mfma_f32_32x32x16_bf16 v[32:47], a[40:43], a[48:51], v[32:47]
    ds_read_b128 a[8:11], v226 offset:8192
    v_mfma_f32_32x32x16_bf16 v[96:111], a[40:43], a[52:55], v[96:111]
    ds_read_b64_tr_b16 a[26:27], v230 offset:18432
    v_mfma_f32_32x32x16_bf16 v[160:175], a[40:43], a[56:59], v[160:175]
    s_add_u32 s45, s58, 2097152
    buffer_load_dwordx4 v[252:255], v236, s[20:23], s45 offen
    v_mfma_f32_32x32x16_bf16 a[64:79], a[40:43], a[60:63], a[64:79]
    ds_read_b64_tr_b16 a[28:29], v231 offset:16384
    v_mfma_f32_32x32x16_bf16 v[48:63], a[44:47], a[48:51], v[48:63]
    ds_read_b128 a[12:15], v226 offset:12288
    v_mfma_f32_32x32x16_bf16 v[112:127], a[44:47], a[52:55], v[112:127]
    ds_read_b64_tr_b16 a[30:31], v231 offset:18432
    v_mfma_f32_32x32x16_bf16 v[176:191], a[44:47], a[56:59], v[176:191]
    v_add_u32 v226, s55, v226
    v_mfma_f32_32x32x16_bf16 a[80:95], a[44:47], a[60:63], a[80:95]
    s_waitcnt lgkmcnt(0)
    v_mfma_f32_32x32x16_bf16 v[0:15], a[0:3], a[16:19], v[0:15]
    ds_read_b64_tr_b16 a[48:49], v228 offset:24576
    s_add_u32 m0, s41, 4096
    s_add_u32 s44, s56, 36864
    buffer_load_dwordx4 v232, s[24:27], s44 offen lds
    v_mfma_f32_32x32x16_bf16 v[64:79], a[0:3], a[20:23], v[64:79]
    ds_read_b128 a[32:35], v227 offset:0
    v_mfma_f32_32x32x16_bf16 v[128:143], a[0:3], a[24:27], v[128:143]
    ds_read_b64_tr_b16 a[50:51], v228 offset:26624
    ds_read_b64_tr_b16 a[52:53], v229 offset:24576
    v_mfma_f32_32x32x16_bf16 v[192:207], a[0:3], a[28:31], v[192:207]
    s_add_u32 m0, s41, 5120
    s_add_u32 s44, s56, 46080
    buffer_load_dwordx4 v233, s[24:27], s44 offen lds
    v_mfma_f32_32x32x16_bf16 v[16:31], a[4:7], a[16:19], v[16:31]
    ds_read_b128 a[36:39], v227 offset:4096
    ds_read_b64_tr_b16 a[54:55], v229 offset:26624
    v_mfma_f32_32x32x16_bf16 v[80:95], a[4:7], a[20:23], v[80:95]
    ds_read_b64_tr_b16 a[56:57], v230 offset:24576
    v_mfma_f32_32x32x16_bf16 v[144:159], a[4:7], a[24:27], v[144:159]
    s_add_u32 m0, s41, 6144
    s_add_u32 s44, s56, 55296
    buffer_load_dwordx4 v232, s[24:27], s44 offen lds
    ds_read_b128 a[40:43], v227 offset:8192
    v_mfma_f32_32x32x16_bf16 v[208:223], a[4:7], a[28:31], v[208:223]
    ds_read_b64_tr_b16 a[58:59], v230 offset:26624
    v_mfma_f32_32x32x16_bf16 v[32:47], a[8:11], a[16:19], v[32:47]
    ds_read_b64_tr_b16 a[60:61], v231 offset:24576
    s_add_u32 m0, s41, 7168
    s_add_u32 s44, s56, 64512
    buffer_load_dwordx4 v233, s[24:27], s44 offen lds
    v_mfma_f32_32x32x16_bf16 v[96:111], a[8:11], a[20:23], v[96:111]
    ds_read_b128 a[44:47], v227 offset:12288
    v_mfma_f32_32x32x16_bf16 v[160:175], a[8:11], a[24:27], v[160:175]
    ds_read_b64_tr_b16 a[62:63], v231 offset:26624
    v_add_u32 v227, s55, v227
    v_mfma_f32_32x32x16_bf16 a[64:79], a[8:11], a[28:31], a[64:79]
    v_add_u32 v224, s55, v224
    v_mfma_f32_32x32x16_bf16 v[48:63], a[12:15], a[16:19], v[48:63]
    v_xor_b32 v228, 32768, v228
    v_xor_b32 v229, 32768, v229
    v_mfma_f32_32x32x16_bf16 v[112:127], a[12:15], a[20:23], v[112:127]
    v_xor_b32 v230, 32768, v230
    v_mfma_f32_32x32x16_bf16 v[176:191], a[12:15], a[24:27], v[176:191]
    v_xor_b32 v231, 32768, v231
    v_mfma_f32_32x32x16_bf16 a[80:95], a[12:15], a[28:31], a[80:95]
    s_waitcnt vmcnt(15) lgkmcnt(0)
    s_barrier
    v_mfma_f32_32x32x16_bf16 v[0:15], a[32:35], a[48:51], v[0:15]
    ds_read_b64_tr_b16 a[16:17], v228 offset:0
    v_mfma_f32_32x32x16_bf16 v[64:79], a[32:35], a[52:55], v[64:79]
    ds_read_b128 a[0:3], v224 offset:0
    v_mfma_f32_32x32x16_bf16 v[128:143], a[32:35], a[56:59], v[128:143]
    ds_read_b64_tr_b16 a[18:19], v228 offset:2048
    v_mfma_f32_32x32x16_bf16 v[192:207], a[32:35], a[60:63], v[192:207]
    s_add_u32 m0, s43, 16384
    s_add_u32 s44, s57, 110592
    buffer_load_dwordx4 v234, s[28:31], s44 offen lds
    v_mfma_f32_32x32x16_bf16 v[16:31], a[36:39], a[48:51], v[16:31]
    ds_read_b64_tr_b16 a[20:21], v229 offset:0
    v_mfma_f32_32x32x16_bf16 v[80:95], a[36:39], a[52:55], v[80:95]
    ds_read_b128 a[4:7], v224 offset:4096
    v_mfma_f32_32x32x16_bf16 v[144:159], a[36:39], a[56:59], v[144:159]
    ds_read_b64_tr_b16 a[22:23], v229 offset:2048
    v_mfma_f32_32x32x16_bf16 v[208:223], a[36:39], a[60:63], v[208:223]
    ds_read_b64_tr_b16 a[24:25], v230 offset:0
    v_mfma_f32_32x32x16_bf16 v[32:47], a[40:43], a[48:51], v[32:47]
    ds_read_b128 a[8:11], v224 offset:8192
    v_mfma_f32_32x32x16_bf16 v[96:111], a[40:43], a[52:55], v[96:111]
    ds_read_b64_tr_b16 a[26:27], v230 offset:2048
    v_mfma_f32_32x32x16_bf16 v[160:175], a[40:43], a[56:59], v[160:175]
    s_add_u32 s45, s58, 3145728
    buffer_load_dwordx4 v[252:255], v236, s[20:23], s45 offen
    v_mfma_f32_32x32x16_bf16 a[64:79], a[40:43], a[60:63], a[64:79]
    ds_read_b64_tr_b16 a[28:29], v231 offset:0
    v_mfma_f32_32x32x16_bf16 v[48:63], a[44:47], a[48:51], v[48:63]
    ds_read_b128 a[12:15], v224 offset:12288
    v_mfma_f32_32x32x16_bf16 v[112:127], a[44:47], a[52:55], v[112:127]
    ds_read_b64_tr_b16 a[30:31], v231 offset:2048
    v_mfma_f32_32x32x16_bf16 v[176:191], a[44:47], a[56:59], v[176:191]
    s_add_u32 s57, s57, 221184
    s_xor_b32 s43, s43, 32768
    v_mfma_f32_32x32x16_bf16 a[80:95], a[44:47], a[60:63], a[80:95]
    s_add_u32 s56, s56, 128
    s_add_u32 s41, s41, 32768
    s_cmp_ge_u32 s41, 163840
    s_cselect_b32 s45, 98304, 0
    s_sub_u32 s41, s41, s45
    s_waitcnt lgkmcnt(0)
    v_mfma_f32_32x32x16_bf16 v[0:15], a[0:3], a[16:19], v[0:15]
    s_add_u32 s47, s47, 32768
    s_mov_b32 s55, 32768
    s_cmp_eq_u32 s47, 163840
    s_cselect_b32 s55, -65536, s55
    s_cselect_b32 s47, 65536, s47
    ds_read_b64_tr_b16 a[48:49], v228 offset:8192
    v_mfma_f32_32x32x16_bf16 v[64:79], a[0:3], a[20:23], v[64:79]
    s_add_u32 m0, s41, 0
    s_add_u32 s44, s56, 0
    buffer_load_dwordx4 v232, s[24:27], s44 offen lds
    v_mfma_f32_32x32x16_bf16 v[128:143], a[0:3], a[24:27], v[128:143]
    ds_read_b128 a[32:35], v225 offset:0
    v_mfma_f32_32x32x16_bf16 v[192:207], a[0:3], a[28:31], v[192:207]
    ds_read_b64_tr_b16 a[50:51], v228 offset:10240
    v_mfma_f32_32x32x16_bf16 v[16:31], a[4:7], a[16:19], v[16:31]
    ds_read_b64_tr_b16 a[52:53], v229 offset:8192
    v_mfma_f32_32x32x16_bf16 v[80:95], a[4:7], a[20:23], v[80:95]
    s_add_u32 m0, s41, 1024
    s_add_u32 s44, s56, 9216
    buffer_load_dwordx4 v233, s[24:27], s44 offen lds
    ds_read_b128 a[36:39], v225 offset:4096
    v_mfma_f32_32x32x16_bf16 v[144:159], a[4:7], a[24:27], v[144:159]
    ds_read_b64_tr_b16 a[54:55], v229 offset:10240
    v_mfma_f32_32x32x16_bf16 v[208:223], a[4:7], a[28:31], v[208:223]
    ds_read_b64_tr_b16 a[56:57], v230 offset:8192
    v_mfma_f32_32x32x16_bf16 v[32:47], a[8:11], a[16:19], v[32:47]
    s_add_u32 m0, s41, 2048
    s_add_u32 s44, s56, 18432
    buffer_load_dwordx4 v232, s[24:27], s44 offen lds
    v_mfma_f32_32x32x16_bf16 v[96:111], a[8:11], a[20:23], v[96:111]
    ds_read_b128 a[40:43], v225 offset:8192
    v_mfma_f32_32x32x16_bf16 v[160:175], a[8:11], a[24:27], v[160:175]
    ds_read_b64_tr_b16 a[58:59], v230 offset:10240
    ds_read_b64_tr_b16 a[60:61], v231 offset:8192
    v_mfma_f32_32x32x16_bf16 a[64:79], a[8:11], a[28:31], a[64:79]
    s_add_u32 m0, s41, 3072
    s_add_u32 s44, s56, 27648
    buffer_load_dwordx4 v233, s[24:27], s44 offen lds
    v_mfma_f32_32x32x16_bf16 v[48:63], a[12:15], a[16:19], v[48:63]
    ds_read_b128 a[44:47], v225 offset:12288
    v_mfma_f32_32x32x16_bf16 v[112:127], a[12:15], a[20:23], v[112:127]
    ds_read_b64_tr_b16 a[62:63], v231 offset:10240
    v_mfma_f32_32x32x16_bf16 v[176:191], a[12:15], a[24:27], v[176:191]
    v_add_u32 v225, s55, v225
    v_mfma_f32_32x32x16_bf16 a[80:95], a[12:15], a[28:31], a[80:95]
    s_waitcnt vmcnt(17) lgkmcnt(0)
    s_barrier
    v_mfma_f32_32x32x16_bf16 v[0:15], a[32:35], a[48:51], v[0:15]
    ds_read_b64_tr_b16 a[16:17], v228 offset:16384
    v_mfma_f32_32x32x16_bf16 v[64:79], a[32:35], a[52:55], v[64:79]
    ds_read_b128 a[0:3], v226 offset:0
    v_mfma_f32_32x32x16_bf16 v[128:143], a[32:35], a[56:59], v[128:143]
    ds_read_b64_tr_b16 a[18:19], v228 offset:18432
    v_mfma_f32_32x32x16_bf16 v[192:207], a[32:35], a[60:63], v[192:207]
    s_add_u32 m0, s43, 0
    s_add_u32 s44, s57, 0
    buffer_load_dwordx4 v234, s[28:31], s44 offen lds
    v_mfma_f32_32x32x16_bf16 v[16:31], a[36:39], a[48:51], v[16:31]
    ds_read_b64_tr_b16 a[20:21], v229 offset:16384
    v_mfma_f32_32x32x16_bf16 v[80:95], a[36:39], a[52:55], v[80:95]
    ds_read_b128 a[4:7], v226 offset:4096
    v_mfma_f32_32x32x16_bf16 v[144:159], a[36:39], a[56:59], v[144:159]
    ds_read_b64_tr_b16 a[22:23], v229 offset:18432
    v_mfma_f32_32x32x16_bf16 v[208:223], a[36:39], a[60:63], v[208:223]
    ds_read_b64_tr_b16 a[24:25], v230 offset:16384
    v_mfma_f32_32x32x16_bf16 v[32:47], a[40:43], a[48:51], v[32:47]
    ds_read_b128 a[8:11], v226 offset:8192
    v_mfma_f32_32x32x16_bf16 v[96:111], a[40:43], a[52:55], v[96:111]
    ds_read_b64_tr_b16 a[26:27], v230 offset:18432
    v_mfma_f32_32x32x16_bf16 v[160:175], a[40:43], a[56:59], v[160:175]
    s_add_u32 s45, s58, 4194304
    buffer_load_dwordx4 v[252:255], v236, s[20:23], s45 offen
    v_mfma_f32_32x32x16_bf16 a[64:79], a[40:43], a[60:63], a[64:79]
    ds_read_b64_tr_b16 a[28:29], v231 offset:16384
    v_mfma_f32_32x32x16_bf16 v[48:63], a[44:47], a[48:51], v[48:63]
    ds_read_b128 a[12:15], v226 offset:12288
    v_mfma_f32_32x32x16_bf16 v[112:127], a[44:47], a[52:55], v[112:127]
    ds_read_b64_tr_b16 a[30:31], v231 offset:18432
    v_mfma_f32_32x32x16_bf16 v[176:191], a[44:47], a[56:59], v[176:191]
    v_add_u32 v226, s55, v226
    v_mfma_f32_32x32x16_bf16 a[80:95], a[44:47], a[60:63], a[80:95]
    s_waitcnt lgkmcnt(0)
    v_mfma_f32_32x32x16_bf16 v[0:15], a[0:3], a[16:19], v[0:15]
    ds_read_b64_tr_b16 a[48:49], v228 offset:24576
    s_add_u32 m0, s41, 4096
    s_add_u32 s44, s56, 36864
    buffer_load_dwordx4 v232, s[24:27], s44 offen lds
    v_mfma_f32_32x32x16_bf16 v[64:79], a[0:3], a[20:23], v[64:79]
    ds_read_b128 a[32:35], v227 offset:0
    v_mfma_f32_32x32x16_bf16 v[128:143], a[0:3], a[24:27], v[128:143]
    ds_read_b64_tr_b16 a[50:51], v228 offset:26624
    ds_read_b64_tr_b16 a[52:53], v229 offset:24576
    v_mfma_f32_32x32x16_bf16 v[192:207], a[0:3], a[28:31], v[192:207]
    s_add_u32 m0, s41, 5120
    s_add_u32 s44, s56, 46080
    buffer_load_dwordx4 v233, s[24:27], s44 offen lds
    v_mfma_f32_32x32x16_bf16 v[16:31], a[4:7], a[16:19], v[16:31]
    ds_read_b128 a[36:39], v227 offset:4096
    ds_read_b64_tr_b16 a[54:55], v229 offset:26624
    v_mfma_f32_32x32x16_bf16 v[80:95], a[4:7], a[20:23], v[80:95]
    ds_read_b64_tr_b16 a[56:57], v230 offset:24576
    v_mfma_f32_32x32x16_bf16 v[144:159], a[4:7], a[24:27], v[144:159]
    s_add_u32 m0, s41, 6144
    s_add_u32 s44, s56, 55296
    buffer_load_dwordx4 v232, s[24:27], s44 offen lds
    ds_read_b128 a[40:43], v227 offset:8192
    v_mfma_f32_32x32x16_bf16 v[208:223], a[4:7], a[28:31], v[208:223]
    ds_read_b64_tr_b16 a[58:59], v230 offset:26624
    v_mfma_f32_32x32x16_bf16 v[32:47], a[8:11], a[16:19], v[32:47]
    ds_read_b64_tr_b16 a[60:61], v231 offset:24576
    s_add_u32 m0, s41, 7168
    s_add_u32 s44, s56, 64512
    buffer_load_dwordx4 v233, s[24:27], s44 offen lds
    v_mfma_f32_32x32x16_bf16 v[96:111], a[8:11], a[20:23], v[96:111]
    ds_read_b128 a[44:47], v227 offset:12288
    v_mfma_f32_32x32x16_bf16 v[160:175], a[8:11], a[24:27], v[160:175]
    ds_read_b64_tr_b16 a[62:63], v231 offset:26624
    v_add_u32 v227, s55, v227
    v_mfma_f32_32x32x16_bf16 a[64:79], a[8:11], a[28:31], a[64:79]
    v_add_u32 v224, s55, v224
    v_mfma_f32_32x32x16_bf16 v[48:63], a[12:15], a[16:19], v[48:63]
    v_xor_b32 v228, 32768, v228
    v_xor_b32 v229, 32768, v229
    v_mfma_f32_32x32x16_bf16 v[112:127], a[12:15], a[20:23], v[112:127]
    v_xor_b32 v230, 32768, v230
    v_mfma_f32_32x32x16_bf16 v[176:191], a[12:15], a[24:27], v[176:191]
    v_xor_b32 v231, 32768, v231
    v_mfma_f32_32x32x16_bf16 a[80:95], a[12:15], a[28:31], a[80:95]
    s_waitcnt lgkmcnt(0)
    s_barrier
    v_mfma_f32_32x32x16_bf16 v[0:15], a[32:35], a[48:51], v[0:15]
    s_add_u32 m0, s43, 16384
    s_add_u32 s44, s57, 110592
    buffer_load_dwordx4 v234, s[28:31], s44 offen lds
    v_mfma_f32_32x32x16_bf16 v[64:79], a[32:35], a[52:55], v[64:79]
    v_mfma_f32_32x32x16_bf16 v[128:143], a[32:35], a[56:59], v[128:143]
    v_mfma_f32_32x32x16_bf16 v[192:207], a[32:35], a[60:63], v[192:207]
    v_mfma_f32_32x32x16_bf16 v[16:31], a[36:39], a[48:51], v[16:31]
    v_mfma_f32_32x32x16_bf16 v[80:95], a[36:39], a[52:55], v[80:95]
    s_add_u32 s57, s57, 221184
    s_xor_b32 s43, s43, 32768
    v_mfma_f32_32x32x16_bf16 v[144:159], a[36:39], a[56:59], v[144:159]
    v_mfma_f32_32x32x16_bf16 v[208:223], a[36:39], a[60:63], v[208:223]
    v_mfma_f32_32x32x16_bf16 v[32:47], a[40:43], a[48:51], v[32:47]
    v_mfma_f32_32x32x16_bf16 v[96:111], a[40:43], a[52:55], v[96:111]
    v_mfma_f32_32x32x16_bf16 v[160:175], a[40:43], a[56:59], v[160:175]
    s_add_u32 s56, s56, 128
    s_add_u32 s41, s41, 32768
    s_cmp_ge_u32 s41, 163840
    s_cselect_b32 s45, 98304, 0
    s_sub_u32 s41, s41, s45
    v_mfma_f32_32x32x16_bf16 a[64:79], a[40:43], a[60:63], a[64:79]
    v_mfma_f32_32x32x16_bf16 v[48:63], a[44:47], a[48:51], v[48:63]
    v_mfma_f32_32x32x16_bf16 v[112:127], a[44:47], a[52:55], v[112:127]
    v_mfma_f32_32x32x16_bf16 v[176:191], a[44:47], a[56:59], v[176:191]
    v_mfma_f32_32x32x16_bf16 a[80:95], a[44:47], a[60:63], a[80:95]
    s_add_u32 s60, s54, 8192
    s_add_u32 s61, s54, 12288
    s_add_u32 s62, s54, 9216
    s_add_u32 s63, s54, 13312
    s_add_u32 s64, s54, 10240
    s_add_u32 s65, s54, 14336
    s_add_u32 s66, s54, 11264
    s_add_u32 s67, s54, 15360
L_proj_B:
    s_nop 7
    s_nop 7
    v_cvt_pk_bf16_f32 v223, v222, v223
    v_cvt_pk_bf16_f32 v222, v220, v221
    v_cvt_pk_bf16_f32 v221, v218, v219
    v_cvt_pk_bf16_f32 v220, v216, v217
    v_cvt_pk_bf16_f32 v219, v214, v215
    v_cvt_pk_bf16_f32 v218, v212, v213
    v_cvt_pk_bf16_f32 v217, v210, v211
    v_cvt_pk_bf16_f32 v216, v208, v209
    v_cvt_pk_bf16_f32 v208, v192, v193
    v_cvt_pk_bf16_f32 v209, v194, v195
    v_cvt_pk_bf16_f32 v210, v196, v197
    v_cvt_pk_bf16_f32 v211, v198, v199
    v_cvt_pk_bf16_f32 v212, v200, v201
    v_cvt_pk_bf16_f32 v213, v202, v203
    v_cvt_pk_bf16_f32 v214, v204, v205
    v_cvt_pk_bf16_f32 v215, v206, v207
    v_cvt_pk_bf16_f32 v200, v176, v177
    v_cvt_pk_bf16_f32 v201, v178, v179
    v_cvt_pk_bf16_f32 v202, v180, v181
    v_cvt_pk_bf16_f32 v203, v182, v183
    v_cvt_pk_bf16_f32 v204, v184, v185
    v_cvt_pk_bf16_f32 v205, v186, v187
    v_cvt_pk_bf16_f32 v206, v188, v189
    v_cvt_pk_bf16_f32 v207, v190, v191
    v_cvt_pk_bf16_f32 v192, v160, v161
    v_cvt_pk_bf16_f32 v193, v162, v163
    v_cvt_pk_bf16_f32 v194, v164, v165
    v_cvt_pk_bf16_f32 v195, v166, v167
    v_cvt_pk_bf16_f32 v196, v168, v169
    v_cvt_pk_bf16_f32 v197, v170, v171
    v_cvt_pk_bf16_f32 v198, v172, v173
    v_cvt_pk_bf16_f32 v199, v174, v175
    v_cvt_pk_bf16_f32 v184, v144, v145
    v_cvt_pk_bf16_f32 v185, v146, v147
    v_cvt_pk_bf16_f32 v186, v148, v149
    v_cvt_pk_bf16_f32 v187, v150, v151
    v_cvt_pk_bf16_f32 v188, v152, v153
    v_cvt_pk_bf16_f32 v189, v154, v155
    v_cvt_pk_bf16_f32 v190, v156, v157
    v_cvt_pk_bf16_f32 v191, v158, v159
    v_cvt_pk_bf16_f32 v176, v128, v129
    v_cvt_pk_bf16_f32 v177, v130, v131
    v_cvt_pk_bf16_f32 v178, v132, v133
    v_cvt_pk_bf16_f32 v179, v134, v135
    v_cvt_pk_bf16_f32 v180, v136, v137
    v_cvt_pk_bf16_f32 v181, v138, v139
    v_cvt_pk_bf16_f32 v182, v140, v141
    v_cvt_pk_bf16_f32 v183, v142, v143
    v_cvt_pk_bf16_f32 v168, v112, v113
    v_cvt_pk_bf16_f32 v169, v114, v115
    v_cvt_pk_bf16_f32 v170, v116, v117
    v_cvt_pk_bf16_f32 v171, v118, v119
    v_cvt_pk_bf16_f32 v172, v120, v121
    v_cvt_pk_bf16_f32 v173, v122, v123
    v_cvt_pk_bf16_f32 v174, v124, v125
    v_cvt_pk_bf16_f32 v175, v126, v127
    v_cvt_pk_bf16_f32 v160, v96, v97
    v_cvt_pk_bf16_f32 v161, v98, v99
    v_cvt_pk_bf16_f32 v162, v100, v101
    v_cvt_pk_bf16_f32 v163, v102, v103
    v_cvt_pk_bf16_f32 v164, v104, v105
    v_cvt_pk_bf16_f32 v165, v106, v107
    v_cvt_pk_bf16_f32 v166, v108, v109
    v_cvt_pk_bf16_f32 v167, v110, v111
    v_cvt_pk_bf16_f32 v152, v80, v81
    v_cvt_pk_bf16_f32 v153, v82, v83
    v_cvt_pk_bf16_f32 v154, v84, v85
    v_cvt_pk_bf16_f32 v155, v86, v87
    v_cvt_pk_bf16_f32 v156, v88, v89
    v_cvt_pk_bf16_f32 v157, v90, v91
    v_cvt_pk_bf16_f32 v158, v92, v93
    v_cvt_pk_bf16_f32 v159, v94, v95
    v_cvt_pk_bf16_f32 v144, v64, v65
    v_cvt_pk_bf16_f32 v145, v66, v67
    v_cvt_pk_bf16_f32 v146, v68, v69
    v_cvt_pk_bf16_f32 v147, v70, v71
    v_cvt_pk_bf16_f32 v148, v72, v73
    v_cvt_pk_bf16_f32 v149, v74, v75
    v_cvt_pk_bf16_f32 v150, v76, v77
    v_cvt_pk_bf16_f32 v151, v78, v79
    v_cvt_pk_bf16_f32 v136, v48, v49
    v_cvt_pk_bf16_f32 v137, v50, v51
    v_cvt_pk_bf16_f32 v138, v52, v53
    v_cvt_pk_bf16_f32 v139, v54, v55
    v_cvt_pk_bf16_f32 v140, v56, v57
    v_cvt_pk_bf16_f32 v141, v58, v59
    v_cvt_pk_bf16_f32 v142, v60, v61
    v_cvt_pk_bf16_f32 v143, v62, v63
    v_cvt_pk_bf16_f32 v128, v32, v33
    v_cvt_pk_bf16_f32 v129, v34, v35
    v_cvt_pk_bf16_f32 v130, v36, v37
    v_cvt_pk_bf16_f32 v131, v38, v39
    v_cvt_pk_bf16_f32 v132, v40, v41
    v_cvt_pk_bf16_f32 v133, v42, v43
    v_cvt_pk_bf16_f32 v134, v44, v45
    v_cvt_pk_bf16_f32 v135, v46, v47
    v_cvt_pk_bf16_f32 v120, v16, v17
    v_cvt_pk_bf16_f32 v121, v18, v19
    v_cvt_pk_bf16_f32 v122, v20, v21
    v_cvt_pk_bf16_f32 v123, v22, v23
    v_cvt_pk_bf16_f32 v124, v24, v25
    v_cvt_pk_bf16_f32 v125, v26, v27
    v_cvt_pk_bf16_f32 v126, v28, v29
    v_cvt_pk_bf16_f32 v127, v30, v31
    v_cvt_pk_bf16_f32 v112, v0, v1
    v_cvt_pk_bf16_f32 v113, v2, v3
    v_cvt_pk_bf16_f32 v114, v4, v5
    v_cvt_pk_bf16_f32 v115, v6, v7
    v_cvt_pk_bf16_f32 v116, v8, v9
    v_cvt_pk_bf16_f32 v117, v10, v11
    v_cvt_pk_bf16_f32 v118, v12, v13
    v_cvt_pk_bf16_f32 v119, v14, v15
    v_accvgpr_read_b32 v0, a64
    v_accvgpr_read_b32 v1, a65
    v_accvgpr_read_b32 v2, a66
    v_accvgpr_read_b32 v3, a67
    v_accvgpr_read_b32 v4, a68
    v_accvgpr_read_b32 v5, a69
    v_accvgpr_read_b32 v6, a70
    v_accvgpr_read_b32 v7, a71
    v_accvgpr_read_b32 v8, a72
    v_accvgpr_read_b32 v9, a73
    v_accvgpr_read_b32 v10, a74
    v_accvgpr_read_b32 v11, a75
    v_accvgpr_read_b32 v12, a76
    v_accvgpr_read_b32 v13, a77
    v_accvgpr_read_b32 v14, a78
    v_accvgpr_read_b32 v15, a79
    v_cvt_pk_bf16_f32 v104, v0, v1
    v_cvt_pk_bf16_f32 v105, v2, v3
    v_cvt_pk_bf16_f32 v106, v4, v5
    v_cvt_pk_bf16_f32 v107, v6, v7
    v_cvt_pk_bf16_f32 v108, v8, v9
    v_cvt_pk_bf16_f32 v109, v10, v11
    v_cvt_pk_bf16_f32 v110, v12, v13
    v_cvt_pk_bf16_f32 v111, v14, v15
    v_accvgpr_read_b32 v16, a80
    v_accvgpr_read_b32 v17, a81
    v_accvgpr_read_b32 v18, a82
    v_accvgpr_read_b32 v19, a83
    v_accvgpr_read_b32 v20, a84
    v_accvgpr_read_b32 v21, a85
    v_accvgpr_read_b32 v22, a86
    v_accvgpr_read_b32 v23, a87
    v_accvgpr_read_b32 v24, a88
    v_accvgpr_read_b32 v25, a89
    v_accvgpr_read_b32 v26, a90
    v_accvgpr_read_b32 v27, a91
    v_accvgpr_read_b32 v28, a92
    v_accvgpr_read_b32 v29, a93
    v_accvgpr_read_b32 v30, a94
    v_accvgpr_read_b32 v31, a95
    v_cvt_pk_bf16_f32 v96, v16, v17
    v_cvt_pk_bf16_f32 v97, v18, v19
    v_cvt_pk_bf16_f32 v98, v20, v21
    v_cvt_pk_bf16_f32 v99, v22, v23
    v_cvt_pk_bf16_f32 v100, v24, v25
    v_cvt_pk_bf16_f32 v101, v26, v27
    v_cvt_pk_bf16_f32 v102, v28, v29
    v_cvt_pk_bf16_f32 v103, v30, v31
    s_cmp_ge_u32 s2, 216
    s_cbranch_scc1 L_proj_noB_X
    s_mov_b32 s40, s56
    s_mov_b32 s42, s57
    s_lshl_b32 s45, s3, 6
    s_mov_b32 s53, 0
    s_and_b32 s46, s43, 32768
    v_add_u32 v237, s45, v245
    v_bfe_u32 v238, v237, 1, 3
    v_xor_b32 v238, v238, v246
    v_lshlrev_b32 v238, 4, v238
    v_lshl_add_u32 v237, v237, 7, v238
    v_add_u32 v237, s47, v237
    v_mov_b32 v224, v237
    v_xor_b32 v225, 32, v237
    v_xor_b32 v226, 64, v237
    v_xor_b32 v227, 96, v237
    v_bfe_u32 v237, v244, 2, 2
    v_lshl_add_u32 v238, v246, 3, v237
    v_mul_u32_u24 v238, 128, v238
    v_bfe_u32 v239, v244, 4, 1
    v_and_b32 v240, 1, v244
    v_lshl_or_b32 v239, v239, 1, v240
    v_bfe_u32 v240, v237, 1, 1
    v_lshlrev_b32 v240, 2, v240
    v_bfe_u32 v241, v244, 1, 1
    v_lshl_add_u32 v238, v241, 3, v238
    v_add_u32 v238, s46, v238
    s_add_u32 s44, s53, 0
    s_lshl_b32 s44, s44, 2
    v_or_b32 v241, s44, v239
    v_xor_b32 v241, v241, v240
    v_lshl_add_u32 v228, v241, 4, v238
    s_add_u32 s44, s53, 1
    s_lshl_b32 s44, s44, 2
    v_or_b32 v241, s44, v239
    v_xor_b32 v241, v241, v240
    v_lshl_add_u32 v229, v241, 4, v238
    s_waitcnt vmcnt(13)
    s_barrier
    ds_read_b64_tr_b16 a[16:17], v228 offset:0
    ds_read_b128 a[0:3], v224 offset:0
    ds_read_b64_tr_b16 a[18:19], v228 offset:512
    ds_read_b64_tr_b16 a[20:21], v229 offset:0
    ds_read_b128 a[4:7], v224 offset:4096
    ds_read_b64_tr_b16 a[22:23], v229 offset:512
    s_waitcnt lgkmcnt(0)
    v_mfma_f32_32x32x16_bf16 v[0:15], a[0:3], a[16:19], 0
    s_add_u32 s47, s47, 32768
    s_mov_b32 s55, 32768
    s_cmp_eq_u32 s47, 163840
    s_cselect_b32 s55, -65536, s55
    s_cselect_b32 s47, 65536, s47
    s_add_u32 m0, s41, 0
    s_add_u32 s44, s40, 0
    buffer_load_dwordx4 v232, s[24:27], s44 offen lds
    ds_read_b64_tr_b16 a[48:49], v228 offset:2048
    s_add_u32 m0, s41, 1024
    s_add_u32 s44, s40, 9216
    buffer_load_dwordx4 v233, s[24:27], s44 offen lds
    ds_read_b128 a[32:35], v225 offset:0
    v_mfma_f32_32x32x16_bf16 v[32:47], a[0:3], a[20:23], 0
    s_add_u32 m0, s41, 2048
    s_add_u32 s44, s40, 18432
    buffer_load_dwordx4 v232, s[24:27], s44 offen lds
    ds_read_b64_tr_b16 a[50:51], v228 offset:2560
    ds_read_b64_tr_b16 a[52:53], v229 offset:2048
    s_add_u32 m0, s41, 3072
    s_add_u32 s44, s40, 27648
    buffer_load_dwordx4 v233, s[24:27], s44 offen lds
    v_mfma_f32_32x32x16_bf16 v[16:31], a[4:7], a[16:19], 0
    ds_read_b128 a[36:39], v225 offset:4096
    s_add_u32 s44, s62, 16384
    buffer_store_dwordx4 v[152:155], v236, s[32:35], s44 offen sc1
    ds_read_b64_tr_b16 a[54:55], v229 offset:2560
    v_add_u32 v225, s55, v225
    v_mfma_f32_32x32x16_bf16 v[48:63], a[4:7], a[20:23], 0
    s_waitcnt vmcnt(17) lgkmcnt(0)
    s_barrier
    v_mfma_f32_32x32x16_bf16 v[0:15], a[32:35], a[48:51], v[0:15]
    ds_read_b64_tr_b16 a[16:17], v228 offset:16384
    s_add_u32 m0, s43, 0
    s_add_u32 s44, s42, 0
    buffer_load_dwordx4 v234, s[28:31], s44 offen lds
    ds_read_b128 a[0:3], v226 offset:0
    v_mfma_f32_32x32x16_bf16 v[32:47], a[32:35], a[52:55], v[32:47]
    ds_read_b64_tr_b16 a[18:19], v228 offset:16896
    ds_read_b64_tr_b16 a[20:21], v229 offset:16384
    v_mfma_f32_32x32x16_bf16 v[16:31], a[36:39], a[48:51], v[16:31]
    s_add_u32 s44, s63, 16384
    buffer_store_dwordx4 v[156:159], v236, s[32:35], s44 offen sc1
    ds_read_b128 a[4:7], v226 offset:4096
    v_mfma_f32_32x32x16_bf16 v[48:63], a[36:39], a[52:55], v[48:63]
    ds_read_b64_tr_b16 a[22:23], v229 offset:16896
    v_add_u32 v226, s55, v226
    s_waitcnt lgkmcnt(0)
    v_mfma_f32_32x32x16_bf16 v[0:15], a[0:3], a[16:19], v[0:15]
    ds_read_b64_tr_b16 a[48:49], v228 offset:18432
    s_add_u32 m0, s41, 4096
    s_add_u32 s44, s40, 36864
    buffer_load_dwordx4 v232, s[24:27], s44 offen lds
    ds_read_b128 a[32:35], v227 offset:0
    s_add_u32 m0, s41, 5120
    s_add_u32 s44, s40, 46080
    buffer_load_dwordx4 v233, s[24:27], s44 offen lds
    ds_read_b64_tr_b16 a[50:51], v228 offset:18944
    v_mfma_f32_32x32x16_bf16 v[32:47], a[0:3], a[20:23], v[32:47]
    s_add_u32 m0, s41, 6144
    s_add_u32 s44, s40, 55296
    buffer_load_dwordx4 v232, s[24:27], s44 offen lds
    ds_read_b64_tr_b16 a[52:53], v229 offset:18432
    s_add_u32 m0, s41, 7168
    s_add_u32 s44, s40, 64512
    buffer_load_dwordx4 v233, s[24:27], s44 offen lds
    ds_read_b128 a[36:39], v227 offset:4096
    s_add_u32 s44, s62, 0
    buffer_store_dwordx4 v[144:147], v236, s[32:35], s44 offen sc1
    v_mfma_f32_32x32x16_bf16 v[16:31], a[4:7], a[16:19], v[16:31]
    ds_read_b64_tr_b16 a[54:55], v229 offset:18944
    v_add_u32 v227, s55, v227
    v_add_u32 v224, s55, v224
    v_xor_b32 v228, 32768, v228
    v_xor_b32 v229, 32768, v229
    v_mfma_f32_32x32x16_bf16 v[48:63], a[4:7], a[20:23], v[48:63]
    s_waitcnt vmcnt(13) lgkmcnt(0)
    s_barrier
    v_mfma_f32_32x32x16_bf16 v[0:15], a[32:35], a[48:51], v[0:15]
    ds_read_b64_tr_b16 a[16:17], v228 offset:0
    s_add_u32 m0, s43, 16384
    s_add_u32 s44, s42, 110592
    buffer_load_dwordx4 v234, s[28:31], s44 offen lds
    ds_read_b128 a[0:3], v224 offset:0
    v_mfma_f32_32x32x16_bf16 v[32:47], a[32:35], a[52:55], v[32:47]
    ds_read_b64_tr_b16 a[18:19], v228 offset:512
    ds_read_b64_tr_b16 a[20:21], v229 offset:0
    v_mfma_f32_32x32x16_bf16 v[16:31], a[36:39], a[48:51], v[16:31]
    s_add_u32 s44, s63, 0
    buffer_store_dwordx4 v[148:151], v236, s[32:35], s44 offen sc1
    ds_read_b128 a[4:7], v224 offset:4096
    ds_read_b64_tr_b16 a[22:23], v229 offset:512
    v_mfma_f32_32x32x16_bf16 v[48:63], a[36:39], a[52:55], v[48:63]
    s_add_u32 s42, s42, 221184
    s_xor_b32 s43, s43, 32768
    s_add_u32 s40, s40, 128
    s_add_u32 s41, s41, 32768
    s_cmp_ge_u32 s41, 163840
    s_cselect_b32 s45, 98304, 0
    s_sub_u32 s41, s41, s45
    s_waitcnt lgkmcnt(0)
    v_mfma_f32_32x32x16_bf16 v[0:15], a[0:3], a[16:19], v[0:15]
    s_add_u32 s47, s47, 32768
    s_mov_b32 s55, 32768
    s_cmp_eq_u32 s47, 163840
    s_cselect_b32 s55, -65536, s55
    s_cselect_b32 s47, 65536, s47
    s_add_u32 m0, s41, 0
    s_add_u32 s44, s40, 0
    buffer_load_dwordx4 v232, s[24:27], s44 offen lds
    ds_read_b64_tr_b16 a[48:49], v228 offset:2048
    s_add_u32 m0, s41, 1024
    s_add_u32 s44, s40, 9216
    buffer_load_dwordx4 v233, s[24:27], s44 offen lds
    ds_read_b128 a[32:35], v225 offset:0
    v_mfma_f32_32x32x16_bf16 v[32:47], a[0:3], a[20:23], v[32:47]
    s_add_u32 m0, s41, 2048
    s_add_u32 s44, s40, 18432
    buffer_load_dwordx4 v232, s[24:27], s44 offen lds
    ds_read_b64_tr_b16 a[50:51], v228 offset:2560
    ds_read_b64_tr_b16 a[52:53], v229 offset:2048
    s_add_u32 m0, s41, 3072
    s_add_u32 s44, s40, 27648
    buffer_load_dwordx4 v233, s[24:27], s44 offen lds
    v_mfma_f32_32x32x16_bf16 v[16:31], a[4:7], a[16:19], v[16:31]
    ds_read_b128 a[36:39], v225 offset:4096
    s_add_u32 s44, s60, 49152
    buffer_store_dwordx4 v[136:139], v236, s[32:35], s44 offen sc1
    ds_read_b64_tr_b16 a[54:55], v229 offset:2560
    v_add_u32 v225, s55, v225
    v_mfma_f32_32x32x16_bf16 v[48:63], a[4:7], a[20:23], v[48:63]
    s_waitcnt vmcnt(19) lgkmcnt(0)
    s_barrier
    v_mfma_f32_32x32x16_bf16 v[0:15], a[32:35], a[48:51], v[0:15]
    ds_read_b64_tr_b16 a[16:17], v228 offset:16384
    s_add_u32 m0, s43, 0
    s_add_u32 s44, s42, 0
    buffer_load_dwordx4 v234, s[28:31], s44 offen lds
    ds_read_b128 a[0:3], v226 offset:0
    v_mfma_f32_32x32x16_bf16 v[32:47], a[32:35], a[52:55], v[32:47]
    ds_read_b64_tr_b16 a[18:19], v228 offset:16896
    ds_read_b64_tr_b16 a[20:21], v229 offset:16384
    v_mfma_f32_32x32x16_bf16 v[16:31], a[36:39], a[48:51], v[16:31]
    s_add_u32 s44, s61, 49152
    buffer_store_dwordx4 v[140:143], v236, s[32:35], s44 offen sc1
    ds_read_b128 a[4:7], v226 offset:4096
    v_mfma_f32_32x32x16_bf16 v[48:63], a[36:39], a[52:55], v[48:63]
    ds_read_b64_tr_b16 a[22:23], v229 offset:16896
    v_add_u32 v226, s55, v226
    s_waitcnt lgkmcnt(0)
    v_mfma_f32_32x32x16_bf16 v[0:15], a[0:3], a[16:19], v[0:15]
    ds_read_b64_tr_b16 a[48:49], v228 offset:18432
    s_add_u32 m0, s41, 4096
    s_add_u32 s44, s40, 36864
    buffer_load_dwordx4 v232, s[24:27], s44 offen lds
    ds_read_b128 a[32:35], v227 offset:0
    s_add_u32 m0, s41, 5120
    s_add_u32 s44, s40, 46080
    buffer_load_dwordx4 v233, s[24:27], s44 offen lds
    ds_read_b64_tr_b16 a[50:51], v228 offset:18944
    v_mfma_f32_32x32x16_bf16 v[32:47], a[0:3], a[20:23], v[32:47]
    s_add_u32 m0, s41, 6144
    s_add_u32 s44, s40, 55296
    buffer_load_dwordx4 v232, s[24:27], s44 offen lds
    ds_read_b64_tr_b16 a[52:53], v229 offset:18432
    s_add_u32 m0, s41, 7168
    s_add_u32 s44, s40, 64512
    buffer_load_dwordx4 v233, s[24:27], s44 offen lds
    ds_read_b128 a[36:39], v227 offset:4096
    s_add_u32 s44, s60, 32768
    buffer_store_dwordx4 v[128:131], v236, s[32:35], s44 offen sc1
    v_mfma_f32_32x32x16_bf16 v[16:31], a[4:7], a[16:19], v[16:31]
    ds_read_b64_tr_b16 a[54:55], v229 offset:18944
    v_add_u32 v227, s55, v227
    v_add_u32 v224, s55, v224
    v_xor_b32 v228, 32768, v228
    v_xor_b32 v229, 32768, v229
    v_mfma_f32_32x32x16_bf16 v[48:63], a[4:7], a[20:23], v[48:63]
    s_waitcnt vmcnt(15) lgkmcnt(0)
    s_barrier
    v_mfma_f32_32x32x16_bf16 v[0:15], a[32:35], a[48:51], v[0:15]
    ds_read_b64_tr_b16 a[16:17], v228 offset:0
    s_add_u32 m0, s43, 16384
    s_add_u32 s44, s42, 110592
    buffer_load_dwordx4 v234, s[28:31], s44 offen lds
    ds_read_b128 a[0:3], v224 offset:0
    v_mfma_f32_32x32x16_bf16 v[32:47], a[32:35], a[52:55], v[32:47]
    ds_read_b64_tr_b16 a[18:19], v228 offset:512
    ds_read_b64_tr_b16 a[20:21], v229 offset:0
    v_mfma_f32_32x32x16_bf16 v[16:31], a[36:39], a[48:51], v[16:31]
    s_add_u32 s44, s61, 32768
    buffer_store_dwordx4 v[132:135], v236, s[32:35], s44 offen sc1
    ds_read_b128 a[4:7], v224 offset:4096
    ds_read_b64_tr_b16 a[22:23], v229 offset:512
    v_mfma_f32_32x32x16_bf16 v[48:63], a[36:39], a[52:55], v[48:63]
    s_add_u32 s42, s42, 221184
    s_xor_b32 s43, s43, 32768
    s_add_u32 s40, s40, 128
    s_add_u32 s41, s41, 32768
    s_cmp_ge_u32 s41, 163840
    s_cselect_b32 s45, 98304, 0
    s_sub_u32 s41, s41, s45
    s_waitcnt lgkmcnt(0)
    v_mfma_f32_32x32x16_bf16 v[0:15], a[0:3], a[16:19], v[0:15]
    s_add_u32 s47, s47, 32768
    s_mov_b32 s55, 32768
    s_cmp_eq_u32 s47, 163840
    s_cselect_b32 s55, -65536, s55
    s_cselect_b32 s47, 65536, s47
    s_add_u32 m0, s41, 0
    s_add_u32 s44, s40, 0
    buffer_load_dwordx4 v232, s[24:27], s44 offen lds
    ds_read_b64_tr_b16 a[48:49], v228 offset:2048
    s_add_u32 m0, s41, 1024
    s_add_u32 s44, s40, 9216
    buffer_load_dwordx4 v233, s[24:27], s44 offen lds
    ds_read_b128 a[32:35], v225 offset:0
    v_mfma_f32_32x32x16_bf16 v[32:47], a[0:3], a[20:23], v[32:47]
    s_add_u32 m0, s41, 2048
    s_add_u32 s44, s40, 18432
    buffer_load_dwordx4 v232, s[24:27], s44 offen lds
    ds_read_b64_tr_b16 a[50:51], v228 offset:2560
    ds_read_b64_tr_b16 a[52:53], v229 offset:2048
    s_add_u32 m0, s41, 3072
    s_add_u32 s44, s40, 27648
    buffer_load_dwordx4 v233, s[24:27], s44 offen lds
    v_mfma_f32_32x32x16_bf16 v[16:31], a[4:7], a[16:19], v[16:31]
    ds_read_b128 a[36:39], v225 offset:4096
    s_add_u32 s44, s60, 16384
    buffer_store_dwordx4 v[120:123], v236, s[32:35], s44 offen sc1
    ds_read_b64_tr_b16 a[54:55], v229 offset:2560
    v_add_u32 v225, s55, v225
    v_mfma_f32_32x32x16_bf16 v[48:63], a[4:7], a[20:23], v[48:63]
    s_waitcnt vmcnt(20) lgkmcnt(0)
    s_barrier
    v_mfma_f32_32x32x16_bf16 v[0:15], a[32:35], a[48:51], v[0:15]
    ds_read_b64_tr_b16 a[16:17], v228 offset:16384
    s_add_u32 m0, s43, 0
    s_add_u32 s44, s42, 0
    buffer_load_dwordx4 v234, s[28:31], s44 offen lds
    ds_read_b128 a[0:3], v226 offset:0
    v_mfma_f32_32x32x16_bf16 v[32:47], a[32:35], a[52:55], v[32:47]
    ds_read_b64_tr_b16 a[18:19], v228 offset:16896
    ds_read_b64_tr_b16 a[20:21], v229 offset:16384
    v_mfma_f32_32x32x16_bf16 v[16:31], a[36:39], a[48:51], v[16:31]
    s_add_u32 s44, s61, 16384
    buffer_store_dwordx4 v[124:127], v236, s[32:35], s44 offen sc1
    ds_read_b128 a[4:7], v226 offset:4096
    v_mfma_f32_32x32x16_bf16 v[48:63], a[36:39], a[52:55], v[48:63]
    ds_read_b64_tr_b16 a[22:23], v229 offset:16896
    v_add_u32 v226, s55, v226
    s_waitcnt lgkmcnt(0)
    v_mfma_f32_32x32x16_bf16 v[0:15], a[0:3], a[16:19], v[0:15]
    ds_read_b64_tr_b16 a[48:49], v228 offset:18432
    s_add_u32 m0, s41, 4096
    s_add_u32 s44, s40, 36864
    buffer_load_dwordx4 v232, s[24:27], s44 offen lds
    ds_read_b128 a[32:35], v227 offset:0
    s_add_u32 m0, s41, 5120
    s_add_u32 s44, s40, 46080
    buffer_load_dwordx4 v233, s[24:27], s44 offen lds
    ds_read_b64_tr_b16 a[50:51], v228 offset:18944
    v_mfma_f32_32x32x16_bf16 v[32:47], a[0:3], a[20:23], v[32:47]
    s_add_u32 m0, s41, 6144
    s_add_u32 s44, s40, 55296
    buffer_load_dwordx4 v232, s[24:27], s44 offen lds
    ds_read_b64_tr_b16 a[52:53], v229 offset:18432
    s_add_u32 m0, s41, 7168
    s_add_u32 s44, s40, 64512
    buffer_load_dwordx4 v233, s[24:27], s44 offen lds
    ds_read_b128 a[36:39], v227 offset:4096
    s_add_u32 s44, s60, 0
    buffer_store_dwordx4 v[112:115], v236, s[32:35], s44 offen sc1
    v_mfma_f32_32x32x16_bf16 v[16:31], a[4:7], a[16:19], v[16:31]
    ds_read_b64_tr_b16 a[54:55], v229 offset:18944
    v_add_u32 v227, s55, v227
    v_add_u32 v224, s55, v224
    v_xor_b32 v228, 32768, v228
    v_xor_b32 v229, 32768, v229
    v_mfma_f32_32x32x16_bf16 v[48:63], a[4:7], a[20:23], v[48:63]
    s_waitcnt vmcnt(15) lgkmcnt(0)
    s_barrier
    v_mfma_f32_32x32x16_bf16 v[0:15], a[32:35], a[48:51], v[0:15]
    ds_read_b64_tr_b16 a[16:17], v228 offset:0
    s_add_u32 m0, s43, 16384
    s_add_u32 s44, s42, 110592
    buffer_load_dwordx4 v234, s[28:31], s44 offen lds
    ds_read_b128 a[0:3], v224 offset:0
    v_mfma_f32_32x32x16_bf16 v[32:47], a[32:35], a[52:55], v[32:47]
    ds_read_b64_tr_b16 a[18:19], v228 offset:512
    ds_read_b64_tr_b16 a[20:21], v229 offset:0
    v_mfma_f32_32x32x16_bf16 v[16:31], a[36:39], a[48:51], v[16:31]
    s_add_u32 s44, s61, 0
    buffer_store_dwordx4 v[116:119], v236, s[32:35], s44 offen sc1
    ds_read_b128 a[4:7], v224 offset:4096
    ds_read_b64_tr_b16 a[22:23], v229 offset:512
    v_mfma_f32_32x32x16_bf16 v[48:63], a[36:39], a[52:55], v[48:63]
    s_add_u32 s42, s42, 221184
    s_xor_b32 s43, s43, 32768
    s_add_u32 s40, s40, 128
    s_add_u32 s41, s41, 32768
    s_cmp_ge_u32 s41, 163840
    s_cselect_b32 s45, 98304, 0
    s_sub_u32 s41, s41, s45
    s_waitcnt lgkmcnt(0)
    v_mfma_f32_32x32x16_bf16 v[0:15], a[0:3], a[16:19], v[0:15]
    s_add_u32 s47, s47, 32768
    s_mov_b32 s55, 32768
    s_cmp_eq_u32 s47, 163840
    s_cselect_b32 s55, -65536, s55
    s_cselect_b32 s47, 65536, s47
    s_add_u32 m0, s41, 0
    s_add_u32 s44, s40, 0
    buffer_load_dwordx4 v232, s[24:27], s44 offen lds
    ds_read_b64_tr_b16 a[48:49], v228 offset:2048
    s_add_u32 m0, s41, 1024
    s_add_u32 s44, s40, 9216
    buffer_load_dwordx4 v233, s[24:27], s44 offen lds
    ds_read_b128 a[32:35], v225 offset:0
    v_mfma_f32_32x32x16_bf16 v[32:47], a[0:3], a[20:23], v[32:47]
    s_add_u32 m0, s41, 2048
    s_add_u32 s44, s40, 18432
    buffer_load_dwordx4 v232, s[24:27], s44 offen lds
    ds_read_b64_tr_b16 a[50:51], v228 offset:2560
    ds_read_b64_tr_b16 a[52:53], v229 offset:2048
    s_add_u32 m0, s41, 3072
    s_add_u32 s44, s40, 27648
    buffer_load_dwordx4 v233, s[24:27], s44 offen lds
    v_mfma_f32_32x32x16_bf16 v[16:31], a[4:7], a[16:19], v[16:31]
    ds_read_b128 a[36:39], v225 offset:4096
    s_add_u32 s44, s66, 32768
    buffer_store_dwordx4 v[104:107], v236, s[32:35], s44 offen sc1
    ds_read_b64_tr_b16 a[54:55], v229 offset:2560
    v_add_u32 v225, s55, v225
    v_mfma_f32_32x32x16_bf16 v[48:63], a[4:7], a[20:23], v[48:63]
    s_waitcnt vmcnt(20) lgkmcnt(0)
    s_barrier
    v_mfma_f32_32x32x16_bf16 v[0:15], a[32:35], a[48:51], v[0:15]
    ds_read_b64_tr_b16 a[16:17], v228 offset:16384
    s_add_u32 m0, s43, 0
    s_add_u32 s44, s42, 0
    buffer_load_dwordx4 v234, s[28:31], s44 offen lds
    ds_read_b128 a[0:3], v226 offset:0
    v_mfma_f32_32x32x16_bf16 v[32:47], a[32:35], a[52:55], v[32:47]
    ds_read_b64_tr_b16 a[18:19], v228 offset:16896
    ds_read_b64_tr_b16 a[20:21], v229 offset:16384
    v_mfma_f32_32x32x16_bf16 v[16:31], a[36:39], a[48:51], v[16:31]
    s_add_u32 s44, s67, 32768
    buffer_store_dwordx4 v[108:111], v236, s[32:35], s44 offen sc1
    ds_read_b128 a[4:7], v226 offset:4096
    v_mfma_f32_32x32x16_bf16 v[48:63], a[36:39], a[52:55], v[48:63]
    ds_read_b64_tr_b16 a[22:23], v229 offset:16896
    v_add_u32 v226, s55, v226
    s_waitcnt lgkmcnt(0)
    v_mfma_f32_32x32x16_bf16 v[0:15], a[0:3], a[16:19], v[0:15]
    ds_read_b64_tr_b16 a[48:49], v228 offset:18432
    s_add_u32 m0, s41, 4096
    s_add_u32 s44, s40, 36864
    buffer_load_dwordx4 v232, s[24:27], s44 offen lds
    ds_read_b128 a[32:35], v227 offset:0
    s_add_u32 m0, s41, 5120
    s_add_u32 s44, s40, 46080
    buffer_load_dwordx4 v233, s[24:27], s44 offen lds
    ds_read_b64_tr_b16 a[50:51], v228 offset:18944
    v_mfma_f32_32x32x16_bf16 v[32:47], a[0:3], a[20:23], v[32:47]
    s_add_u32 m0, s41, 6144
    s_add_u32 s44, s40, 55296
    buffer_load_dwordx4 v232, s[24:27], s44 offen lds
    ds_read_b64_tr_b16 a[52:53], v229 offset:18432
    s_add_u32 m0, s41, 7168
    s_add_u32 s44, s40, 64512
    buffer_load_dwordx4 v233, s[24:27], s44 offen lds
    ds_read_b128 a[36:39], v227 offset:4096
    s_add_u32 s44, s66, 49152
    buffer_store_dwordx4 v[96:99], v236, s[32:35], s44 offen sc1
    v_mfma_f32_32x32x16_bf16 v[16:31], a[4:7], a[16:19], v[16:31]
    ds_read_b64_tr_b16 a[54:55], v229 offset:18944
    v_add_u32 v227, s55, v227
    v_add_u32 v224, s55, v224
    v_xor_b32 v228, 32768, v228
    v_xor_b32 v229, 32768, v229
    v_mfma_f32_32x32x16_bf16 v[48:63], a[4:7], a[20:23], v[48:63]
    s_waitcnt vmcnt(15) lgkmcnt(0)
    s_barrier
    v_mfma_f32_32x32x16_bf16 v[0:15], a[32:35], a[48:51], v[0:15]
    ds_read_b64_tr_b16 a[16:17], v228 offset:0
    s_add_u32 m0, s43, 16384
    s_add_u32 s44, s42, 110592
    buffer_load_dwordx4 v234, s[28:31], s44 offen lds
    ds_read_b128 a[0:3], v224 offset:0
    v_mfma_f32_32x32x16_bf16 v[32:47], a[32:35], a[52:55], v[32:47]
    ds_read_b64_tr_b16 a[18:19], v228 offset:512
    ds_read_b64_tr_b16 a[20:21], v229 offset:0
    v_mfma_f32_32x32x16_bf16 v[16:31], a[36:39], a[48:51], v[16:31]
    s_add_u32 s44, s67, 49152
    buffer_store_dwordx4 v[100:103], v236, s[32:35], s44 offen sc1
    ds_read_b128 a[4:7], v224 offset:4096
    ds_read_b64_tr_b16 a[22:23], v229 offset:512
    v_mfma_f32_32x32x16_bf16 v[48:63], a[36:39], a[52:55], v[48:63]
    s_add_u32 s42, s42, 221184
    s_xor_b32 s43, s43, 32768
    s_add_u32 s40, s40, 128
    s_add_u32 s41, s41, 32768
    s_cmp_ge_u32 s41, 163840
    s_cselect_b32 s45, 98304, 0
    s_sub_u32 s41, s41, s45
    s_waitcnt lgkmcnt(0)
    v_mfma_f32_32x32x16_bf16 v[0:15], a[0:3], a[16:19], v[0:15]
    s_add_u32 s47, s47, 32768
    s_mov_b32 s55, 32768
    s_cmp_eq_u32 s47, 163840
    s_cselect_b32 s55, -65536, s55
    s_cselect_b32 s47, 65536, s47
    s_add_u32 m0, s41, 0
    s_add_u32 s44, s40, 0
    buffer_load_dwordx4 v232, s[24:27], s44 offen lds
    ds_read_b64_tr_b16 a[48:49], v228 offset:2048
    s_add_u32 m0, s41, 1024
    s_add_u32 s44, s40, 9216
    buffer_load_dwordx4 v233, s[24:27], s44 offen lds
    ds_read_b128 a[32:35], v225 offset:0
    v_mfma_f32_32x32x16_bf16 v[32:47], a[0:3], a[20:23], v[32:47]
    s_add_u32 m0, s41, 2048
    s_add_u32 s44, s40, 18432
    buffer_load_dwordx4 v232, s[24:27], s44 offen lds
    ds_read_b64_tr_b16 a[50:51], v228 offset:2560
    ds_read_b64_tr_b16 a[52:53], v229 offset:2048
    s_add_u32 m0, s41, 3072
    s_add_u32 s44, s40, 27648
    buffer_load_dwordx4 v233, s[24:27], s44 offen lds
    v_mfma_f32_32x32x16_bf16 v[16:31], a[4:7], a[16:19], v[16:31]
    ds_read_b128 a[36:39], v225 offset:4096
    s_add_u32 s44, s66, 16384
    buffer_store_dwordx4 v[216:219], v236, s[32:35], s44 offen sc1
    ds_read_b64_tr_b16 a[54:55], v229 offset:2560
    v_add_u32 v225, s55, v225
    v_mfma_f32_32x32x16_bf16 v[48:63], a[4:7], a[20:23], v[48:63]
    s_waitcnt vmcnt(20) lgkmcnt(0)
    s_barrier
    v_mfma_f32_32x32x16_bf16 v[0:15], a[32:35], a[48:51], v[0:15]
    ds_read_b64_tr_b16 a[16:17], v228 offset:16384
    s_add_u32 m0, s43, 0
    s_add_u32 s44, s42, 0
    buffer_load_dwordx4 v234, s[28:31], s44 offen lds
    ds_read_b128 a[0:3], v226 offset:0
    v_mfma_f32_32x32x16_bf16 v[32:47], a[32:35], a[52:55], v[32:47]
    ds_read_b64_tr_b16 a[18:19], v228 offset:16896
    ds_read_b64_tr_b16 a[20:21], v229 offset:16384
    v_mfma_f32_32x32x16_bf16 v[16:31], a[36:39], a[48:51], v[16:31]
    s_add_u32 s44, s67, 16384
    buffer_store_dwordx4 v[220:223], v236, s[32:35], s44 offen sc1
    ds_read_b128 a[4:7], v226 offset:4096
    v_mfma_f32_32x32x16_bf16 v[48:63], a[36:39], a[52:55], v[48:63]
    ds_read_b64_tr_b16 a[22:23], v229 offset:16896
    v_add_u32 v226, s55, v226
    s_waitcnt lgkmcnt(0)
    v_mfma_f32_32x32x16_bf16 v[0:15], a[0:3], a[16:19], v[0:15]
    ds_read_b64_tr_b16 a[48:49], v228 offset:18432
    s_add_u32 m0, s41, 4096
    s_add_u32 s44, s40, 36864
    buffer_load_dwordx4 v232, s[24:27], s44 offen lds
    ds_read_b128 a[32:35], v227 offset:0
    s_add_u32 m0, s41, 5120
    s_add_u32 s44, s40, 46080
    buffer_load_dwordx4 v233, s[24:27], s44 offen lds
    ds_read_b64_tr_b16 a[50:51], v228 offset:18944
    v_mfma_f32_32x32x16_bf16 v[32:47], a[0:3], a[20:23], v[32:47]
    s_add_u32 m0, s41, 6144
    s_add_u32 s44, s40, 55296
    buffer_load_dwordx4 v232, s[24:27], s44 offen lds
    ds_read_b64_tr_b16 a[52:53], v229 offset:18432
    s_add_u32 m0, s41, 7168
    s_add_u32 s44, s40, 64512
    buffer_load_dwordx4 v233, s[24:27], s44 offen lds
    ds_read_b128 a[36:39], v227 offset:4096
    s_add_u32 s44, s66, 0
    buffer_store_dwordx4 v[208:211], v236, s[32:35], s44 offen sc1
    v_mfma_f32_32x32x16_bf16 v[16:31], a[4:7], a[16:19], v[16:31]
    ds_read_b64_tr_b16 a[54:55], v229 offset:18944
    v_add_u32 v227, s55, v227
    v_add_u32 v224, s55, v224
    v_xor_b32 v228, 32768, v228
    v_xor_b32 v229, 32768, v229
    v_mfma_f32_32x32x16_bf16 v[48:63], a[4:7], a[20:23], v[48:63]
    s_waitcnt vmcnt(15) lgkmcnt(0)
    s_barrier
    v_mfma_f32_32x32x16_bf16 v[0:15], a[32:35], a[48:51], v[0:15]
    ds_read_b64_tr_b16 a[16:17], v228 offset:0
    s_add_u32 m0, s43, 16384
    s_add_u32 s44, s42, 110592
    buffer_load_dwordx4 v234, s[28:31], s44 offen lds
    ds_read_b128 a[0:3], v224 offset:0
    v_mfma_f32_32x32x16_bf16 v[32:47], a[32:35], a[52:55], v[32:47]
    ds_read_b64_tr_b16 a[18:19], v228 offset:512
    ds_read_b64_tr_b16 a[20:21], v229 offset:0
    v_mfma_f32_32x32x16_bf16 v[16:31], a[36:39], a[48:51], v[16:31]
    s_add_u32 s44, s67, 0
    buffer_store_dwordx4 v[212:215], v236, s[32:35], s44 offen sc1
    ds_read_b128 a[4:7], v224 offset:4096
    ds_read_b64_tr_b16 a[22:23], v229 offset:512
    v_mfma_f32_32x32x16_bf16 v[48:63], a[36:39], a[52:55], v[48:63]
    s_add_u32 s42, s42, 221184
    s_xor_b32 s43, s43, 32768
    s_add_u32 s40, s40, 128
    s_add_u32 s41, s41, 32768
    s_cmp_ge_u32 s41, 163840
    s_cselect_b32 s45, 98304, 0
    s_sub_u32 s41, s41, s45
    s_waitcnt lgkmcnt(0)
    v_mfma_f32_32x32x16_bf16 v[0:15], a[0:3], a[16:19], v[0:15]
    s_add_u32 s47, s47, 32768
    s_mov_b32 s55, 32768
    s_cmp_eq_u32 s47, 163840
    s_cselect_b32 s55, -65536, s55
    s_cselect_b32 s47, 65536, s47
    s_add_u32 m0, s41, 0
    s_add_u32 s44, s40, 0
    buffer_load_dwordx4 v232, s[24:27], s44 offen lds
    ds_read_b64_tr_b16 a[48:49], v228 offset:2048
    s_add_u32 m0, s41, 1024
    s_add_u32 s44, s40, 9216
    buffer_load_dwordx4 v233, s[24:27], s44 offen lds
    ds_read_b128 a[32:35], v225 offset:0
    v_mfma_f32_32x32x16_bf16 v[32:47], a[0:3], a[20:23], v[32:47]
    s_add_u32 m0, s41, 2048
    s_add_u32 s44, s40, 18432
    buffer_load_dwordx4 v232, s[24:27], s44 offen lds
    ds_read_b64_tr_b16 a[50:51], v228 offset:2560
    ds_read_b64_tr_b16 a[52:53], v229 offset:2048
    s_add_u32 m0, s41, 3072
    s_add_u32 s44, s40, 27648
    buffer_load_dwordx4 v233, s[24:27], s44 offen lds
    v_mfma_f32_32x32x16_bf16 v[16:31], a[4:7], a[16:19], v[16:31]
    ds_read_b128 a[36:39], v225 offset:4096
    s_add_u32 s44, s64, 49152
    buffer_store_dwordx4 v[200:203], v236, s[32:35], s44 offen sc1
    ds_read_b64_tr_b16 a[54:55], v229 offset:2560
    v_add_u32 v225, s55, v225
    v_mfma_f32_32x32x16_bf16 v[48:63], a[4:7], a[20:23], v[48:63]
    s_waitcnt vmcnt(20) lgkmcnt(0)
    s_barrier
    v_mfma_f32_32x32x16_bf16 v[0:15], a[32:35], a[48:51], v[0:15]
    ds_read_b64_tr_b16 a[16:17], v228 offset:16384
    s_add_u32 m0, s43, 0
    s_add_u32 s44, s42, 0
    buffer_load_dwordx4 v234, s[28:31], s44 offen lds
    ds_read_b128 a[0:3], v226 offset:0
    v_mfma_f32_32x32x16_bf16 v[32:47], a[32:35], a[52:55], v[32:47]
    ds_read_b64_tr_b16 a[18:19], v228 offset:16896
    ds_read_b64_tr_b16 a[20:21], v229 offset:16384
    v_mfma_f32_32x32x16_bf16 v[16:31], a[36:39], a[48:51], v[16:31]
    s_add_u32 s44, s65, 49152
    buffer_store_dwordx4 v[204:207], v236, s[32:35], s44 offen sc1
    ds_read_b128 a[4:7], v226 offset:4096
    v_mfma_f32_32x32x16_bf16 v[48:63], a[36:39], a[52:55], v[48:63]
    ds_read_b64_tr_b16 a[22:23], v229 offset:16896
    v_add_u32 v226, s55, v226
    s_waitcnt lgkmcnt(0)
    v_mfma_f32_32x32x16_bf16 v[0:15], a[0:3], a[16:19], v[0:15]
    ds_read_b64_tr_b16 a[48:49], v228 offset:18432
    s_add_u32 m0, s41, 4096
    s_add_u32 s44, s40, 36864
    buffer_load_dwordx4 v232, s[24:27], s44 offen lds
    ds_read_b128 a[32:35], v227 offset:0
    s_add_u32 m0, s41, 5120
    s_add_u32 s44, s40, 46080
    buffer_load_dwordx4 v233, s[24:27], s44 offen lds
    ds_read_b64_tr_b16 a[50:51], v228 offset:18944
    v_mfma_f32_32x32x16_bf16 v[32:47], a[0:3], a[20:23], v[32:47]
    s_add_u32 m0, s41, 6144
    s_add_u32 s44, s40, 55296
    buffer_load_dwordx4 v232, s[24:27], s44 offen lds
    ds_read_b64_tr_b16 a[52:53], v229 offset:18432
    s_add_u32 m0, s41, 7168
    s_add_u32 s44, s40, 64512
    buffer_load_dwordx4 v233, s[24:27], s44 offen lds
    ds_read_b128 a[36:39], v227 offset:4096
    s_add_u32 s44, s64, 32768
    buffer_store_dwordx4 v[192:195], v236, s[32:35], s44 offen sc1
    v_mfma_f32_32x32x16_bf16 v[16:31], a[4:7], a[16:19], v[16:31]
    ds_read_b64_tr_b16 a[54:55], v229 offset:18944
    v_add_u32 v227, s55, v227
    v_add_u32 v224, s55, v224
    v_xor_b32 v228, 32768, v228
    v_xor_b32 v229, 32768, v229
    v_mfma_f32_32x32x16_bf16 v[48:63], a[4:7], a[20:23], v[48:63]
    s_waitcnt vmcnt(15) lgkmcnt(0)
    s_barrier
    v_mfma_f32_32x32x16_bf16 v[0:15], a[32:35], a[48:51], v[0:15]
    ds_read_b64_tr_b16 a[16:17], v228 offset:0
    s_add_u32 m0, s43, 16384
    s_add_u32 s44, s42, 110592
    buffer_load_dwordx4 v234, s[28:31], s44 offen lds
    ds_read_b128 a[0:3], v224 offset:0
    v_mfma_f32_32x32x16_bf16 v[32:47], a[32:35], a[52:55], v[32:47]
    ds_read_b64_tr_b16 a[18:19], v228 offset:512
    ds_read_b64_tr_b16 a[20:21], v229 offset:0
    v_mfma_f32_32x32x16_bf16 v[16:31], a[36:39], a[48:51], v[16:31]
    s_add_u32 s44, s65, 32768
    buffer_store_dwordx4 v[196:199], v236, s[32:35], s44 offen sc1
    ds_read_b128 a[4:7], v224 offset:4096
    ds_read_b64_tr_b16 a[22:23], v229 offset:512
    v_mfma_f32_32x32x16_bf16 v[48:63], a[36:39], a[52:55], v[48:63]
    s_add_u32 s42, s42, 221184
    s_xor_b32 s43, s43, 32768
    s_add_u32 s40, s40, 128
    s_add_u32 s41, s41, 32768
    s_cmp_ge_u32 s41, 163840
    s_cselect_b32 s45, 98304, 0
    s_sub_u32 s41, s41, s45
    s_waitcnt lgkmcnt(0)
    v_mfma_f32_32x32x16_bf16 v[0:15], a[0:3], a[16:19], v[0:15]
    s_add_u32 s47, s47, 32768
    s_mov_b32 s55, 32768
    s_cmp_eq_u32 s47, 163840
    s_cselect_b32 s55, -65536, s55
    s_cselect_b32 s47, 65536, s47
    s_add_u32 m0, s41, 0
    s_add_u32 s44, s40, 0
    buffer_load_dwordx4 v232, s[24:27], s44 offen lds
    ds_read_b64_tr_b16 a[48:49], v228 offset:2048
    s_add_u32 m0, s41, 1024
    s_add_u32 s44, s40, 9216
    buffer_load_dwordx4 v233, s[24:27], s44 offen lds
    ds_read_b128 a[32:35], v225 offset:0
    v_mfma_f32_32x32x16_bf16 v[32:47], a[0:3], a[20:23], v[32:47]
    s_add_u32 m0, s41, 2048
    s_add_u32 s44, s40, 18432
    buffer_load_dwordx4 v232, s[24:27], s44 offen lds
    ds_read_b64_tr_b16 a[50:51], v228 offset:2560
    ds_read_b64_tr_b16 a[52:53], v229 offset:2048
    s_add_u32 m0, s41, 3072
    s_add_u32 s44, s40, 27648
    buffer_load_dwordx4 v233, s[24:27], s44 offen lds
    v_mfma_f32_32x32x16_bf16 v[16:31], a[4:7], a[16:19], v[16:31]
    ds_read_b128 a[36:39], v225 offset:4096
    s_add_u32 s44, s64, 16384
    buffer_store_dwordx4 v[184:187], v236, s[32:35], s44 offen sc1
    ds_read_b64_tr_b16 a[54:55], v229 offset:2560
    v_add_u32 v225, s55, v225
    v_mfma_f32_32x32x16_bf16 v[48:63], a[4:7], a[20:23], v[48:63]
    s_waitcnt vmcnt(20) lgkmcnt(0)
    s_barrier
    v_mfma_f32_32x32x16_bf16 v[0:15], a[32:35], a[48:51], v[0:15]
    ds_read_b64_tr_b16 a[16:17], v228 offset:16384
    s_add_u32 m0, s43, 0
    s_add_u32 s44, s42, 0
    buffer_load_dwordx4 v234, s[28:31], s44 offen lds
    ds_read_b128 a[0:3], v226 offset:0
    v_mfma_f32_32x32x16_bf16 v[32:47], a[32:35], a[52:55], v[32:47]
    ds_read_b64_tr_b16 a[18:19], v228 offset:16896
    ds_read_b64_tr_b16 a[20:21], v229 offset:16384
    v_mfma_f32_32x32x16_bf16 v[16:31], a[36:39], a[48:51], v[16:31]
    s_add_u32 s44, s65, 16384
    buffer_store_dwordx4 v[188:191], v236, s[32:35], s44 offen sc1
    ds_read_b128 a[4:7], v226 offset:4096
    v_mfma_f32_32x32x16_bf16 v[48:63], a[36:39], a[52:55], v[48:63]
    ds_read_b64_tr_b16 a[22:23], v229 offset:16896
    v_add_u32 v226, s55, v226
    s_waitcnt lgkmcnt(0)
    v_mfma_f32_32x32x16_bf16 v[0:15], a[0:3], a[16:19], v[0:15]
    ds_read_b64_tr_b16 a[48:49], v228 offset:18432
    s_add_u32 m0, s41, 4096
    s_add_u32 s44, s40, 36864
    buffer_load_dwordx4 v232, s[24:27], s44 offen lds
    ds_read_b128 a[32:35], v227 offset:0
    s_add_u32 m0, s41, 5120
    s_add_u32 s44, s40, 46080
    buffer_load_dwordx4 v233, s[24:27], s44 offen lds
    ds_read_b64_tr_b16 a[50:51], v228 offset:18944
    v_mfma_f32_32x32x16_bf16 v[32:47], a[0:3], a[20:23], v[32:47]
    s_add_u32 m0, s41, 6144
    s_add_u32 s44, s40, 55296
    buffer_load_dwordx4 v232, s[24:27], s44 offen lds
    ds_read_b64_tr_b16 a[52:53], v229 offset:18432
    s_add_u32 m0, s41, 7168
    s_add_u32 s44, s40, 64512
    buffer_load_dwordx4 v233, s[24:27], s44 offen lds
    ds_read_b128 a[36:39], v227 offset:4096
    s_add_u32 s44, s64, 0
    buffer_store_dwordx4 v[176:179], v236, s[32:35], s44 offen sc1
    v_mfma_f32_32x32x16_bf16 v[16:31], a[4:7], a[16:19], v[16:31]
    ds_read_b64_tr_b16 a[54:55], v229 offset:18944
    v_add_u32 v227, s55, v227
    v_add_u32 v224, s55, v224
    v_xor_b32 v228, 32768, v228
    v_xor_b32 v229, 32768, v229
    v_mfma_f32_32x32x16_bf16 v[48:63], a[4:7], a[20:23], v[48:63]
    s_waitcnt vmcnt(15) lgkmcnt(0)
    s_barrier
    v_mfma_f32_32x32x16_bf16 v[0:15], a[32:35], a[48:51], v[0:15]
    ds_read_b64_tr_b16 a[16:17], v228 offset:0
    s_add_u32 m0, s43, 16384
    s_add_u32 s44, s42, 110592
    buffer_load_dwordx4 v234, s[28:31], s44 offen lds
    ds_read_b128 a[0:3], v224 offset:0
    v_mfma_f32_32x32x16_bf16 v[32:47], a[32:35], a[52:55], v[32:47]
    ds_read_b64_tr_b16 a[18:19], v228 offset:512
    ds_read_b64_tr_b16 a[20:21], v229 offset:0
    v_mfma_f32_32x32x16_bf16 v[16:31], a[36:39], a[48:51], v[16:31]
    s_add_u32 s44, s65, 0
    buffer_store_dwordx4 v[180:183], v236, s[32:35], s44 offen sc1
    ds_read_b128 a[4:7], v224 offset:4096
    ds_read_b64_tr_b16 a[22:23], v229 offset:512
    v_mfma_f32_32x32x16_bf16 v[48:63], a[36:39], a[52:55], v[48:63]
    s_add_u32 s42, s42, 221184
    s_xor_b32 s43, s43, 32768
    s_add_u32 s40, s40, 128
    s_add_u32 s41, s41, 32768
    s_cmp_ge_u32 s41, 163840
    s_cselect_b32 s45, 98304, 0
    s_sub_u32 s41, s41, s45
    s_waitcnt lgkmcnt(0)
    v_mfma_f32_32x32x16_bf16 v[0:15], a[0:3], a[16:19], v[0:15]
    s_add_u32 s47, s47, 32768
    s_mov_b32 s55, 32768
    s_cmp_eq_u32 s47, 163840
    s_cselect_b32 s55, -65536, s55
    s_cselect_b32 s47, 65536, s47
    ds_read_b64_tr_b16 a[48:49], v228 offset:2048
    ds_read_b128 a[32:35], v225 offset:0
    v_mfma_f32_32x32x16_bf16 v[32:47], a[0:3], a[20:23], v[32:47]
    s_add_u32 s44, s62, 49152
    buffer_store_dwordx4 v[168:171], v236, s[32:35], s44 offen sc1
    ds_read_b64_tr_b16 a[50:51], v228 offset:2560
    ds_read_b64_tr_b16 a[52:53], v229 offset:2048
    v_mfma_f32_32x32x16_bf16 v[16:31], a[4:7], a[16:19], v[16:31]
    ds_read_b128 a[36:39], v225 offset:4096
    ds_read_b64_tr_b16 a[54:55], v229 offset:2560
    v_add_u32 v225, s55, v225
    v_mfma_f32_32x32x16_bf16 v[48:63], a[4:7], a[20:23], v[48:63]
    s_waitcnt vmcnt(16) lgkmcnt(0)
    s_barrier
    v_mfma_f32_32x32x16_bf16 v[0:15], a[32:35], a[48:51], v[0:15]
    ds_read_b64_tr_b16 a[16:17], v228 offset:16384
    ds_read_b128 a[0:3], v226 offset:0
    v_mfma_f32_32x32x16_bf16 v[32:47], a[32:35], a[52:55], v[32:47]
    ds_read_b64_tr_b16 a[18:19], v228 offset:16896
    s_add_u32 s44, s63, 49152
    buffer_store_dwordx4 v[172:175], v236, s[32:35], s44 offen sc1
    v_mfma_f32_32x32x16_bf16 v[16:31], a[36:39], a[48:51], v[16:31]
    ds_read_b64_tr_b16 a[20:21], v229 offset:16384
    ds_read_b128 a[4:7], v226 offset:4096
    v_mfma_f32_32x32x16_bf16 v[48:63], a[36:39], a[52:55], v[48:63]
    ds_read_b64_tr_b16 a[22:23], v229 offset:16896
    v_add_u32 v226, s55, v226
    s_waitcnt lgkmcnt(0)
    v_mfma_f32_32x32x16_bf16 v[0:15], a[0:3], a[16:19], v[0:15]
    ds_read_b64_tr_b16 a[48:49], v228 offset:18432
    ds_read_b128 a[32:35], v227 offset:0
    ds_read_b64_tr_b16 a[50:51], v228 offset:18944
    s_add_u32 s44, s62, 32768
    buffer_store_dwordx4 v[160:163], v236, s[32:35], s44 offen sc1
    v_mfma_f32_32x32x16_bf16 v[32:47], a[0:3], a[20:23], v[32:47]
    ds_read_b64_tr_b16 a[52:53], v229 offset:18432
    ds_read_b128 a[36:39], v227 offset:4096
    ds_read_b64_tr_b16 a[54:55], v229 offset:18944
    v_add_u32 v227, s55, v227
    v_mfma_f32_32x32x16_bf16 v[16:31], a[4:7], a[16:19], v[16:31]
    v_add_u32 v224, s55, v224
    v_xor_b32 v228, 32768, v228
    v_xor_b32 v229, 32768, v229
    v_mfma_f32_32x32x16_bf16 v[48:63], a[4:7], a[20:23], v[48:63]
    s_waitcnt vmcnt(6) lgkmcnt(0)
    s_barrier
    v_mfma_f32_32x32x16_bf16 v[0:15], a[32:35], a[48:51], v[0:15]
    ds_read_b64_tr_b16 a[16:17], v228 offset:0
    ds_read_b128 a[0:3], v224 offset:0
    v_mfma_f32_32x32x16_bf16 v[32:47], a[32:35], a[52:55], v[32:47]
    ds_read_b64_tr_b16 a[18:19], v228 offset:512
    s_add_u32 s44, s63, 32768
    buffer_store_dwordx4 v[164:167], v236, s[32:35], s44 offen sc1
    v_mfma_f32_32x32x16_bf16 v[16:31], a[36:39], a[48:51], v[16:31]
    ds_read_b64_tr_b16 a[20:21], v229 offset:0
    ds_read_b128 a[4:7], v224 offset:4096
    v_mfma_f32_32x32x16_bf16 v[48:63], a[36:39], a[52:55], v[48:63]
    ds_read_b64_tr_b16 a[22:23], v229 offset:512
    s_waitcnt lgkmcnt(0)
    v_mfma_f32_32x32x16_bf16 v[0:15], a[0:3], a[16:19], v[0:15]
    s_add_u32 s47, s47, 32768
    s_mov_b32 s55, 32768
    s_cmp_eq_u32 s47, 163840
    s_cselect_b32 s55, -65536, s55
    s_cselect_b32 s47, 65536, s47
    ds_read_b64_tr_b16 a[48:49], v228 offset:2048
    ds_read_b128 a[32:35], v225 offset:0
    v_mfma_f32_32x32x16_bf16 v[32:47], a[0:3], a[20:23], v[32:47]
    ds_read_b64_tr_b16 a[50:51], v228 offset:2560
    ds_read_b64_tr_b16 a[52:53], v229 offset:2048
    ds_read_b128 a[36:39], v225 offset:4096
    v_mfma_f32_32x32x16_bf16 v[16:31], a[4:7], a[16:19], v[16:31]
    ds_read_b64_tr_b16 a[54:55], v229 offset:2560
    v_add_u32 v225, s55, v225
    v_mfma_f32_32x32x16_bf16 v[48:63], a[4:7], a[20:23], v[48:63]
    s_waitcnt vmcnt(5) lgkmcnt(0)
    s_barrier
    v_mfma_f32_32x32x16_bf16 v[0:15], a[32:35], a[48:51], v[0:15]
    ds_read_b64_tr_b16 a[16:17], v228 offset:16384
    ds_read_b128 a[0:3], v226 offset:0
    v_mfma_f32_32x32x16_bf16 v[32:47], a[32:35], a[52:55], v[32:47]
    ds_read_b64_tr_b16 a[18:19], v228 offset:16896
    ds_read_b64_tr_b16 a[20:21], v229 offset:16384
    v_mfma_f32_32x32x16_bf16 v[16:31], a[36:39], a[48:51], v[16:31]
    ds_read_b128 a[4:7], v226 offset:4096
    ds_read_b64_tr_b16 a[22:23], v229 offset:16896
    v_mfma_f32_32x32x16_bf16 v[48:63], a[36:39], a[52:55], v[48:63]
    v_add_u32 v226, s55, v226
    s_waitcnt lgkmcnt(0)
    v_mfma_f32_32x32x16_bf16 v[0:15], a[0:3], a[16:19], v[0:15]
    ds_read_b64_tr_b16 a[48:49], v228 offset:18432
    ds_read_b128 a[32:35], v227 offset:0
    ds_read_b64_tr_b16 a[50:51], v228 offset:18944
    ds_read_b64_tr_b16 a[52:53], v229 offset:18432
    v_mfma_f32_32x32x16_bf16 v[32:47], a[0:3], a[20:23], v[32:47]
    ds_read_b128 a[36:39], v227 offset:4096
    ds_read_b64_tr_b16 a[54:55], v229 offset:18944
    v_add_u32 v227, s55, v227
    v_mfma_f32_32x32x16_bf16 v[16:31], a[4:7], a[16:19], v[16:31]
    v_add_u32 v224, s55, v224
    v_xor_b32 v228, 32768, v228
    v_xor_b32 v229, 32768, v229
    v_mfma_f32_32x32x16_bf16 v[48:63], a[4:7], a[20:23], v[48:63]
    s_waitcnt lgkmcnt(0)
    s_barrier
    v_mfma_f32_32x32x16_bf16 v[0:15], a[32:35], a[48:51], v[0:15]
    v_mfma_f32_32x32x16_bf16 v[32:47], a[32:35], a[52:55], v[32:47]
    v_mfma_f32_32x32x16_bf16 v[16:31], a[36:39], a[48:51], v[16:31]
    v_mfma_f32_32x32x16_bf16 v[48:63], a[36:39], a[52:55], v[48:63]
    s_lshl_b32 s44, s50, 3
    s_lshl_b32 s45, s3, 1
    s_add_u32 s49, s44, s45
    s_cmp_ge_u32 s51, 18
    s_cbranch_scc1 L_proj_epiV
    s_mul_i32 s48, s49, 1280
    s_cmp_lt_u32 s51, 9
    s_cselect_b32 s53, 0x3eae1a93, 1.0
    s_mov_b32 s44, 71303168
    s_cselect_b32 s44, 67108864, s44
    s_cselect_b32 s45, 0, 9
    s_add_u32 s48, s48, s44
    s_sub_u32 s45, s51, s45
    s_lshl_b32 s45, s45, 6
    v_add_u32 v237, s45, v245
    v_mul_u32_u24 v238, 3641, v237
    v_lshrrev_b32 v238, 16, v238
    v_mul_u32_u24 v239, 18, v238
    v_sub_u32 v239, v237, v239
    v_lshlrev_b32 v239, 6, v239
    v_lshl_add_u32 v239, v246, 4, v239
    v_mul_u32_u24 v238, 81920, v238
    v_add_u32 v247, v238, v239
    v_add_u32 v237, s45, v245
    v_add_u32 v237, 32, v237
    v_mul_u32_u24 v238, 3641, v237
    v_lshrrev_b32 v238, 16, v238
    v_mul_u32_u24 v239, 18, v238
    v_sub_u32 v239, v237, v239
    v_lshlrev_b32 v239, 6, v239
    v_lshl_add_u32 v239, v246, 4, v239
    v_mul_u32_u24 v238, 81920, v238
    v_add_u32 v248, v238, v239
    s_nop 7
    v_mul_f32 v0, s53, v0
    v_mul_f32 v1, s53, v1
    v_mul_f32 v2, s53, v2
    v_mul_f32 v3, s53, v3
    v_mul_f32 v4, s53, v4
    v_mul_f32 v5, s53, v5
    v_mul_f32 v6, s53, v6
    v_mul_f32 v7, s53, v7
    v_mul_f32 v8, s53, v8
    v_mul_f32 v9, s53, v9
    v_mul_f32 v10, s53, v10
    v_mul_f32 v11, s53, v11
    v_mul_f32 v12, s53, v12
    v_mul_f32 v13, s53, v13
    v_mul_f32 v14, s53, v14
    v_mul_f32 v15, s53, v15
    v_cvt_pk_bf16_f32 v0, v0, v1
    v_cvt_pk_bf16_f32 v1, v2, v3
    v_cvt_pk_bf16_f32 v2, v4, v5
    v_cvt_pk_bf16_f32 v3, v6, v7
    v_cvt_pk_bf16_f32 v4, v8, v9
    v_cvt_pk_bf16_f32 v5, v10, v11
    v_cvt_pk_bf16_f32 v6, v12, v13
    v_cvt_pk_bf16_f32 v7, v14, v15
    s_add_u32 s44, s48, 0
    buffer_store_dwordx4 v[0:3], v247, s[32:35], s44 offen offset:0
    buffer_store_dwordx4 v[4:7], v247, s[32:35], s44 offen offset:32
    v_mul_f32 v32, s53, v32
    v_mul_f32 v33, s53, v33
    v_mul_f32 v34, s53, v34
    v_mul_f32 v35, s53, v35
    v_mul_f32 v36, s53, v36
    v_mul_f32 v37, s53, v37
    v_mul_f32 v38, s53, v38
    v_mul_f32 v39, s53, v39
    v_mul_f32 v40, s53, v40
    v_mul_f32 v41, s53, v41
    v_mul_f32 v42, s53, v42
    v_mul_f32 v43, s53, v43
    v_mul_f32 v44, s53, v44
    v_mul_f32 v45, s53, v45
    v_mul_f32 v46, s53, v46
    v_mul_f32 v47, s53, v47
    v_cvt_pk_bf16_f32 v32, v32, v33
    v_cvt_pk_bf16_f32 v33, v34, v35
    v_cvt_pk_bf16_f32 v34, v36, v37
    v_cvt_pk_bf16_f32 v35, v38, v39
    v_cvt_pk_bf16_f32 v36, v40, v41
    v_cvt_pk_bf16_f32 v37, v42, v43
    v_cvt_pk_bf16_f32 v38, v44, v45
    v_cvt_pk_bf16_f32 v39, v46, v47
    s_add_u32 s44, s48, 0
    buffer_store_dwordx4 v[32:35], v248, s[32:35], s44 offen offset:0
    buffer_store_dwordx4 v[36:39], v248, s[32:35], s44 offen offset:32
    v_mul_f32 v16, s53, v16
    v_mul_f32 v17, s53, v17
    v_mul_f32 v18, s53, v18
    v_mul_f32 v19, s53, v19
    v_mul_f32 v20, s53, v20
    v_mul_f32 v21, s53, v21
    v_mul_f32 v22, s53, v22
    v_mul_f32 v23, s53, v23
    v_mul_f32 v24, s53, v24
    v_mul_f32 v25, s53, v25
    v_mul_f32 v26, s53, v26
    v_mul_f32 v27, s53, v27
    v_mul_f32 v28, s53, v28
    v_mul_f32 v29, s53, v29
    v_mul_f32 v30, s53, v30
    v_mul_f32 v31, s53, v31
    v_cvt_pk_bf16_f32 v16, v16, v17
    v_cvt_pk_bf16_f32 v17, v18, v19
    v_cvt_pk_bf16_f32 v18, v20, v21
    v_cvt_pk_bf16_f32 v19, v22, v23
    v_cvt_pk_bf16_f32 v20, v24, v25
    v_cvt_pk_bf16_f32 v21, v26, v27
    v_cvt_pk_bf16_f32 v22, v28, v29
    v_cvt_pk_bf16_f32 v23, v30, v31
    s_add_u32 s44, s48, 1280
    buffer_store_dwordx4 v[16:19], v247, s[32:35], s44 offen offset:0
    buffer_store_dwordx4 v[20:23], v247, s[32:35], s44 offen offset:32
    v_mul_f32 v48, s53, v48
    v_mul_f32 v49, s53, v49
    v_mul_f32 v50, s53, v50
    v_mul_f32 v51, s53, v51
    v_mul_f32 v52, s53, v52
    v_mul_f32 v53, s53, v53
    v_mul_f32 v54, s53, v54
    v_mul_f32 v55, s53, v55
    v_mul_f32 v56, s53, v56
    v_mul_f32 v57, s53, v57
    v_mul_f32 v58, s53, v58
    v_mul_f32 v59, s53, v59
    v_mul_f32 v60, s53, v60
    v_mul_f32 v61, s53, v61
    v_mul_f32 v62, s53, v62
    v_mul_f32 v63, s53, v63
    v_cvt_pk_bf16_f32 v48, v48, v49
    v_cvt_pk_bf16_f32 v49, v50, v51
    v_cvt_pk_bf16_f32 v50, v52, v53
    v_cvt_pk_bf16_f32 v51, v54, v55
    v_cvt_pk_bf16_f32 v52, v56, v57
    v_cvt_pk_bf16_f32 v53, v58, v59
    v_cvt_pk_bf16_f32 v54, v60, v61
    v_cvt_pk_bf16_f32 v55, v62, v63
    s_add_u32 s44, s48, 1280
    buffer_store_dwordx4 v[48:51], v248, s[32:35], s44 offen offset:0
    buffer_store_dwordx4 v[52:55], v248, s[32:35], s44 offen offset:32
    s_branch L_proj_epiE
L_proj_epiV:
    s_lshl_b32 s48, s49, 11
    s_add_u32 s48, s48, 75497472
    s_sub_u32 s45, s51, 18
    s_lshl_b32 s45, s45, 6
    v_add_u32 v237, s45, v245
    v_mul_u32_u24 v238, 3641, v237
    v_lshrrev_b32 v238, 16, v238
    v_mul_u32_u24 v239, 18, v238
    v_sub_u32 v239, v237, v239
    v_lshl_add_u32 v239, v246, 5, v239
    v_lshlrev_b32 v239, 4, v239
    v_lshl_add_u32 v247, v238, 17, v239
    v_add_u32 v237, s45, v245
    v_add_u32 v237, 32, v237
    v_mul_u32_u24 v238, 3641, v237
    v_lshrrev_b32 v238, 16, v238
    v_mul_u32_u24 v239, 18, v238
    v_sub_u32 v239, v237, v239
    v_lshl_add_u32 v239, v246, 5, v239
    v_lshlrev_b32 v239, 4, v239
    v_lshl_add_u32 v248, v238, 17, v239
    s_nop 7
    v_cvt_pk_bf16_f32 v0, v0, v1
    v_cvt_pk_bf16_f32 v1, v2, v3
    v_cvt_pk_bf16_f32 v2, v4, v5
    v_cvt_pk_bf16_f32 v3, v6, v7
    v_cvt_pk_bf16_f32 v4, v8, v9
    v_cvt_pk_bf16_f32 v5, v10, v11
    v_cvt_pk_bf16_f32 v6, v12, v13
    v_cvt_pk_bf16_f32 v7, v14, v15
    s_add_u32 s44, s48, 0
    buffer_store_dwordx4 v[0:3], v247, s[32:35], s44 offen
    s_add_u32 s44, s48, 1024
    buffer_store_dwordx4 v[4:7], v247, s[32:35], s44 offen
    v_cvt_pk_bf16_f32 v32, v32, v33
    v_cvt_pk_bf16_f32 v33, v34, v35
    v_cvt_pk_bf16_f32 v34, v36, v37
    v_cvt_pk_bf16_f32 v35, v38, v39
    v_cvt_pk_bf16_f32 v36, v40, v41
    v_cvt_pk_bf16_f32 v37, v42, v43
    v_cvt_pk_bf16_f32 v38, v44, v45
    v_cvt_pk_bf16_f32 v39, v46, v47
    s_add_u32 s44, s48, 0
    buffer_store_dwordx4 v[32:35], v248, s[32:35], s44 offen
    s_add_u32 s44, s48, 1024
    buffer_store_dwordx4 v[36:39], v248, s[32:35], s44 offen
    v_cvt_pk_bf16_f32 v16, v16, v17
    v_cvt_pk_bf16_f32 v17, v18, v19
    v_cvt_pk_bf16_f32 v18, v20, v21
    v_cvt_pk_bf16_f32 v19, v22, v23
    v_cvt_pk_bf16_f32 v20, v24, v25
    v_cvt_pk_bf16_f32 v21, v26, v27
    v_cvt_pk_bf16_f32 v22, v28, v29
    v_cvt_pk_bf16_f32 v23, v30, v31
    s_add_u32 s44, s48, 2048
    buffer_store_dwordx4 v[16:19], v247, s[32:35], s44 offen
    s_add_u32 s44, s48, 3072
    buffer_store_dwordx4 v[20:23], v247, s[32:35], s44 offen
    v_cvt_pk_bf16_f32 v48, v48, v49
    v_cvt_pk_bf16_f32 v49, v50, v51
    v_cvt_pk_bf16_f32 v50, v52, v53
    v_cvt_pk_bf16_f32 v51, v54, v55
    v_cvt_pk_bf16_f32 v52, v56, v57
    v_cvt_pk_bf16_f32 v53, v58, v59
    v_cvt_pk_bf16_f32 v54, v60, v61
    v_cvt_pk_bf16_f32 v55, v62, v63
    s_add_u32 s44, s48, 2048
    buffer_store_dwordx4 v[48:51], v248, s[32:35], s44 offen
    s_add_u32 s44, s48, 3072
    buffer_store_dwordx4 v[52:55], v248, s[32:35], s44 offen
L_proj_epiE:
    s_branch L_proj_end
L_proj_noB_X:
    s_waitcnt vmcnt(0)
    s_add_u32 s44, s62, 16384
    buffer_store_dwordx4 v[152:155], v236, s[32:35], s44 offen sc1
    s_add_u32 s44, s63, 16384
    buffer_store_dwordx4 v[156:159], v236, s[32:35], s44 offen sc1
    s_add_u32 s44, s62, 0
    buffer_store_dwordx4 v[144:147], v236, s[32:35], s44 offen sc1
    s_add_u32 s44, s63, 0
    buffer_store_dwordx4 v[148:151], v236, s[32:35], s44 offen sc1
    s_add_u32 s44, s60, 49152
    buffer_store_dwordx4 v[136:139], v236, s[32:35], s44 offen sc1
    s_add_u32 s44, s61, 49152
    buffer_store_dwordx4 v[140:143], v236, s[32:35], s44 offen sc1
    s_add_u32 s44, s60, 32768
    buffer_store_dwordx4 v[128:131], v236, s[32:35], s44 offen sc1
    s_add_u32 s44, s61, 32768
    buffer_store_dwordx4 v[132:135], v236, s[32:35], s44 offen sc1
    s_add_u32 s44, s60, 16384
    buffer_store_dwordx4 v[120:123], v236, s[32:35], s44 offen sc1
    s_add_u32 s44, s61, 16384
    buffer_store_dwordx4 v[124:127], v236, s[32:35], s44 offen sc1
    s_add_u32 s44, s60, 0
    buffer_store_dwordx4 v[112:115], v236, s[32:35], s44 offen sc1
    s_add_u32 s44, s61, 0
    buffer_store_dwordx4 v[116:119], v236, s[32:35], s44 offen sc1
    s_add_u32 s44, s66, 32768
    buffer_store_dwordx4 v[104:107], v236, s[32:35], s44 offen sc1
    s_add_u32 s44, s67, 32768
    buffer_store_dwordx4 v[108:111], v236, s[32:35], s44 offen sc1
    s_add_u32 s44, s66, 49152
    buffer_store_dwordx4 v[96:99], v236, s[32:35], s44 offen sc1
    s_add_u32 s44, s67, 49152
    buffer_store_dwordx4 v[100:103], v236, s[32:35], s44 offen sc1
    s_add_u32 s44, s66, 16384
    buffer_store_dwordx4 v[216:219], v236, s[32:35], s44 offen sc1
    s_add_u32 s44, s67, 16384
    buffer_store_dwordx4 v[220:223], v236, s[32:35], s44 offen sc1
    s_add_u32 s44, s66, 0
    buffer_store_dwordx4 v[208:211], v236, s[32:35], s44 offen sc1
    s_add_u32 s44, s67, 0
    buffer_store_dwordx4 v[212:215], v236, s[32:35], s44 offen sc1
    s_add_u32 s44, s64, 49152
    buffer_store_dwordx4 v[200:203], v236, s[32:35], s44 offen sc1
    s_add_u32 s44, s65, 49152
    buffer_store_dwordx4 v[204:207], v236, s[32:35], s44 offen sc1
    s_add_u32 s44, s64, 32768
    buffer_store_dwordx4 v[192:195], v236, s[32:35], s44 offen sc1
    s_add_u32 s44, s65, 32768
    buffer_store_dwordx4 v[196:199], v236, s[32:35], s44 offen sc1
    s_add_u32 s44, s64, 16384
    buffer_store_dwordx4 v[184:187], v236, s[32:35], s44 offen sc1
    s_add_u32 s44, s65, 16384
    buffer_store_dwordx4 v[188:191], v236, s[32:35], s44 offen sc1
    s_add_u32 s44, s64, 0
    buffer_store_dwordx4 v[176:179], v236, s[32:35], s44 offen sc1
    s_add_u32 s44, s65, 0
    buffer_store_dwordx4 v[180:183], v236, s[32:35], s44 offen sc1
    s_add_u32 s44, s62, 49152
    buffer_store_dwordx4 v[168:171], v236, s[32:35], s44 offen sc1
    s_add_u32 s44, s63, 49152
    buffer_store_dwordx4 v[172:175], v236, s[32:35], s44 offen sc1
    s_add_u32 s44, s62, 32768
    buffer_store_dwordx4 v[160:163], v236, s[32:35], s44 offen sc1
    s_add_u32 s44, s63, 32768
    buffer_store_dwordx4 v[164:167], v236, s[32:35], s44 offen sc1
    v_and_b32 v237, 31, v244
    v_and_b32 v238, 27, v237
    v_cmp_eq_u32 vcc, 18, v238
    v_mov_b32 v239, 0x3f803f80
    s_nop 0
    v_cndmask_b32 v0, 0, v239, vcc
    v_mov_b32 v1, v0
    v_mov_b32 v2, v0
    v_mov_b32 v3, v0
    s_sub_u32 s44, s2, 216
    s_lshl_b32 s44, s44, 2
    s_add_u32 s44, s44, s3
    s_lshl_b32 s44, s44, 10
    s_add_u32 s44, s44, 75497472
    v_cmp_le_u32 vcc, 18, v237
    s_nop 3
    s_and_saveexec_b64 s[56:57], vcc
    buffer_store_dwordx4 v[0:3], v236, s[32:35], s44 offen
    s_add_u32 s44, s44, 163840
    buffer_store_dwordx4 v[0:3], v236, s[32:35], s44 offen
    s_add_u32 s44, s44, 163840
    buffer_store_dwordx4 v[0:3], v236, s[32:35], s44 offen
    s_add_u32 s44, s44, 163840
    buffer_store_dwordx4 v[0:3], v236, s[32:35], s44 offen
    s_add_u32 s44, s44, 163840
    buffer_store_dwordx4 v[0:3], v236, s[32:35], s44 offen
    s_add_u32 s44, s44, 163840
    buffer_store_dwordx4 v[0:3], v236, s[32:35], s44 offen
    s_add_u32 s44, s44, 163840
    buffer_store_dwordx4 v[0:3], v236, s[32:35], s44 offen
    s_add_u32 s44, s44, 163840
    buffer_store_dwordx4 v[0:3], v236, s[32:35], s44 offen
    s_add_u32 s44, s44, 163840
    buffer_store_dwordx4 v[0:3], v236, s[32:35], s44 offen
    s_add_u32 s44, s44, 163840
    buffer_store_dwordx4 v[0:3], v236, s[32:35], s44 offen
    s_add_u32 s44, s44, 163840
    buffer_store_dwordx4 v[0:3], v236, s[32:35], s44 offen
    s_add_u32 s44, s44, 163840
    buffer_store_dwordx4 v[0:3], v236, s[32:35], s44 offen
    s_add_u32 s44, s44, 163840
    buffer_store_dwordx4 v[0:3], v236, s[32:35], s44 offen
    s_add_u32 s44, s44, 163840
    buffer_store_dwordx4 v[0:3], v236, s[32:35], s44 offen
    s_add_u32 s44, s44, 163840
    buffer_store_dwordx4 v[0:3], v236, s[32:35], s44 offen
    s_add_u32 s44, s44, 163840
    buffer_store_dwordx4 v[0:3], v236, s[32:35], s44 offen
    s_add_u32 s44, s44, 163840
    buffer_store_dwordx4 v[0:3], v236, s[32:35], s44 offen
    s_add_u32 s44, s44, 163840
    buffer_store_dwordx4 v[0:3], v236, s[32:35], s44 offen
    s_add_u32 s44, s44, 163840
    buffer_store_dwordx4 v[0:3], v236, s[32:35], s44 offen
    s_add_u32 s44, s44, 163840
    buffer_store_dwordx4 v[0:3], v236, s[32:35], s44 offen
    s_add_u32 s44, s44, 163840
    buffer_store_dwordx4 v[0:3], v236, s[32:35], s44 offen
    s_add_u32 s44, s44, 163840
    buffer_store_dwordx4 v[0:3], v236, s[32:35], s44 offen
    s_add_u32 s44, s44, 163840
    buffer_store_dwordx4 v[0:3], v236, s[32:35], s44 offen
    s_add_u32 s44, s44, 163840
    buffer_store_dwordx4 v[0:3], v236, s[32:35], s44 offen
    s_add_u32 s44, s44, 163840
    buffer_store_dwordx4 v[0:3], v236, s[32:35], s44 offen
    s_add_u32 s44, s44, 163840
    s_cmp_ge_u32 s44, 79691776
    s_cbranch_scc1 L_proj_cfill_done
    buffer_store_dwordx4 v[0:3], v236, s[32:35], s44 offen
    s_add_u32 s44, s44, 163840
L_proj_cfill_done:
    s_mov_b64 exec, s[56:57]
    s_branch L_proj_end
L_proj_end:
    s_mov_b32 s28, s60
    s_mov_b32 s29, s61
    s_mov_b32 s30, s62
    s_mov_b32 s31, s63
    s_mov_b32 s32, s64
    s_mov_b32 s33, s65
    s_mov_b32 s34, s66
    s_mov_b32 s35, s67
    s_load_dwordx2 s[44:45], s[0:1], 88
    s_load_dwordx2 s[72:73], s[0:1], 0
    s_load_dwordx2 s[74:75], s[0:1], 16
    s_load_dwordx2 s[80:81], s[0:1], 40
    s_load_dwordx2 s[78:79], s[0:1], 64
    v_mbcnt_lo_u32_b32 v129, -1, 0
    v_mbcnt_hi_u32_b32 v129, -1, v129
    v_lshlrev_b32 v128, 4, v129
    v_lshrrev_b32 v131, 5, v129
    v_and_b32 v130, 0x13, v129
    v_and_b32 v224, 4, v129
    v_lshl_or_b32 v130, v224, 1, v130
    v_bfe_u32 v224, v129, 3, 1
    v_lshl_or_b32 v130, v224, 2, v130
    s_waitcnt lgkmcnt(0)
    s_mov_b32 s8, s44
    s_mov_b32 s9, s45
    s_mov_b32 s10, 0x10000000
    s_mov_b32 s11, 0x00020000
    s_barrier
    s_and_b32 s23, s2, 7
    s_lshl_b32 s12, s23, 2
    s_bfe_u32 s23, s2, 0x20003
    s_add_u32 s12, s12, s23
    s_lshr_b32 s13, s2, 5
    s_lshl_b32 s14, s13, 2
    s_add_u32 s14, s14, s3
    s_sub_u32 s15, 63, s14
    s_lshl_b32 s16, s12, 20
    s_lshl_b32 s23, s3, 13
    s_add_u32 s16, s16, s23
    s_add_u32 s16, s16, 16777216
    s_add_u32 s17, s23, 131072
    s_mov_b32 s18, s23
    s_add_u32 s21, s23, 163840
    s_add_u32 s19, s23, 32768
    v_subrev_u32 v135, s23, v128
    s_mov_b32 s48, s8
    s_mov_b32 s49, s9
    s_lshl_b32 s23, s13, 16
    s_sub_u32 s23, 17825792, s23
    s_lshl_b32 s24, s12, 20
    s_add_u32 s50, s23, s24
    s_mov_b32 s51, 0x00020000
    s_mov_b32 s64, s72
    s_mov_b32 s65, s73
    s_mov_b32 s66, 0x240000
    s_mov_b32 s67, 0x00020000
    s_mov_b32 s68, s74
    s_mov_b32 s69, s75
    s_mov_b32 s70, 0x480000
    s_mov_b32 s71, 0x00020000
    v_lshrrev_b32 v224, 3, v129
    v_mul_u32_u24 v224, 1152, v224
    v_and_b32 v225, 7, v129
    v_lshrrev_b32 v226, 4, v129
    v_xor_b32 v225, v225, v226
    v_lshl_add_u32 v157, v225, 4, v224
    v_xor_b32 v158, 64, v157
    v_lshrrev_b32 v224, 4, v129
    v_and_b32 v225, 15, v129
    v_lshlrev_b32 v226, 2, v224
    v_xor_b32 v225, v225, v226
    v_mul_u32_u24 v224, 8192, v224
    v_lshl_add_u32 v159, v225, 4, v224
    s_mul_i32 s52, s14, 36864
    s_mul_i32 s53, s15, 36864
    s_lshl_b32 s55, s3, 16
    s_lshl_b32 s23, s12, 8
    s_add_u32 s55, s55, s23
    s_lshl_b32 s54, s3, 13
    s_add_u32 s54, s54, 32768
    s_lshl_b32 s56, s3, 11
    s_add_u32 s52, s52, 256
    s_add_u32 s53, s53, 256
    s_add_u32 s54, s54, 65536
    s_add_u32 s55, s55, 1048576
    s_add_u32 m0, s54, 4294901760
    s_add_u32 s57, s52, 4294967040
    buffer_load_dwordx4 v157, s[64:67], s57 offen lds
    s_add_u32 m0, s54, 4294902784
    s_add_u32 s57, s52, 8960
    buffer_load_dwordx4 v158, s[64:67], s57 offen lds
    s_add_u32 m0, s54, 4294903808
    s_add_u32 s57, s52, 18176
    buffer_load_dwordx4 v157, s[64:67], s57 offen lds
    s_add_u32 m0, s54, 4294904832
    s_add_u32 s57, s52, 27392
    buffer_load_dwordx4 v158, s[64:67], s57 offen lds
    s_add_u32 m0, s56, 0
    s_add_u32 s57, s55, 4293918720
    buffer_load_dwordx4 v159, s[68:71], s57 offen lds
    s_add_u32 m0, s56, 1024
    s_add_u32 s57, s55, 4293951488
    buffer_load_dwordx4 v159, s[68:71], s57 offen lds
    s_add_u32 m0, s54, 4294905856
    s_add_u32 s57, s53, 4294967040
    buffer_load_dwordx4 v157, s[64:67], s57 offen lds
    s_add_u32 m0, s54, 4294906880
    s_add_u32 s57, s53, 8960
    buffer_load_dwordx4 v158, s[64:67], s57 offen lds
    s_add_u32 m0, s54, 4294907904
    s_add_u32 s57, s53, 18176
    buffer_load_dwordx4 v157, s[64:67], s57 offen lds
    s_add_u32 m0, s54, 4294908928
    s_add_u32 s57, s53, 27392
    buffer_load_dwordx4 v158, s[64:67], s57 offen lds
    s_add_u32 m0, s56, 8192
    s_add_u32 s57, s55, 4294180864
    buffer_load_dwordx4 v159, s[68:71], s57 offen lds
    s_add_u32 m0, s56, 9216
    s_add_u32 s57, s55, 4294213632
    buffer_load_dwordx4 v159, s[68:71], s57 offen lds
    v_accvgpr_write_b32 a0, 0
    v_accvgpr_write_b32 a1, 0
    v_accvgpr_write_b32 a2, 0
    v_accvgpr_write_b32 a3, 0
    v_accvgpr_write_b32 a4, 0
    v_accvgpr_write_b32 a5, 0
    v_accvgpr_write_b32 a6, 0
    v_accvgpr_write_b32 a7, 0
    v_accvgpr_write_b32 a8, 0
    v_accvgpr_write_b32 a9, 0
    v_accvgpr_write_b32 a10, 0
    v_accvgpr_write_b32 a11, 0
    v_accvgpr_write_b32 a12, 0
    v_accvgpr_write_b32 a13, 0
    v_accvgpr_write_b32 a14, 0
    v_accvgpr_write_b32 a15, 0
    v_accvgpr_write_b32 a16, 0
    v_accvgpr_write_b32 a17, 0
    v_accvgpr_write_b32 a18, 0
    v_accvgpr_write_b32 a19, 0
    v_accvgpr_write_b32 a20, 0
    v_accvgpr_write_b32 a21, 0
    v_accvgpr_write_b32 a22, 0
    v_accvgpr_write_b32 a23, 0
    v_accvgpr_write_b32 a24, 0
    v_accvgpr_write_b32 a25, 0
    v_accvgpr_write_b32 a26, 0
    v_accvgpr_write_b32 a27, 0
    v_accvgpr_write_b32 a28, 0
    v_accvgpr_write_b32 a29, 0
    v_accvgpr_write_b32 a30, 0
    v_accvgpr_write_b32 a31, 0
    v_accvgpr_write_b32 a32, 0
    v_accvgpr_write_b32 a33, 0
    v_accvgpr_write_b32 a34, 0
    v_accvgpr_write_b32 a35, 0
    v_accvgpr_write_b32 a36, 0
    v_accvgpr_write_b32 a37, 0
    v_accvgpr_write_b32 a38, 0
    v_accvgpr_write_b32 a39, 0
    v_accvgpr_write_b32 a40, 0
    v_accvgpr_write_b32 a41, 0
    v_accvgpr_write_b32 a42, 0
    v_accvgpr_write_b32 a43, 0
    v_accvgpr_write_b32 a44, 0
    v_accvgpr_write_b32 a45, 0
    v_accvgpr_write_b32 a46, 0
    v_accvgpr_write_b32 a47, 0
    v_accvgpr_write_b32 a48, 0
    v_accvgpr_write_b32 a49, 0
    v_accvgpr_write_b32 a50, 0
    v_accvgpr_write_b32 a51, 0
    v_accvgpr_write_b32 a52, 0
    v_accvgpr_write_b32 a53, 0
    v_accvgpr_write_b32 a54, 0
    v_accvgpr_write_b32 a55, 0
    v_accvgpr_write_b32 a56, 0
    v_accvgpr_write_b32 a57, 0
    v_accvgpr_write_b32 a58, 0
    v_accvgpr_write_b32 a59, 0
    v_accvgpr_write_b32 a60, 0
    v_accvgpr_write_b32 a61, 0
    v_accvgpr_write_b32 a62, 0
    v_accvgpr_write_b32 a63, 0
    v_accvgpr_write_b32 a64, 0
    v_accvgpr_write_b32 a65, 0
    v_accvgpr_write_b32 a66, 0
    v_accvgpr_write_b32 a67, 0
    v_accvgpr_write_b32 a68, 0
    v_accvgpr_write_b32 a69, 0
    v_accvgpr_write_b32 a70, 0
    v_accvgpr_write_b32 a71, 0
    v_accvgpr_write_b32 a72, 0
    v_accvgpr_write_b32 a73, 0
    v_accvgpr_write_b32 a74, 0
    v_accvgpr_write_b32 a75, 0
    v_accvgpr_write_b32 a76, 0
    v_accvgpr_write_b32 a77, 0
    v_accvgpr_write_b32 a78, 0
    v_accvgpr_write_b32 a79, 0
    v_accvgpr_write_b32 a80, 0
    v_accvgpr_write_b32 a81, 0
    v_accvgpr_write_b32 a82, 0
    v_accvgpr_write_b32 a83, 0
    v_accvgpr_write_b32 a84, 0
    v_accvgpr_write_b32 a85, 0
    v_accvgpr_write_b32 a86, 0
    v_accvgpr_write_b32 a87, 0
    v_accvgpr_write_b32 a88, 0
    v_accvgpr_write_b32 a89, 0
    v_accvgpr_write_b32 a90, 0
    v_accvgpr_write_b32 a91, 0
    v_accvgpr_write_b32 a92, 0
    v_accvgpr_write_b32 a93, 0
    v_accvgpr_write_b32 a94, 0
    v_accvgpr_write_b32 a95, 0
    v_accvgpr_write_b32 a96, 0
    v_accvgpr_write_b32 a97, 0
    v_accvgpr_write_b32 a98, 0
    v_accvgpr_write_b32 a99, 0
    v_accvgpr_write_b32 a100, 0
    v_accvgpr_write_b32 a101, 0
    v_accvgpr_write_b32 a102, 0
    v_accvgpr_write_b32 a103, 0
    v_accvgpr_write_b32 a104, 0
    v_accvgpr_write_b32 a105, 0
    v_accvgpr_write_b32 a106, 0
    v_accvgpr_write_b32 a107, 0
    v_accvgpr_write_b32 a108, 0
    v_accvgpr_write_b32 a109, 0
    v_accvgpr_write_b32 a110, 0
    v_accvgpr_write_b32 a111, 0
    v_accvgpr_write_b32 a112, 0
    v_accvgpr_write_b32 a113, 0
    v_accvgpr_write_b32 a114, 0
    v_accvgpr_write_b32 a115, 0
    v_accvgpr_write_b32 a116, 0
    v_accvgpr_write_b32 a117, 0
    v_accvgpr_write_b32 a118, 0
    v_accvgpr_write_b32 a119, 0
    v_accvgpr_write_b32 a120, 0
    v_accvgpr_write_b32 a121, 0
    v_accvgpr_write_b32 a122, 0
    v_accvgpr_write_b32 a123, 0
    v_accvgpr_write_b32 a124, 0
    v_accvgpr_write_b32 a125, 0
    v_accvgpr_write_b32 a126, 0
    v_accvgpr_write_b32 a127, 0
    s_mov_b32 s60, 32768
    s_lshl_b32 s24, s3, 6
    s_mov_b32 s25, 0
    s_mov_b32 s22, 0
    v_add_u32 v224, s24, v130
    v_bfe_u32 v225, v224, 1, 3
    v_xor_b32 v225, v225, v131
    v_lshlrev_b32 v225, 4, v225
    v_lshl_add_u32 v224, v224, 7, v225
    v_add_u32 v224, s60, v224
    v_mov_b32 v149, v224
    v_xor_b32 v150, 32, v224
    v_xor_b32 v151, 64, v224
    v_xor_b32 v152, 96, v224
    v_bfe_u32 v224, v129, 2, 2
    v_lshl_add_u32 v225, v131, 3, v224
    v_mul_u32_u24 v225, 256, v225
    v_bfe_u32 v226, v129, 4, 1
    v_and_b32 v227, 1, v129
    v_lshl_or_b32 v226, v226, 1, v227
    v_lshlrev_b32 v227, 2, v224
    v_bfe_u32 v228, v129, 1, 1
    v_lshl_add_u32 v225, v228, 3, v225
    v_add_u32 v225, s22, v225
    s_add_u32 s57, s25, 0
    s_lshl_b32 s57, s57, 2
    v_or_b32 v228, s57, v226
    v_xor_b32 v228, v228, v227
    v_lshl_add_u32 v153, v228, 4, v225
    s_add_u32 s57, s25, 1
    s_lshl_b32 s57, s57, 2
    v_or_b32 v228, s57, v226
    v_xor_b32 v228, v228, v227
    v_lshl_add_u32 v154, v228, 4, v225
    s_add_u32 s57, s25, 2
    s_lshl_b32 s57, s57, 2
    v_or_b32 v228, s57, v226
    v_xor_b32 v228, v228, v227
    v_lshl_add_u32 v155, v228, 4, v225
    s_add_u32 s57, s25, 3
    s_lshl_b32 s57, s57, 2
    v_or_b32 v228, s57, v226
    v_xor_b32 v228, v228, v227
    v_lshl_add_u32 v156, v228, 4, v225
    s_waitcnt vmcnt(2)
    s_barrier
    ds_read_b64_tr_b16 a[200:201], v153 offset:0
    ds_read_b128 a[192:195], v149 offset:0
    ds_read_b64_tr_b16 a[202:203], v153 offset:1024
    ds_read_b64_tr_b16 a[204:205], v154 offset:0
    ds_read_b128 a[196:199], v149 offset:4096
    ds_read_b64_tr_b16 a[206:207], v154 offset:1024
    ds_read_b64_tr_b16 a[208:209], v155 offset:0
    ds_read_b64_tr_b16 a[210:211], v155 offset:1024
    ds_read_b64_tr_b16 a[212:213], v156 offset:0
    ds_read_b64_tr_b16 a[214:215], v156 offset:1024
    s_waitcnt lgkmcnt(0)
    v_mfma_f32_32x32x16_bf16 v[0:15], a[200:203], a[192:195], 0
    s_add_u32 s60, s60, 32768
    s_mov_b32 s61, 32768
    s_cmp_eq_u32 s60, 131072
    s_cselect_b32 s61, -65536, s61
    s_cselect_b32 s60, 32768, s60
    s_add_u32 m0, s54, 4294934528
    s_add_u32 s57, s52, 4294967168
    buffer_load_dwordx4 v157, s[64:67], s57 offen lds
    ds_read_b64_tr_b16 a[224:225], v153 offset:4096
    s_add_u32 m0, s54, 4294935552
    s_add_u32 s57, s52, 9088
    buffer_load_dwordx4 v158, s[64:67], s57 offen lds
    v_mfma_f32_32x32x16_bf16 v[32:47], a[204:207], a[192:195], 0
    ds_read_b128 a[216:219], v150 offset:0
    s_add_u32 m0, s54, 4294936576
    s_add_u32 s57, s52, 18304
    buffer_load_dwordx4 v157, s[64:67], s57 offen lds
    ds_read_b64_tr_b16 a[226:227], v153 offset:5120
    v_mfma_f32_32x32x16_bf16 v[64:79], a[208:211], a[192:195], 0
    s_add_u32 m0, s54, 4294937600
    s_add_u32 s57, s52, 27520
    buffer_load_dwordx4 v158, s[64:67], s57 offen lds
    ds_read_b64_tr_b16 a[228:229], v154 offset:4096
    s_add_u32 m0, s56, 16384
    s_add_u32 s57, s55, 4294443008
    buffer_load_dwordx4 v159, s[68:71], s57 offen lds
    v_mfma_f32_32x32x16_bf16 v[96:111], a[212:215], a[192:195], 0
    ds_read_b128 a[220:223], v150 offset:4096
    s_add_u32 m0, s56, 17408
    s_add_u32 s57, s55, 4294475776
    buffer_load_dwordx4 v159, s[68:71], s57 offen lds
    ds_read_b64_tr_b16 a[230:231], v154 offset:5120
    v_mfma_f32_32x32x16_bf16 v[16:31], a[200:203], a[196:199], 0
    s_add_u32 m0, s54, 0
    s_add_u32 s57, s52, 0
    buffer_load_dwordx4 v157, s[64:67], s57 offen lds
    ds_read_b64_tr_b16 a[232:233], v155 offset:4096
    s_add_u32 m0, s54, 1024
    s_add_u32 s57, s52, 9216
    buffer_load_dwordx4 v158, s[64:67], s57 offen lds
    v_mfma_f32_32x32x16_bf16 v[48:63], a[204:207], a[196:199], 0
    ds_read_b64_tr_b16 a[234:235], v155 offset:5120
    s_add_u32 m0, s54, 2048
    s_add_u32 s57, s52, 18432
    buffer_load_dwordx4 v157, s[64:67], s57 offen lds
    ds_read_b64_tr_b16 a[236:237], v156 offset:4096
    v_mfma_f32_32x32x16_bf16 v[80:95], a[208:211], a[196:199], 0
    s_add_u32 m0, s54, 3072
    s_add_u32 s57, s52, 27648
    buffer_load_dwordx4 v158, s[64:67], s57 offen lds
    ds_read_b64_tr_b16 a[238:239], v156 offset:5120
    v_add_u32 v150, s61, v150
    v_mfma_f32_32x32x16_bf16 v[112:127], a[212:215], a[196:199], 0
    s_waitcnt vmcnt(10) lgkmcnt(0)
    s_barrier
    v_mfma_f32_32x32x16_bf16 v[0:15], a[224:227], a[216:219], v[0:15]
    ds_read_b64_tr_b16 a[200:201], v153 offset:8192
    s_add_u32 m0, s54, 4294938624
    s_add_u32 s57, s53, 4294967168
    buffer_load_dwordx4 v157, s[64:67], s57 offen lds
    ds_read_b128 a[192:195], v151 offset:0
    v_mfma_f32_32x32x16_bf16 v[32:47], a[228:231], a[216:219], v[32:47]
    s_add_u32 m0, s54, 4294939648
    s_add_u32 s57, s53, 9088
    buffer_load_dwordx4 v158, s[64:67], s57 offen lds
    ds_read_b64_tr_b16 a[202:203], v153 offset:9216
    v_mfma_f32_32x32x16_bf16 v[64:79], a[232:235], a[216:219], v[64:79]
    ds_read_b64_tr_b16 a[204:205], v154 offset:8192
    s_add_u32 m0, s54, 4294940672
    s_add_u32 s57, s53, 18304
    buffer_load_dwordx4 v157, s[64:67], s57 offen lds
    v_mfma_f32_32x32x16_bf16 v[96:111], a[236:239], a[216:219], v[96:111]
    ds_read_b128 a[196:199], v151 offset:4096
    ds_read_b64_tr_b16 a[206:207], v154 offset:9216
    v_mfma_f32_32x32x16_bf16 v[16:31], a[224:227], a[220:223], v[16:31]
    s_add_u32 m0, s54, 4294941696
    s_add_u32 s57, s53, 27520
    buffer_load_dwordx4 v158, s[64:67], s57 offen lds
    ds_read_b64_tr_b16 a[208:209], v155 offset:8192
    v_mfma_f32_32x32x16_bf16 v[48:63], a[228:231], a[220:223], v[48:63]
    s_add_u32 m0, s56, 0
    s_add_u32 s57, s55, 0
    buffer_load_dwordx4 v159, s[68:71], s57 offen lds
    ds_read_b64_tr_b16 a[210:211], v155 offset:9216
    v_mfma_f32_32x32x16_bf16 v[80:95], a[232:235], a[220:223], v[80:95]
    ds_read_b64_tr_b16 a[212:213], v156 offset:8192
    s_add_u32 m0, s56, 1024
    s_add_u32 s57, s55, 32768
    buffer_load_dwordx4 v159, s[68:71], s57 offen lds
    v_mfma_f32_32x32x16_bf16 v[112:127], a[236:239], a[220:223], v[112:127]
    ds_read_b64_tr_b16 a[214:215], v156 offset:9216
    v_add_u32 v151, s61, v151
    s_waitcnt lgkmcnt(0)
    v_mfma_f32_32x32x16_bf16 v[0:15], a[200:203], a[192:195], v[0:15]
    ds_read_b64_tr_b16 a[224:225], v153 offset:12288
    s_add_u32 m0, s56, 24576
    s_add_u32 s57, s55, 4294705152
    buffer_load_dwordx4 v159, s[68:71], s57 offen lds
    ds_read_b128 a[216:219], v152 offset:0
    s_add_u32 m0, s56, 25600
    s_add_u32 s57, s55, 4294737920
    buffer_load_dwordx4 v159, s[68:71], s57 offen lds
    v_mfma_f32_32x32x16_bf16 v[32:47], a[204:207], a[192:195], v[32:47]
    ds_read_b64_tr_b16 a[226:227], v153 offset:13312
    ds_read_b64_tr_b16 a[228:229], v154 offset:12288
    s_add_u32 m0, s54, 4096
    s_add_u32 s57, s53, 0
    buffer_load_dwordx4 v157, s[64:67], s57 offen lds
    v_mfma_f32_32x32x16_bf16 v[64:79], a[208:211], a[192:195], v[64:79]
    ds_read_b128 a[220:223], v152 offset:4096
    ds_read_b64_tr_b16 a[230:231], v154 offset:13312
    s_add_u32 m0, s54, 5120
    s_add_u32 s57, s53, 9216
    buffer_load_dwordx4 v158, s[64:67], s57 offen lds
    v_mfma_f32_32x32x16_bf16 v[96:111], a[212:215], a[192:195], v[96:111]
    ds_read_b64_tr_b16 a[232:233], v155 offset:12288
    s_add_u32 m0, s54, 6144
    s_add_u32 s57, s53, 18432
    buffer_load_dwordx4 v157, s[64:67], s57 offen lds
    ds_read_b64_tr_b16 a[234:235], v155 offset:13312
    v_mfma_f32_32x32x16_bf16 v[16:31], a[200:203], a[196:199], v[16:31]
    ds_read_b64_tr_b16 a[236:237], v156 offset:12288
    s_add_u32 m0, s54, 7168
    s_add_u32 s57, s53, 27648
    buffer_load_dwordx4 v158, s[64:67], s57 offen lds
    ds_read_b64_tr_b16 a[238:239], v156 offset:13312
    v_mfma_f32_32x32x16_bf16 v[48:63], a[204:207], a[196:199], v[48:63]
    v_add_u32 v152, s61, v152
    v_add_u32 v149, s61, v149
    v_xor_b32 v153, 16384, v153
    v_mfma_f32_32x32x16_bf16 v[80:95], a[208:211], a[196:199], v[80:95]
    v_xor_b32 v154, 16384, v154
    v_xor_b32 v155, 16384, v155
    v_xor_b32 v156, 16384, v156
    v_mfma_f32_32x32x16_bf16 v[112:127], a[212:215], a[196:199], v[112:127]
    s_waitcnt vmcnt(8) lgkmcnt(0)
    s_barrier
    v_mfma_f32_32x32x16_bf16 v[0:15], a[224:227], a[216:219], v[0:15]
    ds_read_b64_tr_b16 a[200:201], v153 offset:0
    ds_read_b128 a[192:195], v149 offset:0
    v_mfma_f32_32x32x16_bf16 v[32:47], a[228:231], a[216:219], v[32:47]
    s_add_u32 m0, s56, 8192
    s_add_u32 s57, s55, 262144
    buffer_load_dwordx4 v159, s[68:71], s57 offen lds
    ds_read_b64_tr_b16 a[202:203], v153 offset:1024
    v_mfma_f32_32x32x16_bf16 v[64:79], a[232:235], a[216:219], v[64:79]
    ds_read_b64_tr_b16 a[204:205], v154 offset:0
    ds_read_b128 a[196:199], v149 offset:4096
    v_mfma_f32_32x32x16_bf16 v[96:111], a[236:239], a[216:219], v[96:111]
    ds_read_b64_tr_b16 a[206:207], v154 offset:1024
    v_mfma_f32_32x32x16_bf16 v[16:31], a[224:227], a[220:223], v[16:31]
    ds_read_b64_tr_b16 a[208:209], v155 offset:0
    s_add_u32 m0, s56, 9216
    s_add_u32 s57, s55, 294912
    buffer_load_dwordx4 v159, s[68:71], s57 offen lds
    v_mfma_f32_32x32x16_bf16 v[48:63], a[228:231], a[220:223], v[48:63]
    ds_read_b64_tr_b16 a[210:211], v155 offset:1024
    ds_read_b64_tr_b16 a[212:213], v156 offset:0
    v_mfma_f32_32x32x16_bf16 v[80:95], a[232:235], a[220:223], v[80:95]
    ds_read_b64_tr_b16 a[214:215], v156 offset:1024
    s_add_u32 s55, s55, 524288
    s_xor_b32 s56, s56, 16384
    v_mfma_f32_32x32x16_bf16 v[112:127], a[236:239], a[220:223], v[112:127]
    s_add_u32 s52, s52, 128
    s_add_u32 s53, s53, 128
    s_add_u32 s54, s54, 32768
    s_cmp_ge_u32 s54, 131072
    s_cselect_b32 s58, 98304, 0
    s_sub_u32 s54, s54, s58
    s_waitcnt lgkmcnt(0)
    v_mfma_f32_32x32x16_bf16 v[0:15], a[200:203], a[192:195], v[0:15]
    s_add_u32 s60, s60, 32768
    s_mov_b32 s61, 32768
    s_cmp_eq_u32 s60, 131072
    s_cselect_b32 s61, -65536, s61
    s_cselect_b32 s60, 32768, s60
    s_add_u32 m0, s54, 0
    s_add_u32 s57, s52, 0
    buffer_load_dwordx4 v157, s[64:67], s57 offen lds
    ds_read_b64_tr_b16 a[224:225], v153 offset:4096
    v_mfma_f32_32x32x16_bf16 v[32:47], a[204:207], a[192:195], v[32:47]
    ds_read_b128 a[216:219], v150 offset:0
    ds_read_b64_tr_b16 a[226:227], v153 offset:5120
    v_mfma_f32_32x32x16_bf16 v[64:79], a[208:211], a[192:195], v[64:79]
    s_add_u32 m0, s54, 1024
    s_add_u32 s57, s52, 9216
    buffer_load_dwordx4 v158, s[64:67], s57 offen lds
    ds_read_b64_tr_b16 a[228:229], v154 offset:4096
    v_mfma_f32_32x32x16_bf16 v[96:111], a[212:215], a[192:195], v[96:111]
    ds_read_b128 a[220:223], v150 offset:4096
    ds_read_b64_tr_b16 a[230:231], v154 offset:5120
    s_add_u32 m0, s54, 2048
    s_add_u32 s57, s52, 18432
    buffer_load_dwordx4 v157, s[64:67], s57 offen lds
    v_mfma_f32_32x32x16_bf16 v[16:31], a[200:203], a[196:199], v[16:31]
    ds_read_b64_tr_b16 a[232:233], v155 offset:4096
    ds_read_b64_tr_b16 a[234:235], v155 offset:5120
    v_mfma_f32_32x32x16_bf16 v[48:63], a[204:207], a[196:199], v[48:63]
    ds_read_b64_tr_b16 a[236:237], v156 offset:4096
    s_add_u32 m0, s54, 3072
    s_add_u32 s57, s52, 27648
    buffer_load_dwordx4 v158, s[64:67], s57 offen lds
    v_mfma_f32_32x32x16_bf16 v[80:95], a[208:211], a[196:199], v[80:95]
    ds_read_b64_tr_b16 a[238:239], v156 offset:5120
    v_add_u32 v150, s61, v150
    v_mfma_f32_32x32x16_bf16 v[112:127], a[212:215], a[196:199], v[112:127]
    s_waitcnt vmcnt(10) lgkmcnt(0)
    s_barrier
    v_mfma_f32_32x32x16_bf16 v[0:15], a[224:227], a[216:219], v[0:15]
    ds_read_b64_tr_b16 a[200:201], v153 offset:8192
    ds_read_b128 a[192:195], v151 offset:0
    v_mfma_f32_32x32x16_bf16 v[32:47], a[228:231], a[216:219], v[32:47]
    s_add_u32 m0, s56, 0
    s_add_u32 s57, s55, 0
    buffer_load_dwordx4 v159, s[68:71], s57 offen lds
    ds_read_b64_tr_b16 a[202:203], v153 offset:9216
    v_mfma_f32_32x32x16_bf16 v[64:79], a[232:235], a[216:219], v[64:79]
    ds_read_b64_tr_b16 a[204:205], v154 offset:8192
    v_mfma_f32_32x32x16_bf16 v[96:111], a[236:239], a[216:219], v[96:111]
    ds_read_b128 a[196:199], v151 offset:4096
    ds_read_b64_tr_b16 a[206:207], v154 offset:9216
    v_mfma_f32_32x32x16_bf16 v[16:31], a[224:227], a[220:223], v[16:31]
    ds_read_b64_tr_b16 a[208:209], v155 offset:8192
    s_add_u32 m0, s56, 1024
    s_add_u32 s57, s55, 32768
    buffer_load_dwordx4 v159, s[68:71], s57 offen lds
    v_mfma_f32_32x32x16_bf16 v[48:63], a[228:231], a[220:223], v[48:63]
    ds_read_b64_tr_b16 a[210:211], v155 offset:9216
    v_mfma_f32_32x32x16_bf16 v[80:95], a[232:235], a[220:223], v[80:95]
    ds_read_b64_tr_b16 a[212:213], v156 offset:8192
    ds_read_b64_tr_b16 a[214:215], v156 offset:9216
    v_mfma_f32_32x32x16_bf16 v[112:127], a[236:239], a[220:223], v[112:127]
    v_add_u32 v151, s61, v151
    s_waitcnt lgkmcnt(0)
    v_mfma_f32_32x32x16_bf16 v[0:15], a[200:203], a[192:195], v[0:15]
    ds_read_b64_tr_b16 a[224:225], v153 offset:12288
    s_add_u32 m0, s54, 4096
    s_add_u32 s57, s53, 0
    buffer_load_dwordx4 v157, s[64:67], s57 offen lds
    ds_read_b128 a[216:219], v152 offset:0
    v_mfma_f32_32x32x16_bf16 v[32:47], a[204:207], a[192:195], v[32:47]
    ds_read_b64_tr_b16 a[226:227], v153 offset:13312
    ds_read_b64_tr_b16 a[228:229], v154 offset:12288
    s_add_u32 m0, s54, 5120
    s_add_u32 s57, s53, 9216
    buffer_load_dwordx4 v158, s[64:67], s57 offen lds
    v_mfma_f32_32x32x16_bf16 v[64:79], a[208:211], a[192:195], v[64:79]
    ds_read_b128 a[220:223], v152 offset:4096
    ds_read_b64_tr_b16 a[230:231], v154 offset:13312
    s_add_u32 m0, s54, 6144
    s_add_u32 s57, s53, 18432
    buffer_load_dwordx4 v157, s[64:67], s57 offen lds
    v_mfma_f32_32x32x16_bf16 v[96:111], a[212:215], a[192:195], v[96:111]
    ds_read_b64_tr_b16 a[232:233], v155 offset:12288
    ds_read_b64_tr_b16 a[234:235], v155 offset:13312
    ds_read_b64_tr_b16 a[236:237], v156 offset:12288
    v_mfma_f32_32x32x16_bf16 v[16:31], a[200:203], a[196:199], v[16:31]
    s_add_u32 m0, s54, 7168
    s_add_u32 s57, s53, 27648
    buffer_load_dwordx4 v158, s[64:67], s57 offen lds
    ds_read_b64_tr_b16 a[238:239], v156 offset:13312
    v_add_u32 v152, s61, v152
    v_mfma_f32_32x32x16_bf16 v[48:63], a[204:207], a[196:199], v[48:63]
    v_add_u32 v149, s61, v149
    v_xor_b32 v153, 16384, v153
    v_xor_b32 v154, 16384, v154
    v_mfma_f32_32x32x16_bf16 v[80:95], a[208:211], a[196:199], v[80:95]
    v_xor_b32 v155, 16384, v155
    v_xor_b32 v156, 16384, v156
    v_mfma_f32_32x32x16_bf16 v[112:127], a[212:215], a[196:199], v[112:127]
    s_waitcnt vmcnt(12) lgkmcnt(0)
    s_barrier
    v_mfma_f32_32x32x16_bf16 v[0:15], a[224:227], a[216:219], v[0:15]
    ds_read_b64_tr_b16 a[200:201], v153 offset:0
    ds_read_b128 a[192:195], v149 offset:0
    v_mfma_f32_32x32x16_bf16 v[32:47], a[228:231], a[216:219], v[32:47]
    s_add_u32 m0, s56, 8192
    s_add_u32 s57, s55, 262144
    buffer_load_dwordx4 v159, s[68:71], s57 offen lds
    ds_read_b64_tr_b16 a[202:203], v153 offset:1024
    v_mfma_f32_32x32x16_bf16 v[64:79], a[232:235], a[216:219], v[64:79]
    ds_read_b64_tr_b16 a[204:205], v154 offset:0
    ds_read_b128 a[196:199], v149 offset:4096
    v_mfma_f32_32x32x16_bf16 v[96:111], a[236:239], a[216:219], v[96:111]
    ds_read_b64_tr_b16 a[206:207], v154 offset:1024
    v_mfma_f32_32x32x16_bf16 v[16:31], a[224:227], a[220:223], v[16:31]
    ds_read_b64_tr_b16 a[208:209], v155 offset:0
    s_add_u32 m0, s56, 9216
    s_add_u32 s57, s55, 294912
    buffer_load_dwordx4 v159, s[68:71], s57 offen lds
    v_mfma_f32_32x32x16_bf16 v[48:63], a[228:231], a[220:223], v[48:63]
    ds_read_b64_tr_b16 a[210:211], v155 offset:1024
    ds_read_b64_tr_b16 a[212:213], v156 offset:0
    v_mfma_f32_32x32x16_bf16 v[80:95], a[232:235], a[220:223], v[80:95]
    ds_read_b64_tr_b16 a[214:215], v156 offset:1024
    s_add_u32 s55, s55, 524288
    s_xor_b32 s56, s56, 16384
    v_mfma_f32_32x32x16_bf16 v[112:127], a[236:239], a[220:223], v[112:127]
    s_add_u32 s52, s52, 128
    s_add_u32 s53, s53, 128
    s_add_u32 s54, s54, 32768
    s_cmp_ge_u32 s54, 131072
    s_cselect_b32 s58, 98304, 0
    s_sub_u32 s54, s54, s58
    s_waitcnt lgkmcnt(0)
    v_mfma_f32_32x32x16_bf16 v[0:15], a[200:203], a[192:195], v[0:15]
    s_add_u32 s60, s60, 32768
    s_mov_b32 s61, 32768
    s_cmp_eq_u32 s60, 131072
    s_cselect_b32 s61, -65536, s61
    s_cselect_b32 s60, 32768, s60
    s_add_u32 m0, s54, 0
    s_add_u32 s57, s52, 0
    buffer_load_dwordx4 v157, s[64:67], s57 offen lds
    ds_read_b64_tr_b16 a[224:225], v153 offset:4096
    v_mfma_f32_32x32x16_bf16 v[32:47], a[204:207], a[192:195], v[32:47]
    ds_read_b128 a[216:219], v150 offset:0
    ds_read_b64_tr_b16 a[226:227], v153 offset:5120
    v_mfma_f32_32x32x16_bf16 v[64:79], a[208:211], a[192:195], v[64:79]
    s_add_u32 m0, s54, 1024
    s_add_u32 s57, s52, 9216
    buffer_load_dwordx4 v158, s[64:67], s57 offen lds
    ds_read_b64_tr_b16 a[228:229], v154 offset:4096
    v_mfma_f32_32x32x16_bf16 v[96:111], a[212:215], a[192:195], v[96:111]
    ds_read_b128 a[220:223], v150 offset:4096
    ds_read_b64_tr_b16 a[230:231], v154 offset:5120
    s_add_u32 m0, s54, 2048
    s_add_u32 s57, s52, 18432
    buffer_load_dwordx4 v157, s[64:67], s57 offen lds
    v_mfma_f32_32x32x16_bf16 v[16:31], a[200:203], a[196:199], v[16:31]
    ds_read_b64_tr_b16 a[232:233], v155 offset:4096
    ds_read_b64_tr_b16 a[234:235], v155 offset:5120
    v_mfma_f32_32x32x16_bf16 v[48:63], a[204:207], a[196:199], v[48:63]
    ds_read_b64_tr_b16 a[236:237], v156 offset:4096
    s_add_u32 m0, s54, 3072
    s_add_u32 s57, s52, 27648
    buffer_load_dwordx4 v158, s[64:67], s57 offen lds
    v_mfma_f32_32x32x16_bf16 v[80:95], a[208:211], a[196:199], v[80:95]
    ds_read_b64_tr_b16 a[238:239], v156 offset:5120
    v_add_u32 v150, s61, v150
    v_mfma_f32_32x32x16_bf16 v[112:127], a[212:215], a[196:199], v[112:127]
    s_waitcnt vmcnt(16) lgkmcnt(0)
    s_barrier
    v_mfma_f32_32x32x16_bf16 v[0:15], a[224:227], a[216:219], v[0:15]
    ds_read_b64_tr_b16 a[200:201], v153 offset:8192
    ds_read_b128 a[192:195], v151 offset:0
    v_mfma_f32_32x32x16_bf16 v[32:47], a[228:231], a[216:219], v[32:47]
    s_add_u32 m0, s56, 0
    s_add_u32 s57, s55, 0
    buffer_load_dwordx4 v159, s[68:71], s57 offen lds
    ds_read_b64_tr_b16 a[202:203], v153 offset:9216
    v_mfma_f32_32x32x16_bf16 v[64:79], a[232:235], a[216:219], v[64:79]
    ds_read_b64_tr_b16 a[204:205], v154 offset:8192
    ds_read_b128 a[196:199], v151 offset:4096
    v_mfma_f32_32x32x16_bf16 v[96:111], a[236:239], a[216:219], v[96:111]
    s_add_u32 m0, s56, 1024
    s_add_u32 s57, s55, 32768
    buffer_load_dwordx4 v159, s[68:71], s57 offen lds
    v_mfma_f32_32x32x16_bf16 v[16:31], a[224:227], a[220:223], v[16:31]
    ds_read_b64_tr_b16 a[206:207], v154 offset:9216
    ds_read_b64_tr_b16 a[208:209], v155 offset:8192
    v_mfma_f32_32x32x16_bf16 v[48:63], a[228:231], a[220:223], v[48:63]
    ds_read_b64_tr_b16 a[210:211], v155 offset:9216
    s_cmp_lg_u32 s3, 0
    s_cbranch_scc1 L_arr_1
    s_lshl_b32 s58, s2, 7
    s_add_u32 s58, s58, 92340224
    v_accvgpr_read_b32 v250, a250
    v_mov_b32 v251, 0
    v_add_u32 v250, 1, v250
    s_mov_b64 exec, 1
    buffer_store_dword v250, v251, s[8:11], s58 offen sc1
    s_mov_b64 exec, -1
L_arr_1:
    v_mfma_f32_32x32x16_bf16 v[80:95], a[232:235], a[220:223], v[80:95]
    ds_read_b64_tr_b16 a[212:213], v156 offset:8192
    ds_read_b64_tr_b16 a[214:215], v156 offset:9216
    v_mfma_f32_32x32x16_bf16 v[112:127], a[236:239], a[220:223], v[112:127]
    v_add_u32 v151, s61, v151
    s_waitcnt lgkmcnt(0)
    v_mfma_f32_32x32x16_bf16 v[0:15], a[200:203], a[192:195], v[0:15]
    ds_read_b64_tr_b16 a[224:225], v153 offset:12288
    s_add_u32 m0, s54, 4096
    s_add_u32 s57, s53, 0
    buffer_load_dwordx4 v157, s[64:67], s57 offen lds
    ds_read_b128 a[216:219], v152 offset:0
    v_mfma_f32_32x32x16_bf16 v[32:47], a[204:207], a[192:195], v[32:47]
    ds_read_b64_tr_b16 a[226:227], v153 offset:13312
    ds_read_b64_tr_b16 a[228:229], v154 offset:12288
    s_add_u32 m0, s54, 5120
    s_add_u32 s57, s53, 9216
    buffer_load_dwordx4 v158, s[64:67], s57 offen lds
    v_mfma_f32_32x32x16_bf16 v[64:79], a[208:211], a[192:195], v[64:79]
    ds_read_b128 a[220:223], v152 offset:4096
    ds_read_b64_tr_b16 a[230:231], v154 offset:13312
    s_add_u32 m0, s54, 6144
    s_add_u32 s57, s53, 18432
    buffer_load_dwordx4 v157, s[64:67], s57 offen lds
    v_mfma_f32_32x32x16_bf16 v[96:111], a[212:215], a[192:195], v[96:111]
    ds_read_b64_tr_b16 a[232:233], v155 offset:12288
    ds_read_b64_tr_b16 a[234:235], v155 offset:13312
    ds_read_b64_tr_b16 a[236:237], v156 offset:12288
    v_mfma_f32_32x32x16_bf16 v[16:31], a[200:203], a[196:199], v[16:31]
    s_add_u32 m0, s54, 7168
    s_add_u32 s57, s53, 27648
    buffer_load_dwordx4 v158, s[64:67], s57 offen lds
    ds_read_b64_tr_b16 a[238:239], v156 offset:13312
    v_add_u32 v152, s61, v152
    v_mfma_f32_32x32x16_bf16 v[48:63], a[204:207], a[196:199], v[48:63]
    v_add_u32 v149, s61, v149
    v_xor_b32 v153, 16384, v153
    v_xor_b32 v154, 16384, v154
    v_mfma_f32_32x32x16_bf16 v[80:95], a[208:211], a[196:199], v[80:95]
    v_xor_b32 v155, 16384, v155
    v_xor_b32 v156, 16384, v156
    v_mfma_f32_32x32x16_bf16 v[112:127], a[212:215], a[196:199], v[112:127]
    s_waitcnt vmcnt(12) lgkmcnt(0)
    s_barrier
    v_mfma_f32_32x32x16_bf16 v[0:15], a[224:227], a[216:219], v[0:15]
    ds_read_b64_tr_b16 a[200:201], v153 offset:0
    ds_read_b128 a[192:195], v149 offset:0
    v_mfma_f32_32x32x16_bf16 v[32:47], a[228:231], a[216:219], v[32:47]
    s_add_u32 m0, s56, 8192
    s_add_u32 s57, s55, 262144
    buffer_load_dwordx4 v159, s[68:71], s57 offen lds
    ds_read_b64_tr_b16 a[202:203], v153 offset:1024
    v_mfma_f32_32x32x16_bf16 v[64:79], a[232:235], a[216:219], v[64:79]
    ds_read_b64_tr_b16 a[204:205], v154 offset:0
    ds_read_b128 a[196:199], v149 offset:4096
    v_mfma_f32_32x32x16_bf16 v[96:111], a[236:239], a[216:219], v[96:111]
    ds_read_b64_tr_b16 a[206:207], v154 offset:1024
    v_mfma_f32_32x32x16_bf16 v[16:31], a[224:227], a[220:223], v[16:31]
    ds_read_b64_tr_b16 a[208:209], v155 offset:0
    s_add_u32 m0, s56, 9216
    s_add_u32 s57, s55, 294912
    buffer_load_dwordx4 v159, s[68:71], s57 offen lds
    v_mfma_f32_32x32x16_bf16 v[48:63], a[228:231], a[220:223], v[48:63]
    ds_read_b64_tr_b16 a[210:211], v155 offset:1024
    ds_read_b64_tr_b16 a[212:213], v156 offset:0
    v_mfma_f32_32x32x16_bf16 v[80:95], a[232:235], a[220:223], v[80:95]
    ds_read_b64_tr_b16 a[214:215], v156 offset:1024
    s_add_u32 s55, s55, 524288
    s_xor_b32 s56, s56, 16384
    v_mfma_f32_32x32x16_bf16 v[112:127], a[236:239], a[220:223], v[112:127]
    s_add_u32 s52, s52, 128
    s_add_u32 s53, s53, 128
    s_add_u32 s54, s54, 32768
    s_cmp_ge_u32 s54, 131072
    s_cselect_b32 s58, 98304, 0
    s_sub_u32 s54, s54, s58
    s_waitcnt lgkmcnt(0)
    v_mfma_f32_32x32x16_bf16 v[0:15], a[200:203], a[192:195], v[0:15]
    s_add_u32 s60, s60, 32768
    s_mov_b32 s61, 32768
    s_cmp_eq_u32 s60, 131072
    s_cselect_b32 s61, -65536, s61
    s_cselect_b32 s60, 32768, s60
    s_add_u32 m0, s54, 0
    s_add_u32 s57, s52, 0
    buffer_load_dwordx4 v157, s[64:67], s57 offen lds
    ds_read_b64_tr_b16 a[224:225], v153 offset:4096
    v_mfma_f32_32x32x16_bf16 v[32:47], a[204:207], a[192:195], v[32:47]
    ds_read_b128 a[216:219], v150 offset:0
    ds_read_b64_tr_b16 a[226:227], v153 offset:5120
    v_mfma_f32_32x32x16_bf16 v[64:79], a[208:211], a[192:195], v[64:79]
    s_add_u32 m0, s54, 1024
    s_add_u32 s57, s52, 9216
    buffer_load_dwordx4 v158, s[64:67], s57 offen lds
    ds_read_b64_tr_b16 a[228:229], v154 offset:4096
    v_mfma_f32_32x32x16_bf16 v[96:111], a[212:215], a[192:195], v[96:111]
    ds_read_b128 a[220:223], v150 offset:4096
    ds_read_b64_tr_b16 a[230:231], v154 offset:5120
    s_add_u32 m0, s54, 2048
    s_add_u32 s57, s52, 18432
    buffer_load_dwordx4 v157, s[64:67], s57 offen lds
    v_mfma_f32_32x32x16_bf16 v[16:31], a[200:203], a[196:199], v[16:31]
    ds_read_b64_tr_b16 a[232:233], v155 offset:4096
    ds_read_b64_tr_b16 a[234:235], v155 offset:5120
    v_mfma_f32_32x32x16_bf16 v[48:63], a[204:207], a[196:199], v[48:63]
    ds_read_b64_tr_b16 a[236:237], v156 offset:4096
    s_add_u32 m0, s54, 3072
    s_add_u32 s57, s52, 27648
    buffer_load_dwordx4 v158, s[64:67], s57 offen lds
    v_mfma_f32_32x32x16_bf16 v[80:95], a[208:211], a[196:199], v[80:95]
    ds_read_b64_tr_b16 a[238:239], v156 offset:5120
    v_add_u32 v150, s61, v150
    v_mfma_f32_32x32x16_bf16 v[112:127], a[212:215], a[196:199], v[112:127]
    s_waitcnt vmcnt(16) lgkmcnt(0)
    s_barrier
    v_mfma_f32_32x32x16_bf16 v[0:15], a[224:227], a[216:219], v[0:15]
    ds_read_b64_tr_b16 a[200:201], v153 offset:8192
    ds_read_b128 a[192:195], v151 offset:0
    v_mfma_f32_32x32x16_bf16 v[32:47], a[228:231], a[216:219], v[32:47]
    s_add_u32 m0, s56, 0
    s_add_u32 s57, s55, 0
    buffer_load_dwordx4 v159, s[68:71], s57 offen lds
    ds_read_b64_tr_b16 a[202:203], v153 offset:9216
    v_mfma_f32_32x32x16_bf16 v[64:79], a[232:235], a[216:219], v[64:79]
    ds_read_b64_tr_b16 a[204:205], v154 offset:8192
    v_mfma_f32_32x32x16_bf16 v[96:111], a[236:239], a[216:219], v[96:111]
    ds_read_b128 a[196:199], v151 offset:4096
    ds_read_b64_tr_b16 a[206:207], v154 offset:9216
    v_mfma_f32_32x32x16_bf16 v[16:31], a[224:227], a[220:223], v[16:31]
    ds_read_b64_tr_b16 a[208:209], v155 offset:8192
    s_add_u32 m0, s56, 1024
    s_add_u32 s57, s55, 32768
    buffer_load_dwordx4 v159, s[68:71], s57 offen lds
    v_mfma_f32_32x32x16_bf16 v[48:63], a[228:231], a[220:223], v[48:63]
    ds_read_b64_tr_b16 a[210:211], v155 offset:9216
    v_mfma_f32_32x32x16_bf16 v[80:95], a[232:235], a[220:223], v[80:95]
    ds_read_b64_tr_b16 a[212:213], v156 offset:8192
    ds_read_b64_tr_b16 a[214:215], v156 offset:9216
    v_mfma_f32_32x32x16_bf16 v[112:127], a[236:239], a[220:223], v[112:127]
    v_add_u32 v151, s61, v151
    s_waitcnt lgkmcnt(0)
    v_mfma_f32_32x32x16_bf16 v[0:15], a[200:203], a[192:195], v[0:15]
    ds_read_b64_tr_b16 a[224:225], v153 offset:12288
    s_add_u32 m0, s54, 4096
    s_add_u32 s57, s53, 0
    buffer_load_dwordx4 v157, s[64:67], s57 offen lds
    ds_read_b128 a[216:219], v152 offset:0
    v_mfma_f32_32x32x16_bf16 v[32:47], a[204:207], a[192:195], v[32:47]
    ds_read_b64_tr_b16 a[226:227], v153 offset:13312
    ds_read_b64_tr_b16 a[228:229], v154 offset:12288
    s_add_u32 m0, s54, 5120
    s_add_u32 s57, s53, 9216
    buffer_load_dwordx4 v158, s[64:67], s57 offen lds
    v_mfma_f32_32x32x16_bf16 v[64:79], a[208:211], a[192:195], v[64:79]
    ds_read_b128 a[220:223], v152 offset:4096
    ds_read_b64_tr_b16 a[230:231], v154 offset:13312
    s_add_u32 m0, s54, 6144
    s_add_u32 s57, s53, 18432
    buffer_load_dwordx4 v157, s[64:67], s57 offen lds
    v_mfma_f32_32x32x16_bf16 v[96:111], a[212:215], a[192:195], v[96:111]
    ds_read_b64_tr_b16 a[232:233], v155 offset:12288
    ds_read_b64_tr_b16 a[234:235], v155 offset:13312
    ds_read_b64_tr_b16 a[236:237], v156 offset:12288
    v_mfma_f32_32x32x16_bf16 v[16:31], a[200:203], a[196:199], v[16:31]
    s_add_u32 m0, s54, 7168
    s_add_u32 s57, s53, 27648
    buffer_load_dwordx4 v158, s[64:67], s57 offen lds
    ds_read_b64_tr_b16 a[238:239], v156 offset:13312
    v_add_u32 v152, s61, v152
    v_mfma_f32_32x32x16_bf16 v[48:63], a[204:207], a[196:199], v[48:63]
    v_add_u32 v149, s61, v149
    v_xor_b32 v153, 16384, v153
    v_xor_b32 v154, 16384, v154
    v_mfma_f32_32x32x16_bf16 v[80:95], a[208:211], a[196:199], v[80:95]
    v_xor_b32 v155, 16384, v155
    v_xor_b32 v156, 16384, v156
    v_mfma_f32_32x32x16_bf16 v[112:127], a[212:215], a[196:199], v[112:127]
    s_waitcnt vmcnt(12) lgkmcnt(0)
    s_barrier
    v_mfma_f32_32x32x16_bf16 v[0:15], a[224:227], a[216:219], v[0:15]
    ds_read_b64_tr_b16 a[200:201], v153 offset:0
    ds_read_b128 a[192:195], v149 offset:0
    v_mfma_f32_32x32x16_bf16 v[32:47], a[228:231], a[216:219], v[32:47]
    s_add_u32 m0, s56, 8192
    s_add_u32 s57, s55, 262144
    buffer_load_dwordx4 v159, s[68:71], s57 offen lds
    ds_read_b64_tr_b16 a[202:203], v153 offset:1024
    v_mfma_f32_32x32x16_bf16 v[64:79], a[232:235], a[216:219], v[64:79]
    ds_read_b64_tr_b16 a[204:205], v154 offset:0
    ds_read_b128 a[196:199], v149 offset:4096
    v_mfma_f32_32x32x16_bf16 v[96:111], a[236:239], a[216:219], v[96:111]
    ds_read_b64_tr_b16 a[206:207], v154 offset:1024
    v_mfma_f32_32x32x16_bf16 v[16:31], a[224:227], a[220:223], v[16:31]
    ds_read_b64_tr_b16 a[208:209], v155 offset:0
    s_add_u32 m0, s56, 9216
    s_add_u32 s57, s55, 294912
    buffer_load_dwordx4 v159, s[68:71], s57 offen lds
    v_mfma_f32_32x32x16_bf16 v[48:63], a[228:231], a[220:223], v[48:63]
    ds_read_b64_tr_b16 a[210:211], v155 offset:1024
    ds_read_b64_tr_b16 a[212:213], v156 offset:0
    v_mfma_f32_32x32x16_bf16 v[80:95], a[232:235], a[220:223], v[80:95]
    ds_read_b64_tr_b16 a[214:215], v156 offset:1024
    s_add_u32 s55, s55, 524288
    s_xor_b32 s56, s56, 16384
    v_mfma_f32_32x32x16_bf16 v[112:127], a[236:239], a[220:223], v[112:127]
    s_add_u32 s52, s52, 128
    s_add_u32 s53, s53, 128
    s_add_u32 s54, s54, 32768
    s_cmp_ge_u32 s54, 131072
    s_cselect_b32 s58, 98304, 0
    s_sub_u32 s54, s54, s58
    s_waitcnt lgkmcnt(0)
    v_mfma_f32_32x32x16_bf16 v[0:15], a[200:203], a[192:195], v[0:15]
    s_add_u32 s60, s60, 32768
    s_mov_b32 s61, 32768
    s_cmp_eq_u32 s60, 131072
    s_cselect_b32 s61, -65536, s61
    s_cselect_b32 s60, 32768, s60
    s_add_u32 m0, s54, 0
    s_add_u32 s57, s52, 0
    buffer_load_dwordx4 v157, s[64:67], s57 offen lds
    ds_read_b64_tr_b16 a[224:225], v153 offset:4096
    v_mfma_f32_32x32x16_bf16 v[32:47], a[204:207], a[192:195], v[32:47]
    ds_read_b128 a[216:219], v150 offset:0
    ds_read_b64_tr_b16 a[226:227], v153 offset:5120
    v_mfma_f32_32x32x16_bf16 v[64:79], a[208:211], a[192:195], v[64:79]
    s_add_u32 m0, s54, 1024
    s_add_u32 s57, s52, 9216
    buffer_load_dwordx4 v158, s[64:67], s57 offen lds
    ds_read_b64_tr_b16 a[228:229], v154 offset:4096
    v_mfma_f32_32x32x16_bf16 v[96:111], a[212:215], a[192:195], v[96:111]
    ds_read_b128 a[220:223], v150 offset:4096
    ds_read_b64_tr_b16 a[230:231], v154 offset:5120
    s_add_u32 m0, s54, 2048
    s_add_u32 s57, s52, 18432
    buffer_load_dwordx4 v157, s[64:67], s57 offen lds
    v_mfma_f32_32x32x16_bf16 v[16:31], a[200:203], a[196:199], v[16:31]
    ds_read_b64_tr_b16 a[232:233], v155 offset:4096
    ds_read_b64_tr_b16 a[234:235], v155 offset:5120
    v_mfma_f32_32x32x16_bf16 v[48:63], a[204:207], a[196:199], v[48:63]
    ds_read_b64_tr_b16 a[236:237], v156 offset:4096
    s_add_u32 m0, s54, 3072
    s_add_u32 s57, s52, 27648
    buffer_load_dwordx4 v158, s[64:67], s57 offen lds
    v_mfma_f32_32x32x16_bf16 v[80:95], a[208:211], a[196:199], v[80:95]
    ds_read_b64_tr_b16 a[238:239], v156 offset:5120
    v_add_u32 v150, s61, v150
    v_mfma_f32_32x32x16_bf16 v[112:127], a[212:215], a[196:199], v[112:127]
    s_waitcnt vmcnt(16) lgkmcnt(0)
    s_barrier
    v_mfma_f32_32x32x16_bf16 v[0:15], a[224:227], a[216:219], v[0:15]
    ds_read_b64_tr_b16 a[200:201], v153 offset:8192
    ds_read_b128 a[192:195], v151 offset:0
    v_mfma_f32_32x32x16_bf16 v[32:47], a[228:231], a[216:219], v[32:47]
    s_add_u32 m0, s56, 0
    s_add_u32 s57, s55, 0
    buffer_load_dwordx4 v159, s[68:71], s57 offen lds
    ds_read_b64_tr_b16 a[202:203], v153 offset:9216
    v_mfma_f32_32x32x16_bf16 v[64:79], a[232:235], a[216:219], v[64:79]
    ds_read_b64_tr_b16 a[204:205], v154 offset:8192
    v_mfma_f32_32x32x16_bf16 v[96:111], a[236:239], a[216:219], v[96:111]
    ds_read_b128 a[196:199], v151 offset:4096
    ds_read_b64_tr_b16 a[206:207], v154 offset:9216
    v_mfma_f32_32x32x16_bf16 v[16:31], a[224:227], a[220:223], v[16:31]
    ds_read_b64_tr_b16 a[208:209], v155 offset:8192
    s_add_u32 m0, s56, 1024
    s_add_u32 s57, s55, 32768
    buffer_load_dwordx4 v159, s[68:71], s57 offen lds
    v_mfma_f32_32x32x16_bf16 v[48:63], a[228:231], a[220:223], v[48:63]
    ds_read_b64_tr_b16 a[210:211], v155 offset:9216
    v_mfma_f32_32x32x16_bf16 v[80:95], a[232:235], a[220:223], v[80:95]
    ds_read_b64_tr_b16 a[212:213], v156 offset:8192
    ds_read_b64_tr_b16 a[214:215], v156 offset:9216
    v_mfma_f32_32x32x16_bf16 v[112:127], a[236:239], a[220:223], v[112:127]
    v_add_u32 v151, s61, v151
    s_waitcnt lgkmcnt(0)
    v_mfma_f32_32x32x16_bf16 v[0:15], a[200:203], a[192:195], v[0:15]
    ds_read_b64_tr_b16 a[224:225], v153 offset:12288
    s_add_u32 m0, s54, 4096
    s_add_u32 s57, s53, 0
    buffer_load_dwordx4 v157, s[64:67], s57 offen lds
    ds_read_b128 a[216:219], v152 offset:0
    v_mfma_f32_32x32x16_bf16 v[32:47], a[204:207], a[192:195], v[32:47]
    ds_read_b64_tr_b16 a[226:227], v153 offset:13312
    ds_read_b64_tr_b16 a[228:229], v154 offset:12288
    s_add_u32 m0, s54, 5120
    s_add_u32 s57, s53, 9216
    buffer_load_dwordx4 v158, s[64:67], s57 offen lds
    v_mfma_f32_32x32x16_bf16 v[64:79], a[208:211], a[192:195], v[64:79]
    ds_read_b128 a[220:223], v152 offset:4096
    ds_read_b64_tr_b16 a[230:231], v154 offset:13312
    s_add_u32 m0, s54, 6144
    s_add_u32 s57, s53, 18432
    buffer_load_dwordx4 v157, s[64:67], s57 offen lds
    v_mfma_f32_32x32x16_bf16 v[96:111], a[212:215], a[192:195], v[96:111]
    ds_read_b64_tr_b16 a[232:233], v155 offset:12288
    ds_read_b64_tr_b16 a[234:235], v155 offset:13312
    ds_read_b64_tr_b16 a[236:237], v156 offset:12288
    v_mfma_f32_32x32x16_bf16 v[16:31], a[200:203], a[196:199], v[16:31]
    s_add_u32 m0, s54, 7168
    s_add_u32 s57, s53, 27648
    buffer_load_dwordx4 v158, s[64:67], s57 offen lds
    ds_read_b64_tr_b16 a[238:239], v156 offset:13312
    v_add_u32 v152, s61, v152
    v_mfma_f32_32x32x16_bf16 v[48:63], a[204:207], a[196:199], v[48:63]
    v_add_u32 v149, s61, v149
    v_xor_b32 v153, 16384, v153
    v_xor_b32 v154, 16384, v154
    v_mfma_f32_32x32x16_bf16 v[80:95], a[208:211], a[196:199], v[80:95]
    v_xor_b32 v155, 16384, v155
    v_xor_b32 v156, 16384, v156
    v_mfma_f32_32x32x16_bf16 v[112:127], a[212:215], a[196:199], v[112:127]
    s_waitcnt vmcnt(12) lgkmcnt(0)
    s_barrier
    v_mfma_f32_32x32x16_bf16 v[0:15], a[224:227], a[216:219], v[0:15]
    ds_read_b64_tr_b16 a[200:201], v153 offset:0
    ds_read_b128 a[192:195], v149 offset:0
    v_mfma_f32_32x32x16_bf16 v[32:47], a[228:231], a[216:219], v[32:47]
    s_add_u32 m0, s56, 8192
    s_add_u32 s57, s55, 262144
    buffer_load_dwordx4 v159, s[68:71], s57 offen lds
    ds_read_b64_tr_b16 a[202:203], v153 offset:1024
    v_mfma_f32_32x32x16_bf16 v[64:79], a[232:235], a[216:219], v[64:79]
    ds_read_b64_tr_b16 a[204:205], v154 offset:0
    ds_read_b128 a[196:199], v149 offset:4096
    v_mfma_f32_32x32x16_bf16 v[96:111], a[236:239], a[216:219], v[96:111]
    ds_read_b64_tr_b16 a[206:207], v154 offset:1024
    v_mfma_f32_32x32x16_bf16 v[16:31], a[224:227], a[220:223], v[16:31]
    ds_read_b64_tr_b16 a[208:209], v155 offset:0
    s_add_u32 m0, s56, 9216
    s_add_u32 s57, s55, 294912
    buffer_load_dwordx4 v159, s[68:71], s57 offen lds
    v_mfma_f32_32x32x16_bf16 v[48:63], a[228:231], a[220:223], v[48:63]
    ds_read_b64_tr_b16 a[210:211], v155 offset:1024
    ds_read_b64_tr_b16 a[212:213], v156 offset:0
    v_mfma_f32_32x32x16_bf16 v[80:95], a[232:235], a[220:223], v[80:95]
    ds_read_b64_tr_b16 a[214:215], v156 offset:1024
    s_add_u32 s55, s55, 524288
    s_xor_b32 s56, s56, 16384
    v_mfma_f32_32x32x16_bf16 v[112:127], a[236:239], a[220:223], v[112:127]
    s_add_u32 s52, s52, 128
    s_add_u32 s53, s53, 128
    s_add_u32 s54, s54, 32768
    s_cmp_ge_u32 s54, 131072
    s_cselect_b32 s58, 98304, 0
    s_sub_u32 s54, s54, s58
    s_waitcnt lgkmcnt(0)
    v_mfma_f32_32x32x16_bf16 v[0:15], a[200:203], a[192:195], v[0:15]
    s_add_u32 s60, s60, 32768
    s_mov_b32 s61, 32768
    s_cmp_eq_u32 s60, 131072
    s_cselect_b32 s61, -65536, s61
    s_cselect_b32 s60, 32768, s60
    s_add_u32 m0, s54, 0
    s_add_u32 s57, s52, 0
    buffer_load_dwordx4 v157, s[64:67], s57 offen lds
    ds_read_b64_tr_b16 a[224:225], v153 offset:4096
    v_mfma_f32_32x32x16_bf16 v[32:47], a[204:207], a[192:195], v[32:47]
    ds_read_b128 a[216:219], v150 offset:0
    ds_read_b64_tr_b16 a[226:227], v153 offset:5120
    v_mfma_f32_32x32x16_bf16 v[64:79], a[208:211], a[192:195], v[64:79]
    s_add_u32 m0, s54, 1024
    s_add_u32 s57, s52, 9216
    buffer_load_dwordx4 v158, s[64:67], s57 offen lds
    ds_read_b64_tr_b16 a[228:229], v154 offset:4096
    v_mfma_f32_32x32x16_bf16 v[96:111], a[212:215], a[192:195], v[96:111]
    ds_read_b128 a[220:223], v150 offset:4096
    ds_read_b64_tr_b16 a[230:231], v154 offset:5120
    s_add_u32 m0, s54, 2048
    s_add_u32 s57, s52, 18432
    buffer_load_dwordx4 v157, s[64:67], s57 offen lds
    v_mfma_f32_32x32x16_bf16 v[16:31], a[200:203], a[196:199], v[16:31]
    ds_read_b64_tr_b16 a[232:233], v155 offset:4096
    ds_read_b64_tr_b16 a[234:235], v155 offset:5120
    v_mfma_f32_32x32x16_bf16 v[48:63], a[204:207], a[196:199], v[48:63]
    ds_read_b64_tr_b16 a[236:237], v156 offset:4096
    s_add_u32 m0, s54, 3072
    s_add_u32 s57, s52, 27648
    buffer_load_dwordx4 v158, s[64:67], s57 offen lds
    v_mfma_f32_32x32x16_bf16 v[80:95], a[208:211], a[196:199], v[80:95]
    ds_read_b64_tr_b16 a[238:239], v156 offset:5120
    v_add_u32 v150, s61, v150
    v_mfma_f32_32x32x16_bf16 v[112:127], a[212:215], a[196:199], v[112:127]
    s_waitcnt vmcnt(16) lgkmcnt(0)
    s_barrier
    v_mfma_f32_32x32x16_bf16 v[0:15], a[224:227], a[216:219], v[0:15]
    ds_read_b64_tr_b16 a[200:201], v153 offset:8192
    ds_read_b128 a[192:195], v151 offset:0
    v_mfma_f32_32x32x16_bf16 v[32:47], a[228:231], a[216:219], v[32:47]
    s_add_u32 m0, s56, 0
    s_add_u32 s57, s55, 0
    buffer_load_dwordx4 v159, s[68:71], s57 offen lds
    ds_read_b64_tr_b16 a[202:203], v153 offset:9216
    v_mfma_f32_32x32x16_bf16 v[64:79], a[232:235], a[216:219], v[64:79]
    ds_read_b64_tr_b16 a[204:205], v154 offset:8192
    v_mfma_f32_32x32x16_bf16 v[96:111], a[236:239], a[216:219], v[96:111]
    ds_read_b128 a[196:199], v151 offset:4096
    ds_read_b64_tr_b16 a[206:207], v154 offset:9216
    v_mfma_f32_32x32x16_bf16 v[16:31], a[224:227], a[220:223], v[16:31]
    ds_read_b64_tr_b16 a[208:209], v155 offset:8192
    s_add_u32 m0, s56, 1024
    s_add_u32 s57, s55, 32768
    buffer_load_dwordx4 v159, s[68:71], s57 offen lds
    v_mfma_f32_32x32x16_bf16 v[48:63], a[228:231], a[220:223], v[48:63]
    ds_read_b64_tr_b16 a[210:211], v155 offset:9216
    v_mfma_f32_32x32x16_bf16 v[80:95], a[232:235], a[220:223], v[80:95]
    ds_read_b64_tr_b16 a[212:213], v156 offset:8192
    ds_read_b64_tr_b16 a[214:215], v156 offset:9216
    v_mfma_f32_32x32x16_bf16 v[112:127], a[236:239], a[220:223], v[112:127]
    v_add_u32 v151, s61, v151
    s_waitcnt lgkmcnt(0)
    v_mfma_f32_32x32x16_bf16 v[0:15], a[200:203], a[192:195], v[0:15]
    ds_read_b64_tr_b16 a[224:225], v153 offset:12288
    s_add_u32 m0, s54, 4096
    s_add_u32 s57, s53, 0
    buffer_load_dwordx4 v157, s[64:67], s57 offen lds
    ds_read_b128 a[216:219], v152 offset:0
    v_mfma_f32_32x32x16_bf16 v[32:47], a[204:207], a[192:195], v[32:47]
    ds_read_b64_tr_b16 a[226:227], v153 offset:13312
    ds_read_b64_tr_b16 a[228:229], v154 offset:12288
    s_add_u32 m0, s54, 5120
    s_add_u32 s57, s53, 9216
    buffer_load_dwordx4 v158, s[64:67], s57 offen lds
    v_mfma_f32_32x32x16_bf16 v[64:79], a[208:211], a[192:195], v[64:79]
    ds_read_b128 a[220:223], v152 offset:4096
    ds_read_b64_tr_b16 a[230:231], v154 offset:13312
    s_add_u32 m0, s54, 6144
    s_add_u32 s57, s53, 18432
    buffer_load_dwordx4 v157, s[64:67], s57 offen lds
    v_mfma_f32_32x32x16_bf16 v[96:111], a[212:215], a[192:195], v[96:111]
    ds_read_b64_tr_b16 a[232:233], v155 offset:12288
    ds_read_b64_tr_b16 a[234:235], v155 offset:13312
    ds_read_b64_tr_b16 a[236:237], v156 offset:12288
    v_mfma_f32_32x32x16_bf16 v[16:31], a[200:203], a[196:199], v[16:31]
    s_add_u32 m0, s54, 7168
    s_add_u32 s57, s53, 27648
    buffer_load_dwordx4 v158, s[64:67], s57 offen lds
    ds_read_b64_tr_b16 a[238:239], v156 offset:13312
    v_add_u32 v152, s61, v152
    v_mfma_f32_32x32x16_bf16 v[48:63], a[204:207], a[196:199], v[48:63]
    v_add_u32 v149, s61, v149
    v_xor_b32 v153, 16384, v153
    v_xor_b32 v154, 16384, v154
    v_mfma_f32_32x32x16_bf16 v[80:95], a[208:211], a[196:199], v[80:95]
    v_xor_b32 v155, 16384, v155
    v_xor_b32 v156, 16384, v156
    v_mfma_f32_32x32x16_bf16 v[112:127], a[212:215], a[196:199], v[112:127]
    s_waitcnt vmcnt(12) lgkmcnt(0)
    s_barrier
    v_mfma_f32_32x32x16_bf16 v[0:15], a[224:227], a[216:219], v[0:15]
    ds_read_b64_tr_b16 a[200:201], v153 offset:0
    ds_read_b128 a[192:195], v149 offset:0
    v_mfma_f32_32x32x16_bf16 v[32:47], a[228:231], a[216:219], v[32:47]
    s_add_u32 m0, s56, 8192
    s_add_u32 s57, s55, 262144
    buffer_load_dwordx4 v159, s[68:71], s57 offen lds
    ds_read_b64_tr_b16 a[202:203], v153 offset:1024
    v_mfma_f32_32x32x16_bf16 v[64:79], a[232:235], a[216:219], v[64:79]
    ds_read_b64_tr_b16 a[204:205], v154 offset:0
    ds_read_b128 a[196:199], v149 offset:4096
    v_mfma_f32_32x32x16_bf16 v[96:111], a[236:239], a[216:219], v[96:111]
    ds_read_b64_tr_b16 a[206:207], v154 offset:1024
    v_mfma_f32_32x32x16_bf16 v[16:31], a[224:227], a[220:223], v[16:31]
    ds_read_b64_tr_b16 a[208:209], v155 offset:0
    s_add_u32 m0, s56, 9216
    s_add_u32 s57, s55, 294912
    buffer_load_dwordx4 v159, s[68:71], s57 offen lds
    v_mfma_f32_32x32x16_bf16 v[48:63], a[228:231], a[220:223], v[48:63]
    ds_read_b64_tr_b16 a[210:211], v155 offset:1024
    ds_read_b64_tr_b16 a[212:213], v156 offset:0
    v_mfma_f32_32x32x16_bf16 v[80:95], a[232:235], a[220:223], v[80:95]
    ds_read_b64_tr_b16 a[214:215], v156 offset:1024
    s_add_u32 s55, s55, 524288
    s_xor_b32 s56, s56, 16384
    v_mfma_f32_32x32x16_bf16 v[112:127], a[236:239], a[220:223], v[112:127]
    s_add_u32 s52, s52, 128
    s_add_u32 s53, s53, 128
    s_add_u32 s54, s54, 32768
    s_cmp_ge_u32 s54, 131072
    s_cselect_b32 s58, 98304, 0
    s_sub_u32 s54, s54, s58
    s_waitcnt lgkmcnt(0)
    v_mfma_f32_32x32x16_bf16 v[0:15], a[200:203], a[192:195], v[0:15]
    s_add_u32 s60, s60, 32768
    s_mov_b32 s61, 32768
    s_cmp_eq_u32 s60, 131072
    s_cselect_b32 s61, -65536, s61
    s_cselect_b32 s60, 32768, s60
    s_add_u32 m0, s54, 0
    s_add_u32 s57, s52, 0
    buffer_load_dwordx4 v157, s[64:67], s57 offen lds
    ds_read_b64_tr_b16 a[224:225], v153 offset:4096
    v_mfma_f32_32x32x16_bf16 v[32:47], a[204:207], a[192:195], v[32:47]
    ds_read_b128 a[216:219], v150 offset:0
    ds_read_b64_tr_b16 a[226:227], v153 offset:5120
    v_mfma_f32_32x32x16_bf16 v[64:79], a[208:211], a[192:195], v[64:79]
    s_add_u32 m0, s54, 1024
    s_add_u32 s57, s52, 9216
    buffer_load_dwordx4 v158, s[64:67], s57 offen lds
    ds_read_b64_tr_b16 a[228:229], v154 offset:4096
    v_mfma_f32_32x32x16_bf16 v[96:111], a[212:215], a[192:195], v[96:111]
    ds_read_b128 a[220:223], v150 offset:4096
    ds_read_b64_tr_b16 a[230:231], v154 offset:5120
    s_add_u32 m0, s54, 2048
    s_add_u32 s57, s52, 18432
    buffer_load_dwordx4 v157, s[64:67], s57 offen lds
    v_mfma_f32_32x32x16_bf16 v[16:31], a[200:203], a[196:199], v[16:31]
    ds_read_b64_tr_b16 a[232:233], v155 offset:4096
    ds_read_b64_tr_b16 a[234:235], v155 offset:5120
    v_mfma_f32_32x32x16_bf16 v[48:63], a[204:207], a[196:199], v[48:63]
    ds_read_b64_tr_b16 a[236:237], v156 offset:4096
    s_add_u32 m0, s54, 3072
    s_add_u32 s57, s52, 27648
    buffer_load_dwordx4 v158, s[64:67], s57 offen lds
    v_mfma_f32_32x32x16_bf16 v[80:95], a[208:211], a[196:199], v[80:95]
    ds_read_b64_tr_b16 a[238:239], v156 offset:5120
    v_add_u32 v150, s61, v150
    v_mfma_f32_32x32x16_bf16 v[112:127], a[212:215], a[196:199], v[112:127]
    s_waitcnt vmcnt(16) lgkmcnt(0)
    s_barrier
    v_mfma_f32_32x32x16_bf16 v[0:15], a[224:227], a[216:219], v[0:15]
    ds_read_b64_tr_b16 a[200:201], v153 offset:8192
    ds_read_b128 a[192:195], v151 offset:0
    v_mfma_f32_32x32x16_bf16 v[32:47], a[228:231], a[216:219], v[32:47]
    s_add_u32 m0, s56, 0
    s_add_u32 s57, s55, 0
    buffer_load_dwordx4 v159, s[68:71], s57 offen lds
    ds_read_b64_tr_b16 a[202:203], v153 offset:9216
    v_mfma_f32_32x32x16_bf16 v[64:79], a[232:235], a[216:219], v[64:79]
    ds_read_b64_tr_b16 a[204:205], v154 offset:8192
    v_mfma_f32_32x32x16_bf16 v[96:111], a[236:239], a[216:219], v[96:111]
    ds_read_b128 a[196:199], v151 offset:4096
    ds_read_b64_tr_b16 a[206:207], v154 offset:9216
    v_mfma_f32_32x32x16_bf16 v[16:31], a[224:227], a[220:223], v[16:31]
    ds_read_b64_tr_b16 a[208:209], v155 offset:8192
    s_add_u32 m0, s56, 1024
    s_add_u32 s57, s55, 32768
    buffer_load_dwordx4 v159, s[68:71], s57 offen lds
    v_mfma_f32_32x32x16_bf16 v[48:63], a[228:231], a[220:223], v[48:63]
    ds_read_b64_tr_b16 a[210:211], v155 offset:9216
    v_mfma_f32_32x32x16_bf16 v[80:95], a[232:235], a[220:223], v[80:95]
    ds_read_b64_tr_b16 a[212:213], v156 offset:8192
    ds_read_b64_tr_b16 a[214:215], v156 offset:9216
    v_mfma_f32_32x32x16_bf16 v[112:127], a[236:239], a[220:223], v[112:127]
    v_add_u32 v151, s61, v151
    s_waitcnt lgkmcnt(0)
    v_mfma_f32_32x32x16_bf16 v[0:15], a[200:203], a[192:195], v[0:15]
    ds_read_b64_tr_b16 a[224:225], v153 offset:12288
    s_add_u32 m0, s54, 4096
    s_add_u32 s57, s53, 0
    buffer_load_dwordx4 v157, s[64:67], s57 offen lds
    ds_read_b128 a[216:219], v152 offset:0
    v_mfma_f32_32x32x16_bf16 v[32:47], a[204:207], a[192:195], v[32:47]
    ds_read_b64_tr_b16 a[226:227], v153 offset:13312
    ds_read_b64_tr_b16 a[228:229], v154 offset:12288
    s_add_u32 m0, s54, 5120
    s_add_u32 s57, s53, 9216
    buffer_load_dwordx4 v158, s[64:67], s57 offen lds
    v_mfma_f32_32x32x16_bf16 v[64:79], a[208:211], a[192:195], v[64:79]
    ds_read_b128 a[220:223], v152 offset:4096
    ds_read_b64_tr_b16 a[230:231], v154 offset:13312
    s_add_u32 m0, s54, 6144
    s_add_u32 s57, s53, 18432
    buffer_load_dwordx4 v157, s[64:67], s57 offen lds
    v_mfma_f32_32x32x16_bf16 v[96:111], a[212:215], a[192:195], v[96:111]
    ds_read_b64_tr_b16 a[232:233], v155 offset:12288
    ds_read_b64_tr_b16 a[234:235], v155 offset:13312
    ds_read_b64_tr_b16 a[236:237], v156 offset:12288
    v_mfma_f32_32x32x16_bf16 v[16:31], a[200:203], a[196:199], v[16:31]
    s_add_u32 m0, s54, 7168
    s_add_u32 s57, s53, 27648
    buffer_load_dwordx4 v158, s[64:67], s57 offen lds
    ds_read_b64_tr_b16 a[238:239], v156 offset:13312
    v_add_u32 v152, s61, v152
    v_mfma_f32_32x32x16_bf16 v[48:63], a[204:207], a[196:199], v[48:63]
    v_add_u32 v149, s61, v149
    v_xor_b32 v153, 16384, v153
    v_xor_b32 v154, 16384, v154
    v_mfma_f32_32x32x16_bf16 v[80:95], a[208:211], a[196:199], v[80:95]
    v_xor_b32 v155, 16384, v155
    v_xor_b32 v156, 16384, v156
    v_mfma_f32_32x32x16_bf16 v[112:127], a[212:215], a[196:199], v[112:127]
    s_waitcnt vmcnt(12) lgkmcnt(0)
    s_barrier
    v_mfma_f32_32x32x16_bf16 v[0:15], a[224:227], a[216:219], v[0:15]
    ds_read_b64_tr_b16 a[200:201], v153 offset:0
    ds_read_b128 a[192:195], v149 offset:0
    v_mfma_f32_32x32x16_bf16 v[32:47], a[228:231], a[216:219], v[32:47]
    s_add_u32 m0, s56, 8192
    s_add_u32 s57, s55, 262144
    buffer_load_dwordx4 v159, s[68:71], s57 offen lds
    ds_read_b64_tr_b16 a[202:203], v153 offset:1024
    v_mfma_f32_32x32x16_bf16 v[64:79], a[232:235], a[216:219], v[64:79]
    ds_read_b64_tr_b16 a[204:205], v154 offset:0
    ds_read_b128 a[196:199], v149 offset:4096
    v_mfma_f32_32x32x16_bf16 v[96:111], a[236:239], a[216:219], v[96:111]
    ds_read_b64_tr_b16 a[206:207], v154 offset:1024
    v_mfma_f32_32x32x16_bf16 v[16:31], a[224:227], a[220:223], v[16:31]
    ds_read_b64_tr_b16 a[208:209], v155 offset:0
    s_add_u32 m0, s56, 9216
    s_add_u32 s57, s55, 294912
    buffer_load_dwordx4 v159, s[68:71], s57 offen lds
    v_mfma_f32_32x32x16_bf16 v[48:63], a[228:231], a[220:223], v[48:63]
    ds_read_b64_tr_b16 a[210:211], v155 offset:1024
    ds_read_b64_tr_b16 a[212:213], v156 offset:0
    v_mfma_f32_32x32x16_bf16 v[80:95], a[232:235], a[220:223], v[80:95]
    ds_read_b64_tr_b16 a[214:215], v156 offset:1024
    s_add_u32 s55, s55, 524288
    s_xor_b32 s56, s56, 16384
    v_mfma_f32_32x32x16_bf16 v[112:127], a[236:239], a[220:223], v[112:127]
    s_add_u32 s52, s52, 128
    s_add_u32 s53, s53, 128
    s_add_u32 s54, s54, 32768
    s_cmp_ge_u32 s54, 131072
    s_cselect_b32 s58, 98304, 0
    s_sub_u32 s54, s54, s58
    s_waitcnt lgkmcnt(0)
    s_cmp_lg_u32 s3, 0
    s_cbranch_scc1 L_pold_4
    v_and_b32 v244, 7, v129
    v_lshlrev_b32 v244, 3, v244
    v_bfe_u32 v245, v129, 3, 1
    v_lshl_add_u32 v244, v245, 7, v244
    s_bfe_u32 s57, s2, 0x10004
    s_lshl_b32 s57, s57, 6
    s_and_b32 s58, s2, 7
    s_add_u32 s57, s57, s58
    v_add_u32 v244, s57, v244
    v_lshlrev_b32 v244, 7, v244
    v_accvgpr_read_b32 v245, a251
    s_mov_b32 s57, 92340224
    s_mov_b32 s58, 0
L_pol_3:
    buffer_load_dword v246, v244, s[8:11], s57 offen sc1
    s_waitcnt vmcnt(0)
    v_cmp_eq_u32 vcc, v246, v245
    s_nop 3
    s_cmp_eq_u64 vcc, 0
    s_cbranch_scc1 L_pold_4
    s_add_u32 s58, s58, 1
    s_cmp_ge_u32 s58, 2000
    s_cbranch_scc1 L_pold_4
    s_sleep 8
    s_branch L_pol_3
L_pold_4:
    s_barrier
    v_mfma_f32_32x32x16_bf16 v[0:15], a[200:203], a[192:195], v[0:15]
    s_add_u32 s60, s60, 32768
    s_mov_b32 s61, 32768
    s_cmp_eq_u32 s60, 131072
    s_cselect_b32 s61, -65536, s61
    s_cselect_b32 s60, 32768, s60
    ds_read_b64_tr_b16 a[224:225], v153 offset:4096
    v_mfma_f32_32x32x16_bf16 v[32:47], a[204:207], a[192:195], v[32:47]
    ds_read_b128 a[216:219], v150 offset:0
    ds_read_b64_tr_b16 a[226:227], v153 offset:5120
    v_mfma_f32_32x32x16_bf16 v[64:79], a[208:211], a[192:195], v[64:79]
    ds_read_b64_tr_b16 a[228:229], v154 offset:4096
    ds_read_b128 a[220:223], v150 offset:4096
    v_mfma_f32_32x32x16_bf16 v[96:111], a[212:215], a[192:195], v[96:111]
    ds_read_b64_tr_b16 a[230:231], v154 offset:5120
    v_mfma_f32_32x32x16_bf16 v[16:31], a[200:203], a[196:199], v[16:31]
    ds_read_b64_tr_b16 a[232:233], v155 offset:4096
    ds_read_b64_tr_b16 a[234:235], v155 offset:5120
    v_mfma_f32_32x32x16_bf16 v[48:63], a[204:207], a[196:199], v[48:63]
    ds_read_b64_tr_b16 a[236:237], v156 offset:4096
    ds_read_b64_tr_b16 a[238:239], v156 offset:5120
    v_mfma_f32_32x32x16_bf16 v[80:95], a[208:211], a[196:199], v[80:95]
    v_add_u32 v150, s61, v150
    v_mfma_f32_32x32x16_bf16 v[112:127], a[212:215], a[196:199], v[112:127]
    s_waitcnt vmcnt(12) lgkmcnt(0)
    s_barrier
    v_mfma_f32_32x32x16_bf16 v[0:15], a[224:227], a[216:219], v[0:15]
    ds_read_b64_tr_b16 a[200:201], v153 offset:8192
    s_add_u32 m0, s17, 0
    s_add_u32 s23, s16, 0
    buffer_load_dwordx4 v128, s[48:51], s23 offen lds
    v_mfma_f32_32x32x16_bf16 v[32:47], a[228:231], a[216:219], v[32:47]
    ds_read_b128 a[192:195], v151 offset:0
    ds_read_b64_tr_b16 a[202:203], v153 offset:9216
    v_mfma_f32_32x32x16_bf16 v[64:79], a[232:235], a[216:219], v[64:79]
    ds_read_b64_tr_b16 a[204:205], v154 offset:8192
    buffer_load_dwordx4 v128, s[48:51], s23 offen offset:1024 lds
    v_mfma_f32_32x32x16_bf16 v[96:111], a[236:239], a[216:219], v[96:111]
    ds_read_b128 a[196:199], v151 offset:4096
    ds_read_b64_tr_b16 a[206:207], v154 offset:9216
    v_mfma_f32_32x32x16_bf16 v[16:31], a[224:227], a[220:223], v[16:31]
    buffer_load_dwordx4 v128, s[48:51], s23 offen offset:2048 lds
    ds_read_b64_tr_b16 a[208:209], v155 offset:8192
    v_mfma_f32_32x32x16_bf16 v[48:63], a[228:231], a[220:223], v[48:63]
    ds_read_b64_tr_b16 a[210:211], v155 offset:9216
    ds_read_b64_tr_b16 a[212:213], v156 offset:8192
    v_mfma_f32_32x32x16_bf16 v[80:95], a[232:235], a[220:223], v[80:95]
    buffer_load_dwordx4 v128, s[48:51], s23 offen offset:3072 lds
    ds_read_b64_tr_b16 a[214:215], v156 offset:9216
    v_mfma_f32_32x32x16_bf16 v[112:127], a[236:239], a[220:223], v[112:127]
    v_add_u32 v151, s61, v151
    s_waitcnt lgkmcnt(0)
    v_mfma_f32_32x32x16_bf16 v[0:15], a[200:203], a[192:195], v[0:15]
    ds_read_b64_tr_b16 a[224:225], v153 offset:12288
    s_add_u32 m0, s17, 4096
    s_add_u32 s23, s16, 4096
    buffer_load_dwordx4 v128, s[48:51], s23 offen lds
    ds_read_b128 a[216:219], v152 offset:0
    v_mfma_f32_32x32x16_bf16 v[32:47], a[204:207], a[192:195], v[32:47]
    ds_read_b64_tr_b16 a[226:227], v153 offset:13312
    ds_read_b64_tr_b16 a[228:229], v154 offset:12288
    buffer_load_dwordx4 v128, s[48:51], s23 offen offset:1024 lds
    v_mfma_f32_32x32x16_bf16 v[64:79], a[208:211], a[192:195], v[64:79]
    ds_read_b128 a[220:223], v152 offset:4096
    ds_read_b64_tr_b16 a[230:231], v154 offset:13312
    buffer_load_dwordx4 v128, s[48:51], s23 offen offset:2048 lds
    v_mfma_f32_32x32x16_bf16 v[96:111], a[212:215], a[192:195], v[96:111]
    ds_read_b64_tr_b16 a[232:233], v155 offset:12288
    ds_read_b64_tr_b16 a[234:235], v155 offset:13312
    ds_read_b64_tr_b16 a[236:237], v156 offset:12288
    v_mfma_f32_32x32x16_bf16 v[16:31], a[200:203], a[196:199], v[16:31]
    buffer_load_dwordx4 v128, s[48:51], s23 offen offset:3072 lds
    ds_read_b64_tr_b16 a[238:239], v156 offset:13312
    v_add_u32 v152, s61, v152
    v_mfma_f32_32x32x16_bf16 v[48:63], a[204:207], a[196:199], v[48:63]
    v_add_u32 v149, s61, v149
    v_xor_b32 v153, 16384, v153
    v_xor_b32 v154, 16384, v154
    v_mfma_f32_32x32x16_bf16 v[80:95], a[208:211], a[196:199], v[80:95]
    v_xor_b32 v155, 16384, v155
    v_xor_b32 v156, 16384, v156
    v_mfma_f32_32x32x16_bf16 v[112:127], a[212:215], a[196:199], v[112:127]
    s_waitcnt vmcnt(10) lgkmcnt(0)
    s_barrier
    v_mfma_f32_32x32x16_bf16 v[0:15], a[224:227], a[216:219], v[0:15]
    ds_read_b64_tr_b16 a[200:201], v153 offset:0
    ds_read_b128 a[192:195], v149 offset:0
    v_mfma_f32_32x32x16_bf16 v[32:47], a[228:231], a[216:219], v[32:47]
    s_add_u32 s16, s16, 32768
    ds_read_b64_tr_b16 a[202:203], v153 offset:1024
    v_mfma_f32_32x32x16_bf16 v[64:79], a[232:235], a[216:219], v[64:79]
    ds_read_b64_tr_b16 a[204:205], v154 offset:0
    v_mfma_f32_32x32x16_bf16 v[96:111], a[236:239], a[216:219], v[96:111]
    ds_read_b128 a[196:199], v149 offset:4096
    s_mov_b32 s20, s17
    v_mfma_f32_32x32x16_bf16 v[16:31], a[224:227], a[220:223], v[16:31]
    ds_read_b64_tr_b16 a[206:207], v154 offset:1024
    ds_read_b64_tr_b16 a[208:209], v155 offset:0
    v_mfma_f32_32x32x16_bf16 v[48:63], a[228:231], a[220:223], v[48:63]
    ds_read_b64_tr_b16 a[210:211], v155 offset:1024
    v_mfma_f32_32x32x16_bf16 v[80:95], a[232:235], a[220:223], v[80:95]
    s_add_u32 s17, s17, 32768
    s_cmp_eq_u32 s17, s21
    s_cselect_b32 s17, s18, s17
    ds_read_b64_tr_b16 a[212:213], v156 offset:0
    v_mfma_f32_32x32x16_bf16 v[112:127], a[236:239], a[220:223], v[112:127]
    ds_read_b64_tr_b16 a[214:215], v156 offset:1024
    s_waitcnt lgkmcnt(0)
    v_mfma_f32_32x32x16_bf16 v[0:15], a[200:203], a[192:195], v[0:15]
    s_add_u32 s60, s60, 32768
    s_mov_b32 s61, 32768
    s_cmp_eq_u32 s60, 131072
    s_cselect_b32 s61, -65536, s61
    s_cselect_b32 s60, 32768, s60
    ds_read_b64_tr_b16 a[224:225], v153 offset:4096
    v_mfma_f32_32x32x16_bf16 v[32:47], a[204:207], a[192:195], v[32:47]
    ds_read_b128 a[216:219], v150 offset:0
    ds_read_b64_tr_b16 a[226:227], v153 offset:5120
    v_mfma_f32_32x32x16_bf16 v[64:79], a[208:211], a[192:195], v[64:79]
    ds_read_b64_tr_b16 a[228:229], v154 offset:4096
    ds_read_b128 a[220:223], v150 offset:4096
    v_mfma_f32_32x32x16_bf16 v[96:111], a[212:215], a[192:195], v[96:111]
    ds_read_b64_tr_b16 a[230:231], v154 offset:5120
    v_mfma_f32_32x32x16_bf16 v[16:31], a[200:203], a[196:199], v[16:31]
    ds_read_b64_tr_b16 a[232:233], v155 offset:4096
    ds_read_b64_tr_b16 a[234:235], v155 offset:5120
    v_mfma_f32_32x32x16_bf16 v[48:63], a[204:207], a[196:199], v[48:63]
    ds_read_b64_tr_b16 a[236:237], v156 offset:4096
    ds_read_b64_tr_b16 a[238:239], v156 offset:5120
    v_mfma_f32_32x32x16_bf16 v[80:95], a[208:211], a[196:199], v[80:95]
    v_add_u32 v150, s61, v150
    v_mfma_f32_32x32x16_bf16 v[112:127], a[212:215], a[196:199], v[112:127]
    s_waitcnt vmcnt(8) lgkmcnt(0)
    s_barrier
    v_mfma_f32_32x32x16_bf16 v[0:15], a[224:227], a[216:219], v[0:15]
    ds_read_b64_tr_b16 a[200:201], v153 offset:8192
    ds_read_b128 a[192:195], v151 offset:0
    v_mfma_f32_32x32x16_bf16 v[32:47], a[228:231], a[216:219], v[32:47]
    ds_read_b64_tr_b16 a[202:203], v153 offset:9216
    v_mfma_f32_32x32x16_bf16 v[64:79], a[232:235], a[216:219], v[64:79]
    ds_read_b64_tr_b16 a[204:205], v154 offset:8192
    ds_read_b128 a[196:199], v151 offset:4096
    v_mfma_f32_32x32x16_bf16 v[96:111], a[236:239], a[216:219], v[96:111]
    ds_read_b64_tr_b16 a[206:207], v154 offset:9216
    v_mfma_f32_32x32x16_bf16 v[16:31], a[224:227], a[220:223], v[16:31]
    ds_read_b64_tr_b16 a[208:209], v155 offset:8192
    v_mfma_f32_32x32x16_bf16 v[48:63], a[228:231], a[220:223], v[48:63]
    ds_read_b64_tr_b16 a[210:211], v155 offset:9216
    ds_read_b64_tr_b16 a[212:213], v156 offset:8192
    v_mfma_f32_32x32x16_bf16 v[80:95], a[232:235], a[220:223], v[80:95]
    ds_read_b64_tr_b16 a[214:215], v156 offset:9216
    v_mfma_f32_32x32x16_bf16 v[112:127], a[236:239], a[220:223], v[112:127]
    v_add_u32 v151, s61, v151
    s_waitcnt lgkmcnt(0)
    v_mfma_f32_32x32x16_bf16 v[0:15], a[200:203], a[192:195], v[0:15]
    ds_read_b64_tr_b16 a[224:225], v153 offset:12288
    ds_read_b128 a[216:219], v152 offset:0
    ds_read_b64_tr_b16 a[226:227], v153 offset:13312
    v_mfma_f32_32x32x16_bf16 v[32:47], a[204:207], a[192:195], v[32:47]
    ds_read_b64_tr_b16 a[228:229], v154 offset:12288
    ds_read_b128 a[220:223], v152 offset:4096
    v_mfma_f32_32x32x16_bf16 v[64:79], a[208:211], a[192:195], v[64:79]
    ds_read_b64_tr_b16 a[230:231], v154 offset:13312
    ds_read_b64_tr_b16 a[232:233], v155 offset:12288
    v_mfma_f32_32x32x16_bf16 v[96:111], a[212:215], a[192:195], v[96:111]
    ds_read_b64_tr_b16 a[234:235], v155 offset:13312
    ds_read_b64_tr_b16 a[236:237], v156 offset:12288
    ds_read_b64_tr_b16 a[238:239], v156 offset:13312
    v_mfma_f32_32x32x16_bf16 v[16:31], a[200:203], a[196:199], v[16:31]
    v_add_u32 v152, s61, v152
    v_add_u32 v149, s61, v149
    v_mfma_f32_32x32x16_bf16 v[48:63], a[204:207], a[196:199], v[48:63]
    v_xor_b32 v153, 16384, v153
    v_xor_b32 v154, 16384, v154
    v_mfma_f32_32x32x16_bf16 v[80:95], a[208:211], a[196:199], v[80:95]
    v_xor_b32 v155, 16384, v155
    v_xor_b32 v156, 16384, v156
    v_mfma_f32_32x32x16_bf16 v[112:127], a[212:215], a[196:199], v[112:127]
    s_waitcnt lgkmcnt(0)
    s_barrier
    v_mfma_f32_32x32x16_bf16 v[0:15], a[224:227], a[216:219], v[0:15]
    s_add_u32 m0, s17, 0
    s_add_u32 s23, s16, 0
    buffer_load_dwordx4 v128, s[48:51], s23 offen lds
    buffer_load_dwordx4 v128, s[48:51], s23 offen offset:1024 lds
    buffer_load_dwordx4 v128, s[48:51], s23 offen offset:2048 lds
    v_mfma_f32_32x32x16_bf16 v[32:47], a[228:231], a[216:219], v[32:47]
    buffer_load_dwordx4 v128, s[48:51], s23 offen offset:3072 lds
    s_add_u32 m0, s17, 4096
    s_add_u32 s23, s16, 4096
    buffer_load_dwordx4 v128, s[48:51], s23 offen lds
    buffer_load_dwordx4 v128, s[48:51], s23 offen offset:1024 lds
    v_mfma_f32_32x32x16_bf16 v[64:79], a[232:235], a[216:219], v[64:79]
    buffer_load_dwordx4 v128, s[48:51], s23 offen offset:2048 lds
    buffer_load_dwordx4 v128, s[48:51], s23 offen offset:3072 lds
    s_add_u32 s16, s16, 32768
    v_mfma_f32_32x32x16_bf16 v[96:111], a[236:239], a[216:219], v[96:111]
    s_mov_b32 s20, s17
    s_add_u32 s17, s17, 32768
    s_cmp_eq_u32 s17, s21
    s_cselect_b32 s17, s18, s17
    v_mfma_f32_32x32x16_bf16 v[16:31], a[224:227], a[220:223], v[16:31]
    s_add_u32 m0, s17, 0
    s_add_u32 s23, s16, 0
    buffer_load_dwordx4 v128, s[48:51], s23 offen lds
    buffer_load_dwordx4 v128, s[48:51], s23 offen offset:1024 lds
    buffer_load_dwordx4 v128, s[48:51], s23 offen offset:2048 lds
    v_mfma_f32_32x32x16_bf16 v[48:63], a[228:231], a[220:223], v[48:63]
    buffer_load_dwordx4 v128, s[48:51], s23 offen offset:3072 lds
    s_add_u32 m0, s17, 4096
    s_add_u32 s23, s16, 4096
    buffer_load_dwordx4 v128, s[48:51], s23 offen lds
    buffer_load_dwordx4 v128, s[48:51], s23 offen offset:1024 lds
    v_mfma_f32_32x32x16_bf16 v[80:95], a[232:235], a[220:223], v[80:95]
    buffer_load_dwordx4 v128, s[48:51], s23 offen offset:2048 lds
    buffer_load_dwordx4 v128, s[48:51], s23 offen offset:3072 lds
    s_add_u32 s16, s16, 32768
    v_mfma_f32_32x32x16_bf16 v[112:127], a[236:239], a[220:223], v[112:127]
    s_mov_b32 s20, s17
    s_add_u32 s17, s17, 32768
    s_cmp_eq_u32 s17, s21
    s_cselect_b32 s17, s18, s17
    s_lshl_b32 s23, s2, 2
    s_add_u32 s23, s23, s3
    s_lshl_b32 s23, s23, 10
    s_mov_b32 s64, s78
    s_mov_b32 s65, s79
    s_mov_b32 s66, 0xa2000
    s_mov_b32 s67, 0x00020000
    buffer_load_dwordx4 v[252:255], v128, s[64:67], s23 offen
    s_mov_b32 s68, s80
    s_mov_b32 s69, s81
    s_mov_b32 s70, 0x480000
    s_mov_b32 s71, 0x00020000
    buffer_load_dwordx4 v[252:255], v128, s[68:71], s23 offen
    s_add_u32 s23, s23, 1048576
    buffer_load_dwordx4 v[252:255], v128, s[68:71], s23 offen
    s_add_u32 s23, s23, 1048576
    buffer_load_dwordx4 v[252:255], v128, s[68:71], s23 offen
    s_add_u32 s23, s23, 1048576
    buffer_load_dwordx4 v[252:255], v128, s[68:71], s23 offen
    s_add_u32 s23, s23, 1048576
    buffer_load_dwordx4 v[252:255], v128, s[68:71], s23 offen
    v_mov_b32 v224, 0x3e0293ee
    v_mov_b32 v225, 0x3e0293ee
    s_nop 7
    s_nop 7
    v_pk_mul_f32 v[0:1], v[0:1], v[224:225]
    v_pk_mul_f32 v[2:3], v[2:3], v[224:225]
    v_pk_mul_f32 v[4:5], v[4:5], v[224:225]
    v_pk_mul_f32 v[6:7], v[6:7], v[224:225]
    v_pk_mul_f32 v[8:9], v[8:9], v[224:225]
    v_pk_mul_f32 v[10:11], v[10:11], v[224:225]
    v_pk_mul_f32 v[12:13], v[12:13], v[224:225]
    v_pk_mul_f32 v[14:15], v[14:15], v[224:225]
    v_cvt_pk_bf16_f32 v160, v0, v1
    v_cvt_pk_bf16_f32 v161, v2, v3
    v_cvt_pk_bf16_f32 v162, v4, v5
    v_cvt_pk_bf16_f32 v163, v6, v7
    v_cvt_pk_bf16_f32 v164, v8, v9
    v_cvt_pk_bf16_f32 v165, v10, v11
    v_cvt_pk_bf16_f32 v166, v12, v13
    v_cvt_pk_bf16_f32 v167, v14, v15
    v_pk_mul_f32 v[16:17], v[16:17], v[224:225]
    v_pk_mul_f32 v[18:19], v[18:19], v[224:225]
    v_pk_mul_f32 v[20:21], v[20:21], v[224:225]
    v_pk_mul_f32 v[22:23], v[22:23], v[224:225]
    v_pk_mul_f32 v[24:25], v[24:25], v[224:225]
    v_pk_mul_f32 v[26:27], v[26:27], v[224:225]
    v_pk_mul_f32 v[28:29], v[28:29], v[224:225]
    v_pk_mul_f32 v[30:31], v[30:31], v[224:225]
    v_cvt_pk_bf16_f32 v192, v16, v17
    v_cvt_pk_bf16_f32 v193, v18, v19
    v_cvt_pk_bf16_f32 v194, v20, v21
    v_cvt_pk_bf16_f32 v195, v22, v23
    v_cvt_pk_bf16_f32 v196, v24, v25
    v_cvt_pk_bf16_f32 v197, v26, v27
    v_cvt_pk_bf16_f32 v198, v28, v29
    v_cvt_pk_bf16_f32 v199, v30, v31
    v_pk_mul_f32 v[32:33], v[32:33], v[224:225]
    v_pk_mul_f32 v[34:35], v[34:35], v[224:225]
    v_pk_mul_f32 v[36:37], v[36:37], v[224:225]
    v_pk_mul_f32 v[38:39], v[38:39], v[224:225]
    v_pk_mul_f32 v[40:41], v[40:41], v[224:225]
    v_pk_mul_f32 v[42:43], v[42:43], v[224:225]
    v_pk_mul_f32 v[44:45], v[44:45], v[224:225]
    v_pk_mul_f32 v[46:47], v[46:47], v[224:225]
    v_cvt_pk_bf16_f32 v168, v32, v33
    v_cvt_pk_bf16_f32 v169, v34, v35
    v_cvt_pk_bf16_f32 v170, v36, v37
    v_cvt_pk_bf16_f32 v171, v38, v39
    v_cvt_pk_bf16_f32 v172, v40, v41
    v_cvt_pk_bf16_f32 v173, v42, v43
    v_cvt_pk_bf16_f32 v174, v44, v45
    v_cvt_pk_bf16_f32 v175, v46, v47
    v_pk_mul_f32 v[48:49], v[48:49], v[224:225]
    v_pk_mul_f32 v[50:51], v[50:51], v[224:225]
    v_pk_mul_f32 v[52:53], v[52:53], v[224:225]
    v_pk_mul_f32 v[54:55], v[54:55], v[224:225]
    v_pk_mul_f32 v[56:57], v[56:57], v[224:225]
    v_pk_mul_f32 v[58:59], v[58:59], v[224:225]
    v_pk_mul_f32 v[60:61], v[60:61], v[224:225]
    v_pk_mul_f32 v[62:63], v[62:63], v[224:225]
    v_cvt_pk_bf16_f32 v200, v48, v49
    v_cvt_pk_bf16_f32 v201, v50, v51
    v_cvt_pk_bf16_f32 v202, v52, v53
    v_cvt_pk_bf16_f32 v203, v54, v55
    v_cvt_pk_bf16_f32 v204, v56, v57
    v_cvt_pk_bf16_f32 v205, v58, v59
    v_cvt_pk_bf16_f32 v206, v60, v61
    v_cvt_pk_bf16_f32 v207, v62, v63
    v_pk_mul_f32 v[64:65], v[64:65], v[224:225]
    v_pk_mul_f32 v[66:67], v[66:67], v[224:225]
    v_pk_mul_f32 v[68:69], v[68:69], v[224:225]
    v_pk_mul_f32 v[70:71], v[70:71], v[224:225]
    v_pk_mul_f32 v[72:73], v[72:73], v[224:225]
    v_pk_mul_f32 v[74:75], v[74:75], v[224:225]
    v_pk_mul_f32 v[76:77], v[76:77], v[224:225]
    v_pk_mul_f32 v[78:79], v[78:79], v[224:225]
    v_cvt_pk_bf16_f32 v176, v64, v65
    v_cvt_pk_bf16_f32 v177, v66, v67
    v_cvt_pk_bf16_f32 v178, v68, v69
    v_cvt_pk_bf16_f32 v179, v70, v71
    v_cvt_pk_bf16_f32 v180, v72, v73
    v_cvt_pk_bf16_f32 v181, v74, v75
    v_cvt_pk_bf16_f32 v182, v76, v77
    v_cvt_pk_bf16_f32 v183, v78, v79
    v_pk_mul_f32 v[80:81], v[80:81], v[224:225]
    v_pk_mul_f32 v[82:83], v[82:83], v[224:225]
    v_pk_mul_f32 v[84:85], v[84:85], v[224:225]
    v_pk_mul_f32 v[86:87], v[86:87], v[224:225]
    v_pk_mul_f32 v[88:89], v[88:89], v[224:225]
    v_pk_mul_f32 v[90:91], v[90:91], v[224:225]
    v_pk_mul_f32 v[92:93], v[92:93], v[224:225]
    v_pk_mul_f32 v[94:95], v[94:95], v[224:225]
    v_cvt_pk_bf16_f32 v208, v80, v81
    v_cvt_pk_bf16_f32 v209, v82, v83
    v_cvt_pk_bf16_f32 v210, v84, v85
    v_cvt_pk_bf16_f32 v211, v86, v87
    v_cvt_pk_bf16_f32 v212, v88, v89
    v_cvt_pk_bf16_f32 v213, v90, v91
    v_cvt_pk_bf16_f32 v214, v92, v93
    v_cvt_pk_bf16_f32 v215, v94, v95
    v_pk_mul_f32 v[96:97], v[96:97], v[224:225]
    v_pk_mul_f32 v[98:99], v[98:99], v[224:225]
    v_pk_mul_f32 v[100:101], v[100:101], v[224:225]
    v_pk_mul_f32 v[102:103], v[102:103], v[224:225]
    v_pk_mul_f32 v[104:105], v[104:105], v[224:225]
    v_pk_mul_f32 v[106:107], v[106:107], v[224:225]
    v_pk_mul_f32 v[108:109], v[108:109], v[224:225]
    v_pk_mul_f32 v[110:111], v[110:111], v[224:225]
    v_cvt_pk_bf16_f32 v184, v96, v97
    v_cvt_pk_bf16_f32 v185, v98, v99
    v_cvt_pk_bf16_f32 v186, v100, v101
    v_cvt_pk_bf16_f32 v187, v102, v103
    v_cvt_pk_bf16_f32 v188, v104, v105
    v_cvt_pk_bf16_f32 v189, v106, v107
    v_cvt_pk_bf16_f32 v190, v108, v109
    v_cvt_pk_bf16_f32 v191, v110, v111
    v_pk_mul_f32 v[112:113], v[112:113], v[224:225]
    v_pk_mul_f32 v[114:115], v[114:115], v[224:225]
    v_pk_mul_f32 v[116:117], v[116:117], v[224:225]
    v_pk_mul_f32 v[118:119], v[118:119], v[224:225]
    v_pk_mul_f32 v[120:121], v[120:121], v[224:225]
    v_pk_mul_f32 v[122:123], v[122:123], v[224:225]
    v_pk_mul_f32 v[124:125], v[124:125], v[224:225]
    v_pk_mul_f32 v[126:127], v[126:127], v[224:225]
    v_cvt_pk_bf16_f32 v216, v112, v113
    v_cvt_pk_bf16_f32 v217, v114, v115
    v_cvt_pk_bf16_f32 v218, v116, v117
    v_cvt_pk_bf16_f32 v219, v118, v119
    v_cvt_pk_bf16_f32 v220, v120, v121
    v_cvt_pk_bf16_f32 v221, v122, v123
    v_cvt_pk_bf16_f32 v222, v124, v125
    v_cvt_pk_bf16_f32 v223, v126, v127
    v_lshlrev_b32 v224, 3, v131
    v_sub_u32 v224, v130, v224
    v_cmp_gt_i32 s[28:29], 0, v224
    v_cmp_gt_i32 s[30:31], 1, v224
    v_cmp_gt_i32 s[32:33], 2, v224
    v_cmp_gt_i32 s[34:35], 3, v224
    v_cmp_gt_i32 s[36:37], 4, v224
    v_cmp_gt_i32 s[38:39], 5, v224
    v_cmp_gt_i32 s[40:41], 6, v224
    v_cmp_gt_i32 s[42:43], 7, v224
    v_cmp_gt_i32 s[52:53], 16, v224
    v_cmp_gt_i32 s[54:55], 17, v224
    v_cmp_gt_i32 s[56:57], 18, v224
    v_cmp_gt_i32 s[58:59], 19, v224
    v_cmp_gt_i32 s[60:61], 20, v224
    v_cmp_gt_i32 s[62:63], 21, v224
    v_cmp_gt_i32 s[64:65], 22, v224
    v_cmp_gt_i32 s[66:67], 23, v224
    s_mov_b32 s27, 0
    v_mov_b32 v96, 0
    v_mov_b32 v97, 0
    v_mov_b32 v98, 0
    v_mov_b32 v99, 0
    v_mov_b32 v100, 0
    v_mov_b32 v101, 0
    v_mov_b32 v102, 0
    v_mov_b32 v103, 0
    v_mov_b32 v104, 0
    v_mov_b32 v105, 0
    v_mov_b32 v106, 0
    v_mov_b32 v107, 0
    v_mov_b32 v108, 0
    v_mov_b32 v109, 0
    v_mov_b32 v110, 0
    v_mov_b32 v111, 0
    v_mov_b32 v112, 0
    v_mov_b32 v113, 0
    v_mov_b32 v114, 0
    v_mov_b32 v115, 0
    v_mov_b32 v148, 0xff800000
    v_and_b32 v224, 7, v129
    v_bfe_u32 v225, v129, 4, 1
    v_lshlrev_b32 v225, 2, v225
    v_cmp_eq_u32 vcc, v224, v225
    v_mov_b32 v226, 0x3f803f80
    s_nop 0
    v_cndmask_b32 v144, 0, v226, vcc
    v_mov_b32 v145, v144
    v_mov_b32 v146, v144
    v_mov_b32 v147, v144
    v_mov_b32 v140, 0
    v_mov_b32 v141, 0
    v_mov_b32 v142, 0
    v_mov_b32 v143, 0
    s_lshl_b32 s23, s14, 5
    v_lshlrev_b32 v224, 3, v131
    v_sub_u32 v224, v130, v224
    v_add_u32 v136, s23, v224
    s_lshl_b32 s23, s15, 5
    v_lshlrev_b32 v224, 3, v131
    v_sub_u32 v224, v130, v224
    v_add_u32 v137, s23, v224
    v_add_u32 v132, 131072, v128
    v_add_u32 v133, 131072, v128
    v_mov_b32 v134, v128
    s_mov_b32 s25, 0
    s_waitcnt vmcnt(22)
    s_barrier
    ds_read_b128 a[192:195], v133 offset:0
    ds_read_b128 a[196:199], v133 offset:1024
    ds_read_b128 a[200:203], v133 offset:2048
    ds_read_b128 a[204:207], v133 offset:3072
    ds_read_b128 a[208:211], v133 offset:4096
    ds_read_b128 a[212:215], v133 offset:5120
    ds_read_b128 a[216:219], v133 offset:6144
    ds_read_b128 a[220:223], v133 offset:7168
    s_waitcnt lgkmcnt(0)
    v_mfma_f32_32x32x16_bf16 v[0:15], a[192:195], v[160:163], 0
    v_mfma_f32_32x32x16_bf16 v[16:31], a[192:195], v[192:195], 0
    v_mfma_f32_32x32x16_bf16 v[0:15], a[196:199], v[164:167], v[0:15]
    v_mfma_f32_32x32x16_bf16 v[16:31], a[196:199], v[196:199], v[16:31]
    v_mfma_f32_32x32x16_bf16 v[0:15], a[200:203], v[168:171], v[0:15]
    v_mfma_f32_32x32x16_bf16 v[16:31], a[200:203], v[200:203], v[16:31]
    v_mfma_f32_32x32x16_bf16 v[0:15], a[204:207], v[172:175], v[0:15]
    v_mfma_f32_32x32x16_bf16 v[16:31], a[204:207], v[204:207], v[16:31]
    v_mfma_f32_32x32x16_bf16 v[0:15], a[208:211], v[176:179], v[0:15]
    v_mfma_f32_32x32x16_bf16 v[16:31], a[208:211], v[208:211], v[16:31]
    v_mfma_f32_32x32x16_bf16 v[0:15], a[212:215], v[180:183], v[0:15]
    v_mfma_f32_32x32x16_bf16 v[16:31], a[212:215], v[212:215], v[16:31]
    v_mfma_f32_32x32x16_bf16 v[0:15], a[216:219], v[184:187], v[0:15]
    v_mfma_f32_32x32x16_bf16 v[16:31], a[216:219], v[216:219], v[16:31]
    v_mfma_f32_32x32x16_bf16 v[0:15], a[220:223], v[188:191], v[0:15]
    v_mfma_f32_32x32x16_bf16 v[16:31], a[220:223], v[220:223], v[16:31]
    s_nop 7
    s_nop 7
    s_add_u32 s24, s25, 0
    s_cmp_lt_u32 s24, s14
    s_cbranch_scc1 L_mskip_5
    s_cmp_gt_u32 s24, s14
    s_cbranch_scc1 L_mall_6
    v_cndmask_b32 v0, v0, v148, s[28:29]
    v_cndmask_b32 v1, v1, v148, s[30:31]
    v_cndmask_b32 v2, v2, v148, s[32:33]
    v_cndmask_b32 v3, v3, v148, s[34:35]
    v_cndmask_b32 v4, v4, v148, s[36:37]
    v_cndmask_b32 v5, v5, v148, s[38:39]
    v_cndmask_b32 v6, v6, v148, s[40:41]
    v_cndmask_b32 v7, v7, v148, s[42:43]
    v_cndmask_b32 v8, v8, v148, s[52:53]
    v_cndmask_b32 v9, v9, v148, s[54:55]
    v_cndmask_b32 v10, v10, v148, s[56:57]
    v_cndmask_b32 v11, v11, v148, s[58:59]
    v_cndmask_b32 v12, v12, v148, s[60:61]
    v_cndmask_b32 v13, v13, v148, s[62:63]
    v_cndmask_b32 v14, v14, v148, s[64:65]
    v_cndmask_b32 v15, v15, v148, s[66:67]
    s_branch L_mskip_5
L_mall_6:
    v_mov_b32 v0, v148
    v_mov_b32 v1, v148
    v_mov_b32 v2, v148
    v_mov_b32 v3, v148
    v_mov_b32 v4, v148
    v_mov_b32 v5, v148
    v_mov_b32 v6, v148
    v_mov_b32 v7, v148
    v_mov_b32 v8, v148
    v_mov_b32 v9, v148
    v_mov_b32 v10, v148
    v_mov_b32 v11, v148
    v_mov_b32 v12, v148
    v_mov_b32 v13, v148
    v_mov_b32 v14, v148
    v_mov_b32 v15, v148
L_mskip_5:
    v_max3_f32 v224, v0, v1, v2
    v_max3_f32 v224, v224, v3, v4
    v_max3_f32 v224, v224, v5, v6
    v_max3_f32 v224, v224, v7, v8
    v_max3_f32 v224, v224, v9, v10
    v_max3_f32 v224, v224, v11, v12
    v_max3_f32 v224, v224, v13, v14
    v_max_f32 v224, v224, v15
    v_mov_b32 v225, v224
    s_nop 1
    v_permlane32_swap_b32 v224, v225
    s_nop 1
    v_max_f32 v224, v224, v225
    v_add_f32 v224, 0x42c00000, v224
    v_sub_f32 v224, 0, v224
    v_mov_b32 v225, v224
    v_pk_add_f32 v[0:1], v[0:1], v[224:225]
    v_pk_add_f32 v[2:3], v[2:3], v[224:225]
    v_pk_add_f32 v[4:5], v[4:5], v[224:225]
    v_pk_add_f32 v[6:7], v[6:7], v[224:225]
    v_pk_add_f32 v[8:9], v[8:9], v[224:225]
    v_pk_add_f32 v[10:11], v[10:11], v[224:225]
    v_pk_add_f32 v[12:13], v[12:13], v[224:225]
    v_pk_add_f32 v[14:15], v[14:15], v[224:225]
    v_mov_b32 v64, v224
    v_mov_b32 v65, v224
    v_mov_b32 v66, v224
    v_mov_b32 v67, v224
    v_mov_b32 v68, v224
    v_mov_b32 v69, v224
    v_mov_b32 v70, v224
    v_mov_b32 v71, v224
    v_mov_b32 v72, v224
    v_mov_b32 v73, v224
    v_mov_b32 v74, v224
    v_mov_b32 v75, v224
    v_mov_b32 v76, v224
    v_mov_b32 v77, v224
    v_mov_b32 v78, v224
    v_mov_b32 v79, v224
    v_max3_f32 v226, v16, v17, v18
    v_max3_f32 v226, v226, v19, v20
    v_max3_f32 v226, v226, v21, v22
    v_max3_f32 v226, v226, v23, v24
    v_max3_f32 v226, v226, v25, v26
    v_max3_f32 v226, v226, v27, v28
    v_max3_f32 v226, v226, v29, v30
    v_max_f32 v226, v226, v31
    v_mov_b32 v227, v226
    s_nop 1
    v_permlane32_swap_b32 v226, v227
    s_nop 1
    v_max_f32 v226, v226, v227
    v_add_f32 v226, 0x42c00000, v226
    v_sub_f32 v226, 0, v226
    v_mov_b32 v227, v226
    v_pk_add_f32 v[16:17], v[16:17], v[226:227]
    v_pk_add_f32 v[18:19], v[18:19], v[226:227]
    v_pk_add_f32 v[20:21], v[20:21], v[226:227]
    v_pk_add_f32 v[22:23], v[22:23], v[226:227]
    v_pk_add_f32 v[24:25], v[24:25], v[226:227]
    v_pk_add_f32 v[26:27], v[26:27], v[226:227]
    v_pk_add_f32 v[28:29], v[28:29], v[226:227]
    v_pk_add_f32 v[30:31], v[30:31], v[226:227]
    v_mov_b32 v80, v226
    v_mov_b32 v81, v226
    v_mov_b32 v82, v226
    v_mov_b32 v83, v226
    v_mov_b32 v84, v226
    v_mov_b32 v85, v226
    v_mov_b32 v86, v226
    v_mov_b32 v87, v226
    v_mov_b32 v88, v226
    v_mov_b32 v89, v226
    v_mov_b32 v90, v226
    v_mov_b32 v91, v226
    v_mov_b32 v92, v226
    v_mov_b32 v93, v226
    v_mov_b32 v94, v226
    v_mov_b32 v95, v226
    ds_read_b128 a[192:195], v133 offset:16384
    ds_read_b128 a[196:199], v133 offset:17408
    ds_read_b128 a[200:203], v133 offset:18432
    ds_read_b128 a[204:207], v133 offset:19456
    ds_read_b128 a[208:211], v133 offset:20480
    ds_read_b128 a[212:215], v133 offset:21504
    ds_read_b128 a[216:219], v133 offset:22528
    ds_read_b128 a[220:223], v133 offset:23552
L_A_main:
    s_lshl_b32 s22, s13, 1
    s_cmp_eq_u32 s22, 0
    s_cbranch_scc1 L_Aend_8
.p2align 6
L_A_7:
    s_waitcnt lgkmcnt(6)
    v_mfma_f32_32x32x16_bf16 v[32:47], a[192:195], v[160:163], v[64:79]
    ds_read_b128 a[224:227], v132 offset:28672
    v_exp_f32 v0, v0
    v_exp_f32 v1, v1
    v_mfma_f32_32x32x16_bf16 v[48:63], a[192:195], v[192:195], v[80:95]
    s_waitcnt vmcnt(8)
    s_barrier
    v_mfma_f32_32x32x16_bf16 v[32:47], a[196:199], v[164:167], v[32:47]
    ds_read_b128 a[228:231], v132 offset:29696
    v_exp_f32 v2, v2
    v_add_f32 v112, v112, v0
    v_exp_f32 v3, v3
    v_mfma_f32_32x32x16_bf16 v[48:63], a[196:199], v[196:199], v[48:63]
    s_waitcnt lgkmcnt(6)
    v_add_f32 v112, v112, v1
    v_cvt_pk_bf16_f32 v96, v0, v1
    v_exp_f32 v4, v4
    v_add_f32 v112, v112, v2
    v_mfma_f32_32x32x16_bf16 v[32:47], a[200:203], v[168:171], v[32:47]
    ds_read_b128 a[232:235], v132 offset:30720
    v_exp_f32 v5, v5
    v_add_f32 v112, v112, v3
    v_cvt_pk_bf16_f32 v97, v2, v3
    v_mfma_f32_32x32x16_bf16 v[48:63], a[200:203], v[200:203], v[48:63]
    v_exp_f32 v6, v6
    v_add_f32 v112, v112, v4
    v_exp_f32 v7, v7
    v_add_f32 v112, v112, v5
    v_mfma_f32_32x32x16_bf16 v[32:47], a[204:207], v[172:175], v[32:47]
    ds_read_b128 a[236:239], v132 offset:31744
    v_cvt_pk_bf16_f32 v98, v4, v5
    v_exp_f32 v16, v16
    v_add_f32 v112, v112, v6
    v_mfma_f32_32x32x16_bf16 v[48:63], a[204:207], v[204:207], v[48:63]
    s_waitcnt lgkmcnt(6)
    s_add_u32 m0, s17, 0
    s_add_u32 s23, s16, 0
    buffer_load_dwordx4 v128, s[48:51], s23 offen lds
    v_mfma_f32_32x32x16_bf16 v[32:47], a[208:211], v[176:179], v[32:47]
    ds_read_b128 a[240:243], v133 offset:8192
    v_exp_f32 v17, v17
    v_add_f32 v112, v112, v7
    v_cvt_pk_bf16_f32 v99, v6, v7
    v_mfma_f32_32x32x16_bf16 v[48:63], a[208:211], v[208:211], v[48:63]
    v_exp_f32 v18, v18
    v_add_f32 v113, v113, v16
    v_exp_f32 v19, v19
    v_add_f32 v113, v113, v17
    v_mfma_f32_32x32x16_bf16 v[32:47], a[212:215], v[180:183], v[32:47]
    ds_read_b128 a[244:247], v133 offset:9216
    v_cvt_pk_bf16_f32 v104, v16, v17
    v_exp_f32 v20, v20
    v_add_f32 v113, v113, v18
    v_mfma_f32_32x32x16_bf16 v[48:63], a[212:215], v[212:215], v[48:63]
    s_waitcnt lgkmcnt(6)
    v_exp_f32 v21, v21
    v_add_f32 v113, v113, v19
    v_cvt_pk_bf16_f32 v105, v18, v19
    v_exp_f32 v22, v22
    v_mfma_f32_32x32x16_bf16 v[32:47], a[216:219], v[184:187], v[32:47]
    ds_read_b128 a[248:251], v133 offset:10240
    v_add_f32 v113, v113, v20
    v_exp_f32 v23, v23
    v_add_f32 v113, v113, v21
    v_cvt_pk_bf16_f32 v106, v20, v21
    v_mfma_f32_32x32x16_bf16 v[48:63], a[216:219], v[216:219], v[48:63]
    buffer_load_dwordx4 v128, s[48:51], s23 offen offset:1024 lds
    v_add_f32 v113, v113, v22
    v_add_f32 v113, v113, v23
    v_cvt_pk_bf16_f32 v107, v22, v23
    v_mfma_f32_32x32x16_bf16 v[32:47], a[220:223], v[188:191], v[32:47]
    ds_read_b128 a[252:255], v133 offset:11264
    v_exp_f32 v8, v8
    v_exp_f32 v9, v9
    v_mfma_f32_32x32x16_bf16 v[48:63], a[220:223], v[220:223], v[48:63]
    s_waitcnt lgkmcnt(6)
    v_exp_f32 v10, v10
    v_add_f32 v112, v112, v8
    v_exp_f32 v11, v11
    v_add_f32 v112, v112, v9
    v_mfma_f32_32x32x16_bf16 a[0:15], a[224:227], v[100:103], a[0:15]
    ds_read_b128 a[192:195], v134 offset:0
    v_exp_f32 v12, v12
    v_add_f32 v112, v112, v10
    v_exp_f32 v13, v13
    v_mfma_f32_32x32x16_bf16 a[64:79], a[224:227], v[108:111], a[64:79]
    v_add_f32 v112, v112, v11
    v_exp_f32 v14, v14
    v_add_f32 v112, v112, v12
    v_exp_f32 v15, v15
    v_mfma_f32_32x32x16_bf16 a[16:31], a[228:231], v[100:103], a[16:31]
    ds_read_b128 a[196:199], v134 offset:1024
    v_add_f32 v112, v112, v13
    v_exp_f32 v24, v24
    v_add_f32 v112, v112, v14
    v_mfma_f32_32x32x16_bf16 a[80:95], a[228:231], v[108:111], a[80:95]
    s_waitcnt lgkmcnt(6)
    buffer_load_dwordx4 v128, s[48:51], s23 offen offset:2048 lds
    v_exp_f32 v25, v25
    v_add_f32 v112, v112, v15
    v_mfma_f32_32x32x16_bf16 a[32:47], a[232:235], v[100:103], a[32:47]
    ds_read_b128 a[200:203], v134 offset:2048
    v_exp_f32 v26, v26
    v_add_f32 v113, v113, v24
    v_exp_f32 v27, v27
    v_mfma_f32_32x32x16_bf16 a[96:111], a[232:235], v[108:111], a[96:111]
    v_add_f32 v113, v113, v25
    v_exp_f32 v28, v28
    v_add_f32 v113, v113, v26
    v_exp_f32 v29, v29
    v_mfma_f32_32x32x16_bf16 a[48:63], a[236:239], v[100:103], a[48:63]
    ds_read_b128 a[204:207], v134 offset:3072
    v_add_f32 v113, v113, v27
    v_exp_f32 v30, v30
    v_add_f32 v113, v113, v28
    v_mfma_f32_32x32x16_bf16 a[112:127], a[236:239], v[108:111], a[112:127]
    s_waitcnt lgkmcnt(6)
    buffer_load_dwordx4 v128, s[48:51], s23 offen offset:3072 lds
    v_exp_f32 v31, v31
    v_cvt_pk_bf16_f32 v100, v8, v9
    v_mfma_f32_32x32x16_bf16 a[0:15], a[240:243], v[96:99], a[0:15]
    ds_read_b128 a[208:211], v134 offset:4096
    v_cvt_pk_bf16_f32 v101, v10, v11
    v_cvt_pk_bf16_f32 v102, v12, v13
    v_cvt_pk_bf16_f32 v103, v14, v15
    v_cvt_pk_bf16_f32 v108, v24, v25
    v_add_f32 v113, v113, v29
    v_mfma_f32_32x32x16_bf16 a[64:79], a[240:243], v[104:107], a[64:79]
    v_cvt_pk_bf16_f32 v109, v26, v27
    v_add_f32 v113, v113, v30
    v_add_f32 v113, v113, v31
    v_mfma_f32_32x32x16_bf16 a[16:31], a[244:247], v[96:99], a[16:31]
    ds_read_b128 a[212:215], v134 offset:5120
    v_cvt_pk_bf16_f32 v110, v28, v29
    v_mfma_f32_32x32x16_bf16 a[80:95], a[244:247], v[104:107], a[80:95]
    s_waitcnt lgkmcnt(6)
    v_mfma_f32_32x32x16_bf16 a[32:47], a[248:251], v[96:99], a[32:47]
    ds_read_b128 a[216:219], v134 offset:6144
    v_cvt_pk_bf16_f32 v111, v30, v31
    v_mfma_f32_32x32x16_bf16 a[96:111], a[248:251], v[104:107], a[96:111]
    v_mfma_f32_32x32x16_bf16 a[48:63], a[252:255], v[96:99], a[48:63]
    ds_read_b128 a[220:223], v134 offset:7168
    v_mfma_f32_32x32x16_bf16 a[112:127], a[252:255], v[104:107], a[112:127]
    s_waitcnt lgkmcnt(6)
    v_mfma_f32_32x32x16_bf16 v[0:15], a[192:195], v[160:163], v[64:79]
    ds_read_b128 a[224:227], v133 offset:12288
    v_exp_f32 v32, v32
    v_exp_f32 v33, v33
    v_mfma_f32_32x32x16_bf16 v[16:31], a[192:195], v[192:195], v[80:95]
    v_exp_f32 v34, v34
    v_add_f32 v112, v112, v32
    v_exp_f32 v35, v35
    v_add_f32 v112, v112, v33
    v_mfma_f32_32x32x16_bf16 v[0:15], a[196:199], v[164:167], v[0:15]
    ds_read_b128 a[228:231], v133 offset:13312
    v_cvt_pk_bf16_f32 v96, v32, v33
    v_exp_f32 v36, v36
    v_add_f32 v112, v112, v34
    v_mfma_f32_32x32x16_bf16 v[16:31], a[196:199], v[196:199], v[16:31]
    s_waitcnt lgkmcnt(6)
    v_exp_f32 v37, v37
    v_add_f32 v112, v112, v35
    v_cvt_pk_bf16_f32 v97, v34, v35
    v_exp_f32 v38, v38
    v_mfma_f32_32x32x16_bf16 v[0:15], a[200:203], v[168:171], v[0:15]
    s_add_u32 m0, s17, 4096
    ds_read_b128 a[232:235], v133 offset:14336
    s_add_u32 s23, s16, 4096
    buffer_load_dwordx4 v128, s[48:51], s23 offen lds
    v_mfma_f32_32x32x16_bf16 v[16:31], a[200:203], v[200:203], v[16:31]
    v_add_f32 v112, v112, v36
    v_exp_f32 v39, v39
    v_add_f32 v112, v112, v37
    v_cvt_pk_bf16_f32 v98, v36, v37
    v_mfma_f32_32x32x16_bf16 v[0:15], a[204:207], v[172:175], v[0:15]
    ds_read_b128 a[236:239], v133 offset:15360
    v_exp_f32 v48, v48
    v_add_f32 v112, v112, v38
    v_exp_f32 v49, v49
    v_mfma_f32_32x32x16_bf16 v[16:31], a[204:207], v[204:207], v[16:31]
    s_waitcnt lgkmcnt(6)
    v_add_f32 v112, v112, v39
    v_cvt_pk_bf16_f32 v99, v38, v39
    v_exp_f32 v50, v50
    v_add_f32 v113, v113, v48
    v_mfma_f32_32x32x16_bf16 v[0:15], a[208:211], v[176:179], v[0:15]
    ds_read_b128 a[240:243], v133 offset:24576
    v_exp_f32 v51, v51
    v_add_f32 v113, v113, v49
    v_cvt_pk_bf16_f32 v104, v48, v49
    v_mfma_f32_32x32x16_bf16 v[16:31], a[208:211], v[208:211], v[16:31]
    v_exp_f32 v52, v52
    v_add_f32 v113, v113, v50
    v_exp_f32 v53, v53
    v_add_f32 v113, v113, v51
    v_mfma_f32_32x32x16_bf16 v[0:15], a[212:215], v[180:183], v[0:15]
    ds_read_b128 a[244:247], v133 offset:25600
    buffer_load_dwordx4 v128, s[48:51], s23 offen offset:1024 lds
    v_cvt_pk_bf16_f32 v105, v50, v51
    v_mfma_f32_32x32x16_bf16 v[16:31], a[212:215], v[212:215], v[16:31]
    s_waitcnt lgkmcnt(6)
    v_exp_f32 v54, v54
    v_add_f32 v113, v113, v52
    v_exp_f32 v55, v55
    v_add_f32 v113, v113, v53
    v_mfma_f32_32x32x16_bf16 v[0:15], a[216:219], v[184:187], v[0:15]
    ds_read_b128 a[248:251], v133 offset:26624
    v_cvt_pk_bf16_f32 v106, v52, v53
    v_add_f32 v113, v113, v54
    v_add_f32 v113, v113, v55
    v_cvt_pk_bf16_f32 v107, v54, v55
    v_mfma_f32_32x32x16_bf16 v[16:31], a[216:219], v[216:219], v[16:31]
    v_exp_f32 v40, v40
    v_exp_f32 v41, v41
    v_exp_f32 v42, v42
    v_mfma_f32_32x32x16_bf16 v[0:15], a[220:223], v[188:191], v[0:15]
    ds_read_b128 a[252:255], v133 offset:27648
    v_add_f32 v112, v112, v40
    v_exp_f32 v43, v43
    v_add_f32 v112, v112, v41
    v_mfma_f32_32x32x16_bf16 v[16:31], a[220:223], v[220:223], v[16:31]
    s_waitcnt lgkmcnt(6)
    v_exp_f32 v44, v44
    v_add_f32 v112, v112, v42
    v_exp_f32 v45, v45
    v_add_f32 v112, v112, v43
    v_mfma_f32_32x32x16_bf16 a[0:15], a[224:227], v[100:103], a[0:15]
    ds_read_b128 a[192:195], v134 offset:16384
    v_exp_f32 v46, v46
    v_add_f32 v112, v112, v44
    v_exp_f32 v47, v47
    v_mfma_f32_32x32x16_bf16 a[64:79], a[224:227], v[108:111], a[64:79]
    buffer_load_dwordx4 v128, s[48:51], s23 offen offset:2048 lds
    v_add_f32 v112, v112, v45
    v_exp_f32 v56, v56
    v_mfma_f32_32x32x16_bf16 a[16:31], a[228:231], v[100:103], a[16:31]
    ds_read_b128 a[196:199], v134 offset:17408
    v_add_f32 v112, v112, v46
    v_exp_f32 v57, v57
    v_add_f32 v112, v112, v47
    v_mfma_f32_32x32x16_bf16 a[80:95], a[228:231], v[108:111], a[80:95]
    s_waitcnt lgkmcnt(6)
    v_exp_f32 v58, v58
    v_add_f32 v113, v113, v56
    v_exp_f32 v59, v59
    v_add_f32 v113, v113, v57
    v_mfma_f32_32x32x16_bf16 a[32:47], a[232:235], v[100:103], a[32:47]
    ds_read_b128 a[200:203], v134 offset:18432
    v_exp_f32 v60, v60
    v_add_f32 v113, v113, v58
    v_exp_f32 v61, v61
    v_mfma_f32_32x32x16_bf16 a[96:111], a[232:235], v[108:111], a[96:111]
    v_add_f32 v113, v113, v59
    v_exp_f32 v62, v62
    v_add_f32 v113, v113, v60
    v_exp_f32 v63, v63
    v_mfma_f32_32x32x16_bf16 a[48:63], a[236:239], v[100:103], a[48:63]
    ds_read_b128 a[204:207], v134 offset:19456
    buffer_load_dwordx4 v128, s[48:51], s23 offen offset:3072 lds
    v_add_f32 v113, v113, v61
    v_add_f32 v113, v113, v62
    v_mfma_f32_32x32x16_bf16 a[112:127], a[236:239], v[108:111], a[112:127]
    s_waitcnt lgkmcnt(6)
    v_cvt_pk_bf16_f32 v100, v40, v41
    v_cvt_pk_bf16_f32 v101, v42, v43
    v_cvt_pk_bf16_f32 v102, v44, v45
    v_cvt_pk_bf16_f32 v103, v46, v47
    v_add_f32 v113, v113, v63
    v_mfma_f32_32x32x16_bf16 a[0:15], a[240:243], v[96:99], a[0:15]
    ds_read_b128 a[208:211], v134 offset:20480
    v_cvt_pk_bf16_f32 v108, v56, v57
    v_mfma_f32_32x32x16_bf16 a[64:79], a[240:243], v[104:107], a[64:79]
    v_mfma_f32_32x32x16_bf16 a[16:31], a[244:247], v[96:99], a[16:31]
    ds_read_b128 a[212:215], v134 offset:21504
    v_cvt_pk_bf16_f32 v109, v58, v59
    v_mfma_f32_32x32x16_bf16 a[80:95], a[244:247], v[104:107], a[80:95]
    s_waitcnt lgkmcnt(6)
    v_cvt_pk_bf16_f32 v110, v60, v61
    v_mfma_f32_32x32x16_bf16 a[32:47], a[248:251], v[96:99], a[32:47]
    s_add_u32 s16, s16, 32768
    ds_read_b128 a[216:219], v134 offset:22528
    s_mov_b32 s20, s17
    s_add_u32 s17, s17, 32768
    s_cmp_eq_u32 s17, s21
    s_cselect_b32 s17, s18, s17
    v_mfma_f32_32x32x16_bf16 a[96:111], a[248:251], v[104:107], a[96:111]
    v_mov_b32 v132, v133
    v_mov_b32 v133, v134
    v_cvt_pk_bf16_f32 v111, v62, v63
    v_mfma_f32_32x32x16_bf16 a[48:63], a[252:255], v[96:99], a[48:63]
    ds_read_b128 a[220:223], v134 offset:23552
    v_add_u32 v134, s19, v135
    s_mov_b32 s19, s20
    s_sub_u32 s22, s22, 1
    s_cmp_lg_u32 s22, 0
    v_mfma_f32_32x32x16_bf16 a[112:127], a[252:255], v[104:107], a[112:127]
    s_cbranch_scc1 L_A_7
L_Aend_8:
    s_lshl_b32 s25, s13, 2
    s_add_u32 s24, s25, 0
    s_cmp_lt_u32 s24, s14
    s_cbranch_scc1 L_mskip_9
    s_cmp_gt_u32 s24, s14
    s_cbranch_scc1 L_mall_10
    v_cndmask_b32 v0, v0, v148, s[28:29]
    v_cndmask_b32 v1, v1, v148, s[30:31]
    v_cndmask_b32 v2, v2, v148, s[32:33]
    v_cndmask_b32 v3, v3, v148, s[34:35]
    v_cndmask_b32 v4, v4, v148, s[36:37]
    v_cndmask_b32 v5, v5, v148, s[38:39]
    v_cndmask_b32 v6, v6, v148, s[40:41]
    v_cndmask_b32 v7, v7, v148, s[42:43]
    v_cndmask_b32 v8, v8, v148, s[52:53]
    v_cndmask_b32 v9, v9, v148, s[54:55]
    v_cndmask_b32 v10, v10, v148, s[56:57]
    v_cndmask_b32 v11, v11, v148, s[58:59]
    v_cndmask_b32 v12, v12, v148, s[60:61]
    v_cndmask_b32 v13, v13, v148, s[62:63]
    v_cndmask_b32 v14, v14, v148, s[64:65]
    v_cndmask_b32 v15, v15, v148, s[66:67]
    s_branch L_mskip_9
L_mall_10:
    v_mov_b32 v0, v148
    v_mov_b32 v1, v148
    v_mov_b32 v2, v148
    v_mov_b32 v3, v148
    v_mov_b32 v4, v148
    v_mov_b32 v5, v148
    v_mov_b32 v6, v148
    v_mov_b32 v7, v148
    v_mov_b32 v8, v148
    v_mov_b32 v9, v148
    v_mov_b32 v10, v148
    v_mov_b32 v11, v148
    v_mov_b32 v12, v148
    v_mov_b32 v13, v148
    v_mov_b32 v14, v148
    v_mov_b32 v15, v148
L_mskip_9:
    s_waitcnt lgkmcnt(6)
    v_mfma_f32_32x32x16_bf16 v[32:47], a[192:195], v[160:163], v[64:79]
    ds_read_b128 a[224:227], v132 offset:28672
    v_exp_f32 v0, v0
    v_exp_f32 v1, v1
    v_mfma_f32_32x32x16_bf16 v[48:63], a[192:195], v[192:195], v[80:95]
    s_waitcnt vmcnt(8)
    s_barrier
    v_mfma_f32_32x32x16_bf16 v[32:47], a[196:199], v[164:167], v[32:47]
    ds_read_b128 a[228:231], v132 offset:29696
    v_exp_f32 v2, v2
    v_add_f32 v112, v112, v0
    v_exp_f32 v3, v3
    v_mfma_f32_32x32x16_bf16 v[48:63], a[196:199], v[196:199], v[48:63]
    s_waitcnt lgkmcnt(6)
    v_add_f32 v112, v112, v1
    v_cvt_pk_bf16_f32 v96, v0, v1
    v_exp_f32 v4, v4
    v_add_f32 v112, v112, v2
    v_mfma_f32_32x32x16_bf16 v[32:47], a[200:203], v[168:171], v[32:47]
    ds_read_b128 a[232:235], v132 offset:30720
    v_exp_f32 v5, v5
    v_add_f32 v112, v112, v3
    v_cvt_pk_bf16_f32 v97, v2, v3
    v_mfma_f32_32x32x16_bf16 v[48:63], a[200:203], v[200:203], v[48:63]
    v_exp_f32 v6, v6
    v_add_f32 v112, v112, v4
    v_exp_f32 v7, v7
    v_add_f32 v112, v112, v5
    v_mfma_f32_32x32x16_bf16 v[32:47], a[204:207], v[172:175], v[32:47]
    ds_read_b128 a[236:239], v132 offset:31744
    v_cvt_pk_bf16_f32 v98, v4, v5
    v_exp_f32 v16, v16
    v_add_f32 v112, v112, v6
    v_mfma_f32_32x32x16_bf16 v[48:63], a[204:207], v[204:207], v[48:63]
    s_waitcnt lgkmcnt(6)
    s_add_u32 m0, s17, 0
    s_add_u32 s23, s16, 0
    buffer_load_dwordx4 v128, s[48:51], s23 offen lds
    v_mfma_f32_32x32x16_bf16 v[32:47], a[208:211], v[176:179], v[32:47]
    ds_read_b128 a[240:243], v133 offset:8192
    v_exp_f32 v17, v17
    v_add_f32 v112, v112, v7
    v_cvt_pk_bf16_f32 v99, v6, v7
    v_mfma_f32_32x32x16_bf16 v[48:63], a[208:211], v[208:211], v[48:63]
    v_exp_f32 v18, v18
    v_add_f32 v113, v113, v16
    v_exp_f32 v19, v19
    v_add_f32 v113, v113, v17
    v_mfma_f32_32x32x16_bf16 v[32:47], a[212:215], v[180:183], v[32:47]
    ds_read_b128 a[244:247], v133 offset:9216
    v_cvt_pk_bf16_f32 v104, v16, v17
    v_exp_f32 v20, v20
    v_add_f32 v113, v113, v18
    v_mfma_f32_32x32x16_bf16 v[48:63], a[212:215], v[212:215], v[48:63]
    s_waitcnt lgkmcnt(6)
    v_exp_f32 v21, v21
    v_add_f32 v113, v113, v19
    v_cvt_pk_bf16_f32 v105, v18, v19
    v_exp_f32 v22, v22
    v_mfma_f32_32x32x16_bf16 v[32:47], a[216:219], v[184:187], v[32:47]
    ds_read_b128 a[248:251], v133 offset:10240
    v_add_f32 v113, v113, v20
    v_exp_f32 v23, v23
    v_add_f32 v113, v113, v21
    v_cvt_pk_bf16_f32 v106, v20, v21
    v_mfma_f32_32x32x16_bf16 v[48:63], a[216:219], v[216:219], v[48:63]
    buffer_load_dwordx4 v128, s[48:51], s23 offen offset:1024 lds
    v_add_f32 v113, v113, v22
    v_add_f32 v113, v113, v23
    v_cvt_pk_bf16_f32 v107, v22, v23
    v_mfma_f32_32x32x16_bf16 v[32:47], a[220:223], v[188:191], v[32:47]
    ds_read_b128 a[252:255], v133 offset:11264
    v_exp_f32 v8, v8
    v_exp_f32 v9, v9
    v_mfma_f32_32x32x16_bf16 v[48:63], a[220:223], v[220:223], v[48:63]
    s_waitcnt lgkmcnt(6)
    v_exp_f32 v10, v10
    v_add_f32 v112, v112, v8
    v_exp_f32 v11, v11
    v_add_f32 v112, v112, v9
    v_mfma_f32_32x32x16_bf16 a[0:15], a[224:227], v[100:103], a[0:15]
    ds_read_b128 a[192:195], v134 offset:0
    v_exp_f32 v12, v12
    v_add_f32 v112, v112, v10
    v_exp_f32 v13, v13
    v_mfma_f32_32x32x16_bf16 a[64:79], a[224:227], v[108:111], a[64:79]
    v_add_f32 v112, v112, v11
    v_exp_f32 v14, v14
    v_add_f32 v112, v112, v12
    v_exp_f32 v15, v15
    v_mfma_f32_32x32x16_bf16 a[16:31], a[228:231], v[100:103], a[16:31]
    ds_read_b128 a[196:199], v134 offset:1024
    v_add_f32 v112, v112, v13
    v_exp_f32 v24, v24
    v_add_f32 v112, v112, v14
    v_mfma_f32_32x32x16_bf16 a[80:95], a[228:231], v[108:111], a[80:95]
    s_waitcnt lgkmcnt(6)
    buffer_load_dwordx4 v128, s[48:51], s23 offen offset:2048 lds
    v_exp_f32 v25, v25
    v_add_f32 v112, v112, v15
    v_mfma_f32_32x32x16_bf16 a[32:47], a[232:235], v[100:103], a[32:47]
    ds_read_b128 a[200:203], v134 offset:2048
    v_exp_f32 v26, v26
    v_add_f32 v113, v113, v24
    v_exp_f32 v27, v27
    v_mfma_f32_32x32x16_bf16 a[96:111], a[232:235], v[108:111], a[96:111]
    v_add_f32 v113, v113, v25
    v_exp_f32 v28, v28
    v_add_f32 v113, v113, v26
    v_exp_f32 v29, v29
    v_mfma_f32_32x32x16_bf16 a[48:63], a[236:239], v[100:103], a[48:63]
    ds_read_b128 a[204:207], v134 offset:3072
    v_add_f32 v113, v113, v27
    v_exp_f32 v30, v30
    v_add_f32 v113, v113, v28
    v_mfma_f32_32x32x16_bf16 a[112:127], a[236:239], v[108:111], a[112:127]
    s_waitcnt lgkmcnt(6)
    buffer_load_dwordx4 v128, s[48:51], s23 offen offset:3072 lds
    v_exp_f32 v31, v31
    v_cvt_pk_bf16_f32 v100, v8, v9
    v_mfma_f32_32x32x16_bf16 a[0:15], a[240:243], v[96:99], a[0:15]
    ds_read_b128 a[208:211], v134 offset:4096
    v_cvt_pk_bf16_f32 v101, v10, v11
    v_cvt_pk_bf16_f32 v102, v12, v13
    v_cvt_pk_bf16_f32 v103, v14, v15
    v_cvt_pk_bf16_f32 v108, v24, v25
    v_add_f32 v113, v113, v29
    v_mfma_f32_32x32x16_bf16 a[64:79], a[240:243], v[104:107], a[64:79]
    v_cvt_pk_bf16_f32 v109, v26, v27
    v_add_f32 v113, v113, v30
    v_add_f32 v113, v113, v31
    v_mfma_f32_32x32x16_bf16 a[16:31], a[244:247], v[96:99], a[16:31]
    ds_read_b128 a[212:215], v134 offset:5120
    v_cvt_pk_bf16_f32 v110, v28, v29
    v_mfma_f32_32x32x16_bf16 a[80:95], a[244:247], v[104:107], a[80:95]
    s_waitcnt lgkmcnt(6)
    v_mfma_f32_32x32x16_bf16 a[32:47], a[248:251], v[96:99], a[32:47]
    ds_read_b128 a[216:219], v134 offset:6144
    v_cvt_pk_bf16_f32 v111, v30, v31
    v_mfma_f32_32x32x16_bf16 a[96:111], a[248:251], v[104:107], a[96:111]
    v_mfma_f32_32x32x16_bf16 a[48:63], a[252:255], v[96:99], a[48:63]
    ds_read_b128 a[220:223], v134 offset:7168
    v_mfma_f32_32x32x16_bf16 a[112:127], a[252:255], v[104:107], a[112:127]
    s_add_u32 s24, s25, 1
    s_cmp_lt_u32 s24, s14
    s_cbranch_scc1 L_mskip_11
    s_cmp_gt_u32 s24, s14
    s_cbranch_scc1 L_mall_12
    v_cndmask_b32 v32, v32, v148, s[28:29]
    v_cndmask_b32 v33, v33, v148, s[30:31]
    v_cndmask_b32 v34, v34, v148, s[32:33]
    v_cndmask_b32 v35, v35, v148, s[34:35]
    v_cndmask_b32 v36, v36, v148, s[36:37]
    v_cndmask_b32 v37, v37, v148, s[38:39]
    v_cndmask_b32 v38, v38, v148, s[40:41]
    v_cndmask_b32 v39, v39, v148, s[42:43]
    v_cndmask_b32 v40, v40, v148, s[52:53]
    v_cndmask_b32 v41, v41, v148, s[54:55]
    v_cndmask_b32 v42, v42, v148, s[56:57]
    v_cndmask_b32 v43, v43, v148, s[58:59]
    v_cndmask_b32 v44, v44, v148, s[60:61]
    v_cndmask_b32 v45, v45, v148, s[62:63]
    v_cndmask_b32 v46, v46, v148, s[64:65]
    v_cndmask_b32 v47, v47, v148, s[66:67]
    s_branch L_mskip_11
L_mall_12:
    v_mov_b32 v32, v148
    v_mov_b32 v33, v148
    v_mov_b32 v34, v148
    v_mov_b32 v35, v148
    v_mov_b32 v36, v148
    v_mov_b32 v37, v148
    v_mov_b32 v38, v148
    v_mov_b32 v39, v148
    v_mov_b32 v40, v148
    v_mov_b32 v41, v148
    v_mov_b32 v42, v148
    v_mov_b32 v43, v148
    v_mov_b32 v44, v148
    v_mov_b32 v45, v148
    v_mov_b32 v46, v148
    v_mov_b32 v47, v148
L_mskip_11:
    s_waitcnt lgkmcnt(6)
    v_mfma_f32_32x32x16_bf16 v[0:15], a[192:195], v[160:163], v[64:79]
    ds_read_b128 a[224:227], v133 offset:12288
    v_exp_f32 v32, v32
    v_exp_f32 v33, v33
    v_mfma_f32_32x32x16_bf16 v[16:31], a[192:195], v[192:195], v[80:95]
    v_exp_f32 v34, v34
    v_add_f32 v112, v112, v32
    v_exp_f32 v35, v35
    v_add_f32 v112, v112, v33
    v_mfma_f32_32x32x16_bf16 v[0:15], a[196:199], v[164:167], v[0:15]
    ds_read_b128 a[228:231], v133 offset:13312
    v_cvt_pk_bf16_f32 v96, v32, v33
    v_exp_f32 v36, v36
    v_add_f32 v112, v112, v34
    v_mfma_f32_32x32x16_bf16 v[16:31], a[196:199], v[196:199], v[16:31]
    s_waitcnt lgkmcnt(6)
    v_exp_f32 v37, v37
    v_add_f32 v112, v112, v35
    v_cvt_pk_bf16_f32 v97, v34, v35
    v_exp_f32 v38, v38
    v_mfma_f32_32x32x16_bf16 v[0:15], a[200:203], v[168:171], v[0:15]
    s_add_u32 m0, s17, 4096
    ds_read_b128 a[232:235], v133 offset:14336
    s_add_u32 s23, s16, 4096
    buffer_load_dwordx4 v128, s[48:51], s23 offen lds
    v_mfma_f32_32x32x16_bf16 v[16:31], a[200:203], v[200:203], v[16:31]
    v_add_f32 v112, v112, v36
    v_exp_f32 v39, v39
    v_add_f32 v112, v112, v37
    v_cvt_pk_bf16_f32 v98, v36, v37
    v_mfma_f32_32x32x16_bf16 v[0:15], a[204:207], v[172:175], v[0:15]
    ds_read_b128 a[236:239], v133 offset:15360
    v_exp_f32 v48, v48
    v_add_f32 v112, v112, v38
    v_exp_f32 v49, v49
    v_mfma_f32_32x32x16_bf16 v[16:31], a[204:207], v[204:207], v[16:31]
    s_waitcnt lgkmcnt(6)
    v_add_f32 v112, v112, v39
    v_cvt_pk_bf16_f32 v99, v38, v39
    v_exp_f32 v50, v50
    v_add_f32 v113, v113, v48
    v_mfma_f32_32x32x16_bf16 v[0:15], a[208:211], v[176:179], v[0:15]
    ds_read_b128 a[240:243], v133 offset:24576
    v_exp_f32 v51, v51
    v_add_f32 v113, v113, v49
    v_cvt_pk_bf16_f32 v104, v48, v49
    v_mfma_f32_32x32x16_bf16 v[16:31], a[208:211], v[208:211], v[16:31]
    v_exp_f32 v52, v52
    v_add_f32 v113, v113, v50
    v_exp_f32 v53, v53
    v_add_f32 v113, v113, v51
    v_mfma_f32_32x32x16_bf16 v[0:15], a[212:215], v[180:183], v[0:15]
    ds_read_b128 a[244:247], v133 offset:25600
    buffer_load_dwordx4 v128, s[48:51], s23 offen offset:1024 lds
    v_cvt_pk_bf16_f32 v105, v50, v51
    v_mfma_f32_32x32x16_bf16 v[16:31], a[212:215], v[212:215], v[16:31]
    s_waitcnt lgkmcnt(6)
    v_exp_f32 v54, v54
    v_add_f32 v113, v113, v52
    v_exp_f32 v55, v55
    v_add_f32 v113, v113, v53
    v_mfma_f32_32x32x16_bf16 v[0:15], a[216:219], v[184:187], v[0:15]
    ds_read_b128 a[248:251], v133 offset:26624
    v_cvt_pk_bf16_f32 v106, v52, v53
    v_add_f32 v113, v113, v54
    v_add_f32 v113, v113, v55
    v_cvt_pk_bf16_f32 v107, v54, v55
    v_mfma_f32_32x32x16_bf16 v[16:31], a[216:219], v[216:219], v[16:31]
    v_exp_f32 v40, v40
    v_exp_f32 v41, v41
    v_exp_f32 v42, v42
    v_mfma_f32_32x32x16_bf16 v[0:15], a[220:223], v[188:191], v[0:15]
    ds_read_b128 a[252:255], v133 offset:27648
    v_add_f32 v112, v112, v40
    v_exp_f32 v43, v43
    v_add_f32 v112, v112, v41
    v_mfma_f32_32x32x16_bf16 v[16:31], a[220:223], v[220:223], v[16:31]
    s_waitcnt lgkmcnt(6)
    v_exp_f32 v44, v44
    v_add_f32 v112, v112, v42
    v_exp_f32 v45, v45
    v_add_f32 v112, v112, v43
    v_mfma_f32_32x32x16_bf16 a[0:15], a[224:227], v[100:103], a[0:15]
    ds_read_b128 a[192:195], v134 offset:16384
    v_exp_f32 v46, v46
    v_add_f32 v112, v112, v44
    v_exp_f32 v47, v47
    v_mfma_f32_32x32x16_bf16 a[64:79], a[224:227], v[108:111], a[64:79]
    buffer_load_dwordx4 v128, s[48:51], s23 offen offset:2048 lds
    v_add_f32 v112, v112, v45
    v_exp_f32 v56, v56
    v_mfma_f32_32x32x16_bf16 a[16:31], a[228:231], v[100:103], a[16:31]
    ds_read_b128 a[196:199], v134 offset:17408
    v_add_f32 v112, v112, v46
    v_exp_f32 v57, v57
    v_add_f32 v112, v112, v47
    v_mfma_f32_32x32x16_bf16 a[80:95], a[228:231], v[108:111], a[80:95]
    s_waitcnt lgkmcnt(6)
    v_exp_f32 v58, v58
    v_add_f32 v113, v113, v56
    v_exp_f32 v59, v59
    v_add_f32 v113, v113, v57
    v_mfma_f32_32x32x16_bf16 a[32:47], a[232:235], v[100:103], a[32:47]
    ds_read_b128 a[200:203], v134 offset:18432
    v_exp_f32 v60, v60
    v_add_f32 v113, v113, v58
    v_exp_f32 v61, v61
    v_mfma_f32_32x32x16_bf16 a[96:111], a[232:235], v[108:111], a[96:111]
    v_add_f32 v113, v113, v59
    v_exp_f32 v62, v62
    v_add_f32 v113, v113, v60
    v_exp_f32 v63, v63
    v_mfma_f32_32x32x16_bf16 a[48:63], a[236:239], v[100:103], a[48:63]
    ds_read_b128 a[204:207], v134 offset:19456
    buffer_load_dwordx4 v128, s[48:51], s23 offen offset:3072 lds
    v_add_f32 v113, v113, v61
    v_add_f32 v113, v113, v62
    v_mfma_f32_32x32x16_bf16 a[112:127], a[236:239], v[108:111], a[112:127]
    s_waitcnt lgkmcnt(6)
    v_cvt_pk_bf16_f32 v100, v40, v41
    v_cvt_pk_bf16_f32 v101, v42, v43
    v_cvt_pk_bf16_f32 v102, v44, v45
    v_cvt_pk_bf16_f32 v103, v46, v47
    v_add_f32 v113, v113, v63
    v_mfma_f32_32x32x16_bf16 a[0:15], a[240:243], v[96:99], a[0:15]
    ds_read_b128 a[208:211], v134 offset:20480
    v_cvt_pk_bf16_f32 v108, v56, v57
    v_mfma_f32_32x32x16_bf16 a[64:79], a[240:243], v[104:107], a[64:79]
    v_mfma_f32_32x32x16_bf16 a[16:31], a[244:247], v[96:99], a[16:31]
    ds_read_b128 a[212:215], v134 offset:21504
    v_cvt_pk_bf16_f32 v109, v58, v59
    v_mfma_f32_32x32x16_bf16 a[80:95], a[244:247], v[104:107], a[80:95]
    s_waitcnt lgkmcnt(6)
    v_cvt_pk_bf16_f32 v110, v60, v61
    v_mfma_f32_32x32x16_bf16 a[32:47], a[248:251], v[96:99], a[32:47]
    s_add_u32 s16, s16, 32768
    ds_read_b128 a[216:219], v134 offset:22528
    s_mov_b32 s20, s17
    s_add_u32 s17, s17, 32768
    s_cmp_eq_u32 s17, s21
    s_cselect_b32 s17, s18, s17
    v_mfma_f32_32x32x16_bf16 a[96:111], a[248:251], v[104:107], a[96:111]
    v_mov_b32 v132, v133
    v_mov_b32 v133, v134
    v_cvt_pk_bf16_f32 v111, v62, v63
    v_mfma_f32_32x32x16_bf16 a[48:63], a[252:255], v[96:99], a[48:63]
    ds_read_b128 a[220:223], v134 offset:23552
    v_add_u32 v134, s19, v135
    s_mov_b32 s19, s20
    s_add_u32 s25, s25, 2
    v_mfma_f32_32x32x16_bf16 a[112:127], a[252:255], v[104:107], a[112:127]
    s_add_u32 s24, s25, 0
    s_cmp_lt_u32 s24, s14
    s_cbranch_scc1 L_mskip_13
    s_cmp_gt_u32 s24, s14
    s_cbranch_scc1 L_mall_14
    v_cndmask_b32 v0, v0, v148, s[28:29]
    v_cndmask_b32 v1, v1, v148, s[30:31]
    v_cndmask_b32 v2, v2, v148, s[32:33]
    v_cndmask_b32 v3, v3, v148, s[34:35]
    v_cndmask_b32 v4, v4, v148, s[36:37]
    v_cndmask_b32 v5, v5, v148, s[38:39]
    v_cndmask_b32 v6, v6, v148, s[40:41]
    v_cndmask_b32 v7, v7, v148, s[42:43]
    v_cndmask_b32 v8, v8, v148, s[52:53]
    v_cndmask_b32 v9, v9, v148, s[54:55]
    v_cndmask_b32 v10, v10, v148, s[56:57]
    v_cndmask_b32 v11, v11, v148, s[58:59]
    v_cndmask_b32 v12, v12, v148, s[60:61]
    v_cndmask_b32 v13, v13, v148, s[62:63]
    v_cndmask_b32 v14, v14, v148, s[64:65]
    v_cndmask_b32 v15, v15, v148, s[66:67]
    s_branch L_mskip_13
L_mall_14:
    v_mov_b32 v0, v148
    v_mov_b32 v1, v148
    v_mov_b32 v2, v148
    v_mov_b32 v3, v148
    v_mov_b32 v4, v148
    v_mov_b32 v5, v148
    v_mov_b32 v6, v148
    v_mov_b32 v7, v148
    v_mov_b32 v8, v148
    v_mov_b32 v9, v148
    v_mov_b32 v10, v148
    v_mov_b32 v11, v148
    v_mov_b32 v12, v148
    v_mov_b32 v13, v148
    v_mov_b32 v14, v148
    v_mov_b32 v15, v148
L_mskip_13:
    s_waitcnt lgkmcnt(6)
    v_mfma_f32_32x32x16_bf16 v[32:47], a[192:195], v[160:163], v[64:79]
    ds_read_b128 a[224:227], v132 offset:28672
    v_exp_f32 v0, v0
    v_exp_f32 v1, v1
    v_mfma_f32_32x32x16_bf16 v[48:63], a[192:195], v[192:195], v[80:95]
    s_waitcnt vmcnt(8)
    s_barrier
    v_mfma_f32_32x32x16_bf16 v[32:47], a[196:199], v[164:167], v[32:47]
    ds_read_b128 a[228:231], v132 offset:29696
    v_exp_f32 v2, v2
    v_add_f32 v112, v112, v0
    v_exp_f32 v3, v3
    v_mfma_f32_32x32x16_bf16 v[48:63], a[196:199], v[196:199], v[48:63]
    s_waitcnt lgkmcnt(6)
    v_add_f32 v112, v112, v1
    v_cvt_pk_bf16_f32 v96, v0, v1
    v_exp_f32 v4, v4
    v_add_f32 v112, v112, v2
    v_mfma_f32_32x32x16_bf16 v[32:47], a[200:203], v[168:171], v[32:47]
    ds_read_b128 a[232:235], v132 offset:30720
    v_exp_f32 v5, v5
    v_add_f32 v112, v112, v3
    v_cvt_pk_bf16_f32 v97, v2, v3
    v_mfma_f32_32x32x16_bf16 v[48:63], a[200:203], v[200:203], v[48:63]
    v_exp_f32 v6, v6
    v_add_f32 v112, v112, v4
    v_exp_f32 v7, v7
    v_add_f32 v112, v112, v5
    v_mfma_f32_32x32x16_bf16 v[32:47], a[204:207], v[172:175], v[32:47]
    ds_read_b128 a[236:239], v132 offset:31744
    v_cvt_pk_bf16_f32 v98, v4, v5
    v_exp_f32 v16, v16
    v_add_f32 v112, v112, v6
    v_mfma_f32_32x32x16_bf16 v[48:63], a[204:207], v[204:207], v[48:63]
    s_waitcnt lgkmcnt(6)
    s_add_u32 m0, s17, 0
    s_add_u32 s23, s16, 0
    buffer_load_dwordx4 v128, s[48:51], s23 offen lds
    v_mfma_f32_32x32x16_bf16 v[32:47], a[208:211], v[176:179], v[32:47]
    ds_read_b128 a[240:243], v133 offset:8192
    v_exp_f32 v17, v17
    v_add_f32 v112, v112, v7
    v_cvt_pk_bf16_f32 v99, v6, v7
    v_mfma_f32_32x32x16_bf16 v[48:63], a[208:211], v[208:211], v[48:63]
    v_exp_f32 v18, v18
    v_add_f32 v113, v113, v16
    v_exp_f32 v19, v19
    v_add_f32 v113, v113, v17
    v_mfma_f32_32x32x16_bf16 v[32:47], a[212:215], v[180:183], v[32:47]
    ds_read_b128 a[244:247], v133 offset:9216
    v_cvt_pk_bf16_f32 v104, v16, v17
    v_exp_f32 v20, v20
    v_add_f32 v113, v113, v18
    v_mfma_f32_32x32x16_bf16 v[48:63], a[212:215], v[212:215], v[48:63]
    s_waitcnt lgkmcnt(6)
    v_exp_f32 v21, v21
    v_add_f32 v113, v113, v19
    v_cvt_pk_bf16_f32 v105, v18, v19
    v_exp_f32 v22, v22
    v_mfma_f32_32x32x16_bf16 v[32:47], a[216:219], v[184:187], v[32:47]
    ds_read_b128 a[248:251], v133 offset:10240
    v_add_f32 v113, v113, v20
    v_exp_f32 v23, v23
    v_add_f32 v113, v113, v21
    v_cvt_pk_bf16_f32 v106, v20, v21
    v_mfma_f32_32x32x16_bf16 v[48:63], a[216:219], v[216:219], v[48:63]
    buffer_load_dwordx4 v128, s[48:51], s23 offen offset:1024 lds
    v_add_f32 v113, v113, v22
    v_add_f32 v113, v113, v23
    v_cvt_pk_bf16_f32 v107, v22, v23
    v_mfma_f32_32x32x16_bf16 v[32:47], a[220:223], v[188:191], v[32:47]
    ds_read_b128 a[252:255], v133 offset:11264
    v_exp_f32 v8, v8
    v_exp_f32 v9, v9
    v_mfma_f32_32x32x16_bf16 v[48:63], a[220:223], v[220:223], v[48:63]
    s_waitcnt lgkmcnt(6)
    v_exp_f32 v10, v10
    v_add_f32 v112, v112, v8
    v_exp_f32 v11, v11
    v_add_f32 v112, v112, v9
    v_mfma_f32_32x32x16_bf16 a[0:15], a[224:227], v[100:103], a[0:15]
    ds_read_b128 a[192:195], v134 offset:0
    v_exp_f32 v12, v12
    v_add_f32 v112, v112, v10
    v_exp_f32 v13, v13
    v_mfma_f32_32x32x16_bf16 a[64:79], a[224:227], v[108:111], a[64:79]
    v_add_f32 v112, v112, v11
    v_exp_f32 v14, v14
    v_add_f32 v112, v112, v12
    v_exp_f32 v15, v15
    v_mfma_f32_32x32x16_bf16 a[16:31], a[228:231], v[100:103], a[16:31]
    ds_read_b128 a[196:199], v134 offset:1024
    v_add_f32 v112, v112, v13
    v_exp_f32 v24, v24
    v_add_f32 v112, v112, v14
    v_mfma_f32_32x32x16_bf16 a[80:95], a[228:231], v[108:111], a[80:95]
    s_waitcnt lgkmcnt(6)
    buffer_load_dwordx4 v128, s[48:51], s23 offen offset:2048 lds
    v_exp_f32 v25, v25
    v_add_f32 v112, v112, v15
    v_mfma_f32_32x32x16_bf16 a[32:47], a[232:235], v[100:103], a[32:47]
    ds_read_b128 a[200:203], v134 offset:2048
    v_exp_f32 v26, v26
    v_add_f32 v113, v113, v24
    v_exp_f32 v27, v27
    v_mfma_f32_32x32x16_bf16 a[96:111], a[232:235], v[108:111], a[96:111]
    v_add_f32 v113, v113, v25
    v_exp_f32 v28, v28
    v_add_f32 v113, v113, v26
    v_exp_f32 v29, v29
    v_mfma_f32_32x32x16_bf16 a[48:63], a[236:239], v[100:103], a[48:63]
    ds_read_b128 a[204:207], v134 offset:3072
    v_add_f32 v113, v113, v27
    v_exp_f32 v30, v30
    v_add_f32 v113, v113, v28
    v_mfma_f32_32x32x16_bf16 a[112:127], a[236:239], v[108:111], a[112:127]
    s_waitcnt lgkmcnt(6)
    buffer_load_dwordx4 v128, s[48:51], s23 offen offset:3072 lds
    v_exp_f32 v31, v31
    v_cvt_pk_bf16_f32 v100, v8, v9
    v_mfma_f32_32x32x16_bf16 a[0:15], a[240:243], v[96:99], a[0:15]
    ds_read_b128 a[208:211], v134 offset:4096
    v_cvt_pk_bf16_f32 v101, v10, v11
    v_cvt_pk_bf16_f32 v102, v12, v13
    v_cvt_pk_bf16_f32 v103, v14, v15
    v_cvt_pk_bf16_f32 v108, v24, v25
    v_add_f32 v113, v113, v29
    v_mfma_f32_32x32x16_bf16 a[64:79], a[240:243], v[104:107], a[64:79]
    v_cvt_pk_bf16_f32 v109, v26, v27
    v_add_f32 v113, v113, v30
    v_add_f32 v113, v113, v31
    v_mfma_f32_32x32x16_bf16 a[16:31], a[244:247], v[96:99], a[16:31]
    ds_read_b128 a[212:215], v134 offset:5120
    v_cvt_pk_bf16_f32 v110, v28, v29
    v_mfma_f32_32x32x16_bf16 a[80:95], a[244:247], v[104:107], a[80:95]
    s_waitcnt lgkmcnt(6)
    v_mfma_f32_32x32x16_bf16 a[32:47], a[248:251], v[96:99], a[32:47]
    ds_read_b128 a[216:219], v134 offset:6144
    v_cvt_pk_bf16_f32 v111, v30, v31
    v_mfma_f32_32x32x16_bf16 a[96:111], a[248:251], v[104:107], a[96:111]
    v_mfma_f32_32x32x16_bf16 a[48:63], a[252:255], v[96:99], a[48:63]
    ds_read_b128 a[220:223], v134 offset:7168
    v_mfma_f32_32x32x16_bf16 a[112:127], a[252:255], v[104:107], a[112:127]
    s_add_u32 s24, s25, 1
    s_cmp_lt_u32 s24, s14
    s_cbranch_scc1 L_mskip_15
    s_cmp_gt_u32 s24, s14
    s_cbranch_scc1 L_mall_16
    v_cndmask_b32 v32, v32, v148, s[28:29]
    v_cndmask_b32 v33, v33, v148, s[30:31]
    v_cndmask_b32 v34, v34, v148, s[32:33]
    v_cndmask_b32 v35, v35, v148, s[34:35]
    v_cndmask_b32 v36, v36, v148, s[36:37]
    v_cndmask_b32 v37, v37, v148, s[38:39]
    v_cndmask_b32 v38, v38, v148, s[40:41]
    v_cndmask_b32 v39, v39, v148, s[42:43]
    v_cndmask_b32 v40, v40, v148, s[52:53]
    v_cndmask_b32 v41, v41, v148, s[54:55]
    v_cndmask_b32 v42, v42, v148, s[56:57]
    v_cndmask_b32 v43, v43, v148, s[58:59]
    v_cndmask_b32 v44, v44, v148, s[60:61]
    v_cndmask_b32 v45, v45, v148, s[62:63]
    v_cndmask_b32 v46, v46, v148, s[64:65]
    v_cndmask_b32 v47, v47, v148, s[66:67]
    s_branch L_mskip_15
L_mall_16:
    v_mov_b32 v32, v148
    v_mov_b32 v33, v148
    v_mov_b32 v34, v148
    v_mov_b32 v35, v148
    v_mov_b32 v36, v148
    v_mov_b32 v37, v148
    v_mov_b32 v38, v148
    v_mov_b32 v39, v148
    v_mov_b32 v40, v148
    v_mov_b32 v41, v148
    v_mov_b32 v42, v148
    v_mov_b32 v43, v148
    v_mov_b32 v44, v148
    v_mov_b32 v45, v148
    v_mov_b32 v46, v148
    v_mov_b32 v47, v148
L_mskip_15:
    s_waitcnt lgkmcnt(6)
    v_mfma_f32_32x32x16_bf16 v[16:31], a[192:195], v[192:195], v[80:95]
    ds_read_b128 a[224:227], v133 offset:12288
    v_exp_f32 v32, v32
    v_exp_f32 v33, v33
    v_mfma_f32_32x32x16_bf16 v[16:31], a[196:199], v[196:199], v[16:31]
    s_waitcnt lgkmcnt(5)
    ds_read_b128 a[228:231], v133 offset:13312
    v_exp_f32 v34, v34
    v_add_f32 v112, v112, v32
    v_exp_f32 v35, v35
    v_mfma_f32_32x32x16_bf16 v[16:31], a[200:203], v[200:203], v[16:31]
    ds_read_b128 a[232:235], v133 offset:14336
    v_add_f32 v112, v112, v33
    v_cvt_pk_bf16_f32 v96, v32, v33
    v_exp_f32 v36, v36
    v_add_f32 v112, v112, v34
    v_mfma_f32_32x32x16_bf16 v[16:31], a[204:207], v[204:207], v[16:31]
    s_waitcnt lgkmcnt(5)
    ds_read_b128 a[236:239], v133 offset:15360
    s_add_u32 m0, s17, 4096
    s_add_u32 s23, s16, 4096
    buffer_load_dwordx4 v128, s[48:51], s23 offen lds
    v_mfma_f32_32x32x16_bf16 v[16:31], a[208:211], v[208:211], v[16:31]
    ds_read_b128 a[240:243], v133 offset:24576
    v_exp_f32 v37, v37
    v_add_f32 v112, v112, v35
    v_cvt_pk_bf16_f32 v97, v34, v35
    v_mfma_f32_32x32x16_bf16 v[16:31], a[212:215], v[212:215], v[16:31]
    s_waitcnt lgkmcnt(5)
    ds_read_b128 a[244:247], v133 offset:25600
    v_exp_f32 v38, v38
    v_add_f32 v112, v112, v36
    v_exp_f32 v39, v39
    v_mfma_f32_32x32x16_bf16 v[16:31], a[216:219], v[216:219], v[16:31]
    ds_read_b128 a[248:251], v133 offset:26624
    v_add_f32 v112, v112, v37
    v_cvt_pk_bf16_f32 v98, v36, v37
    v_exp_f32 v48, v48
    v_add_f32 v112, v112, v38
    v_mfma_f32_32x32x16_bf16 v[16:31], a[220:223], v[220:223], v[16:31]
    s_waitcnt lgkmcnt(5)
    ds_read_b128 a[252:255], v133 offset:27648
    v_exp_f32 v49, v49
    v_add_f32 v112, v112, v39
    v_cvt_pk_bf16_f32 v99, v38, v39
    v_mfma_f32_32x32x16_bf16 a[0:15], a[224:227], v[100:103], a[0:15]
    ds_read_b128 a[192:195], v134 offset:16384
    buffer_load_dwordx4 v128, s[48:51], s23 offen offset:1024 lds
    v_exp_f32 v50, v50
    v_mfma_f32_32x32x16_bf16 a[64:79], a[224:227], v[108:111], a[64:79]
    v_add_f32 v113, v113, v48
    v_exp_f32 v51, v51
    v_add_f32 v113, v113, v49
    v_cvt_pk_bf16_f32 v104, v48, v49
    v_mfma_f32_32x32x16_bf16 a[16:31], a[228:231], v[100:103], a[16:31]
    ds_read_b128 a[196:199], v134 offset:17408
    v_exp_f32 v52, v52
    v_add_f32 v113, v113, v50
    v_exp_f32 v53, v53
    v_mfma_f32_32x32x16_bf16 a[80:95], a[228:231], v[108:111], a[80:95]
    s_waitcnt lgkmcnt(6)
    v_add_f32 v113, v113, v51
    v_cvt_pk_bf16_f32 v105, v50, v51
    v_exp_f32 v54, v54
    v_add_f32 v113, v113, v52
    v_mfma_f32_32x32x16_bf16 a[32:47], a[232:235], v[100:103], a[32:47]
    ds_read_b128 a[200:203], v134 offset:18432
    v_exp_f32 v55, v55
    v_add_f32 v113, v113, v53
    v_cvt_pk_bf16_f32 v106, v52, v53
    v_add_f32 v113, v113, v54
    v_mfma_f32_32x32x16_bf16 a[96:111], a[232:235], v[108:111], a[96:111]
    buffer_load_dwordx4 v128, s[48:51], s23 offen offset:2048 lds
    v_add_f32 v113, v113, v55
    v_cvt_pk_bf16_f32 v107, v54, v55
    v_mfma_f32_32x32x16_bf16 a[48:63], a[236:239], v[100:103], a[48:63]
    ds_read_b128 a[204:207], v134 offset:19456
    v_exp_f32 v40, v40
    v_exp_f32 v41, v41
    v_mfma_f32_32x32x16_bf16 a[112:127], a[236:239], v[108:111], a[112:127]
    s_waitcnt lgkmcnt(6)
    v_exp_f32 v42, v42
    v_add_f32 v112, v112, v40
    v_exp_f32 v43, v43
    v_add_f32 v112, v112, v41
    v_mfma_f32_32x32x16_bf16 a[0:15], a[240:243], v[96:99], a[0:15]
    ds_read_b128 a[208:211], v134 offset:20480
    v_exp_f32 v44, v44
    v_add_f32 v112, v112, v42
    v_exp_f32 v45, v45
    v_mfma_f32_32x32x16_bf16 a[64:79], a[240:243], v[104:107], a[64:79]
    v_add_f32 v112, v112, v43
    v_exp_f32 v46, v46
    v_add_f32 v112, v112, v44
    v_exp_f32 v47, v47
    v_mfma_f32_32x32x16_bf16 a[16:31], a[244:247], v[96:99], a[16:31]
    ds_read_b128 a[212:215], v134 offset:21504
    v_add_f32 v112, v112, v45
    v_exp_f32 v56, v56
    v_add_f32 v112, v112, v46
    v_cvt_pk_bf16_f32 v100, v40, v41
    v_mfma_f32_32x32x16_bf16 a[80:95], a[244:247], v[104:107], a[80:95]
    s_waitcnt lgkmcnt(6)
    buffer_load_dwordx4 v128, s[48:51], s23 offen offset:3072 lds
    v_exp_f32 v57, v57
    v_add_f32 v112, v112, v47
    v_mfma_f32_32x32x16_bf16 a[32:47], a[248:251], v[96:99], a[32:47]
    ds_read_b128 a[216:219], v134 offset:22528
    v_exp_f32 v58, v58
    v_add_f32 v113, v113, v56
    v_exp_f32 v59, v59
    v_mfma_f32_32x32x16_bf16 a[96:111], a[248:251], v[104:107], a[96:111]
    v_add_f32 v113, v113, v57
    v_exp_f32 v60, v60
    v_add_f32 v113, v113, v58
    v_exp_f32 v61, v61
    v_mfma_f32_32x32x16_bf16 a[48:63], a[252:255], v[96:99], a[48:63]
    s_add_u32 s16, s16, 32768
    ds_read_b128 a[220:223], v134 offset:23552
    s_mov_b32 s20, s17
    v_add_f32 v113, v113, v59
    v_exp_f32 v62, v62
    v_mfma_f32_32x32x16_bf16 a[112:127], a[252:255], v[104:107], a[112:127]
    s_add_u32 s17, s17, 32768
    s_cmp_eq_u32 s17, s21
    s_cselect_b32 s17, s18, s17
    v_cvt_pk_bf16_f32 v101, v42, v43
    v_add_f32 v113, v113, v60
    v_cvt_pk_bf16_f32 v102, v44, v45
    v_exp_f32 v63, v63
    v_mov_b32 v132, v133
    v_cvt_pk_bf16_f32 v103, v46, v47
    v_mov_b32 v133, v134
    v_cvt_pk_bf16_f32 v108, v56, v57
    v_add_f32 v113, v113, v61
    v_add_u32 v134, s19, v135
    s_mov_b32 s19, s20
    s_add_u32 s25, s25, 2
    v_cvt_pk_bf16_f32 v109, v58, v59
    v_add_f32 v113, v113, v62
    v_cvt_pk_bf16_f32 v110, v60, v61
    v_add_f32 v113, v113, v63
    v_cvt_pk_bf16_f32 v111, v62, v63
    s_waitcnt lgkmcnt(0)
    ds_read_b128 a[224:227], v132 offset:28672
    ds_read_b128 a[228:231], v132 offset:29696
    ds_read_b128 a[232:235], v132 offset:30720
    ds_read_b128 a[236:239], v132 offset:31744
    s_waitcnt lgkmcnt(0)
    v_mfma_f32_32x32x16_bf16 a[0:15], a[224:227], v[100:103], a[0:15]
    v_mfma_f32_32x32x16_bf16 a[16:31], a[228:231], v[100:103], a[16:31]
    v_mfma_f32_32x32x16_bf16 a[32:47], a[232:235], v[100:103], a[32:47]
    v_mfma_f32_32x32x16_bf16 a[48:63], a[236:239], v[100:103], a[48:63]
    s_lshl_b32 s22, s13, 2
    s_sub_u32 s22, 28, s22
    s_cmp_eq_u32 s22, 0
    s_cbranch_scc1 L_Cend_18
.p2align 6
L_C_17:
    s_waitcnt lgkmcnt(6)
    v_mfma_f32_32x32x16_bf16 v[48:63], a[192:195], v[192:195], v[80:95]
    ds_read_b128 a[224:227], v132 offset:28672
    v_exp_f32 v16, v16
    v_exp_f32 v17, v17
    v_mfma_f32_32x32x16_bf16 v[48:63], a[196:199], v[196:199], v[48:63]
    s_waitcnt lgkmcnt(5)
    ds_read_b128 a[228:231], v132 offset:29696
    s_waitcnt vmcnt(8)
    s_barrier
    v_mfma_f32_32x32x16_bf16 v[48:63], a[200:203], v[200:203], v[48:63]
    ds_read_b128 a[232:235], v132 offset:30720
    v_exp_f32 v18, v18
    v_add_f32 v113, v113, v16
    v_exp_f32 v19, v19
    v_mfma_f32_32x32x16_bf16 v[48:63], a[204:207], v[204:207], v[48:63]
    s_waitcnt lgkmcnt(5)
    ds_read_b128 a[236:239], v132 offset:31744
    s_add_u32 m0, s17, 0
    s_add_u32 s23, s16, 0
    buffer_load_dwordx4 v128, s[48:51], s23 offen lds
    v_mfma_f32_32x32x16_bf16 v[48:63], a[208:211], v[208:211], v[48:63]
    ds_read_b128 a[240:243], v133 offset:8192
    v_add_f32 v113, v113, v17
    v_cvt_pk_bf16_f32 v104, v16, v17
    v_exp_f32 v20, v20
    v_add_f32 v113, v113, v18
    v_mfma_f32_32x32x16_bf16 v[48:63], a[212:215], v[212:215], v[48:63]
    s_waitcnt lgkmcnt(5)
    ds_read_b128 a[244:247], v133 offset:9216
    v_exp_f32 v21, v21
    v_add_f32 v113, v113, v19
    v_cvt_pk_bf16_f32 v105, v18, v19
    v_mfma_f32_32x32x16_bf16 v[48:63], a[216:219], v[216:219], v[48:63]
    ds_read_b128 a[248:251], v133 offset:10240
    v_exp_f32 v22, v22
    v_add_f32 v113, v113, v20
    v_exp_f32 v23, v23
    v_mfma_f32_32x32x16_bf16 v[48:63], a[220:223], v[220:223], v[48:63]
    s_waitcnt lgkmcnt(5)
    ds_read_b128 a[252:255], v133 offset:11264
    buffer_load_dwordx4 v128, s[48:51], s23 offen offset:1024 lds
    v_add_f32 v113, v113, v21
    v_cvt_pk_bf16_f32 v106, v20, v21
    v_mfma_f32_32x32x16_bf16 a[64:79], a[224:227], v[108:111], a[64:79]
    ds_read_b128 a[192:195], v134 offset:0
    v_add_f32 v113, v113, v22
    v_add_f32 v113, v113, v23
    v_cvt_pk_bf16_f32 v107, v22, v23
    v_exp_f32 v24, v24
    v_mfma_f32_32x32x16_bf16 a[80:95], a[228:231], v[108:111], a[80:95]
    s_waitcnt lgkmcnt(5)
    ds_read_b128 a[196:199], v134 offset:1024
    buffer_load_dwordx4 v128, s[48:51], s23 offen offset:2048 lds
    v_exp_f32 v25, v25
    v_mfma_f32_32x32x16_bf16 a[96:111], a[232:235], v[108:111], a[96:111]
    ds_read_b128 a[200:203], v134 offset:2048
    v_exp_f32 v26, v26
    v_add_f32 v113, v113, v24
    v_exp_f32 v27, v27
    v_mfma_f32_32x32x16_bf16 a[112:127], a[236:239], v[108:111], a[112:127]
    s_waitcnt lgkmcnt(5)
    ds_read_b128 a[204:207], v134 offset:3072
    v_add_f32 v113, v113, v25
    v_exp_f32 v28, v28
    v_add_f32 v113, v113, v26
    v_mfma_f32_32x32x16_bf16 a[64:79], a[240:243], v[104:107], a[64:79]
    ds_read_b128 a[208:211], v134 offset:4096
    v_exp_f32 v29, v29
    v_add_f32 v113, v113, v27
    v_exp_f32 v30, v30
    v_mfma_f32_32x32x16_bf16 a[80:95], a[244:247], v[104:107], a[80:95]
    s_waitcnt lgkmcnt(5)
    ds_read_b128 a[212:215], v134 offset:5120
    buffer_load_dwordx4 v128, s[48:51], s23 offen offset:3072 lds
    v_add_f32 v113, v113, v28
    v_cvt_pk_bf16_f32 v108, v24, v25
    v_mfma_f32_32x32x16_bf16 a[96:111], a[248:251], v[104:107], a[96:111]
    ds_read_b128 a[216:219], v134 offset:6144
    v_exp_f32 v31, v31
    v_add_f32 v113, v113, v29
    v_cvt_pk_bf16_f32 v109, v26, v27
    v_add_f32 v113, v113, v30
    v_mfma_f32_32x32x16_bf16 a[112:127], a[252:255], v[104:107], a[112:127]
    ds_read_b128 a[220:223], v134 offset:7168
    v_cvt_pk_bf16_f32 v110, v28, v29
    v_add_f32 v113, v113, v31
    v_cvt_pk_bf16_f32 v111, v30, v31
    s_waitcnt lgkmcnt(6)
    v_mfma_f32_32x32x16_bf16 v[16:31], a[192:195], v[192:195], v[80:95]
    ds_read_b128 a[224:227], v133 offset:12288
    v_exp_f32 v48, v48
    v_exp_f32 v49, v49
    v_mfma_f32_32x32x16_bf16 v[16:31], a[196:199], v[196:199], v[16:31]
    s_waitcnt lgkmcnt(5)
    ds_read_b128 a[228:231], v133 offset:13312
    v_exp_f32 v50, v50
    v_add_f32 v113, v113, v48
    v_exp_f32 v51, v51
    v_mfma_f32_32x32x16_bf16 v[16:31], a[200:203], v[200:203], v[16:31]
    s_add_u32 m0, s17, 4096
    ds_read_b128 a[232:235], v133 offset:14336
    s_add_u32 s23, s16, 4096
    buffer_load_dwordx4 v128, s[48:51], s23 offen lds
    v_mfma_f32_32x32x16_bf16 v[16:31], a[204:207], v[204:207], v[16:31]
    s_waitcnt lgkmcnt(5)
    ds_read_b128 a[236:239], v133 offset:15360
    v_add_f32 v113, v113, v49
    v_cvt_pk_bf16_f32 v104, v48, v49
    v_exp_f32 v52, v52
    v_add_f32 v113, v113, v50
    v_mfma_f32_32x32x16_bf16 v[16:31], a[208:211], v[208:211], v[16:31]
    ds_read_b128 a[240:243], v133 offset:24576
    v_exp_f32 v53, v53
    v_add_f32 v113, v113, v51
    v_cvt_pk_bf16_f32 v105, v50, v51
    v_mfma_f32_32x32x16_bf16 v[16:31], a[212:215], v[212:215], v[16:31]
    s_waitcnt lgkmcnt(5)
    ds_read_b128 a[244:247], v133 offset:25600
    buffer_load_dwordx4 v128, s[48:51], s23 offen offset:1024 lds
    v_exp_f32 v54, v54
    v_mfma_f32_32x32x16_bf16 v[16:31], a[216:219], v[216:219], v[16:31]
    ds_read_b128 a[248:251], v133 offset:26624
    v_add_f32 v113, v113, v52
    v_exp_f32 v55, v55
    v_add_f32 v113, v113, v53
    v_cvt_pk_bf16_f32 v106, v52, v53
    v_mfma_f32_32x32x16_bf16 v[16:31], a[220:223], v[220:223], v[16:31]
    s_waitcnt lgkmcnt(5)
    ds_read_b128 a[252:255], v133 offset:27648
    v_add_f32 v113, v113, v54
    v_add_f32 v113, v113, v55
    v_cvt_pk_bf16_f32 v107, v54, v55
    v_exp_f32 v56, v56
    v_mfma_f32_32x32x16_bf16 a[64:79], a[224:227], v[108:111], a[64:79]
    ds_read_b128 a[192:195], v134 offset:16384
    buffer_load_dwordx4 v128, s[48:51], s23 offen offset:2048 lds
    v_exp_f32 v57, v57
    v_mfma_f32_32x32x16_bf16 a[80:95], a[228:231], v[108:111], a[80:95]
    s_waitcnt lgkmcnt(5)
    ds_read_b128 a[196:199], v134 offset:17408
    v_exp_f32 v58, v58
    v_add_f32 v113, v113, v56
    v_exp_f32 v59, v59
    v_mfma_f32_32x32x16_bf16 a[96:111], a[232:235], v[108:111], a[96:111]
    ds_read_b128 a[200:203], v134 offset:18432
    buffer_load_dwordx4 v128, s[48:51], s23 offen offset:3072 lds
    v_add_f32 v113, v113, v57
    v_mfma_f32_32x32x16_bf16 a[112:127], a[236:239], v[108:111], a[112:127]
    s_waitcnt lgkmcnt(5)
    ds_read_b128 a[204:207], v134 offset:19456
    v_exp_f32 v60, v60
    v_add_f32 v113, v113, v58
    v_exp_f32 v61, v61
    v_mfma_f32_32x32x16_bf16 a[64:79], a[240:243], v[104:107], a[64:79]
    s_add_u32 s16, s16, 32768
    ds_read_b128 a[208:211], v134 offset:20480
    s_mov_b32 s20, s17
    v_add_f32 v113, v113, v59
    v_exp_f32 v62, v62
    v_mfma_f32_32x32x16_bf16 a[80:95], a[244:247], v[104:107], a[80:95]
    s_waitcnt lgkmcnt(5)
    ds_read_b128 a[212:215], v134 offset:21504
    s_add_u32 s17, s17, 32768
    s_cmp_eq_u32 s17, s21
    s_cselect_b32 s17, s18, s17
    v_add_f32 v113, v113, v60
    v_mov_b32 v132, v133
    v_mfma_f32_32x32x16_bf16 a[96:111], a[248:251], v[104:107], a[96:111]
    ds_read_b128 a[216:219], v134 offset:22528
    v_exp_f32 v63, v63
    v_mov_b32 v133, v134
    v_cvt_pk_bf16_f32 v108, v56, v57
    v_add_f32 v113, v113, v61
    v_mfma_f32_32x32x16_bf16 a[112:127], a[252:255], v[104:107], a[112:127]
    ds_read_b128 a[220:223], v134 offset:23552
    v_add_u32 v134, s19, v135
    s_mov_b32 s19, s20
    s_sub_u32 s22, s22, 1
    s_cmp_lg_u32 s22, 0
    v_cvt_pk_bf16_f32 v109, v58, v59
    v_add_f32 v113, v113, v62
    v_cvt_pk_bf16_f32 v110, v60, v61
    v_add_f32 v113, v113, v63
    v_cvt_pk_bf16_f32 v111, v62, v63
    s_cbranch_scc1 L_C_17
L_Cend_18:
    s_lshl_b32 s25, s13, 2
    s_sub_u32 s25, 60, s25
    s_add_u32 s24, s25, 0
    s_cmp_lt_u32 s24, s15
    s_cbranch_scc1 L_mskip_19
    s_cmp_gt_u32 s24, s15
    s_cbranch_scc1 L_mall_20
    v_cndmask_b32 v16, v16, v148, s[28:29]
    v_cndmask_b32 v17, v17, v148, s[30:31]
    v_cndmask_b32 v18, v18, v148, s[32:33]
    v_cndmask_b32 v19, v19, v148, s[34:35]
    v_cndmask_b32 v20, v20, v148, s[36:37]
    v_cndmask_b32 v21, v21, v148, s[38:39]
    v_cndmask_b32 v22, v22, v148, s[40:41]
    v_cndmask_b32 v23, v23, v148, s[42:43]
    v_cndmask_b32 v24, v24, v148, s[52:53]
    v_cndmask_b32 v25, v25, v148, s[54:55]
    v_cndmask_b32 v26, v26, v148, s[56:57]
    v_cndmask_b32 v27, v27, v148, s[58:59]
    v_cndmask_b32 v28, v28, v148, s[60:61]
    v_cndmask_b32 v29, v29, v148, s[62:63]
    v_cndmask_b32 v30, v30, v148, s[64:65]
    v_cndmask_b32 v31, v31, v148, s[66:67]
    s_branch L_mskip_19
L_mall_20:
    v_mov_b32 v16, v148
    v_mov_b32 v17, v148
    v_mov_b32 v18, v148
    v_mov_b32 v19, v148
    v_mov_b32 v20, v148
    v_mov_b32 v21, v148
    v_mov_b32 v22, v148
    v_mov_b32 v23, v148
    v_mov_b32 v24, v148
    v_mov_b32 v25, v148
    v_mov_b32 v26, v148
    v_mov_b32 v27, v148
    v_mov_b32 v28, v148
    v_mov_b32 v29, v148
    v_mov_b32 v30, v148
    v_mov_b32 v31, v148
L_mskip_19:
    s_waitcnt lgkmcnt(6)
    v_mfma_f32_32x32x16_bf16 v[48:63], a[192:195], v[192:195], v[80:95]
    ds_read_b128 a[224:227], v132 offset:28672
    v_exp_f32 v16, v16
    v_exp_f32 v17, v17
    v_mfma_f32_32x32x16_bf16 v[48:63], a[196:199], v[196:199], v[48:63]
    s_waitcnt lgkmcnt(5)
    ds_read_b128 a[228:231], v132 offset:29696
    s_waitcnt vmcnt(8)
    s_barrier
    v_mfma_f32_32x32x16_bf16 v[48:63], a[200:203], v[200:203], v[48:63]
    ds_read_b128 a[232:235], v132 offset:30720
    v_exp_f32 v18, v18
    v_add_f32 v113, v113, v16
    v_exp_f32 v19, v19
    v_mfma_f32_32x32x16_bf16 v[48:63], a[204:207], v[204:207], v[48:63]
    s_waitcnt lgkmcnt(5)
    ds_read_b128 a[236:239], v132 offset:31744
    s_add_u32 m0, s17, 0
    s_add_u32 s23, s16, 0
    buffer_load_dwordx4 v128, s[48:51], s23 offen lds
    v_mfma_f32_32x32x16_bf16 v[48:63], a[208:211], v[208:211], v[48:63]
    ds_read_b128 a[240:243], v133 offset:8192
    v_add_f32 v113, v113, v17
    v_cvt_pk_bf16_f32 v104, v16, v17
    v_exp_f32 v20, v20
    v_add_f32 v113, v113, v18
    v_mfma_f32_32x32x16_bf16 v[48:63], a[212:215], v[212:215], v[48:63]
    s_waitcnt lgkmcnt(5)
    ds_read_b128 a[244:247], v133 offset:9216
    v_exp_f32 v21, v21
    v_add_f32 v113, v113, v19
    v_cvt_pk_bf16_f32 v105, v18, v19
    v_mfma_f32_32x32x16_bf16 v[48:63], a[216:219], v[216:219], v[48:63]
    ds_read_b128 a[248:251], v133 offset:10240
    v_exp_f32 v22, v22
    v_add_f32 v113, v113, v20
    v_exp_f32 v23, v23
    v_mfma_f32_32x32x16_bf16 v[48:63], a[220:223], v[220:223], v[48:63]
    s_waitcnt lgkmcnt(5)
    ds_read_b128 a[252:255], v133 offset:11264
    buffer_load_dwordx4 v128, s[48:51], s23 offen offset:1024 lds
    v_add_f32 v113, v113, v21
    v_cvt_pk_bf16_f32 v106, v20, v21
    v_mfma_f32_32x32x16_bf16 a[64:79], a[224:227], v[108:111], a[64:79]
    ds_read_b128 a[192:195], v134 offset:0
    v_add_f32 v113, v113, v22
    v_add_f32 v113, v113, v23
    v_cvt_pk_bf16_f32 v107, v22, v23
    v_exp_f32 v24, v24
    v_mfma_f32_32x32x16_bf16 a[80:95], a[228:231], v[108:111], a[80:95]
    s_waitcnt lgkmcnt(5)
    ds_read_b128 a[196:199], v134 offset:1024
    buffer_load_dwordx4 v128, s[48:51], s23 offen offset:2048 lds
    v_exp_f32 v25, v25
    v_mfma_f32_32x32x16_bf16 a[96:111], a[232:235], v[108:111], a[96:111]
    ds_read_b128 a[200:203], v134 offset:2048
    v_exp_f32 v26, v26
    v_add_f32 v113, v113, v24
    v_exp_f32 v27, v27
    v_mfma_f32_32x32x16_bf16 a[112:127], a[236:239], v[108:111], a[112:127]
    s_waitcnt lgkmcnt(5)
    ds_read_b128 a[204:207], v134 offset:3072
    v_add_f32 v113, v113, v25
    v_exp_f32 v28, v28
    v_add_f32 v113, v113, v26
    v_mfma_f32_32x32x16_bf16 a[64:79], a[240:243], v[104:107], a[64:79]
    ds_read_b128 a[208:211], v134 offset:4096
    v_exp_f32 v29, v29
    v_add_f32 v113, v113, v27
    v_exp_f32 v30, v30
    v_mfma_f32_32x32x16_bf16 a[80:95], a[244:247], v[104:107], a[80:95]
    s_waitcnt lgkmcnt(5)
    ds_read_b128 a[212:215], v134 offset:5120
    buffer_load_dwordx4 v128, s[48:51], s23 offen offset:3072 lds
    v_add_f32 v113, v113, v28
    v_cvt_pk_bf16_f32 v108, v24, v25
    v_mfma_f32_32x32x16_bf16 a[96:111], a[248:251], v[104:107], a[96:111]
    ds_read_b128 a[216:219], v134 offset:6144
    v_exp_f32 v31, v31
    v_add_f32 v113, v113, v29
    v_cvt_pk_bf16_f32 v109, v26, v27
    v_add_f32 v113, v113, v30
    v_mfma_f32_32x32x16_bf16 a[112:127], a[252:255], v[104:107], a[112:127]
    ds_read_b128 a[220:223], v134 offset:7168
    v_cvt_pk_bf16_f32 v110, v28, v29
    v_add_f32 v113, v113, v31
    v_cvt_pk_bf16_f32 v111, v30, v31
    s_add_u32 s24, s25, 1
    s_cmp_lt_u32 s24, s15
    s_cbranch_scc1 L_mskip_21
    s_cmp_gt_u32 s24, s15
    s_cbranch_scc1 L_mall_22
    v_cndmask_b32 v48, v48, v148, s[28:29]
    v_cndmask_b32 v49, v49, v148, s[30:31]
    v_cndmask_b32 v50, v50, v148, s[32:33]
    v_cndmask_b32 v51, v51, v148, s[34:35]
    v_cndmask_b32 v52, v52, v148, s[36:37]
    v_cndmask_b32 v53, v53, v148, s[38:39]
    v_cndmask_b32 v54, v54, v148, s[40:41]
    v_cndmask_b32 v55, v55, v148, s[42:43]
    v_cndmask_b32 v56, v56, v148, s[52:53]
    v_cndmask_b32 v57, v57, v148, s[54:55]
    v_cndmask_b32 v58, v58, v148, s[56:57]
    v_cndmask_b32 v59, v59, v148, s[58:59]
    v_cndmask_b32 v60, v60, v148, s[60:61]
    v_cndmask_b32 v61, v61, v148, s[62:63]
    v_cndmask_b32 v62, v62, v148, s[64:65]
    v_cndmask_b32 v63, v63, v148, s[66:67]
    s_branch L_mskip_21
L_mall_22:
    v_mov_b32 v48, v148
    v_mov_b32 v49, v148
    v_mov_b32 v50, v148
    v_mov_b32 v51, v148
    v_mov_b32 v52, v148
    v_mov_b32 v53, v148
    v_mov_b32 v54, v148
    v_mov_b32 v55, v148
    v_mov_b32 v56, v148
    v_mov_b32 v57, v148
    v_mov_b32 v58, v148
    v_mov_b32 v59, v148
    v_mov_b32 v60, v148
    v_mov_b32 v61, v148
    v_mov_b32 v62, v148
    v_mov_b32 v63, v148
L_mskip_21:
    s_waitcnt lgkmcnt(6)
    v_mfma_f32_32x32x16_bf16 v[16:31], a[192:195], v[192:195], v[80:95]
    ds_read_b128 a[224:227], v133 offset:12288
    v_exp_f32 v48, v48
    v_exp_f32 v49, v49
    v_mfma_f32_32x32x16_bf16 v[16:31], a[196:199], v[196:199], v[16:31]
    s_waitcnt lgkmcnt(5)
    ds_read_b128 a[228:231], v133 offset:13312
    v_exp_f32 v50, v50
    v_add_f32 v113, v113, v48
    v_exp_f32 v51, v51
    v_mfma_f32_32x32x16_bf16 v[16:31], a[200:203], v[200:203], v[16:31]
    s_add_u32 m0, s17, 4096
    ds_read_b128 a[232:235], v133 offset:14336
    s_add_u32 s23, s16, 4096
    buffer_load_dwordx4 v128, s[48:51], s23 offen lds
    v_mfma_f32_32x32x16_bf16 v[16:31], a[204:207], v[204:207], v[16:31]
    s_waitcnt lgkmcnt(5)
    ds_read_b128 a[236:239], v133 offset:15360
    v_add_f32 v113, v113, v49
    v_cvt_pk_bf16_f32 v104, v48, v49
    v_exp_f32 v52, v52
    v_add_f32 v113, v113, v50
    v_mfma_f32_32x32x16_bf16 v[16:31], a[208:211], v[208:211], v[16:31]
    ds_read_b128 a[240:243], v133 offset:24576
    v_exp_f32 v53, v53
    v_add_f32 v113, v113, v51
    v_cvt_pk_bf16_f32 v105, v50, v51
    v_mfma_f32_32x32x16_bf16 v[16:31], a[212:215], v[212:215], v[16:31]
    s_waitcnt lgkmcnt(5)
    ds_read_b128 a[244:247], v133 offset:25600
    buffer_load_dwordx4 v128, s[48:51], s23 offen offset:1024 lds
    v_exp_f32 v54, v54
    v_mfma_f32_32x32x16_bf16 v[16:31], a[216:219], v[216:219], v[16:31]
    ds_read_b128 a[248:251], v133 offset:26624
    v_add_f32 v113, v113, v52
    v_exp_f32 v55, v55
    v_add_f32 v113, v113, v53
    v_cvt_pk_bf16_f32 v106, v52, v53
    v_mfma_f32_32x32x16_bf16 v[16:31], a[220:223], v[220:223], v[16:31]
    s_waitcnt lgkmcnt(5)
    ds_read_b128 a[252:255], v133 offset:27648
    v_add_f32 v113, v113, v54
    v_add_f32 v113, v113, v55
    v_cvt_pk_bf16_f32 v107, v54, v55
    v_exp_f32 v56, v56
    v_mfma_f32_32x32x16_bf16 a[64:79], a[224:227], v[108:111], a[64:79]
    ds_read_b128 a[192:195], v134 offset:16384
    buffer_load_dwordx4 v128, s[48:51], s23 offen offset:2048 lds
    v_exp_f32 v57, v57
    v_mfma_f32_32x32x16_bf16 a[80:95], a[228:231], v[108:111], a[80:95]
    s_waitcnt lgkmcnt(5)
    ds_read_b128 a[196:199], v134 offset:17408
    v_exp_f32 v58, v58
    v_add_f32 v113, v113, v56
    v_exp_f32 v59, v59
    v_mfma_f32_32x32x16_bf16 a[96:111], a[232:235], v[108:111], a[96:111]
    ds_read_b128 a[200:203], v134 offset:18432
    buffer_load_dwordx4 v128, s[48:51], s23 offen offset:3072 lds
    v_add_f32 v113, v113, v57
    v_mfma_f32_32x32x16_bf16 a[112:127], a[236:239], v[108:111], a[112:127]
    s_waitcnt lgkmcnt(5)
    ds_read_b128 a[204:207], v134 offset:19456
    v_exp_f32 v60, v60
    v_add_f32 v113, v113, v58
    v_exp_f32 v61, v61
    v_mfma_f32_32x32x16_bf16 a[64:79], a[240:243], v[104:107], a[64:79]
    s_add_u32 s16, s16, 32768
    ds_read_b128 a[208:211], v134 offset:20480
    s_mov_b32 s20, s17
    v_add_f32 v113, v113, v59
    v_exp_f32 v62, v62
    v_mfma_f32_32x32x16_bf16 a[80:95], a[244:247], v[104:107], a[80:95]
    s_waitcnt lgkmcnt(5)
    ds_read_b128 a[212:215], v134 offset:21504
    s_add_u32 s17, s17, 32768
    s_cmp_eq_u32 s17, s21
    s_cselect_b32 s17, s18, s17
    v_add_f32 v113, v113, v60
    v_mov_b32 v132, v133
    v_mfma_f32_32x32x16_bf16 a[96:111], a[248:251], v[104:107], a[96:111]
    ds_read_b128 a[216:219], v134 offset:22528
    v_exp_f32 v63, v63
    v_mov_b32 v133, v134
    v_cvt_pk_bf16_f32 v108, v56, v57
    v_add_f32 v113, v113, v61
    v_mfma_f32_32x32x16_bf16 a[112:127], a[252:255], v[104:107], a[112:127]
    ds_read_b128 a[220:223], v134 offset:23552
    v_add_u32 v134, s19, v135
    s_mov_b32 s19, s20
    s_add_u32 s25, s25, 2
    v_cvt_pk_bf16_f32 v109, v58, v59
    v_add_f32 v113, v113, v62
    v_cvt_pk_bf16_f32 v110, v60, v61
    v_add_f32 v113, v113, v63
    v_cvt_pk_bf16_f32 v111, v62, v63
    s_add_u32 s24, s25, 0
    s_cmp_lt_u32 s24, s15
    s_cbranch_scc1 L_mskip_23
    s_cmp_gt_u32 s24, s15
    s_cbranch_scc1 L_mall_24
    v_cndmask_b32 v16, v16, v148, s[28:29]
    v_cndmask_b32 v17, v17, v148, s[30:31]
    v_cndmask_b32 v18, v18, v148, s[32:33]
    v_cndmask_b32 v19, v19, v148, s[34:35]
    v_cndmask_b32 v20, v20, v148, s[36:37]
    v_cndmask_b32 v21, v21, v148, s[38:39]
    v_cndmask_b32 v22, v22, v148, s[40:41]
    v_cndmask_b32 v23, v23, v148, s[42:43]
    v_cndmask_b32 v24, v24, v148, s[52:53]
    v_cndmask_b32 v25, v25, v148, s[54:55]
    v_cndmask_b32 v26, v26, v148, s[56:57]
    v_cndmask_b32 v27, v27, v148, s[58:59]
    v_cndmask_b32 v28, v28, v148, s[60:61]
    v_cndmask_b32 v29, v29, v148, s[62:63]
    v_cndmask_b32 v30, v30, v148, s[64:65]
    v_cndmask_b32 v31, v31, v148, s[66:67]
    s_branch L_mskip_23
L_mall_24:
    v_mov_b32 v16, v148
    v_mov_b32 v17, v148
    v_mov_b32 v18, v148
    v_mov_b32 v19, v148
    v_mov_b32 v20, v148
    v_mov_b32 v21, v148
    v_mov_b32 v22, v148
    v_mov_b32 v23, v148
    v_mov_b32 v24, v148
    v_mov_b32 v25, v148
    v_mov_b32 v26, v148
    v_mov_b32 v27, v148
    v_mov_b32 v28, v148
    v_mov_b32 v29, v148
    v_mov_b32 v30, v148
    v_mov_b32 v31, v148
L_mskip_23:
    s_waitcnt lgkmcnt(6)
    v_mfma_f32_32x32x16_bf16 v[48:63], a[192:195], v[192:195], v[80:95]
    ds_read_b128 a[224:227], v132 offset:28672
    v_exp_f32 v16, v16
    v_exp_f32 v17, v17
    v_mfma_f32_32x32x16_bf16 v[48:63], a[196:199], v[196:199], v[48:63]
    s_waitcnt lgkmcnt(5)
    ds_read_b128 a[228:231], v132 offset:29696
    s_waitcnt vmcnt(8)
    s_barrier
    v_mfma_f32_32x32x16_bf16 v[48:63], a[200:203], v[200:203], v[48:63]
    ds_read_b128 a[232:235], v132 offset:30720
    v_exp_f32 v18, v18
    v_add_f32 v113, v113, v16
    v_exp_f32 v19, v19
    v_mfma_f32_32x32x16_bf16 v[48:63], a[204:207], v[204:207], v[48:63]
    s_waitcnt lgkmcnt(5)
    ds_read_b128 a[236:239], v132 offset:31744
    s_add_u32 m0, s17, 0
    s_add_u32 s23, s16, 0
    buffer_load_dwordx4 v128, s[48:51], s23 offen lds
    v_mfma_f32_32x32x16_bf16 v[48:63], a[208:211], v[208:211], v[48:63]
    ds_read_b128 a[240:243], v133 offset:8192
    v_add_f32 v113, v113, v17
    v_cvt_pk_bf16_f32 v104, v16, v17
    v_exp_f32 v20, v20
    v_add_f32 v113, v113, v18
    v_mfma_f32_32x32x16_bf16 v[48:63], a[212:215], v[212:215], v[48:63]
    s_waitcnt lgkmcnt(5)
    ds_read_b128 a[244:247], v133 offset:9216
    v_exp_f32 v21, v21
    v_add_f32 v113, v113, v19
    v_cvt_pk_bf16_f32 v105, v18, v19
    v_mfma_f32_32x32x16_bf16 v[48:63], a[216:219], v[216:219], v[48:63]
    ds_read_b128 a[248:251], v133 offset:10240
    v_exp_f32 v22, v22
    v_add_f32 v113, v113, v20
    v_exp_f32 v23, v23
    v_mfma_f32_32x32x16_bf16 v[48:63], a[220:223], v[220:223], v[48:63]
    s_waitcnt lgkmcnt(5)
    ds_read_b128 a[252:255], v133 offset:11264
    buffer_load_dwordx4 v128, s[48:51], s23 offen offset:1024 lds
    v_add_f32 v113, v113, v21
    v_cvt_pk_bf16_f32 v106, v20, v21
    v_mfma_f32_32x32x16_bf16 a[64:79], a[224:227], v[108:111], a[64:79]
    ds_read_b128 a[192:195], v134 offset:0
    v_add_f32 v113, v113, v22
    v_add_f32 v113, v113, v23
    v_cvt_pk_bf16_f32 v107, v22, v23
    v_exp_f32 v24, v24
    v_mfma_f32_32x32x16_bf16 a[80:95], a[228:231], v[108:111], a[80:95]
    s_waitcnt lgkmcnt(5)
    ds_read_b128 a[196:199], v134 offset:1024
    buffer_load_dwordx4 v128, s[48:51], s23 offen offset:2048 lds
    v_exp_f32 v25, v25
    v_mfma_f32_32x32x16_bf16 a[96:111], a[232:235], v[108:111], a[96:111]
    ds_read_b128 a[200:203], v134 offset:2048
    v_exp_f32 v26, v26
    v_add_f32 v113, v113, v24
    v_exp_f32 v27, v27
    v_mfma_f32_32x32x16_bf16 a[112:127], a[236:239], v[108:111], a[112:127]
    s_waitcnt lgkmcnt(5)
    ds_read_b128 a[204:207], v134 offset:3072
    v_add_f32 v113, v113, v25
    v_exp_f32 v28, v28
    v_add_f32 v113, v113, v26
    v_mfma_f32_32x32x16_bf16 a[64:79], a[240:243], v[104:107], a[64:79]
    ds_read_b128 a[208:211], v134 offset:4096
    v_exp_f32 v29, v29
    v_add_f32 v113, v113, v27
    v_exp_f32 v30, v30
    v_mfma_f32_32x32x16_bf16 a[80:95], a[244:247], v[104:107], a[80:95]
    s_waitcnt lgkmcnt(5)
    ds_read_b128 a[212:215], v134 offset:5120
    buffer_load_dwordx4 v128, s[48:51], s23 offen offset:3072 lds
    v_add_f32 v113, v113, v28
    v_cvt_pk_bf16_f32 v108, v24, v25
    v_mfma_f32_32x32x16_bf16 a[96:111], a[248:251], v[104:107], a[96:111]
    ds_read_b128 a[216:219], v134 offset:6144
    v_exp_f32 v31, v31
    v_add_f32 v113, v113, v29
    v_cvt_pk_bf16_f32 v109, v26, v27
    v_add_f32 v113, v113, v30
    v_mfma_f32_32x32x16_bf16 a[112:127], a[252:255], v[104:107], a[112:127]
    ds_read_b128 a[220:223], v134 offset:7168
    v_cvt_pk_bf16_f32 v110, v28, v29
    v_add_f32 v113, v113, v31
    v_cvt_pk_bf16_f32 v111, v30, v31
    s_add_u32 s24, s25, 1
    s_cmp_lt_u32 s24, s15
    s_cbranch_scc1 L_mskip_25
    s_cmp_gt_u32 s24, s15
    s_cbranch_scc1 L_mall_26
    v_cndmask_b32 v48, v48, v148, s[28:29]
    v_cndmask_b32 v49, v49, v148, s[30:31]
    v_cndmask_b32 v50, v50, v148, s[32:33]
    v_cndmask_b32 v51, v51, v148, s[34:35]
    v_cndmask_b32 v52, v52, v148, s[36:37]
    v_cndmask_b32 v53, v53, v148, s[38:39]
    v_cndmask_b32 v54, v54, v148, s[40:41]
    v_cndmask_b32 v55, v55, v148, s[42:43]
    v_cndmask_b32 v56, v56, v148, s[52:53]
    v_cndmask_b32 v57, v57, v148, s[54:55]
    v_cndmask_b32 v58, v58, v148, s[56:57]
    v_cndmask_b32 v59, v59, v148, s[58:59]
    v_cndmask_b32 v60, v60, v148, s[60:61]
    v_cndmask_b32 v61, v61, v148, s[62:63]
    v_cndmask_b32 v62, v62, v148, s[64:65]
    v_cndmask_b32 v63, v63, v148, s[66:67]
    s_branch L_mskip_25
L_mall_26:
    v_mov_b32 v48, v148
    v_mov_b32 v49, v148
    v_mov_b32 v50, v148
    v_mov_b32 v51, v148
    v_mov_b32 v52, v148
    v_mov_b32 v53, v148
    v_mov_b32 v54, v148
    v_mov_b32 v55, v148
    v_mov_b32 v56, v148
    v_mov_b32 v57, v148
    v_mov_b32 v58, v148
    v_mov_b32 v59, v148
    v_mov_b32 v60, v148
    v_mov_b32 v61, v148
    v_mov_b32 v62, v148
    v_mov_b32 v63, v148
L_mskip_25:
    ds_read_b128 a[224:227], v133 offset:12288
    ds_read_b128 a[228:231], v133 offset:13312
    ds_read_b128 a[232:235], v133 offset:14336
    ds_read_b128 a[236:239], v133 offset:15360
    ds_read_b128 a[240:243], v133 offset:24576
    ds_read_b128 a[244:247], v133 offset:25600
    ds_read_b128 a[248:251], v133 offset:26624
    ds_read_b128 a[252:255], v133 offset:27648
    s_waitcnt lgkmcnt(7)
    v_mfma_f32_32x32x16_bf16 a[64:79], a[224:227], v[108:111], a[64:79]
    s_waitcnt lgkmcnt(6)
    v_exp_f32 v48, v48
    v_exp_f32 v49, v49
    v_exp_f32 v50, v50
    v_mfma_f32_32x32x16_bf16 a[80:95], a[228:231], v[108:111], a[80:95]
    s_waitcnt lgkmcnt(5)
    s_add_u32 m0, s17, 4096
    s_add_u32 s23, s16, 4096
    buffer_load_dwordx4 v128, s[48:51], s23 offen lds
    v_add_f32 v113, v113, v48
    v_mfma_f32_32x32x16_bf16 a[96:111], a[232:235], v[108:111], a[96:111]
    s_waitcnt lgkmcnt(3)
    buffer_load_dwordx4 v128, s[48:51], s23 offen offset:1024 lds
    v_exp_f32 v51, v51
    v_add_f32 v113, v113, v49
    v_cvt_pk_bf16_f32 v104, v48, v49
    v_exp_f32 v52, v52
    v_add_f32 v113, v113, v50
    v_exp_f32 v53, v53
    v_add_f32 v113, v113, v51
    v_cvt_pk_bf16_f32 v105, v50, v51
    v_exp_f32 v54, v54
    v_add_f32 v113, v113, v52
    v_exp_f32 v55, v55
    v_add_f32 v113, v113, v53
    v_cvt_pk_bf16_f32 v106, v52, v53
    v_add_f32 v113, v113, v54
    v_add_f32 v113, v113, v55
    v_cvt_pk_bf16_f32 v107, v54, v55
    v_mfma_f32_32x32x16_bf16 a[112:127], a[236:239], v[108:111], a[112:127]
    buffer_load_dwordx4 v128, s[48:51], s23 offen offset:2048 lds
    v_exp_f32 v56, v56
    v_mfma_f32_32x32x16_bf16 a[64:79], a[240:243], v[104:107], a[64:79]
    s_waitcnt lgkmcnt(1)
    buffer_load_dwordx4 v128, s[48:51], s23 offen offset:3072 lds
    s_add_u32 s16, s16, 32768
    v_exp_f32 v57, v57
    v_mfma_f32_32x32x16_bf16 a[80:95], a[244:247], v[104:107], a[80:95]
    v_exp_f32 v58, v58
    v_add_f32 v113, v113, v56
    v_exp_f32 v59, v59
    v_add_f32 v113, v113, v57
    v_mfma_f32_32x32x16_bf16 a[96:111], a[248:251], v[104:107], a[96:111]
    s_waitcnt lgkmcnt(0)
    v_exp_f32 v60, v60
    v_add_f32 v113, v113, v58
    v_exp_f32 v61, v61
    v_add_f32 v113, v113, v59
    v_mfma_f32_32x32x16_bf16 a[112:127], a[252:255], v[104:107], a[112:127]
    s_mov_b32 s20, s17
    s_add_u32 s17, s17, 32768
    s_cmp_eq_u32 s17, s21
    s_cselect_b32 s17, s18, s17
    v_exp_f32 v62, v62
    v_add_f32 v113, v113, v60
    v_exp_f32 v63, v63
    v_mov_b32 v132, v133
    v_mov_b32 v133, v134
    v_cvt_pk_bf16_f32 v108, v56, v57
    v_add_f32 v113, v113, v61
    v_add_u32 v134, s19, v135
    s_mov_b32 s19, s20
    s_add_u32 s25, s25, 2
    v_cvt_pk_bf16_f32 v109, v58, v59
    v_add_f32 v113, v113, v62
    v_cvt_pk_bf16_f32 v110, v60, v61
    v_add_f32 v113, v113, v63
    v_cvt_pk_bf16_f32 v111, v62, v63
    s_waitcnt lgkmcnt(0)
    ds_read_b128 a[224:227], v132 offset:28672
    ds_read_b128 a[228:231], v132 offset:29696
    ds_read_b128 a[232:235], v132 offset:30720
    ds_read_b128 a[236:239], v132 offset:31744
    s_waitcnt lgkmcnt(0)
    v_mfma_f32_32x32x16_bf16 a[64:79], a[224:227], v[108:111], a[64:79]
    v_mfma_f32_32x32x16_bf16 a[80:95], a[228:231], v[108:111], a[80:95]
    v_mfma_f32_32x32x16_bf16 a[96:111], a[232:235], v[108:111], a[96:111]
    v_mfma_f32_32x32x16_bf16 a[112:127], a[236:239], v[108:111], a[112:127]
    v_mov_b32 v226, 0
    v_mov_b32 v227, 0
    v_mov_b32 v228, 0x7b800000
    s_mov_b64 s[28:29], 0
    v_mov_b32 v224, v112
    v_mov_b32 v225, v112
    s_nop 1
    v_permlane32_swap_b32 v224, v225
    s_nop 1
    v_add_f32 v224, v224, v225
    v_cmp_nlt_f32 vcc, v224, v228
    v_rcp_f32 v224, v224
    s_nop 2
    s_or_b64 s[28:29], s[28:29], vcc
    v_mov_b32 v225, v224
    v_accvgpr_read_b32 v64, a0
    v_accvgpr_read_b32 v65, a1
    v_accvgpr_read_b32 v66, a2
    v_accvgpr_read_b32 v67, a3
    v_accvgpr_read_b32 v68, a4
    v_accvgpr_read_b32 v69, a5
    v_accvgpr_read_b32 v70, a6
    v_accvgpr_read_b32 v71, a7
    v_accvgpr_read_b32 v72, a8
    v_accvgpr_read_b32 v73, a9
    v_accvgpr_read_b32 v74, a10
    v_accvgpr_read_b32 v75, a11
    v_accvgpr_read_b32 v76, a12
    v_accvgpr_read_b32 v77, a13
    v_accvgpr_read_b32 v78, a14
    v_accvgpr_read_b32 v79, a15
    v_pk_mul_f32 v[64:65], v[64:65], v[224:225]
    v_pk_mul_f32 v[66:67], v[66:67], v[224:225]
    v_pk_mul_f32 v[68:69], v[68:69], v[224:225]
    v_pk_mul_f32 v[70:71], v[70:71], v[224:225]
    v_pk_mul_f32 v[72:73], v[72:73], v[224:225]
    v_pk_mul_f32 v[74:75], v[74:75], v[224:225]
    v_pk_mul_f32 v[76:77], v[76:77], v[224:225]
    v_pk_mul_f32 v[78:79], v[78:79], v[224:225]
    v_pk_fma_f32 v[226:227], v[64:65], 0, v[226:227]
    v_pk_fma_f32 v[226:227], v[66:67], 0, v[226:227]
    v_pk_fma_f32 v[226:227], v[68:69], 0, v[226:227]
    v_pk_fma_f32 v[226:227], v[70:71], 0, v[226:227]
    v_pk_fma_f32 v[226:227], v[72:73], 0, v[226:227]
    v_pk_fma_f32 v[226:227], v[74:75], 0, v[226:227]
    v_pk_fma_f32 v[226:227], v[76:77], 0, v[226:227]
    v_pk_fma_f32 v[226:227], v[78:79], 0, v[226:227]
    v_cvt_pk_bf16_f32 v0, v64, v65
    v_cvt_pk_bf16_f32 v1, v66, v67
    v_cvt_pk_bf16_f32 v2, v68, v69
    v_cvt_pk_bf16_f32 v3, v70, v71
    v_cvt_pk_bf16_f32 v4, v72, v73
    v_cvt_pk_bf16_f32 v5, v74, v75
    v_cvt_pk_bf16_f32 v6, v76, v77
    v_cvt_pk_bf16_f32 v7, v78, v79
    v_accvgpr_read_b32 v64, a16
    v_accvgpr_read_b32 v65, a17
    v_accvgpr_read_b32 v66, a18
    v_accvgpr_read_b32 v67, a19
    v_accvgpr_read_b32 v68, a20
    v_accvgpr_read_b32 v69, a21
    v_accvgpr_read_b32 v70, a22
    v_accvgpr_read_b32 v71, a23
    v_accvgpr_read_b32 v72, a24
    v_accvgpr_read_b32 v73, a25
    v_accvgpr_read_b32 v74, a26
    v_accvgpr_read_b32 v75, a27
    v_accvgpr_read_b32 v76, a28
    v_accvgpr_read_b32 v77, a29
    v_accvgpr_read_b32 v78, a30
    v_accvgpr_read_b32 v79, a31
    v_pk_mul_f32 v[64:65], v[64:65], v[224:225]
    v_pk_mul_f32 v[66:67], v[66:67], v[224:225]
    v_pk_mul_f32 v[68:69], v[68:69], v[224:225]
    v_pk_mul_f32 v[70:71], v[70:71], v[224:225]
    v_pk_mul_f32 v[72:73], v[72:73], v[224:225]
    v_pk_mul_f32 v[74:75], v[74:75], v[224:225]
    v_pk_mul_f32 v[76:77], v[76:77], v[224:225]
    v_pk_mul_f32 v[78:79], v[78:79], v[224:225]
    v_pk_fma_f32 v[226:227], v[64:65], 0, v[226:227]
    v_pk_fma_f32 v[226:227], v[66:67], 0, v[226:227]
    v_pk_fma_f32 v[226:227], v[68:69], 0, v[226:227]
    v_pk_fma_f32 v[226:227], v[70:71], 0, v[226:227]
    v_pk_fma_f32 v[226:227], v[72:73], 0, v[226:227]
    v_pk_fma_f32 v[226:227], v[74:75], 0, v[226:227]
    v_pk_fma_f32 v[226:227], v[76:77], 0, v[226:227]
    v_pk_fma_f32 v[226:227], v[78:79], 0, v[226:227]
    v_cvt_pk_bf16_f32 v8, v64, v65
    v_cvt_pk_bf16_f32 v9, v66, v67
    v_cvt_pk_bf16_f32 v10, v68, v69
    v_cvt_pk_bf16_f32 v11, v70, v71
    v_cvt_pk_bf16_f32 v12, v72, v73
    v_cvt_pk_bf16_f32 v13, v74, v75
    v_cvt_pk_bf16_f32 v14, v76, v77
    v_cvt_pk_bf16_f32 v15, v78, v79
    v_accvgpr_read_b32 v64, a32
    v_accvgpr_read_b32 v65, a33
    v_accvgpr_read_b32 v66, a34
    v_accvgpr_read_b32 v67, a35
    v_accvgpr_read_b32 v68, a36
    v_accvgpr_read_b32 v69, a37
    v_accvgpr_read_b32 v70, a38
    v_accvgpr_read_b32 v71, a39
    v_accvgpr_read_b32 v72, a40
    v_accvgpr_read_b32 v73, a41
    v_accvgpr_read_b32 v74, a42
    v_accvgpr_read_b32 v75, a43
    v_accvgpr_read_b32 v76, a44
    v_accvgpr_read_b32 v77, a45
    v_accvgpr_read_b32 v78, a46
    v_accvgpr_read_b32 v79, a47
    v_pk_mul_f32 v[64:65], v[64:65], v[224:225]
    v_pk_mul_f32 v[66:67], v[66:67], v[224:225]
    v_pk_mul_f32 v[68:69], v[68:69], v[224:225]
    v_pk_mul_f32 v[70:71], v[70:71], v[224:225]
    v_pk_mul_f32 v[72:73], v[72:73], v[224:225]
    v_pk_mul_f32 v[74:75], v[74:75], v[224:225]
    v_pk_mul_f32 v[76:77], v[76:77], v[224:225]
    v_pk_mul_f32 v[78:79], v[78:79], v[224:225]
    v_pk_fma_f32 v[226:227], v[64:65], 0, v[226:227]
    v_pk_fma_f32 v[226:227], v[66:67], 0, v[226:227]
    v_pk_fma_f32 v[226:227], v[68:69], 0, v[226:227]
    v_pk_fma_f32 v[226:227], v[70:71], 0, v[226:227]
    v_pk_fma_f32 v[226:227], v[72:73], 0, v[226:227]
    v_pk_fma_f32 v[226:227], v[74:75], 0, v[226:227]
    v_pk_fma_f32 v[226:227], v[76:77], 0, v[226:227]
    v_pk_fma_f32 v[226:227], v[78:79], 0, v[226:227]
    v_cvt_pk_bf16_f32 v16, v64, v65
    v_cvt_pk_bf16_f32 v17, v66, v67
    v_cvt_pk_bf16_f32 v18, v68, v69
    v_cvt_pk_bf16_f32 v19, v70, v71
    v_cvt_pk_bf16_f32 v20, v72, v73
    v_cvt_pk_bf16_f32 v21, v74, v75
    v_cvt_pk_bf16_f32 v22, v76, v77
    v_cvt_pk_bf16_f32 v23, v78, v79
    v_accvgpr_read_b32 v64, a48
    v_accvgpr_read_b32 v65, a49
    v_accvgpr_read_b32 v66, a50
    v_accvgpr_read_b32 v67, a51
    v_accvgpr_read_b32 v68, a52
    v_accvgpr_read_b32 v69, a53
    v_accvgpr_read_b32 v70, a54
    v_accvgpr_read_b32 v71, a55
    v_accvgpr_read_b32 v72, a56
    v_accvgpr_read_b32 v73, a57
    v_accvgpr_read_b32 v74, a58
    v_accvgpr_read_b32 v75, a59
    v_accvgpr_read_b32 v76, a60
    v_accvgpr_read_b32 v77, a61
    v_accvgpr_read_b32 v78, a62
    v_accvgpr_read_b32 v79, a63
    v_pk_mul_f32 v[64:65], v[64:65], v[224:225]
    v_pk_mul_f32 v[66:67], v[66:67], v[224:225]
    v_pk_mul_f32 v[68:69], v[68:69], v[224:225]
    v_pk_mul_f32 v[70:71], v[70:71], v[224:225]
    v_pk_mul_f32 v[72:73], v[72:73], v[224:225]
    v_pk_mul_f32 v[74:75], v[74:75], v[224:225]
    v_pk_mul_f32 v[76:77], v[76:77], v[224:225]
    v_pk_mul_f32 v[78:79], v[78:79], v[224:225]
    v_pk_fma_f32 v[226:227], v[64:65], 0, v[226:227]
    v_pk_fma_f32 v[226:227], v[66:67], 0, v[226:227]
    v_pk_fma_f32 v[226:227], v[68:69], 0, v[226:227]
    v_pk_fma_f32 v[226:227], v[70:71], 0, v[226:227]
    v_pk_fma_f32 v[226:227], v[72:73], 0, v[226:227]
    v_pk_fma_f32 v[226:227], v[74:75], 0, v[226:227]
    v_pk_fma_f32 v[226:227], v[76:77], 0, v[226:227]
    v_pk_fma_f32 v[226:227], v[78:79], 0, v[226:227]
    v_cvt_pk_bf16_f32 v24, v64, v65
    v_cvt_pk_bf16_f32 v25, v66, v67
    v_cvt_pk_bf16_f32 v26, v68, v69
    v_cvt_pk_bf16_f32 v27, v70, v71
    v_cvt_pk_bf16_f32 v28, v72, v73
    v_cvt_pk_bf16_f32 v29, v74, v75
    v_cvt_pk_bf16_f32 v30, v76, v77
    v_cvt_pk_bf16_f32 v31, v78, v79
    v_mov_b32 v224, v113
    v_mov_b32 v225, v113
    s_nop 1
    v_permlane32_swap_b32 v224, v225
    s_nop 1
    v_add_f32 v224, v224, v225
    v_cmp_nlt_f32 vcc, v224, v228
    v_rcp_f32 v224, v224
    s_nop 2
    s_or_b64 s[28:29], s[28:29], vcc
    v_mov_b32 v225, v224
    v_accvgpr_read_b32 v64, a64
    v_accvgpr_read_b32 v65, a65
    v_accvgpr_read_b32 v66, a66
    v_accvgpr_read_b32 v67, a67
    v_accvgpr_read_b32 v68, a68
    v_accvgpr_read_b32 v69, a69
    v_accvgpr_read_b32 v70, a70
    v_accvgpr_read_b32 v71, a71
    v_accvgpr_read_b32 v72, a72
    v_accvgpr_read_b32 v73, a73
    v_accvgpr_read_b32 v74, a74
    v_accvgpr_read_b32 v75, a75
    v_accvgpr_read_b32 v76, a76
    v_accvgpr_read_b32 v77, a77
    v_accvgpr_read_b32 v78, a78
    v_accvgpr_read_b32 v79, a79
    v_pk_mul_f32 v[64:65], v[64:65], v[224:225]
    v_pk_mul_f32 v[66:67], v[66:67], v[224:225]
    v_pk_mul_f32 v[68:69], v[68:69], v[224:225]
    v_pk_mul_f32 v[70:71], v[70:71], v[224:225]
    v_pk_mul_f32 v[72:73], v[72:73], v[224:225]
    v_pk_mul_f32 v[74:75], v[74:75], v[224:225]
    v_pk_mul_f32 v[76:77], v[76:77], v[224:225]
    v_pk_mul_f32 v[78:79], v[78:79], v[224:225]
    v_pk_fma_f32 v[226:227], v[64:65], 0, v[226:227]
    v_pk_fma_f32 v[226:227], v[66:67], 0, v[226:227]
    v_pk_fma_f32 v[226:227], v[68:69], 0, v[226:227]
    v_pk_fma_f32 v[226:227], v[70:71], 0, v[226:227]
    v_pk_fma_f32 v[226:227], v[72:73], 0, v[226:227]
    v_pk_fma_f32 v[226:227], v[74:75], 0, v[226:227]
    v_pk_fma_f32 v[226:227], v[76:77], 0, v[226:227]
    v_pk_fma_f32 v[226:227], v[78:79], 0, v[226:227]
    v_cvt_pk_bf16_f32 v32, v64, v65
    v_cvt_pk_bf16_f32 v33, v66, v67
    v_cvt_pk_bf16_f32 v34, v68, v69
    v_cvt_pk_bf16_f32 v35, v70, v71
    v_cvt_pk_bf16_f32 v36, v72, v73
    v_cvt_pk_bf16_f32 v37, v74, v75
    v_cvt_pk_bf16_f32 v38, v76, v77
    v_cvt_pk_bf16_f32 v39, v78, v79
    v_accvgpr_read_b32 v64, a80
    v_accvgpr_read_b32 v65, a81
    v_accvgpr_read_b32 v66, a82
    v_accvgpr_read_b32 v67, a83
    v_accvgpr_read_b32 v68, a84
    v_accvgpr_read_b32 v69, a85
    v_accvgpr_read_b32 v70, a86
    v_accvgpr_read_b32 v71, a87
    v_accvgpr_read_b32 v72, a88
    v_accvgpr_read_b32 v73, a89
    v_accvgpr_read_b32 v74, a90
    v_accvgpr_read_b32 v75, a91
    v_accvgpr_read_b32 v76, a92
    v_accvgpr_read_b32 v77, a93
    v_accvgpr_read_b32 v78, a94
    v_accvgpr_read_b32 v79, a95
    v_pk_mul_f32 v[64:65], v[64:65], v[224:225]
    v_pk_mul_f32 v[66:67], v[66:67], v[224:225]
    v_pk_mul_f32 v[68:69], v[68:69], v[224:225]
    v_pk_mul_f32 v[70:71], v[70:71], v[224:225]
    v_pk_mul_f32 v[72:73], v[72:73], v[224:225]
    v_pk_mul_f32 v[74:75], v[74:75], v[224:225]
    v_pk_mul_f32 v[76:77], v[76:77], v[224:225]
    v_pk_mul_f32 v[78:79], v[78:79], v[224:225]
    v_pk_fma_f32 v[226:227], v[64:65], 0, v[226:227]
    v_pk_fma_f32 v[226:227], v[66:67], 0, v[226:227]
    v_pk_fma_f32 v[226:227], v[68:69], 0, v[226:227]
    v_pk_fma_f32 v[226:227], v[70:71], 0, v[226:227]
    v_pk_fma_f32 v[226:227], v[72:73], 0, v[226:227]
    v_pk_fma_f32 v[226:227], v[74:75], 0, v[226:227]
    v_pk_fma_f32 v[226:227], v[76:77], 0, v[226:227]
    v_pk_fma_f32 v[226:227], v[78:79], 0, v[226:227]
    v_cvt_pk_bf16_f32 v40, v64, v65
    v_cvt_pk_bf16_f32 v41, v66, v67
    v_cvt_pk_bf16_f32 v42, v68, v69
    v_cvt_pk_bf16_f32 v43, v70, v71
    v_cvt_pk_bf16_f32 v44, v72, v73
    v_cvt_pk_bf16_f32 v45, v74, v75
    v_cvt_pk_bf16_f32 v46, v76, v77
    v_cvt_pk_bf16_f32 v47, v78, v79
    v_accvgpr_read_b32 v64, a96
    v_accvgpr_read_b32 v65, a97
    v_accvgpr_read_b32 v66, a98
    v_accvgpr_read_b32 v67, a99
    v_accvgpr_read_b32 v68, a100
    v_accvgpr_read_b32 v69, a101
    v_accvgpr_read_b32 v70, a102
    v_accvgpr_read_b32 v71, a103
    v_accvgpr_read_b32 v72, a104
    v_accvgpr_read_b32 v73, a105
    v_accvgpr_read_b32 v74, a106
    v_accvgpr_read_b32 v75, a107
    v_accvgpr_read_b32 v76, a108
    v_accvgpr_read_b32 v77, a109
    v_accvgpr_read_b32 v78, a110
    v_accvgpr_read_b32 v79, a111
    v_pk_mul_f32 v[64:65], v[64:65], v[224:225]
    v_pk_mul_f32 v[66:67], v[66:67], v[224:225]
    v_pk_mul_f32 v[68:69], v[68:69], v[224:225]
    v_pk_mul_f32 v[70:71], v[70:71], v[224:225]
    v_pk_mul_f32 v[72:73], v[72:73], v[224:225]
    v_pk_mul_f32 v[74:75], v[74:75], v[224:225]
    v_pk_mul_f32 v[76:77], v[76:77], v[224:225]
    v_pk_mul_f32 v[78:79], v[78:79], v[224:225]
    v_pk_fma_f32 v[226:227], v[64:65], 0, v[226:227]
    v_pk_fma_f32 v[226:227], v[66:67], 0, v[226:227]
    v_pk_fma_f32 v[226:227], v[68:69], 0, v[226:227]
    v_pk_fma_f32 v[226:227], v[70:71], 0, v[226:227]
    v_pk_fma_f32 v[226:227], v[72:73], 0, v[226:227]
    v_pk_fma_f32 v[226:227], v[74:75], 0, v[226:227]
    v_pk_fma_f32 v[226:227], v[76:77], 0, v[226:227]
    v_pk_fma_f32 v[226:227], v[78:79], 0, v[226:227]
    v_cvt_pk_bf16_f32 v48, v64, v65
    v_cvt_pk_bf16_f32 v49, v66, v67
    v_cvt_pk_bf16_f32 v50, v68, v69
    v_cvt_pk_bf16_f32 v51, v70, v71
    v_cvt_pk_bf16_f32 v52, v72, v73
    v_cvt_pk_bf16_f32 v53, v74, v75
    v_cvt_pk_bf16_f32 v54, v76, v77
    v_cvt_pk_bf16_f32 v55, v78, v79
    v_accvgpr_read_b32 v64, a112
    v_accvgpr_read_b32 v65, a113
    v_accvgpr_read_b32 v66, a114
    v_accvgpr_read_b32 v67, a115
    v_accvgpr_read_b32 v68, a116
    v_accvgpr_read_b32 v69, a117
    v_accvgpr_read_b32 v70, a118
    v_accvgpr_read_b32 v71, a119
    v_accvgpr_read_b32 v72, a120
    v_accvgpr_read_b32 v73, a121
    v_accvgpr_read_b32 v74, a122
    v_accvgpr_read_b32 v75, a123
    v_accvgpr_read_b32 v76, a124
    v_accvgpr_read_b32 v77, a125
    v_accvgpr_read_b32 v78, a126
    v_accvgpr_read_b32 v79, a127
    v_pk_mul_f32 v[64:65], v[64:65], v[224:225]
    v_pk_mul_f32 v[66:67], v[66:67], v[224:225]
    v_pk_mul_f32 v[68:69], v[68:69], v[224:225]
    v_pk_mul_f32 v[70:71], v[70:71], v[224:225]
    v_pk_mul_f32 v[72:73], v[72:73], v[224:225]
    v_pk_mul_f32 v[74:75], v[74:75], v[224:225]
    v_pk_mul_f32 v[76:77], v[76:77], v[224:225]
    v_pk_mul_f32 v[78:79], v[78:79], v[224:225]
    v_pk_fma_f32 v[226:227], v[64:65], 0, v[226:227]
    v_pk_fma_f32 v[226:227], v[66:67], 0, v[226:227]
    v_pk_fma_f32 v[226:227], v[68:69], 0, v[226:227]
    v_pk_fma_f32 v[226:227], v[70:71], 0, v[226:227]
    v_pk_fma_f32 v[226:227], v[72:73], 0, v[226:227]
    v_pk_fma_f32 v[226:227], v[74:75], 0, v[226:227]
    v_pk_fma_f32 v[226:227], v[76:77], 0, v[226:227]
    v_pk_fma_f32 v[226:227], v[78:79], 0, v[226:227]
    v_cvt_pk_bf16_f32 v56, v64, v65
    v_cvt_pk_bf16_f32 v57, v66, v67
    v_cvt_pk_bf16_f32 v58, v68, v69
    v_cvt_pk_bf16_f32 v59, v70, v71
    v_cvt_pk_bf16_f32 v60, v72, v73
    v_cvt_pk_bf16_f32 v61, v74, v75
    v_cvt_pk_bf16_f32 v62, v76, v77
    v_cvt_pk_bf16_f32 v63, v78, v79
    v_add_f32 v226, v226, v227
    v_cmp_u_f32 vcc, v226, v226
    s_nop 3
    s_or_b64 s[28:29], s[28:29], vcc
    s_cmp_lg_u64 s[28:29], 0
    s_cselect_b32 s23, 1, 0
    s_lshl_b32 s24, s3, 2
    s_add_u32 s24, s24, 131072
    v_mov_b32 v230, s24
    v_mov_b32 v231, s23
    ds_write_b32 v230, v231
    s_lshl_b32 s23, s14, 8
    s_lshl_b32 s24, s12, 3
    s_add_u32 s23, s23, s24
    s_lshl_b32 s23, s23, 10
    s_add_u32 s23, s23, 50331648
    buffer_store_dwordx4 v[0:3], v128, s[8:11], s23 offen offset:0 sc1
    buffer_store_dwordx4 v[4:7], v128, s[8:11], s23 offen offset:1024 sc1
    buffer_store_dwordx4 v[8:11], v128, s[8:11], s23 offen offset:2048 sc1
    buffer_store_dwordx4 v[12:15], v128, s[8:11], s23 offen offset:3072 sc1
    s_add_u32 s23, s23, 4096
    buffer_store_dwordx4 v[16:19], v128, s[8:11], s23 offen offset:0 sc1
    buffer_store_dwordx4 v[20:23], v128, s[8:11], s23 offen offset:1024 sc1
    buffer_store_dwordx4 v[24:27], v128, s[8:11], s23 offen offset:2048 sc1
    buffer_store_dwordx4 v[28:31], v128, s[8:11], s23 offen offset:3072 sc1
    s_lshl_b32 s23, s15, 8
    s_lshl_b32 s24, s12, 3
    s_add_u32 s23, s23, s24
    s_lshl_b32 s23, s23, 10
    s_add_u32 s23, s23, 50331648
    buffer_store_dwordx4 v[32:35], v128, s[8:11], s23 offen offset:0 sc1
    buffer_store_dwordx4 v[36:39], v128, s[8:11], s23 offen offset:1024 sc1
    buffer_store_dwordx4 v[40:43], v128, s[8:11], s23 offen offset:2048 sc1
    buffer_store_dwordx4 v[44:47], v128, s[8:11], s23 offen offset:3072 sc1
    s_add_u32 s23, s23, 4096
    buffer_store_dwordx4 v[48:51], v128, s[8:11], s23 offen offset:0 sc1
    buffer_store_dwordx4 v[52:55], v128, s[8:11], s23 offen offset:1024 sc1
    buffer_store_dwordx4 v[56:59], v128, s[8:11], s23 offen offset:2048 sc1
    buffer_store_dwordx4 v[60:63], v128, s[8:11], s23 offen offset:3072 sc1
    s_getpc_b64 s[74:75]
L_pc_k2a:
    s_add_u32 s74, s74, k3_kernel-L_pc_k2a
    s_addc_u32 s75, s75, 0
    s_lshr_b32 s73, s2, 3
    s_and_b32 s73, s73, 31
    s_lshl_b32 s73, s73, 2
    s_add_u32 s73, s73, s3
    s_cmp_ge_u32 s73, (L_text_end-k3_kernel)>>10
    s_cbranch_scc1 L_npc_k2a
    s_lshl_b32 s73, s73, 10
    v_add_u32 v251, s73, v128
    global_load_dwordx4 v[252:255], v251, s[74:75]
L_npc_k2a:
    s_waitcnt lgkmcnt(0)
    s_barrier
    v_mov_b32 v230, 131072
    ds_read_b128 v[232:235], v230
    s_waitcnt lgkmcnt(0)
    v_or_b32 v232, v232, v233
    v_or3_b32 v232, v232, v234, v235
    s_nop 0
    v_readfirstlane_b32 s23, v232
    s_nop 3
    s_cmp_eq_u32 s23, 0
    s_cbranch_scc1 L_A_ok
    s_cmp_lg_u32 s27, 0
    s_cbranch_scc1 L_A_ok
    s_waitcnt vmcnt(0)
    s_barrier
    v_lshlrev_b32 v224, 3, v131
    v_sub_u32 v224, v130, v224
    v_cmp_gt_i32 s[28:29], 0, v224
    v_cmp_gt_i32 s[30:31], 1, v224
    v_cmp_gt_i32 s[32:33], 2, v224
    v_cmp_gt_i32 s[34:35], 3, v224
    v_cmp_gt_i32 s[36:37], 4, v224
    v_cmp_gt_i32 s[38:39], 5, v224
    v_cmp_gt_i32 s[40:41], 6, v224
    v_cmp_gt_i32 s[42:43], 7, v224
    v_cmp_gt_i32 s[52:53], 16, v224
    v_cmp_gt_i32 s[54:55], 17, v224
    v_cmp_gt_i32 s[56:57], 18, v224
    v_cmp_gt_i32 s[58:59], 19, v224
    v_cmp_gt_i32 s[60:61], 20, v224
    v_cmp_gt_i32 s[62:63], 21, v224
    v_cmp_gt_i32 s[64:65], 22, v224
    v_cmp_gt_i32 s[66:67], 23, v224
    v_mov_b32 v236, v148
    v_mov_b32 v237, v148
    s_lshl_b32 s16, s12, 20
    s_lshl_b32 s23, s3, 13
    s_add_u32 s16, s16, s23
    s_add_u32 s16, s16, 16777216
    s_add_u32 s17, s23, 131072
    s_add_u32 s19, s23, 32768
    v_add_u32 v133, 131072, v128
    s_mov_b32 s25, 0
    s_lshl_b32 s22, s13, 1
    s_sub_u32 s22, 32, s22
L_A_fbloop:
    s_add_u32 m0, s17, 0
    s_add_u32 s23, s16, 0
    buffer_load_dwordx4 v128, s[48:51], s23 offen lds
    buffer_load_dwordx4 v128, s[48:51], s23 offen offset:1024 lds
    buffer_load_dwordx4 v128, s[48:51], s23 offen offset:2048 lds
    buffer_load_dwordx4 v128, s[48:51], s23 offen offset:3072 lds
    s_add_u32 m0, s17, 4096
    s_add_u32 s23, s16, 4096
    buffer_load_dwordx4 v128, s[48:51], s23 offen lds
    buffer_load_dwordx4 v128, s[48:51], s23 offen offset:1024 lds
    buffer_load_dwordx4 v128, s[48:51], s23 offen offset:2048 lds
    buffer_load_dwordx4 v128, s[48:51], s23 offen offset:3072 lds
    s_add_u32 s16, s16, 32768
    s_waitcnt vmcnt(0)
    s_barrier
    ds_read_b128 a[192:195], v133 offset:0
    ds_read_b128 a[196:199], v133 offset:1024
    ds_read_b128 a[200:203], v133 offset:2048
    ds_read_b128 a[204:207], v133 offset:3072
    ds_read_b128 a[208:211], v133 offset:4096
    ds_read_b128 a[212:215], v133 offset:5120
    ds_read_b128 a[216:219], v133 offset:6144
    ds_read_b128 a[220:223], v133 offset:7168
    s_waitcnt lgkmcnt(0)
    v_mfma_f32_32x32x16_bf16 v[0:15], a[192:195], v[160:163], 0
    v_mfma_f32_32x32x16_bf16 v[16:31], a[192:195], v[192:195], 0
    v_mfma_f32_32x32x16_bf16 v[0:15], a[196:199], v[164:167], v[0:15]
    v_mfma_f32_32x32x16_bf16 v[16:31], a[196:199], v[196:199], v[16:31]
    v_mfma_f32_32x32x16_bf16 v[0:15], a[200:203], v[168:171], v[0:15]
    v_mfma_f32_32x32x16_bf16 v[16:31], a[200:203], v[200:203], v[16:31]
    v_mfma_f32_32x32x16_bf16 v[0:15], a[204:207], v[172:175], v[0:15]
    v_mfma_f32_32x32x16_bf16 v[16:31], a[204:207], v[204:207], v[16:31]
    v_mfma_f32_32x32x16_bf16 v[0:15], a[208:211], v[176:179], v[0:15]
    v_mfma_f32_32x32x16_bf16 v[16:31], a[208:211], v[208:211], v[16:31]
    v_mfma_f32_32x32x16_bf16 v[0:15], a[212:215], v[180:183], v[0:15]
    v_mfma_f32_32x32x16_bf16 v[16:31], a[212:215], v[212:215], v[16:31]
    v_mfma_f32_32x32x16_bf16 v[0:15], a[216:219], v[184:187], v[0:15]
    v_mfma_f32_32x32x16_bf16 v[16:31], a[216:219], v[216:219], v[16:31]
    v_mfma_f32_32x32x16_bf16 v[0:15], a[220:223], v[188:191], v[0:15]
    v_mfma_f32_32x32x16_bf16 v[16:31], a[220:223], v[220:223], v[16:31]
    s_nop 7
    s_nop 7
    s_add_u32 s24, s25, 0
    s_cmp_lt_u32 s24, s14
    s_cbranch_scc1 L_mskip_27
    s_cmp_gt_u32 s24, s14
    s_cbranch_scc1 L_mall_28
    v_cndmask_b32 v0, v0, v148, s[28:29]
    v_cndmask_b32 v1, v1, v148, s[30:31]
    v_cndmask_b32 v2, v2, v148, s[32:33]
    v_cndmask_b32 v3, v3, v148, s[34:35]
    v_cndmask_b32 v4, v4, v148, s[36:37]
    v_cndmask_b32 v5, v5, v148, s[38:39]
    v_cndmask_b32 v6, v6, v148, s[40:41]
    v_cndmask_b32 v7, v7, v148, s[42:43]
    v_cndmask_b32 v8, v8, v148, s[52:53]
    v_cndmask_b32 v9, v9, v148, s[54:55]
    v_cndmask_b32 v10, v10, v148, s[56:57]
    v_cndmask_b32 v11, v11, v148, s[58:59]
    v_cndmask_b32 v12, v12, v148, s[60:61]
    v_cndmask_b32 v13, v13, v148, s[62:63]
    v_cndmask_b32 v14, v14, v148, s[64:65]
    v_cndmask_b32 v15, v15, v148, s[66:67]
    s_branch L_mskip_27
L_mall_28:
    v_mov_b32 v0, v148
    v_mov_b32 v1, v148
    v_mov_b32 v2, v148
    v_mov_b32 v3, v148
    v_mov_b32 v4, v148
    v_mov_b32 v5, v148
    v_mov_b32 v6, v148
    v_mov_b32 v7, v148
    v_mov_b32 v8, v148
    v_mov_b32 v9, v148
    v_mov_b32 v10, v148
    v_mov_b32 v11, v148
    v_mov_b32 v12, v148
    v_mov_b32 v13, v148
    v_mov_b32 v14, v148
    v_mov_b32 v15, v148
L_mskip_27:
    s_add_u32 s24, s25, 0
    s_cmp_lt_u32 s24, s15
    s_cbranch_scc1 L_mskip_29
    s_cmp_gt_u32 s24, s15
    s_cbranch_scc1 L_mall_30
    v_cndmask_b32 v16, v16, v148, s[28:29]
    v_cndmask_b32 v17, v17, v148, s[30:31]
    v_cndmask_b32 v18, v18, v148, s[32:33]
    v_cndmask_b32 v19, v19, v148, s[34:35]
    v_cndmask_b32 v20, v20, v148, s[36:37]
    v_cndmask_b32 v21, v21, v148, s[38:39]
    v_cndmask_b32 v22, v22, v148, s[40:41]
    v_cndmask_b32 v23, v23, v148, s[42:43]
    v_cndmask_b32 v24, v24, v148, s[52:53]
    v_cndmask_b32 v25, v25, v148, s[54:55]
    v_cndmask_b32 v26, v26, v148, s[56:57]
    v_cndmask_b32 v27, v27, v148, s[58:59]
    v_cndmask_b32 v28, v28, v148, s[60:61]
    v_cndmask_b32 v29, v29, v148, s[62:63]
    v_cndmask_b32 v30, v30, v148, s[64:65]
    v_cndmask_b32 v31, v31, v148, s[66:67]
    s_branch L_mskip_29
L_mall_30:
    v_mov_b32 v16, v148
    v_mov_b32 v17, v148
    v_mov_b32 v18, v148
    v_mov_b32 v19, v148
    v_mov_b32 v20, v148
    v_mov_b32 v21, v148
    v_mov_b32 v22, v148
    v_mov_b32 v23, v148
    v_mov_b32 v24, v148
    v_mov_b32 v25, v148
    v_mov_b32 v26, v148
    v_mov_b32 v27, v148
    v_mov_b32 v28, v148
    v_mov_b32 v29, v148
    v_mov_b32 v30, v148
    v_mov_b32 v31, v148
L_mskip_29:
    v_max3_f32 v236, v236, v0, v1
    v_max3_f32 v236, v236, v2, v3
    v_max3_f32 v236, v236, v4, v5
    v_max3_f32 v236, v236, v6, v7
    v_max3_f32 v236, v236, v8, v9
    v_max3_f32 v236, v236, v10, v11
    v_max3_f32 v236, v236, v12, v13
    v_max3_f32 v236, v236, v14, v15
    v_max3_f32 v237, v237, v16, v17
    v_max3_f32 v237, v237, v18, v19
    v_max3_f32 v237, v237, v20, v21
    v_max3_f32 v237, v237, v22, v23
    v_max3_f32 v237, v237, v24, v25
    v_max3_f32 v237, v237, v26, v27
    v_max3_f32 v237, v237, v28, v29
    v_max3_f32 v237, v237, v30, v31
    ds_read_b128 a[192:195], v133 offset:16384
    ds_read_b128 a[196:199], v133 offset:17408
    ds_read_b128 a[200:203], v133 offset:18432
    ds_read_b128 a[204:207], v133 offset:19456
    ds_read_b128 a[208:211], v133 offset:20480
    ds_read_b128 a[212:215], v133 offset:21504
    ds_read_b128 a[216:219], v133 offset:22528
    ds_read_b128 a[220:223], v133 offset:23552
    s_waitcnt lgkmcnt(0)
    v_mfma_f32_32x32x16_bf16 v[0:15], a[192:195], v[160:163], 0
    v_mfma_f32_32x32x16_bf16 v[16:31], a[192:195], v[192:195], 0
    v_mfma_f32_32x32x16_bf16 v[0:15], a[196:199], v[164:167], v[0:15]
    v_mfma_f32_32x32x16_bf16 v[16:31], a[196:199], v[196:199], v[16:31]
    v_mfma_f32_32x32x16_bf16 v[0:15], a[200:203], v[168:171], v[0:15]
    v_mfma_f32_32x32x16_bf16 v[16:31], a[200:203], v[200:203], v[16:31]
    v_mfma_f32_32x32x16_bf16 v[0:15], a[204:207], v[172:175], v[0:15]
    v_mfma_f32_32x32x16_bf16 v[16:31], a[204:207], v[204:207], v[16:31]
    v_mfma_f32_32x32x16_bf16 v[0:15], a[208:211], v[176:179], v[0:15]
    v_mfma_f32_32x32x16_bf16 v[16:31], a[208:211], v[208:211], v[16:31]
    v_mfma_f32_32x32x16_bf16 v[0:15], a[212:215], v[180:183], v[0:15]
    v_mfma_f32_32x32x16_bf16 v[16:31], a[212:215], v[212:215], v[16:31]
    v_mfma_f32_32x32x16_bf16 v[0:15], a[216:219], v[184:187], v[0:15]
    v_mfma_f32_32x32x16_bf16 v[16:31], a[216:219], v[216:219], v[16:31]
    v_mfma_f32_32x32x16_bf16 v[0:15], a[220:223], v[188:191], v[0:15]
    v_mfma_f32_32x32x16_bf16 v[16:31], a[220:223], v[220:223], v[16:31]
    s_nop 7
    s_nop 7
    s_add_u32 s24, s25, 1
    s_cmp_lt_u32 s24, s14
    s_cbranch_scc1 L_mskip_31
    s_cmp_gt_u32 s24, s14
    s_cbranch_scc1 L_mall_32
    v_cndmask_b32 v0, v0, v148, s[28:29]
    v_cndmask_b32 v1, v1, v148, s[30:31]
    v_cndmask_b32 v2, v2, v148, s[32:33]
    v_cndmask_b32 v3, v3, v148, s[34:35]
    v_cndmask_b32 v4, v4, v148, s[36:37]
    v_cndmask_b32 v5, v5, v148, s[38:39]
    v_cndmask_b32 v6, v6, v148, s[40:41]
    v_cndmask_b32 v7, v7, v148, s[42:43]
    v_cndmask_b32 v8, v8, v148, s[52:53]
    v_cndmask_b32 v9, v9, v148, s[54:55]
    v_cndmask_b32 v10, v10, v148, s[56:57]
    v_cndmask_b32 v11, v11, v148, s[58:59]
    v_cndmask_b32 v12, v12, v148, s[60:61]
    v_cndmask_b32 v13, v13, v148, s[62:63]
    v_cndmask_b32 v14, v14, v148, s[64:65]
    v_cndmask_b32 v15, v15, v148, s[66:67]
    s_branch L_mskip_31
L_mall_32:
    v_mov_b32 v0, v148
    v_mov_b32 v1, v148
    v_mov_b32 v2, v148
    v_mov_b32 v3, v148
    v_mov_b32 v4, v148
    v_mov_b32 v5, v148
    v_mov_b32 v6, v148
    v_mov_b32 v7, v148
    v_mov_b32 v8, v148
    v_mov_b32 v9, v148
    v_mov_b32 v10, v148
    v_mov_b32 v11, v148
    v_mov_b32 v12, v148
    v_mov_b32 v13, v148
    v_mov_b32 v14, v148
    v_mov_b32 v15, v148
L_mskip_31:
    s_add_u32 s24, s25, 1
    s_cmp_lt_u32 s24, s15
    s_cbranch_scc1 L_mskip_33
    s_cmp_gt_u32 s24, s15
    s_cbranch_scc1 L_mall_34
    v_cndmask_b32 v16, v16, v148, s[28:29]
    v_cndmask_b32 v17, v17, v148, s[30:31]
    v_cndmask_b32 v18, v18, v148, s[32:33]
    v_cndmask_b32 v19, v19, v148, s[34:35]
    v_cndmask_b32 v20, v20, v148, s[36:37]
    v_cndmask_b32 v21, v21, v148, s[38:39]
    v_cndmask_b32 v22, v22, v148, s[40:41]
    v_cndmask_b32 v23, v23, v148, s[42:43]
    v_cndmask_b32 v24, v24, v148, s[52:53]
    v_cndmask_b32 v25, v25, v148, s[54:55]
    v_cndmask_b32 v26, v26, v148, s[56:57]
    v_cndmask_b32 v27, v27, v148, s[58:59]
    v_cndmask_b32 v28, v28, v148, s[60:61]
    v_cndmask_b32 v29, v29, v148, s[62:63]
    v_cndmask_b32 v30, v30, v148, s[64:65]
    v_cndmask_b32 v31, v31, v148, s[66:67]
    s_branch L_mskip_33
L_mall_34:
    v_mov_b32 v16, v148
    v_mov_b32 v17, v148
    v_mov_b32 v18, v148
    v_mov_b32 v19, v148
    v_mov_b32 v20, v148
    v_mov_b32 v21, v148
    v_mov_b32 v22, v148
    v_mov_b32 v23, v148
    v_mov_b32 v24, v148
    v_mov_b32 v25, v148
    v_mov_b32 v26, v148
    v_mov_b32 v27, v148
    v_mov_b32 v28, v148
    v_mov_b32 v29, v148
    v_mov_b32 v30, v148
    v_mov_b32 v31, v148
L_mskip_33:
    v_max3_f32 v236, v236, v0, v1
    v_max3_f32 v236, v236, v2, v3
    v_max3_f32 v236, v236, v4, v5
    v_max3_f32 v236, v236, v6, v7
    v_max3_f32 v236, v236, v8, v9
    v_max3_f32 v236, v236, v10, v11
    v_max3_f32 v236, v236, v12, v13
    v_max3_f32 v236, v236, v14, v15
    v_max3_f32 v237, v237, v16, v17
    v_max3_f32 v237, v237, v18, v19
    v_max3_f32 v237, v237, v20, v21
    v_max3_f32 v237, v237, v22, v23
    v_max3_f32 v237, v237, v24, v25
    v_max3_f32 v237, v237, v26, v27
    v_max3_f32 v237, v237, v28, v29
    v_max3_f32 v237, v237, v30, v31
    s_add_u32 s25, s25, 2
    s_barrier
    s_sub_u32 s22, s22, 1
    s_cmp_lg_u32 s22, 0
    s_cbranch_scc1 L_A_fbloop
    v_mov_b32 v224, v236
    v_mov_b32 v225, v236
    s_nop 1
    v_permlane32_swap_b32 v224, v225
    s_nop 1
    v_max_f32 v224, v224, v225
    v_sub_f32 v64, 0, v224
    v_sub_f32 v65, 0, v224
    v_sub_f32 v66, 0, v224
    v_sub_f32 v67, 0, v224
    v_sub_f32 v68, 0, v224
    v_sub_f32 v69, 0, v224
    v_sub_f32 v70, 0, v224
    v_sub_f32 v71, 0, v224
    v_sub_f32 v72, 0, v224
    v_sub_f32 v73, 0, v224
    v_sub_f32 v74, 0, v224
    v_sub_f32 v75, 0, v224
    v_sub_f32 v76, 0, v224
    v_sub_f32 v77, 0, v224
    v_sub_f32 v78, 0, v224
    v_sub_f32 v79, 0, v224
    v_mov_b32 v224, v237
    v_mov_b32 v225, v237
    s_nop 1
    v_permlane32_swap_b32 v224, v225
    s_nop 1
    v_max_f32 v224, v224, v225
    v_sub_f32 v80, 0, v224
    v_sub_f32 v81, 0, v224
    v_sub_f32 v82, 0, v224
    v_sub_f32 v83, 0, v224
    v_sub_f32 v84, 0, v224
    v_sub_f32 v85, 0, v224
    v_sub_f32 v86, 0, v224
    v_sub_f32 v87, 0, v224
    v_sub_f32 v88, 0, v224
    v_sub_f32 v89, 0, v224
    v_sub_f32 v90, 0, v224
    v_sub_f32 v91, 0, v224
    v_sub_f32 v92, 0, v224
    v_sub_f32 v93, 0, v224
    v_sub_f32 v94, 0, v224
    v_sub_f32 v95, 0, v224
    s_lshl_b32 s16, s12, 20
    s_lshl_b32 s23, s3, 13
    s_add_u32 s16, s16, s23
    s_add_u32 s16, s16, 16777216
    s_add_u32 s17, s23, 131072
    s_add_u32 s19, s23, 32768
    s_add_u32 m0, s17, 0
    s_add_u32 s23, s16, 0
    buffer_load_dwordx4 v128, s[48:51], s23 offen lds
    buffer_load_dwordx4 v128, s[48:51], s23 offen offset:1024 lds
    buffer_load_dwordx4 v128, s[48:51], s23 offen offset:2048 lds
    buffer_load_dwordx4 v128, s[48:51], s23 offen offset:3072 lds
    s_add_u32 m0, s17, 4096
    s_add_u32 s23, s16, 4096
    buffer_load_dwordx4 v128, s[48:51], s23 offen lds
    buffer_load_dwordx4 v128, s[48:51], s23 offen offset:1024 lds
    buffer_load_dwordx4 v128, s[48:51], s23 offen offset:2048 lds
    buffer_load_dwordx4 v128, s[48:51], s23 offen offset:3072 lds
    s_add_u32 s16, s16, 32768
    s_mov_b32 s20, s17
    s_add_u32 s17, s17, 32768
    s_cmp_eq_u32 s17, s21
    s_cselect_b32 s17, s18, s17
    s_add_u32 m0, s17, 0
    s_add_u32 s23, s16, 0
    buffer_load_dwordx4 v128, s[48:51], s23 offen lds
    buffer_load_dwordx4 v128, s[48:51], s23 offen offset:1024 lds
    buffer_load_dwordx4 v128, s[48:51], s23 offen offset:2048 lds
    buffer_load_dwordx4 v128, s[48:51], s23 offen offset:3072 lds
    s_add_u32 m0, s17, 4096
    s_add_u32 s23, s16, 4096
    buffer_load_dwordx4 v128, s[48:51], s23 offen lds
    buffer_load_dwordx4 v128, s[48:51], s23 offen offset:1024 lds
    buffer_load_dwordx4 v128, s[48:51], s23 offen offset:2048 lds
    buffer_load_dwordx4 v128, s[48:51], s23 offen offset:3072 lds
    s_add_u32 s16, s16, 32768
    s_mov_b32 s20, s17
    s_add_u32 s17, s17, 32768
    s_cmp_eq_u32 s17, s21
    s_cselect_b32 s17, s18, s17
    s_add_u32 m0, s17, 0
    s_add_u32 s23, s16, 0
    buffer_load_dwordx4 v128, s[48:51], s23 offen lds
    buffer_load_dwordx4 v128, s[48:51], s23 offen offset:1024 lds
    buffer_load_dwordx4 v128, s[48:51], s23 offen offset:2048 lds
    buffer_load_dwordx4 v128, s[48:51], s23 offen offset:3072 lds
    s_add_u32 m0, s17, 4096
    s_add_u32 s23, s16, 4096
    buffer_load_dwordx4 v128, s[48:51], s23 offen lds
    buffer_load_dwordx4 v128, s[48:51], s23 offen offset:1024 lds
    buffer_load_dwordx4 v128, s[48:51], s23 offen offset:2048 lds
    buffer_load_dwordx4 v128, s[48:51], s23 offen offset:3072 lds
    s_add_u32 s16, s16, 32768
    s_mov_b32 s20, s17
    s_add_u32 s17, s17, 32768
    s_cmp_eq_u32 s17, s21
    s_cselect_b32 s17, s18, s17
    v_accvgpr_write_b32 a0, 0
    v_accvgpr_write_b32 a1, 0
    v_accvgpr_write_b32 a2, 0
    v_accvgpr_write_b32 a3, 0
    v_accvgpr_write_b32 a4, 0
    v_accvgpr_write_b32 a5, 0
    v_accvgpr_write_b32 a6, 0
    v_accvgpr_write_b32 a7, 0
    v_accvgpr_write_b32 a8, 0
    v_accvgpr_write_b32 a9, 0
    v_accvgpr_write_b32 a10, 0
    v_accvgpr_write_b32 a11, 0
    v_accvgpr_write_b32 a12, 0
    v_accvgpr_write_b32 a13, 0
    v_accvgpr_write_b32 a14, 0
    v_accvgpr_write_b32 a15, 0
    v_accvgpr_write_b32 a16, 0
    v_accvgpr_write_b32 a17, 0
    v_accvgpr_write_b32 a18, 0
    v_accvgpr_write_b32 a19, 0
    v_accvgpr_write_b32 a20, 0
    v_accvgpr_write_b32 a21, 0
    v_accvgpr_write_b32 a22, 0
    v_accvgpr_write_b32 a23, 0
    v_accvgpr_write_b32 a24, 0
    v_accvgpr_write_b32 a25, 0
    v_accvgpr_write_b32 a26, 0
    v_accvgpr_write_b32 a27, 0
    v_accvgpr_write_b32 a28, 0
    v_accvgpr_write_b32 a29, 0
    v_accvgpr_write_b32 a30, 0
    v_accvgpr_write_b32 a31, 0
    v_accvgpr_write_b32 a32, 0
    v_accvgpr_write_b32 a33, 0
    v_accvgpr_write_b32 a34, 0
    v_accvgpr_write_b32 a35, 0
    v_accvgpr_write_b32 a36, 0
    v_accvgpr_write_b32 a37, 0
    v_accvgpr_write_b32 a38, 0
    v_accvgpr_write_b32 a39, 0
    v_accvgpr_write_b32 a40, 0
    v_accvgpr_write_b32 a41, 0
    v_accvgpr_write_b32 a42, 0
    v_accvgpr_write_b32 a43, 0
    v_accvgpr_write_b32 a44, 0
    v_accvgpr_write_b32 a45, 0
    v_accvgpr_write_b32 a46, 0
    v_accvgpr_write_b32 a47, 0
    v_accvgpr_write_b32 a48, 0
    v_accvgpr_write_b32 a49, 0
    v_accvgpr_write_b32 a50, 0
    v_accvgpr_write_b32 a51, 0
    v_accvgpr_write_b32 a52, 0
    v_accvgpr_write_b32 a53, 0
    v_accvgpr_write_b32 a54, 0
    v_accvgpr_write_b32 a55, 0
    v_accvgpr_write_b32 a56, 0
    v_accvgpr_write_b32 a57, 0
    v_accvgpr_write_b32 a58, 0
    v_accvgpr_write_b32 a59, 0
    v_accvgpr_write_b32 a60, 0
    v_accvgpr_write_b32 a61, 0
    v_accvgpr_write_b32 a62, 0
    v_accvgpr_write_b32 a63, 0
    v_accvgpr_write_b32 a64, 0
    v_accvgpr_write_b32 a65, 0
    v_accvgpr_write_b32 a66, 0
    v_accvgpr_write_b32 a67, 0
    v_accvgpr_write_b32 a68, 0
    v_accvgpr_write_b32 a69, 0
    v_accvgpr_write_b32 a70, 0
    v_accvgpr_write_b32 a71, 0
    v_accvgpr_write_b32 a72, 0
    v_accvgpr_write_b32 a73, 0
    v_accvgpr_write_b32 a74, 0
    v_accvgpr_write_b32 a75, 0
    v_accvgpr_write_b32 a76, 0
    v_accvgpr_write_b32 a77, 0
    v_accvgpr_write_b32 a78, 0
    v_accvgpr_write_b32 a79, 0
    v_accvgpr_write_b32 a80, 0
    v_accvgpr_write_b32 a81, 0
    v_accvgpr_write_b32 a82, 0
    v_accvgpr_write_b32 a83, 0
    v_accvgpr_write_b32 a84, 0
    v_accvgpr_write_b32 a85, 0
    v_accvgpr_write_b32 a86, 0
    v_accvgpr_write_b32 a87, 0
    v_accvgpr_write_b32 a88, 0
    v_accvgpr_write_b32 a89, 0
    v_accvgpr_write_b32 a90, 0
    v_accvgpr_write_b32 a91, 0
    v_accvgpr_write_b32 a92, 0
    v_accvgpr_write_b32 a93, 0
    v_accvgpr_write_b32 a94, 0
    v_accvgpr_write_b32 a95, 0
    v_accvgpr_write_b32 a96, 0
    v_accvgpr_write_b32 a97, 0
    v_accvgpr_write_b32 a98, 0
    v_accvgpr_write_b32 a99, 0
    v_accvgpr_write_b32 a100, 0
    v_accvgpr_write_b32 a101, 0
    v_accvgpr_write_b32 a102, 0
    v_accvgpr_write_b32 a103, 0
    v_accvgpr_write_b32 a104, 0
    v_accvgpr_write_b32 a105, 0
    v_accvgpr_write_b32 a106, 0
    v_accvgpr_write_b32 a107, 0
    v_accvgpr_write_b32 a108, 0
    v_accvgpr_write_b32 a109, 0
    v_accvgpr_write_b32 a110, 0
    v_accvgpr_write_b32 a111, 0
    v_accvgpr_write_b32 a112, 0
    v_accvgpr_write_b32 a113, 0
    v_accvgpr_write_b32 a114, 0
    v_accvgpr_write_b32 a115, 0
    v_accvgpr_write_b32 a116, 0
    v_accvgpr_write_b32 a117, 0
    v_accvgpr_write_b32 a118, 0
    v_accvgpr_write_b32 a119, 0
    v_accvgpr_write_b32 a120, 0
    v_accvgpr_write_b32 a121, 0
    v_accvgpr_write_b32 a122, 0
    v_accvgpr_write_b32 a123, 0
    v_accvgpr_write_b32 a124, 0
    v_accvgpr_write_b32 a125, 0
    v_accvgpr_write_b32 a126, 0
    v_accvgpr_write_b32 a127, 0
    v_mov_b32 v96, 0
    v_mov_b32 v97, 0
    v_mov_b32 v98, 0
    v_mov_b32 v99, 0
    v_mov_b32 v100, 0
    v_mov_b32 v101, 0
    v_mov_b32 v102, 0
    v_mov_b32 v103, 0
    v_mov_b32 v104, 0
    v_mov_b32 v105, 0
    v_mov_b32 v106, 0
    v_mov_b32 v107, 0
    v_mov_b32 v108, 0
    v_mov_b32 v109, 0
    v_mov_b32 v110, 0
    v_mov_b32 v111, 0
    v_mov_b32 v112, 0
    v_mov_b32 v140, 0
    v_mov_b32 v113, 0
    v_mov_b32 v141, 0
    v_mov_b32 v114, 0
    v_mov_b32 v142, 0
    v_mov_b32 v115, 0
    v_mov_b32 v143, 0
    v_add_u32 v132, 131072, v128
    v_add_u32 v133, 131072, v128
    v_mov_b32 v134, v128
    s_mov_b32 s25, 0
    s_mov_b32 s27, 1
    s_waitcnt vmcnt(16)
    s_barrier
    ds_read_b128 a[192:195], v133 offset:0
    ds_read_b128 a[196:199], v133 offset:1024
    ds_read_b128 a[200:203], v133 offset:2048
    ds_read_b128 a[204:207], v133 offset:3072
    ds_read_b128 a[208:211], v133 offset:4096
    ds_read_b128 a[212:215], v133 offset:5120
    ds_read_b128 a[216:219], v133 offset:6144
    ds_read_b128 a[220:223], v133 offset:7168
    s_waitcnt lgkmcnt(0)
    v_mfma_f32_32x32x16_bf16 v[0:15], a[192:195], v[160:163], v[64:79]
    v_mfma_f32_32x32x16_bf16 v[16:31], a[192:195], v[192:195], v[80:95]
    v_mfma_f32_32x32x16_bf16 v[0:15], a[196:199], v[164:167], v[0:15]
    v_mfma_f32_32x32x16_bf16 v[16:31], a[196:199], v[196:199], v[16:31]
    v_mfma_f32_32x32x16_bf16 v[0:15], a[200:203], v[168:171], v[0:15]
    v_mfma_f32_32x32x16_bf16 v[16:31], a[200:203], v[200:203], v[16:31]
    v_mfma_f32_32x32x16_bf16 v[0:15], a[204:207], v[172:175], v[0:15]
    v_mfma_f32_32x32x16_bf16 v[16:31], a[204:207], v[204:207], v[16:31]
    v_mfma_f32_32x32x16_bf16 v[0:15], a[208:211], v[176:179], v[0:15]
    v_mfma_f32_32x32x16_bf16 v[16:31], a[208:211], v[208:211], v[16:31]
    v_mfma_f32_32x32x16_bf16 v[0:15], a[212:215], v[180:183], v[0:15]
    v_mfma_f32_32x32x16_bf16 v[16:31], a[212:215], v[212:215], v[16:31]
    v_mfma_f32_32x32x16_bf16 v[0:15], a[216:219], v[184:187], v[0:15]
    v_mfma_f32_32x32x16_bf16 v[16:31], a[216:219], v[216:219], v[16:31]
    v_mfma_f32_32x32x16_bf16 v[0:15], a[220:223], v[188:191], v[0:15]
    v_mfma_f32_32x32x16_bf16 v[16:31], a[220:223], v[220:223], v[16:31]
    s_nop 7
    s_nop 7
    s_add_u32 s24, s25, 0
    s_cmp_lt_u32 s24, s14
    s_cbranch_scc1 L_mskip_35
    s_cmp_gt_u32 s24, s14
    s_cbranch_scc1 L_mall_36
    v_cndmask_b32 v0, v0, v148, s[28:29]
    v_cndmask_b32 v1, v1, v148, s[30:31]
    v_cndmask_b32 v2, v2, v148, s[32:33]
    v_cndmask_b32 v3, v3, v148, s[34:35]
    v_cndmask_b32 v4, v4, v148, s[36:37]
    v_cndmask_b32 v5, v5, v148, s[38:39]
    v_cndmask_b32 v6, v6, v148, s[40:41]
    v_cndmask_b32 v7, v7, v148, s[42:43]
    v_cndmask_b32 v8, v8, v148, s[52:53]
    v_cndmask_b32 v9, v9, v148, s[54:55]
    v_cndmask_b32 v10, v10, v148, s[56:57]
    v_cndmask_b32 v11, v11, v148, s[58:59]
    v_cndmask_b32 v12, v12, v148, s[60:61]
    v_cndmask_b32 v13, v13, v148, s[62:63]
    v_cndmask_b32 v14, v14, v148, s[64:65]
    v_cndmask_b32 v15, v15, v148, s[66:67]
    s_branch L_mskip_35
L_mall_36:
    v_mov_b32 v0, v148
    v_mov_b32 v1, v148
    v_mov_b32 v2, v148
    v_mov_b32 v3, v148
    v_mov_b32 v4, v148
    v_mov_b32 v5, v148
    v_mov_b32 v6, v148
    v_mov_b32 v7, v148
    v_mov_b32 v8, v148
    v_mov_b32 v9, v148
    v_mov_b32 v10, v148
    v_mov_b32 v11, v148
    v_mov_b32 v12, v148
    v_mov_b32 v13, v148
    v_mov_b32 v14, v148
    v_mov_b32 v15, v148
L_mskip_35:
    ds_read_b128 a[192:195], v133 offset:16384
    ds_read_b128 a[196:199], v133 offset:17408
    ds_read_b128 a[200:203], v133 offset:18432
    ds_read_b128 a[204:207], v133 offset:19456
    ds_read_b128 a[208:211], v133 offset:20480
    ds_read_b128 a[212:215], v133 offset:21504
    ds_read_b128 a[216:219], v133 offset:22528
    ds_read_b128 a[220:223], v133 offset:23552
    s_branch L_A_main
L_A_ok:
L_attn_end:
    s_waitcnt vmcnt(0)
L_proj_exit:
    s_endpgm
.text
.globl k3_kernel
.p2align 8
.type k3_kernel,@function
k3_kernel:
    s_cmp_ge_u32 s2, 512
    s_cbranch_scc1 L_k3_exit
    s_cmp_ge_u32 s2, 256
    s_cbranch_scc1 L_k3_hi
    s_load_dwordx2 s[32:33], s[0:1], 88
    s_load_dwordx2 s[34:35], s[0:1], 64
    v_and_b32 v126, 63, v0
    v_lshrrev_b32 v1, 6, v0
    v_lshlrev_b32 v112, 4, v126
    v_readfirstlane_b32 s3, v1
    v_lshrrev_b32 v115, 5, v126
    s_waitcnt lgkmcnt(0)
    s_mov_b32 s8, s32
    s_mov_b32 s9, s33
    s_mov_b32 s10, 0x10000000
    s_mov_b32 s11, 0x00020000
    s_mov_b32 s40, s34
    s_mov_b32 s41, s35
    s_mov_b32 s42, 0xa2000
    s_mov_b32 s43, 0x00020000
    s_lshr_b32 s47, s2, 3
    s_and_b32 s47, s47, 31
    s_lshl_b32 s47, s47, 2
    s_add_u32 s47, s47, s3
    s_lshl_b32 s47, s47, 10
    s_sub_u32 s48, s2, 0
    s_and_b32 s49, s48, 7
    s_lshl_b32 s49, s49, 2
    s_bfe_u32 s50, s48, 0x20003
    s_add_u32 s49, s49, s50
    s_lshr_b32 s48, s48, 5
    s_lshl_b32 s48, s48, 5
    s_add_u32 s48, s48, s49
    s_lshl_b32 s48, s48, 7
    s_add_u32 s48, s48, 92274688
    v_mov_b32 v2, 0
    buffer_load_dword a84, v2, s[8:11], s48 offen sc1
    s_and_b32 s50, s2, 7
    s_lshl_b32 s50, s50, 12
    s_add_u32 s50, s50, 92274688
    v_and_b32 v2, 31, v126
    v_lshlrev_b32 v2, 7, v2
    buffer_load_dword a85, v2, s[8:11], s50 offen sc1
    s_sub_u32 s13, s2, 0
    s_and_b32 s23, s13, 7
    s_lshl_b32 s12, s23, 2
    s_bfe_u32 s23, s13, 0x20003
    s_add_u32 s12, s12, s23
    s_lshr_b32 s13, s13, 5
    s_lshl_b32 s23, s13, 3
    s_lshl_b32 s24, s3, 1
    s_add_u32 s23, s23, s24
    s_mul_i32 s23, s23, 1280
    s_mul_i32 s16, s12, 81920
    s_add_u32 s23, s23, s16
    s_add_u32 s23, s23, 67108864
    s_mul_i32 s24, s3, 3072
    s_add_u32 m0, s24, 54272
    s_mul_i32 s24, s3, 2560
    buffer_load_dwordx4 v112, s[8:11], s23 offen offset:0 lds
    buffer_load_dwordx4 v112, s[8:11], s23 offen offset:1024 lds
    buffer_load_dwordx4 v112, s[8:11], s23 offen offset:2048 lds
    s_mul_i32 s16, s12, 81920
    s_mul_i32 s24, s3, 2560
    s_add_u32 s16, s16, s24
    s_add_u32 s16, s16, 71303168
    s_mov_b32 s18, s24
    s_lshl_b32 s17, s12, 17
    s_lshl_b32 s23, s3, 12
    s_add_u32 s17, s17, s23
    s_add_u32 s17, s17, 75497472
    s_add_u32 s21, s23, 10752
    s_mov_b32 m0, s18
    s_nop 0
    buffer_load_dwordx4 v112, s[8:11], s16 offen lds
    buffer_load_dwordx4 v112, s[8:11], s16 offen offset:1024 lds
    buffer_load_dwordx4 v112, s[8:11], s16 offen offset:2048 lds
    s_mov_b32 m0, s21
    s_nop 0
    buffer_load_dwordx4 v112, s[8:11], s17 offen lds
    buffer_load_dwordx4 v112, s[8:11], s17 offen offset:1024 lds
    buffer_load_dwordx4 v112, s[8:11], s17 offen offset:2048 lds
    buffer_load_dwordx4 v112, s[8:11], s17 offen offset:3072 lds
    s_add_u32 s16, s16, 10240
    s_add_u32 s17, s17, 16384
    s_add_u32 s18, s18, 27136
    s_add_u32 s21, s21, 27136
    s_cmp_ge_u32 s18, 81408
    s_cselect_b32 s24, 81408, 0
    s_sub_u32 s18, s18, s24
    s_sub_u32 s21, s21, s24
    s_mov_b32 m0, s18
    s_nop 0
    buffer_load_dwordx4 v112, s[8:11], s16 offen lds
    buffer_load_dwordx4 v112, s[8:11], s16 offen offset:1024 lds
    buffer_load_dwordx4 v112, s[8:11], s16 offen offset:2048 lds
    s_mov_b32 m0, s21
    s_nop 0
    buffer_load_dwordx4 v112, s[8:11], s17 offen lds
    buffer_load_dwordx4 v112, s[8:11], s17 offen offset:1024 lds
    buffer_load_dwordx4 v112, s[8:11], s17 offen offset:2048 lds
    buffer_load_dwordx4 v112, s[8:11], s17 offen offset:3072 lds
    s_add_u32 s16, s16, 10240
    s_add_u32 s17, s17, 16384
    s_add_u32 s18, s18, 27136
    s_add_u32 s21, s21, 27136
    s_cmp_ge_u32 s18, 81408
    s_cselect_b32 s24, 81408, 0
    s_sub_u32 s18, s18, s24
    s_sub_u32 s21, s21, s24
    v_bfe_u32 v0, v126, 2, 2
    v_bfe_u32 v1, v126, 4, 1
    v_lshlrev_b32 v1, 5, v1
    v_and_b32 v2, 1, v126
    v_lshl_add_u32 v1, v2, 4, v1
    v_bfe_u32 v2, v126, 1, 1
    v_lshl_add_u32 v1, v2, 3, v1
    v_lshl_add_u32 v2, v115, 3, v0
    v_lshl_add_u32 v113, v2, 6, v1
    v_and_b32 v2, 1, v0
    v_add_u32 v2, 16, v2
    v_lshl_add_u32 v121, v2, 6, v1
    v_accvgpr_write_b32 a0, 0
    v_accvgpr_write_b32 a1, 0
    v_accvgpr_write_b32 a2, 0
    v_accvgpr_write_b32 a3, 0
    v_accvgpr_write_b32 a4, 0
    v_accvgpr_write_b32 a5, 0
    v_accvgpr_write_b32 a6, 0
    v_accvgpr_write_b32 a7, 0
    v_accvgpr_write_b32 a8, 0
    v_accvgpr_write_b32 a9, 0
    v_accvgpr_write_b32 a10, 0
    v_accvgpr_write_b32 a11, 0
    v_accvgpr_write_b32 a12, 0
    v_accvgpr_write_b32 a13, 0
    v_accvgpr_write_b32 a14, 0
    v_accvgpr_write_b32 a15, 0
    v_accvgpr_write_b32 a16, 0
    v_accvgpr_write_b32 a17, 0
    v_accvgpr_write_b32 a18, 0
    v_accvgpr_write_b32 a19, 0
    v_accvgpr_write_b32 a20, 0
    v_accvgpr_write_b32 a21, 0
    v_accvgpr_write_b32 a22, 0
    v_accvgpr_write_b32 a23, 0
    v_accvgpr_write_b32 a24, 0
    v_accvgpr_write_b32 a25, 0
    v_accvgpr_write_b32 a26, 0
    v_accvgpr_write_b32 a27, 0
    v_accvgpr_write_b32 a28, 0
    v_accvgpr_write_b32 a29, 0
    v_accvgpr_write_b32 a30, 0
    v_accvgpr_write_b32 a31, 0
    v_mov_b32 v96, 0
    v_mov_b32 v97, 0
    v_mov_b32 v98, 0
    v_mov_b32 v99, 0
    v_mov_b32 v100, 0
    v_mov_b32 v101, 0
    v_mov_b32 v102, 0
    v_mov_b32 v103, 0
    v_mov_b32 v104, 0
    v_mov_b32 v105, 0
    v_mov_b32 v106, 0
    v_mov_b32 v107, 0
    v_mov_b32 v108, 0
    v_mov_b32 v109, 0
    v_mov_b32 v110, 0
    v_mov_b32 v111, 0
    v_accvgpr_write_b32 a54, 0
    v_accvgpr_write_b32 a55, 0
    v_accvgpr_write_b32 a70, 0
    v_accvgpr_write_b32 a71, 0
    s_mov_b32 s20, 27136
    v_mov_b32 v116, v112
    v_mov_b32 v118, v112
    v_add_u32 v117, 27136, v112
    v_mov_b32 v127, v113
    v_add_u32 v114, 27136, v113
    v_mov_b32 v119, v121
    v_add_u32 v120, 27136, v121
    s_mov_b32 s26, 0
    s_mul_i32 s23, s3, 3072
    s_add_u32 s23, s23, 54272
    v_add_u32 v122, s23, v113
    v_add_u32 v123, s23, v121
    s_waitcnt vmcnt(7)
    ds_read_b64_tr_b16 a[32:33], v122 offset:0
    ds_read_b64_tr_b16 a[34:35], v122 offset:256
    ds_read_b64_tr_b16 a[40:41], v123 offset:0
    ds_read_b64_tr_b16 a[36:37], v122 offset:1280
    ds_read_b64_tr_b16 a[38:39], v122 offset:1536
    ds_read_b64_tr_b16 a[44:45], v123 offset:1280
    s_waitcnt lgkmcnt(0)
    v_cmp_eq_u32 vcc, 0, v115
    v_accvgpr_read_b32 v124, a40
    v_accvgpr_read_b32 v125, a44
    v_cndmask_b32 v124, 0, v124, vcc
    v_accvgpr_write_b32 a40, v124
    v_accvgpr_write_b32 a41, 0
    v_accvgpr_write_b32 a42, 0
    v_accvgpr_write_b32 a43, 0
    v_cndmask_b32 v125, 0, v125, vcc
    v_accvgpr_write_b32 a44, v125
    v_accvgpr_write_b32 a45, 0
    v_accvgpr_write_b32 a46, 0
    v_accvgpr_write_b32 a47, 0
    s_waitcnt lgkmcnt(0)
    s_barrier
    ds_read_b64_tr_b16 a[64:65], v127 offset:0
    ds_read_b64_tr_b16 a[66:67], v127 offset:256
    ds_read_b64_tr_b16 a[68:69], v119 offset:0
    s_waitcnt lgkmcnt(0)
    v_mfma_f32_32x32x16_bf16 v[0:15], a[64:67], a[32:35], 0
    v_mfma_f32_32x32x16_bf16 v[16:31], a[64:67], a[36:39], 0
    v_mfma_f32_32x32x16_bf16 v[0:15], a[68:71], a[40:43], v[0:15]
    v_mfma_f32_32x32x16_bf16 v[16:31], a[68:71], a[44:47], v[16:31]
    ds_read_b64_tr_b16 a[48:49], v127 offset:1280
    ds_read_b64_tr_b16 a[50:51], v127 offset:1536
    ds_read_b64_tr_b16 a[52:53], v119 offset:1280
    ds_read_b128 a[56:59], v118 offset:26112
    ds_read_b128 a[60:63], v116 offset:10752
    s_nop 7
    s_nop 7
    v_max3_f32 v122, v0, v1, v2
    v_max3_f32 v122, v122, v3, v4
    v_max3_f32 v122, v122, v5, v6
    v_max3_f32 v122, v122, v7, v8
    v_max3_f32 v122, v122, v9, v10
    v_max3_f32 v122, v122, v11, v12
    v_max3_f32 v122, v122, v13, v14
    v_max_f32 v122, v122, v15
    v_mov_b32 v123, v122
    s_nop 1
    v_permlane32_swap_b32 v122, v123
    s_nop 1
    v_max_f32 v122, v122, v123
    v_add_f32 v122, 0x42c00000, v122
    v_sub_f32 v0, v0, v122
    v_sub_f32 v1, v1, v122
    v_sub_f32 v2, v2, v122
    v_sub_f32 v3, v3, v122
    v_sub_f32 v4, v4, v122
    v_sub_f32 v5, v5, v122
    v_sub_f32 v6, v6, v122
    v_sub_f32 v7, v7, v122
    v_sub_f32 v8, v8, v122
    v_sub_f32 v9, v9, v122
    v_sub_f32 v10, v10, v122
    v_sub_f32 v11, v11, v122
    v_sub_f32 v12, v12, v122
    v_sub_f32 v13, v13, v122
    v_sub_f32 v14, v14, v122
    v_sub_f32 v15, v15, v122
    v_sub_f32 v64, 0, v122
    v_sub_f32 v65, 0, v122
    v_sub_f32 v66, 0, v122
    v_sub_f32 v67, 0, v122
    v_sub_f32 v68, 0, v122
    v_sub_f32 v69, 0, v122
    v_sub_f32 v70, 0, v122
    v_sub_f32 v71, 0, v122
    v_sub_f32 v72, 0, v122
    v_sub_f32 v73, 0, v122
    v_sub_f32 v74, 0, v122
    v_sub_f32 v75, 0, v122
    v_sub_f32 v76, 0, v122
    v_sub_f32 v77, 0, v122
    v_sub_f32 v78, 0, v122
    v_sub_f32 v79, 0, v122
    v_max3_f32 v124, v16, v17, v18
    v_max3_f32 v124, v124, v19, v20
    v_max3_f32 v124, v124, v21, v22
    v_max3_f32 v124, v124, v23, v24
    v_max3_f32 v124, v124, v25, v26
    v_max3_f32 v124, v124, v27, v28
    v_max3_f32 v124, v124, v29, v30
    v_max_f32 v124, v124, v31
    v_mov_b32 v125, v124
    s_nop 1
    v_permlane32_swap_b32 v124, v125
    s_nop 1
    v_max_f32 v124, v124, v125
    v_add_f32 v124, 0x42c00000, v124
    v_sub_f32 v16, v16, v124
    v_sub_f32 v17, v17, v124
    v_sub_f32 v18, v18, v124
    v_sub_f32 v19, v19, v124
    v_sub_f32 v20, v20, v124
    v_sub_f32 v21, v21, v124
    v_sub_f32 v22, v22, v124
    v_sub_f32 v23, v23, v124
    v_sub_f32 v24, v24, v124
    v_sub_f32 v25, v25, v124
    v_sub_f32 v26, v26, v124
    v_sub_f32 v27, v27, v124
    v_sub_f32 v28, v28, v124
    v_sub_f32 v29, v29, v124
    v_sub_f32 v30, v30, v124
    v_sub_f32 v31, v31, v124
    v_sub_f32 v80, 0, v124
    v_sub_f32 v81, 0, v124
    v_sub_f32 v82, 0, v124
    v_sub_f32 v83, 0, v124
    v_sub_f32 v84, 0, v124
    v_sub_f32 v85, 0, v124
    v_sub_f32 v86, 0, v124
    v_sub_f32 v87, 0, v124
    v_sub_f32 v88, 0, v124
    v_sub_f32 v89, 0, v124
    v_sub_f32 v90, 0, v124
    v_sub_f32 v91, 0, v124
    v_sub_f32 v92, 0, v124
    v_sub_f32 v93, 0, v124
    v_sub_f32 v94, 0, v124
    v_sub_f32 v95, 0, v124
L_B_main:
    s_mov_b32 s22, 8
.p2align 6
L_B_1:
    s_waitcnt lgkmcnt(0)
    v_mfma_f32_32x32x16_bf16 v[32:47], a[48:51], a[32:35], v[64:79]
    ds_read_b64_tr_b16 a[64:65], v127 offset:2560
    v_exp_f32 v0, v0
    v_exp_f32 v1, v1
    v_exp_f32 v2, v2
    v_cvt_pk_bf16_f32 v96, v0, v1
    v_exp_f32 v3, v3
    v_exp_f32 v4, v4
    v_mfma_f32_32x32x16_bf16 a[0:15], a[56:59], v[100:103], a[0:15]
    ds_read_b64_tr_b16 a[66:67], v127 offset:2816
    v_cvt_pk_bf16_f32 v97, v2, v3
    v_exp_f32 v5, v5
    v_exp_f32 v6, v6
    v_cvt_pk_bf16_f32 v98, v4, v5
    v_exp_f32 v7, v7
    v_exp_f32 v16, v16
    v_mfma_f32_32x32x16_bf16 v[48:63], a[48:51], a[36:39], v[80:95]
    ds_read_b64_tr_b16 a[68:69], v119 offset:2560
    v_cvt_pk_bf16_f32 v99, v6, v7
    v_exp_f32 v17, v17
    v_exp_f32 v18, v18
    v_cvt_pk_bf16_f32 v104, v16, v17
    v_exp_f32 v19, v19
    v_exp_f32 v20, v20
    v_mfma_f32_32x32x16_bf16 a[16:31], a[56:59], v[108:111], a[16:31]
    ds_read_b128 a[72:75], v116 offset:11776
    v_cvt_pk_bf16_f32 v105, v18, v19
    v_exp_f32 v21, v21
    v_exp_f32 v22, v22
    v_cvt_pk_bf16_f32 v106, v20, v21
    v_exp_f32 v23, v23
    v_exp_f32 v8, v8
    v_mfma_f32_32x32x16_bf16 v[32:47], a[52:55], a[40:43], v[32:47]
    ds_read_b128 a[76:79], v116 offset:12800
    v_cvt_pk_bf16_f32 v107, v22, v23
    v_exp_f32 v9, v9
    v_exp_f32 v10, v10
    v_cvt_pk_bf16_f32 v100, v8, v9
    v_exp_f32 v11, v11
    v_exp_f32 v12, v12
    v_mfma_f32_32x32x16_bf16 a[0:15], a[60:63], v[96:99], a[0:15]
    v_cvt_pk_bf16_f32 v101, v10, v11
    v_exp_f32 v13, v13
    v_exp_f32 v14, v14
    v_cvt_pk_bf16_f32 v102, v12, v13
    v_exp_f32 v15, v15
    v_exp_f32 v24, v24
    v_mfma_f32_32x32x16_bf16 v[48:63], a[52:55], a[44:47], v[48:63]
    v_cvt_pk_bf16_f32 v103, v14, v15
    v_exp_f32 v25, v25
    v_exp_f32 v26, v26
    v_cvt_pk_bf16_f32 v108, v24, v25
    v_exp_f32 v27, v27
    v_exp_f32 v28, v28
    v_cvt_pk_bf16_f32 v109, v26, v27
    v_exp_f32 v29, v29
    v_exp_f32 v30, v30
    v_cvt_pk_bf16_f32 v110, v28, v29
    v_exp_f32 v31, v31
    v_mfma_f32_32x32x16_bf16 a[16:31], a[60:63], v[104:107], a[16:31]
    v_cvt_pk_bf16_f32 v111, v30, v31
    s_waitcnt vmcnt(0)
    s_barrier
    s_waitcnt lgkmcnt(0)
    v_mfma_f32_32x32x16_bf16 v[0:15], a[64:67], a[32:35], v[64:79]
    ds_read_b64_tr_b16 a[48:49], v127 offset:3840
    v_exp_f32 v32, v32
    v_exp_f32 v33, v33
    v_exp_f32 v34, v34
    v_cvt_pk_bf16_f32 v96, v32, v33
    v_exp_f32 v35, v35
    v_exp_f32 v36, v36
    v_mfma_f32_32x32x16_bf16 a[0:15], a[72:75], v[100:103], a[0:15]
    ds_read_b64_tr_b16 a[50:51], v127 offset:4096
    v_cvt_pk_bf16_f32 v97, v34, v35
    v_exp_f32 v37, v37
    v_exp_f32 v38, v38
    v_cvt_pk_bf16_f32 v98, v36, v37
    v_exp_f32 v39, v39
    v_exp_f32 v48, v48
    v_mfma_f32_32x32x16_bf16 v[16:31], a[64:67], a[36:39], v[80:95]
    ds_read_b64_tr_b16 a[52:53], v119 offset:3840
    v_cvt_pk_bf16_f32 v99, v38, v39
    v_exp_f32 v49, v49
    v_exp_f32 v50, v50
    v_cvt_pk_bf16_f32 v104, v48, v49
    v_exp_f32 v51, v51
    v_exp_f32 v52, v52
    v_mfma_f32_32x32x16_bf16 a[16:31], a[72:75], v[108:111], a[16:31]
    ds_read_b128 a[56:59], v116 offset:13824
    v_cvt_pk_bf16_f32 v105, v50, v51
    v_exp_f32 v53, v53
    v_exp_f32 v54, v54
    v_cvt_pk_bf16_f32 v106, v52, v53
    v_exp_f32 v55, v55
    v_exp_f32 v40, v40
    v_mfma_f32_32x32x16_bf16 v[0:15], a[68:71], a[40:43], v[0:15]
    ds_read_b128 a[60:63], v116 offset:14848
    v_cvt_pk_bf16_f32 v107, v54, v55
    v_exp_f32 v41, v41
    v_exp_f32 v42, v42
    v_cvt_pk_bf16_f32 v100, v40, v41
    v_exp_f32 v43, v43
    v_exp_f32 v44, v44
    v_mfma_f32_32x32x16_bf16 a[0:15], a[76:79], v[96:99], a[0:15]
    s_mov_b32 m0, s18
    s_nop 0
    buffer_load_dwordx4 v112, s[8:11], s16 offen lds
    v_cvt_pk_bf16_f32 v101, v42, v43
    v_exp_f32 v45, v45
    v_exp_f32 v46, v46
    v_cvt_pk_bf16_f32 v102, v44, v45
    v_exp_f32 v47, v47
    v_exp_f32 v56, v56
    v_mfma_f32_32x32x16_bf16 v[16:31], a[68:71], a[44:47], v[16:31]
    buffer_load_dwordx4 v112, s[8:11], s16 offen offset:1024 lds
    v_cvt_pk_bf16_f32 v103, v46, v47
    v_exp_f32 v57, v57
    v_exp_f32 v58, v58
    v_cvt_pk_bf16_f32 v108, v56, v57
    v_exp_f32 v59, v59
    v_exp_f32 v60, v60
    v_cvt_pk_bf16_f32 v109, v58, v59
    v_exp_f32 v61, v61
    v_exp_f32 v62, v62
    v_cvt_pk_bf16_f32 v110, v60, v61
    v_exp_f32 v63, v63
    v_mfma_f32_32x32x16_bf16 a[16:31], a[76:79], v[104:107], a[16:31]
    buffer_load_dwordx4 a[80:83], v112, s[40:43], s47 offen
    s_add_u32 s47, s47, 131072
    v_cvt_pk_bf16_f32 v111, v62, v63
    s_waitcnt lgkmcnt(0)
    v_mfma_f32_32x32x16_bf16 v[32:47], a[48:51], a[32:35], v[64:79]
    ds_read_b64_tr_b16 a[64:65], v127 offset:5120
    v_exp_f32 v0, v0
    v_exp_f32 v1, v1
    v_exp_f32 v2, v2
    v_cvt_pk_bf16_f32 v96, v0, v1
    v_exp_f32 v3, v3
    v_exp_f32 v4, v4
    v_mfma_f32_32x32x16_bf16 a[0:15], a[56:59], v[100:103], a[0:15]
    ds_read_b64_tr_b16 a[66:67], v127 offset:5376
    v_cvt_pk_bf16_f32 v97, v2, v3
    v_exp_f32 v5, v5
    v_exp_f32 v6, v6
    v_cvt_pk_bf16_f32 v98, v4, v5
    v_exp_f32 v7, v7
    v_exp_f32 v16, v16
    v_mfma_f32_32x32x16_bf16 v[48:63], a[48:51], a[36:39], v[80:95]
    ds_read_b64_tr_b16 a[68:69], v119 offset:5120
    v_cvt_pk_bf16_f32 v99, v6, v7
    v_exp_f32 v17, v17
    v_exp_f32 v18, v18
    v_cvt_pk_bf16_f32 v104, v16, v17
    v_exp_f32 v19, v19
    v_exp_f32 v20, v20
    v_mfma_f32_32x32x16_bf16 a[16:31], a[56:59], v[108:111], a[16:31]
    ds_read_b128 a[72:75], v116 offset:15872
    v_cvt_pk_bf16_f32 v105, v18, v19
    v_exp_f32 v21, v21
    v_exp_f32 v22, v22
    v_cvt_pk_bf16_f32 v106, v20, v21
    v_exp_f32 v23, v23
    v_exp_f32 v8, v8
    v_mfma_f32_32x32x16_bf16 v[32:47], a[52:55], a[40:43], v[32:47]
    ds_read_b128 a[76:79], v116 offset:16896
    v_cvt_pk_bf16_f32 v107, v22, v23
    v_exp_f32 v9, v9
    v_exp_f32 v10, v10
    v_cvt_pk_bf16_f32 v100, v8, v9
    v_exp_f32 v11, v11
    v_exp_f32 v12, v12
    v_mfma_f32_32x32x16_bf16 a[0:15], a[60:63], v[96:99], a[0:15]
    buffer_load_dwordx4 v112, s[8:11], s16 offen offset:2048 lds
    v_cvt_pk_bf16_f32 v101, v10, v11
    v_exp_f32 v13, v13
    v_exp_f32 v14, v14
    v_cvt_pk_bf16_f32 v102, v12, v13
    v_exp_f32 v15, v15
    v_exp_f32 v24, v24
    v_mfma_f32_32x32x16_bf16 v[48:63], a[52:55], a[44:47], v[48:63]
    s_mov_b32 m0, s21
    s_nop 0
    buffer_load_dwordx4 v112, s[8:11], s17 offen lds
    v_cvt_pk_bf16_f32 v103, v14, v15
    v_exp_f32 v25, v25
    v_exp_f32 v26, v26
    v_cvt_pk_bf16_f32 v108, v24, v25
    v_exp_f32 v27, v27
    v_exp_f32 v28, v28
    v_cvt_pk_bf16_f32 v109, v26, v27
    v_exp_f32 v29, v29
    v_exp_f32 v30, v30
    v_cvt_pk_bf16_f32 v110, v28, v29
    v_exp_f32 v31, v31
    v_mfma_f32_32x32x16_bf16 a[16:31], a[60:63], v[104:107], a[16:31]
    v_cvt_pk_bf16_f32 v111, v30, v31
    s_waitcnt lgkmcnt(0)
    v_mfma_f32_32x32x16_bf16 v[0:15], a[64:67], a[32:35], v[64:79]
    ds_read_b64_tr_b16 a[48:49], v127 offset:6400
    v_exp_f32 v32, v32
    v_exp_f32 v33, v33
    v_exp_f32 v34, v34
    v_cvt_pk_bf16_f32 v96, v32, v33
    v_exp_f32 v35, v35
    v_exp_f32 v36, v36
    v_mfma_f32_32x32x16_bf16 a[0:15], a[72:75], v[100:103], a[0:15]
    ds_read_b64_tr_b16 a[50:51], v127 offset:6656
    v_cvt_pk_bf16_f32 v97, v34, v35
    v_exp_f32 v37, v37
    v_exp_f32 v38, v38
    v_cvt_pk_bf16_f32 v98, v36, v37
    v_exp_f32 v39, v39
    v_exp_f32 v48, v48
    v_mfma_f32_32x32x16_bf16 v[16:31], a[64:67], a[36:39], v[80:95]
    ds_read_b64_tr_b16 a[52:53], v119 offset:6400
    v_cvt_pk_bf16_f32 v99, v38, v39
    v_exp_f32 v49, v49
    v_exp_f32 v50, v50
    v_cvt_pk_bf16_f32 v104, v48, v49
    v_exp_f32 v51, v51
    v_exp_f32 v52, v52
    v_mfma_f32_32x32x16_bf16 a[16:31], a[72:75], v[108:111], a[16:31]
    ds_read_b128 a[56:59], v116 offset:17920
    v_cvt_pk_bf16_f32 v105, v50, v51
    v_exp_f32 v53, v53
    v_exp_f32 v54, v54
    v_cvt_pk_bf16_f32 v106, v52, v53
    v_exp_f32 v55, v55
    v_exp_f32 v40, v40
    v_mfma_f32_32x32x16_bf16 v[0:15], a[68:71], a[40:43], v[0:15]
    ds_read_b128 a[60:63], v116 offset:18944
    v_cvt_pk_bf16_f32 v107, v54, v55
    v_exp_f32 v41, v41
    v_exp_f32 v42, v42
    v_cvt_pk_bf16_f32 v100, v40, v41
    v_exp_f32 v43, v43
    v_exp_f32 v44, v44
    v_mfma_f32_32x32x16_bf16 a[0:15], a[76:79], v[96:99], a[0:15]
    buffer_load_dwordx4 v112, s[8:11], s17 offen offset:1024 lds
    v_cvt_pk_bf16_f32 v101, v42, v43
    v_exp_f32 v45, v45
    v_exp_f32 v46, v46
    v_cvt_pk_bf16_f32 v102, v44, v45
    v_exp_f32 v47, v47
    v_exp_f32 v56, v56
    v_mfma_f32_32x32x16_bf16 v[16:31], a[68:71], a[44:47], v[16:31]
    buffer_load_dwordx4 v112, s[8:11], s17 offen offset:2048 lds
    v_cvt_pk_bf16_f32 v103, v46, v47
    v_exp_f32 v57, v57
    v_exp_f32 v58, v58
    v_cvt_pk_bf16_f32 v108, v56, v57
    v_exp_f32 v59, v59
    v_exp_f32 v60, v60
    v_cvt_pk_bf16_f32 v109, v58, v59
    v_exp_f32 v61, v61
    v_exp_f32 v62, v62
    v_cvt_pk_bf16_f32 v110, v60, v61
    v_exp_f32 v63, v63
    v_mfma_f32_32x32x16_bf16 a[16:31], a[76:79], v[104:107], a[16:31]
    v_cvt_pk_bf16_f32 v111, v62, v63
    s_waitcnt lgkmcnt(0)
    v_mfma_f32_32x32x16_bf16 v[32:47], a[48:51], a[32:35], v[64:79]
    ds_read_b64_tr_b16 a[64:65], v127 offset:7680
    v_exp_f32 v0, v0
    v_exp_f32 v1, v1
    v_exp_f32 v2, v2
    v_cvt_pk_bf16_f32 v96, v0, v1
    v_exp_f32 v3, v3
    v_exp_f32 v4, v4
    v_mfma_f32_32x32x16_bf16 a[0:15], a[56:59], v[100:103], a[0:15]
    ds_read_b64_tr_b16 a[66:67], v127 offset:7936
    v_cvt_pk_bf16_f32 v97, v2, v3
    v_exp_f32 v5, v5
    v_exp_f32 v6, v6
    v_cvt_pk_bf16_f32 v98, v4, v5
    v_exp_f32 v7, v7
    v_exp_f32 v16, v16
    v_mfma_f32_32x32x16_bf16 v[48:63], a[48:51], a[36:39], v[80:95]
    ds_read_b64_tr_b16 a[68:69], v119 offset:7680
    v_cvt_pk_bf16_f32 v99, v6, v7
    v_exp_f32 v17, v17
    v_exp_f32 v18, v18
    v_cvt_pk_bf16_f32 v104, v16, v17
    v_exp_f32 v19, v19
    v_exp_f32 v20, v20
    v_mfma_f32_32x32x16_bf16 a[16:31], a[56:59], v[108:111], a[16:31]
    ds_read_b128 a[72:75], v116 offset:19968
    v_cvt_pk_bf16_f32 v105, v18, v19
    v_exp_f32 v21, v21
    v_exp_f32 v22, v22
    v_cvt_pk_bf16_f32 v106, v20, v21
    v_exp_f32 v23, v23
    v_exp_f32 v8, v8
    v_mfma_f32_32x32x16_bf16 v[32:47], a[52:55], a[40:43], v[32:47]
    ds_read_b128 a[76:79], v116 offset:20992
    v_cvt_pk_bf16_f32 v107, v22, v23
    v_exp_f32 v9, v9
    v_exp_f32 v10, v10
    v_cvt_pk_bf16_f32 v100, v8, v9
    v_exp_f32 v11, v11
    v_exp_f32 v12, v12
    v_mfma_f32_32x32x16_bf16 a[0:15], a[60:63], v[96:99], a[0:15]
    buffer_load_dwordx4 v112, s[8:11], s17 offen offset:3072 lds
    v_cvt_pk_bf16_f32 v101, v10, v11
    v_exp_f32 v13, v13
    v_exp_f32 v14, v14
    v_cvt_pk_bf16_f32 v102, v12, v13
    v_exp_f32 v15, v15
    v_exp_f32 v24, v24
    v_mfma_f32_32x32x16_bf16 v[48:63], a[52:55], a[44:47], v[48:63]
    s_add_u32 s16, s16, 10240
    s_add_u32 s17, s17, 16384
    s_add_u32 s18, s18, 27136
    s_add_u32 s21, s21, 27136
    v_cvt_pk_bf16_f32 v103, v14, v15
    v_exp_f32 v25, v25
    v_exp_f32 v26, v26
    v_cvt_pk_bf16_f32 v108, v24, v25
    v_exp_f32 v27, v27
    v_exp_f32 v28, v28
    v_cvt_pk_bf16_f32 v109, v26, v27
    v_exp_f32 v29, v29
    v_exp_f32 v30, v30
    v_cvt_pk_bf16_f32 v110, v28, v29
    v_exp_f32 v31, v31
    v_mfma_f32_32x32x16_bf16 a[16:31], a[60:63], v[104:107], a[16:31]
    v_cvt_pk_bf16_f32 v111, v30, v31
    s_waitcnt lgkmcnt(0)
    v_mfma_f32_32x32x16_bf16 v[0:15], a[64:67], a[32:35], v[64:79]
    ds_read_b64_tr_b16 a[48:49], v127 offset:8960
    v_exp_f32 v32, v32
    v_exp_f32 v33, v33
    v_exp_f32 v34, v34
    v_cvt_pk_bf16_f32 v96, v32, v33
    v_exp_f32 v35, v35
    v_exp_f32 v36, v36
    v_mfma_f32_32x32x16_bf16 a[0:15], a[72:75], v[100:103], a[0:15]
    ds_read_b64_tr_b16 a[50:51], v127 offset:9216
    v_cvt_pk_bf16_f32 v97, v34, v35
    v_exp_f32 v37, v37
    v_exp_f32 v38, v38
    v_cvt_pk_bf16_f32 v98, v36, v37
    v_exp_f32 v39, v39
    v_exp_f32 v48, v48
    v_mfma_f32_32x32x16_bf16 v[16:31], a[64:67], a[36:39], v[80:95]
    ds_read_b64_tr_b16 a[52:53], v119 offset:8960
    v_cvt_pk_bf16_f32 v99, v38, v39
    v_exp_f32 v49, v49
    v_exp_f32 v50, v50
    v_cvt_pk_bf16_f32 v104, v48, v49
    v_exp_f32 v51, v51
    v_exp_f32 v52, v52
    v_mfma_f32_32x32x16_bf16 a[16:31], a[72:75], v[108:111], a[16:31]
    ds_read_b128 a[56:59], v116 offset:22016
    v_cvt_pk_bf16_f32 v105, v50, v51
    v_exp_f32 v53, v53
    v_exp_f32 v54, v54
    v_cvt_pk_bf16_f32 v106, v52, v53
    v_exp_f32 v55, v55
    v_exp_f32 v40, v40
    v_mfma_f32_32x32x16_bf16 v[0:15], a[68:71], a[40:43], v[0:15]
    ds_read_b128 a[60:63], v116 offset:23040
    v_cvt_pk_bf16_f32 v107, v54, v55
    v_exp_f32 v41, v41
    v_exp_f32 v42, v42
    v_cvt_pk_bf16_f32 v100, v40, v41
    v_exp_f32 v43, v43
    v_exp_f32 v44, v44
    v_mfma_f32_32x32x16_bf16 a[0:15], a[76:79], v[96:99], a[0:15]
    v_cvt_pk_bf16_f32 v101, v42, v43
    v_exp_f32 v45, v45
    v_exp_f32 v46, v46
    v_cvt_pk_bf16_f32 v102, v44, v45
    v_exp_f32 v47, v47
    v_exp_f32 v56, v56
    v_mfma_f32_32x32x16_bf16 v[16:31], a[68:71], a[44:47], v[16:31]
    s_cmp_ge_u32 s18, 81408
    s_cselect_b32 s24, 81408, 0
    s_sub_u32 s18, s18, s24
    s_sub_u32 s21, s21, s24
    v_cvt_pk_bf16_f32 v103, v46, v47
    v_exp_f32 v57, v57
    v_exp_f32 v58, v58
    v_cvt_pk_bf16_f32 v108, v56, v57
    v_exp_f32 v59, v59
    v_exp_f32 v60, v60
    v_cvt_pk_bf16_f32 v109, v58, v59
    v_exp_f32 v61, v61
    v_exp_f32 v62, v62
    v_cvt_pk_bf16_f32 v110, v60, v61
    v_exp_f32 v63, v63
    v_mfma_f32_32x32x16_bf16 a[16:31], a[76:79], v[104:107], a[16:31]
    v_cvt_pk_bf16_f32 v111, v62, v63
    s_waitcnt lgkmcnt(0)
    v_mfma_f32_32x32x16_bf16 v[32:47], a[48:51], a[32:35], v[64:79]
    ds_read_b64_tr_b16 a[64:65], v114 offset:0
    v_exp_f32 v0, v0
    v_exp_f32 v1, v1
    v_exp_f32 v2, v2
    v_cvt_pk_bf16_f32 v96, v0, v1
    v_exp_f32 v3, v3
    v_exp_f32 v4, v4
    v_mfma_f32_32x32x16_bf16 a[0:15], a[56:59], v[100:103], a[0:15]
    ds_read_b64_tr_b16 a[66:67], v114 offset:256
    v_cvt_pk_bf16_f32 v97, v2, v3
    v_exp_f32 v5, v5
    v_exp_f32 v6, v6
    v_cvt_pk_bf16_f32 v98, v4, v5
    v_exp_f32 v7, v7
    v_exp_f32 v16, v16
    v_mfma_f32_32x32x16_bf16 v[48:63], a[48:51], a[36:39], v[80:95]
    ds_read_b64_tr_b16 a[68:69], v120 offset:0
    v_cvt_pk_bf16_f32 v99, v6, v7
    v_exp_f32 v17, v17
    v_exp_f32 v18, v18
    v_cvt_pk_bf16_f32 v104, v16, v17
    v_exp_f32 v19, v19
    v_exp_f32 v20, v20
    v_mfma_f32_32x32x16_bf16 a[16:31], a[56:59], v[108:111], a[16:31]
    ds_read_b128 a[72:75], v116 offset:24064
    v_cvt_pk_bf16_f32 v105, v18, v19
    v_exp_f32 v21, v21
    v_exp_f32 v22, v22
    v_cvt_pk_bf16_f32 v106, v20, v21
    v_exp_f32 v23, v23
    v_exp_f32 v8, v8
    v_mfma_f32_32x32x16_bf16 v[32:47], a[52:55], a[40:43], v[32:47]
    ds_read_b128 a[76:79], v116 offset:25088
    v_cvt_pk_bf16_f32 v107, v22, v23
    v_exp_f32 v9, v9
    v_exp_f32 v10, v10
    v_cvt_pk_bf16_f32 v100, v8, v9
    v_exp_f32 v11, v11
    v_exp_f32 v12, v12
    v_mfma_f32_32x32x16_bf16 a[0:15], a[60:63], v[96:99], a[0:15]
    v_cvt_pk_bf16_f32 v101, v10, v11
    v_exp_f32 v13, v13
    v_exp_f32 v14, v14
    v_cvt_pk_bf16_f32 v102, v12, v13
    v_exp_f32 v15, v15
    v_exp_f32 v24, v24
    v_mfma_f32_32x32x16_bf16 v[48:63], a[52:55], a[44:47], v[48:63]
    v_cvt_pk_bf16_f32 v103, v14, v15
    v_exp_f32 v25, v25
    v_exp_f32 v26, v26
    v_cvt_pk_bf16_f32 v108, v24, v25
    v_exp_f32 v27, v27
    v_exp_f32 v28, v28
    v_cvt_pk_bf16_f32 v109, v26, v27
    v_exp_f32 v29, v29
    v_exp_f32 v30, v30
    v_cvt_pk_bf16_f32 v110, v28, v29
    v_exp_f32 v31, v31
    v_mfma_f32_32x32x16_bf16 a[16:31], a[60:63], v[104:107], a[16:31]
    v_cvt_pk_bf16_f32 v111, v30, v31
    v_mov_b32 v118, v116
    v_mov_b32 v116, v117
    v_mov_b32 v119, v120
    v_mov_b32 v127, v114
    s_waitcnt lgkmcnt(0)
    v_mfma_f32_32x32x16_bf16 v[0:15], a[64:67], a[32:35], v[64:79]
    ds_read_b64_tr_b16 a[48:49], v127 offset:1280
    v_exp_f32 v32, v32
    v_exp_f32 v33, v33
    v_exp_f32 v34, v34
    v_cvt_pk_bf16_f32 v96, v32, v33
    v_exp_f32 v35, v35
    v_exp_f32 v36, v36
    v_mfma_f32_32x32x16_bf16 a[0:15], a[72:75], v[100:103], a[0:15]
    ds_read_b64_tr_b16 a[50:51], v127 offset:1536
    v_cvt_pk_bf16_f32 v97, v34, v35
    v_exp_f32 v37, v37
    v_exp_f32 v38, v38
    v_cvt_pk_bf16_f32 v98, v36, v37
    v_exp_f32 v39, v39
    v_exp_f32 v48, v48
    v_mfma_f32_32x32x16_bf16 v[16:31], a[64:67], a[36:39], v[80:95]
    ds_read_b64_tr_b16 a[52:53], v119 offset:1280
    v_cvt_pk_bf16_f32 v99, v38, v39
    v_exp_f32 v49, v49
    v_exp_f32 v50, v50
    v_cvt_pk_bf16_f32 v104, v48, v49
    v_exp_f32 v51, v51
    v_exp_f32 v52, v52
    v_mfma_f32_32x32x16_bf16 a[16:31], a[72:75], v[108:111], a[16:31]
    ds_read_b128 a[56:59], v118 offset:26112
    v_cvt_pk_bf16_f32 v105, v50, v51
    v_exp_f32 v53, v53
    v_exp_f32 v54, v54
    v_cvt_pk_bf16_f32 v106, v52, v53
    v_exp_f32 v55, v55
    v_exp_f32 v40, v40
    v_mfma_f32_32x32x16_bf16 v[0:15], a[68:71], a[40:43], v[0:15]
    ds_read_b128 a[60:63], v116 offset:10752
    v_cvt_pk_bf16_f32 v107, v54, v55
    v_exp_f32 v41, v41
    v_exp_f32 v42, v42
    v_cvt_pk_bf16_f32 v100, v40, v41
    v_exp_f32 v43, v43
    v_exp_f32 v44, v44
    v_mfma_f32_32x32x16_bf16 a[0:15], a[76:79], v[96:99], a[0:15]
    s_add_u32 s20, s20, 27136
    s_cmp_eq_u32 s20, 81408
    s_cselect_b32 s20, 0, s20
    v_cvt_pk_bf16_f32 v101, v42, v43
    v_exp_f32 v45, v45
    v_exp_f32 v46, v46
    v_cvt_pk_bf16_f32 v102, v44, v45
    v_exp_f32 v47, v47
    v_exp_f32 v56, v56
    v_mfma_f32_32x32x16_bf16 v[16:31], a[68:71], a[44:47], v[16:31]
    s_sub_u32 s22, s22, 1
    s_cmp_lg_u32 s22, 0
    v_cvt_pk_bf16_f32 v103, v46, v47
    v_exp_f32 v57, v57
    v_exp_f32 v58, v58
    v_cvt_pk_bf16_f32 v108, v56, v57
    v_add_u32 v117, s20, v112
    v_add_u32 v120, s20, v121
    v_add_u32 v114, s20, v113
    v_exp_f32 v59, v59
    v_exp_f32 v60, v60
    v_cvt_pk_bf16_f32 v109, v58, v59
    v_exp_f32 v61, v61
    v_exp_f32 v62, v62
    v_cvt_pk_bf16_f32 v110, v60, v61
    v_exp_f32 v63, v63
    v_mfma_f32_32x32x16_bf16 a[16:31], a[76:79], v[104:107], a[16:31]
    v_cvt_pk_bf16_f32 v111, v62, v63
    s_cbranch_scc1 L_B_1
    s_waitcnt lgkmcnt(0)
    v_mfma_f32_32x32x16_bf16 a[0:15], a[56:59], v[100:103], a[0:15]
    v_mfma_f32_32x32x16_bf16 a[16:31], a[56:59], v[108:111], a[16:31]
    s_nop 7
    s_nop 7
    v_mov_b32 v122, 0
    v_mov_b32 v123, 0x7b800000
    s_mov_b64 s[28:29], 0
    v_accvgpr_read_b32 v0, a0
    v_accvgpr_read_b32 v1, a1
    v_accvgpr_read_b32 v2, a2
    v_accvgpr_read_b32 v3, a3
    v_accvgpr_read_b32 v4, a4
    v_accvgpr_read_b32 v5, a5
    v_accvgpr_read_b32 v6, a6
    v_accvgpr_read_b32 v7, a7
    v_accvgpr_read_b32 v8, a8
    v_accvgpr_read_b32 v9, a9
    v_accvgpr_read_b32 v10, a10
    v_cmp_nlt_f32 vcc, v10, v123
    s_nop 3
    s_or_b64 s[28:29], s[28:29], vcc
    v_accvgpr_read_b32 v16, a16
    v_accvgpr_read_b32 v17, a17
    v_accvgpr_read_b32 v18, a18
    v_accvgpr_read_b32 v19, a19
    v_accvgpr_read_b32 v20, a20
    v_accvgpr_read_b32 v21, a21
    v_accvgpr_read_b32 v22, a22
    v_accvgpr_read_b32 v23, a23
    v_accvgpr_read_b32 v24, a24
    v_accvgpr_read_b32 v25, a25
    v_accvgpr_read_b32 v26, a26
    v_cmp_nlt_f32 vcc, v26, v123
    s_nop 3
    s_or_b64 s[28:29], s[28:29], vcc
    v_fma_f32 v122, v0, 0, v122
    v_fma_f32 v122, v1, 0, v122
    v_fma_f32 v122, v2, 0, v122
    v_fma_f32 v122, v3, 0, v122
    v_fma_f32 v122, v4, 0, v122
    v_fma_f32 v122, v5, 0, v122
    v_fma_f32 v122, v6, 0, v122
    v_fma_f32 v122, v7, 0, v122
    v_fma_f32 v122, v8, 0, v122
    v_fma_f32 v122, v9, 0, v122
    v_fma_f32 v122, v16, 0, v122
    v_fma_f32 v122, v17, 0, v122
    v_fma_f32 v122, v18, 0, v122
    v_fma_f32 v122, v19, 0, v122
    v_fma_f32 v122, v20, 0, v122
    v_fma_f32 v122, v21, 0, v122
    v_fma_f32 v122, v22, 0, v122
    v_fma_f32 v122, v23, 0, v122
    v_fma_f32 v122, v24, 0, v122
    v_fma_f32 v122, v25, 0, v122
    v_cmp_u_f32 vcc, v122, v122
    s_nop 3
    s_or_b64 s[28:29], s[28:29], vcc
    s_cmp_lg_u64 s[28:29], 0
    s_cselect_b32 s23, 1, 0
    s_mov_b32 s20, s23
    v_rcp_f32 v10, v10
    s_nop 0
    v_mul_f32 v0, v0, v10
    v_mul_f32 v1, v1, v10
    v_mul_f32 v2, v2, v10
    v_mul_f32 v3, v3, v10
    v_mul_f32 v4, v4, v10
    v_mul_f32 v5, v5, v10
    v_mul_f32 v6, v6, v10
    v_mul_f32 v7, v7, v10
    v_mul_f32 v8, v8, v10
    v_mul_f32 v9, v9, v10
    v_cvt_pk_bf16_f32 v0, v0, v1
    v_cvt_pk_bf16_f32 v1, v2, v3
    v_cvt_pk_bf16_f32 v2, v4, v5
    v_cvt_pk_bf16_f32 v3, v6, v7
    v_cvt_pk_bf16_f32 v4, v8, v9
    v_mov_b32 v5, 0
    v_mov_b32 v6, 0
    v_mov_b32 v7, 0
    s_lshl_b32 s23, s13, 3
    s_lshl_b32 s22, s3, 1
    s_add_u32 s23, s23, s22
    s_add_u32 s23, s23, 0
    s_mul_i32 s23, s23, 49152
    s_mul_i32 s22, s12, 1536
    s_add_u32 s23, s23, s22
    s_add_u32 s23, s23, 79691776
    v_permlane32_swap_b32 v0, v2
    v_permlane32_swap_b32 v1, v3
    s_nop 1
    buffer_store_dwordx4 v[0:3], v112, s[8:11], s23 offen sc1
    s_mov_b32 exec_hi, 0
    buffer_store_dwordx4 v[4:7], v112, s[8:11], s23 offen offset:1024 sc1
    s_mov_b64 exec, -1
    v_rcp_f32 v26, v26
    s_nop 0
    v_mul_f32 v16, v16, v26
    v_mul_f32 v17, v17, v26
    v_mul_f32 v18, v18, v26
    v_mul_f32 v19, v19, v26
    v_mul_f32 v20, v20, v26
    v_mul_f32 v21, v21, v26
    v_mul_f32 v22, v22, v26
    v_mul_f32 v23, v23, v26
    v_mul_f32 v24, v24, v26
    v_mul_f32 v25, v25, v26
    v_cvt_pk_bf16_f32 v16, v16, v17
    v_cvt_pk_bf16_f32 v17, v18, v19
    v_cvt_pk_bf16_f32 v18, v20, v21
    v_cvt_pk_bf16_f32 v19, v22, v23
    v_cvt_pk_bf16_f32 v20, v24, v25
    v_mov_b32 v21, 0
    v_mov_b32 v22, 0
    v_mov_b32 v23, 0
    s_lshl_b32 s23, s13, 3
    s_lshl_b32 s22, s3, 1
    s_add_u32 s23, s23, s22
    s_add_u32 s23, s23, 1
    s_mul_i32 s23, s23, 49152
    s_mul_i32 s22, s12, 1536
    s_add_u32 s23, s23, s22
    s_add_u32 s23, s23, 79691776
    v_permlane32_swap_b32 v16, v18
    v_permlane32_swap_b32 v17, v19
    s_nop 1
    buffer_store_dwordx4 v[16:19], v112, s[8:11], s23 offen sc1
    s_mov_b32 exec_hi, 0
    buffer_store_dwordx4 v[20:23], v112, s[8:11], s23 offen offset:1024 sc1
    s_mov_b64 exec, -1
    s_mov_b32 s23, s20
    s_waitcnt vmcnt(0)
    s_lshl_b32 s24, s3, 2
    s_add_u32 s24, s24, 81408
    v_mov_b32 v96, s24
    v_mov_b32 v97, s23
    ds_write_b32 v96, v97
    v_mov_b32 v96, 81408
    s_waitcnt lgkmcnt(0)
    s_barrier
    ds_read_b128 v[100:103], v96
    s_waitcnt lgkmcnt(0)
    v_or_b32 v100, v100, v101
    v_or3_b32 v100, v100, v102, v103
    s_nop 0
    v_readfirstlane_b32 s23, v100
    s_nop 3
    s_cmp_eq_u32 s23, 0
    s_cbranch_scc1 L_B_ok
    s_cmp_lg_u32 s26, 0
    s_cbranch_scc1 L_B_ok
    s_waitcnt vmcnt(0)
    s_barrier
    s_mul_i32 s16, s12, 81920
    s_mul_i32 s24, s3, 2560
    s_add_u32 s16, s16, s24
    s_add_u32 s16, s16, 71303168
    s_mov_b32 s18, s24
    s_lshl_b32 s17, s12, 17
    s_lshl_b32 s23, s3, 12
    s_add_u32 s17, s17, s23
    s_add_u32 s17, s17, 75497472
    s_add_u32 s21, s23, 10752
    v_mov_b32 v122, 0xff800000
    v_mov_b32 v123, 0xff800000
    s_mov_b32 s22, 8
L_B_fbstep:
    s_mov_b32 m0, s18
    s_nop 0
    buffer_load_dwordx4 v112, s[8:11], s16 offen lds
    buffer_load_dwordx4 v112, s[8:11], s16 offen offset:1024 lds
    buffer_load_dwordx4 v112, s[8:11], s16 offen offset:2048 lds
    s_add_u32 s16, s16, 10240
    s_waitcnt vmcnt(0)
    s_barrier
    v_mov_b32 v124, v113
    v_mov_b32 v125, v121
    s_mov_b32 s20, 8
L_B_fbtile:
    ds_read_b64_tr_b16 a[64:65], v124 offset:0
    ds_read_b64_tr_b16 a[66:67], v124 offset:256
    ds_read_b64_tr_b16 a[68:69], v125 offset:0
    s_waitcnt lgkmcnt(0)
    v_mfma_f32_32x32x16_bf16 v[0:15], a[64:67], a[32:35], 0
    v_mfma_f32_32x32x16_bf16 v[16:31], a[64:67], a[36:39], 0
    v_mfma_f32_32x32x16_bf16 v[0:15], a[68:71], a[40:43], v[0:15]
    v_mfma_f32_32x32x16_bf16 v[16:31], a[68:71], a[44:47], v[16:31]
    v_add_u32 v124, 1280, v124
    v_add_u32 v125, 1280, v125
    s_nop 7
    s_nop 7
    v_max3_f32 v122, v122, v0, v1
    v_max3_f32 v122, v122, v2, v3
    v_max3_f32 v122, v122, v4, v5
    v_max3_f32 v122, v122, v6, v7
    v_max3_f32 v122, v122, v8, v9
    v_max3_f32 v122, v122, v10, v11
    v_max3_f32 v122, v122, v12, v13
    v_max3_f32 v122, v122, v14, v15
    v_max3_f32 v123, v123, v16, v17
    v_max3_f32 v123, v123, v18, v19
    v_max3_f32 v123, v123, v20, v21
    v_max3_f32 v123, v123, v22, v23
    v_max3_f32 v123, v123, v24, v25
    v_max3_f32 v123, v123, v26, v27
    v_max3_f32 v123, v123, v28, v29
    v_max3_f32 v123, v123, v30, v31
    s_sub_u32 s20, s20, 1
    s_cmp_lg_u32 s20, 0
    s_cbranch_scc1 L_B_fbtile
    s_barrier
    s_sub_u32 s22, s22, 1
    s_cmp_lg_u32 s22, 0
    s_cbranch_scc1 L_B_fbstep
    v_mov_b32 v124, v122
    v_mov_b32 v125, v122
    s_nop 1
    v_permlane32_swap_b32 v124, v125
    s_nop 1
    v_max_f32 v124, v124, v125
    v_sub_f32 v64, 0, v124
    v_sub_f32 v65, 0, v124
    v_sub_f32 v66, 0, v124
    v_sub_f32 v67, 0, v124
    v_sub_f32 v68, 0, v124
    v_sub_f32 v69, 0, v124
    v_sub_f32 v70, 0, v124
    v_sub_f32 v71, 0, v124
    v_sub_f32 v72, 0, v124
    v_sub_f32 v73, 0, v124
    v_sub_f32 v74, 0, v124
    v_sub_f32 v75, 0, v124
    v_sub_f32 v76, 0, v124
    v_sub_f32 v77, 0, v124
    v_sub_f32 v78, 0, v124
    v_sub_f32 v79, 0, v124
    v_mov_b32 v124, v123
    v_mov_b32 v125, v123
    s_nop 1
    v_permlane32_swap_b32 v124, v125
    s_nop 1
    v_max_f32 v124, v124, v125
    v_sub_f32 v80, 0, v124
    v_sub_f32 v81, 0, v124
    v_sub_f32 v82, 0, v124
    v_sub_f32 v83, 0, v124
    v_sub_f32 v84, 0, v124
    v_sub_f32 v85, 0, v124
    v_sub_f32 v86, 0, v124
    v_sub_f32 v87, 0, v124
    v_sub_f32 v88, 0, v124
    v_sub_f32 v89, 0, v124
    v_sub_f32 v90, 0, v124
    v_sub_f32 v91, 0, v124
    v_sub_f32 v92, 0, v124
    v_sub_f32 v93, 0, v124
    v_sub_f32 v94, 0, v124
    v_sub_f32 v95, 0, v124
    s_mul_i32 s16, s12, 81920
    s_mul_i32 s24, s3, 2560
    s_add_u32 s16, s16, s24
    s_add_u32 s16, s16, 71303168
    s_mov_b32 s18, s24
    s_lshl_b32 s17, s12, 17
    s_lshl_b32 s23, s3, 12
    s_add_u32 s17, s17, s23
    s_add_u32 s17, s17, 75497472
    s_add_u32 s21, s23, 10752
    s_mov_b32 m0, s18
    s_nop 0
    buffer_load_dwordx4 v112, s[8:11], s16 offen lds
    buffer_load_dwordx4 v112, s[8:11], s16 offen offset:1024 lds
    buffer_load_dwordx4 v112, s[8:11], s16 offen offset:2048 lds
    s_mov_b32 m0, s21
    s_nop 0
    buffer_load_dwordx4 v112, s[8:11], s17 offen lds
    buffer_load_dwordx4 v112, s[8:11], s17 offen offset:1024 lds
    buffer_load_dwordx4 v112, s[8:11], s17 offen offset:2048 lds
    buffer_load_dwordx4 v112, s[8:11], s17 offen offset:3072 lds
    s_add_u32 s16, s16, 10240
    s_add_u32 s17, s17, 16384
    s_add_u32 s18, s18, 27136
    s_add_u32 s21, s21, 27136
    s_cmp_ge_u32 s18, 81408
    s_cselect_b32 s24, 81408, 0
    s_sub_u32 s18, s18, s24
    s_sub_u32 s21, s21, s24
    s_mov_b32 m0, s18
    s_nop 0
    buffer_load_dwordx4 v112, s[8:11], s16 offen lds
    buffer_load_dwordx4 v112, s[8:11], s16 offen offset:1024 lds
    buffer_load_dwordx4 v112, s[8:11], s16 offen offset:2048 lds
    s_mov_b32 m0, s21
    s_nop 0
    buffer_load_dwordx4 v112, s[8:11], s17 offen lds
    buffer_load_dwordx4 v112, s[8:11], s17 offen offset:1024 lds
    buffer_load_dwordx4 v112, s[8:11], s17 offen offset:2048 lds
    buffer_load_dwordx4 v112, s[8:11], s17 offen offset:3072 lds
    s_add_u32 s16, s16, 10240
    s_add_u32 s17, s17, 16384
    s_add_u32 s18, s18, 27136
    s_add_u32 s21, s21, 27136
    s_cmp_ge_u32 s18, 81408
    s_cselect_b32 s24, 81408, 0
    s_sub_u32 s18, s18, s24
    s_sub_u32 s21, s21, s24
    v_accvgpr_write_b32 a0, 0
    v_accvgpr_write_b32 a1, 0
    v_accvgpr_write_b32 a2, 0
    v_accvgpr_write_b32 a3, 0
    v_accvgpr_write_b32 a4, 0
    v_accvgpr_write_b32 a5, 0
    v_accvgpr_write_b32 a6, 0
    v_accvgpr_write_b32 a7, 0
    v_accvgpr_write_b32 a8, 0
    v_accvgpr_write_b32 a9, 0
    v_accvgpr_write_b32 a10, 0
    v_accvgpr_write_b32 a11, 0
    v_accvgpr_write_b32 a12, 0
    v_accvgpr_write_b32 a13, 0
    v_accvgpr_write_b32 a14, 0
    v_accvgpr_write_b32 a15, 0
    v_accvgpr_write_b32 a16, 0
    v_accvgpr_write_b32 a17, 0
    v_accvgpr_write_b32 a18, 0
    v_accvgpr_write_b32 a19, 0
    v_accvgpr_write_b32 a20, 0
    v_accvgpr_write_b32 a21, 0
    v_accvgpr_write_b32 a22, 0
    v_accvgpr_write_b32 a23, 0
    v_accvgpr_write_b32 a24, 0
    v_accvgpr_write_b32 a25, 0
    v_accvgpr_write_b32 a26, 0
    v_accvgpr_write_b32 a27, 0
    v_accvgpr_write_b32 a28, 0
    v_accvgpr_write_b32 a29, 0
    v_accvgpr_write_b32 a30, 0
    v_accvgpr_write_b32 a31, 0
    v_mov_b32 v96, 0
    v_mov_b32 v97, 0
    v_mov_b32 v98, 0
    v_mov_b32 v99, 0
    v_mov_b32 v100, 0
    v_mov_b32 v101, 0
    v_mov_b32 v102, 0
    v_mov_b32 v103, 0
    v_mov_b32 v104, 0
    v_mov_b32 v105, 0
    v_mov_b32 v106, 0
    v_mov_b32 v107, 0
    v_mov_b32 v108, 0
    v_mov_b32 v109, 0
    v_mov_b32 v110, 0
    v_mov_b32 v111, 0
    s_mov_b32 s20, 27136
    v_mov_b32 v116, v112
    v_mov_b32 v118, v112
    v_add_u32 v117, 27136, v112
    v_mov_b32 v127, v113
    v_add_u32 v114, 27136, v113
    v_mov_b32 v119, v121
    v_add_u32 v120, 27136, v121
    s_mov_b32 s26, 1
    s_waitcnt vmcnt(7)
    s_barrier
    ds_read_b64_tr_b16 a[64:65], v127 offset:0
    ds_read_b64_tr_b16 a[66:67], v127 offset:256
    ds_read_b64_tr_b16 a[68:69], v119 offset:0
    s_waitcnt lgkmcnt(0)
    v_mfma_f32_32x32x16_bf16 v[0:15], a[64:67], a[32:35], v[64:79]
    v_mfma_f32_32x32x16_bf16 v[16:31], a[64:67], a[36:39], v[80:95]
    v_mfma_f32_32x32x16_bf16 v[0:15], a[68:71], a[40:43], v[0:15]
    v_mfma_f32_32x32x16_bf16 v[16:31], a[68:71], a[44:47], v[16:31]
    ds_read_b64_tr_b16 a[48:49], v127 offset:1280
    ds_read_b64_tr_b16 a[50:51], v127 offset:1536
    ds_read_b64_tr_b16 a[52:53], v119 offset:1280
    ds_read_b128 a[56:59], v118 offset:26112
    ds_read_b128 a[60:63], v116 offset:10752
    s_nop 7
    s_nop 7
    s_branch L_B_main
L_B_ok:
    s_cmp_lg_u32 s3, 0
    s_cbranch_scc1 L_pub_2
    v_accvgpr_read_b32 v96, a84
    v_mov_b32 v97, 0
    v_add_u32 v96, 1, v96
    s_mov_b64 exec, 1
    buffer_store_dword v96, v97, s[8:11], s48 offen sc1
    s_mov_b64 exec, -1
L_pub_2:
    s_cmp_ge_u32 s2, 32
    s_cbranch_scc1 L_k3_done
    s_barrier
    v_accvgpr_read_b32 v112, a85
    s_load_dwordx2 s[32:33], s[0:1], 40
    s_load_dwordx2 s[34:35], s[0:1], 64
    s_load_dwordx2 s[36:37], s[0:1], 72
    s_load_dwordx2 s[38:39], s[0:1], 88
    v_mbcnt_lo_u32_b32 v100, -1, 0
    v_mbcnt_hi_u32_b32 v100, -1, v100
    v_lshlrev_b32 v96, 4, v100
    v_lshrrev_b32 v102, 5, v100
    v_and_b32 v101, 0x13, v100
    v_and_b32 v104, 4, v100
    v_lshl_or_b32 v101, v104, 1, v101
    v_bfe_u32 v104, v100, 3, 1
    v_lshl_or_b32 v101, v104, 2, v101
    v_lshrrev_b32 v104, 3, v100
    v_and_b32 v105, 7, v100
    v_bfe_u32 v106, v104, 1, 1
    v_lshlrev_b32 v106, 2, v106
    v_xor_b32 v105, v105, v106
    v_mul_u32_u24 v104, 1152, v104
    v_lshl_add_u32 v97, v105, 4, v104
    v_bfe_u32 v104, v100, 2, 2
    v_lshl_add_u32 v105, v102, 3, v104
    v_lshlrev_b32 v105, 7, v105
    v_bfe_u32 v106, v100, 4, 1
    v_and_b32 v107, 1, v100
    v_lshl_or_b32 v106, v106, 1, v107
    v_bfe_u32 v107, v104, 1, 1
    v_lshlrev_b32 v107, 2, v107
    v_bfe_u32 v108, v100, 1, 1
    v_lshl_add_u32 v105, v108, 3, v105
    s_mul_i32 s24, s3, 20480
    v_add_u32 v105, s24, v105
    v_or_b32 v108, 0, v106
    v_xor_b32 v108, v108, v107
    v_lshl_add_u32 v98, v108, 4, v105
    v_or_b32 v108, 4, v106
    v_xor_b32 v108, v108, v107
    v_lshl_add_u32 v99, v108, 4, v105
    s_waitcnt lgkmcnt(0)
    s_mov_b32 s8, s38
    s_mov_b32 s9, s39
    s_mov_b32 s10, 0x10000000
    s_mov_b32 s11, 0x00020000
    s_mov_b32 s16, s36
    s_mov_b32 s17, s37
    s_mov_b32 s18, 0x480000
    s_mov_b32 s19, 0x00020000
    s_and_b32 s50, s2, 7
    s_lshl_b32 s50, s50, 12
    s_add_u32 s50, s50, 92274688
    v_and_b32 v113, 31, v100
    v_lshlrev_b32 v113, 7, v113
    s_mov_b32 s52, 8
    s_branch L_k3_bt
    s_branch L_k3_done
L_k3_hi:
    s_bfe_u32 s52, s2, 0x30005
    s_and_b32 s25, s2, 7
    s_bfe_u32 s29, s2, 0x50003
    s_mul_i32 s31, s25, 45
    s_add_u32 s31, s31, 1
    s_add_u32 s26, s31, 45
    s_lshr_b32 s31, s31, 1
    s_lshr_b32 s26, s26, 1
    s_add_u32 s31, s31, s29
    s_sub_u32 s31, s31, 9
    s_cmp_lt_i32 s31, s26
    s_cbranch_scc1 L_imok_3
    s_lshr_b32 s31, s25, 1
    s_add_u32 s31, s31, 180
L_imok_3:
    s_add_u32 s31, s31, 72
    s_cmp_ge_u32 s29, 9
    s_cbranch_scc1 L_imend_5
    s_mul_i32 s31, s25, 9
    s_add_u32 s31, s31, s29
L_imend_5:
    s_load_dwordx2 s[32:33], s[0:1], 40
    s_load_dwordx2 s[34:35], s[0:1], 64
    s_load_dwordx2 s[36:37], s[0:1], 72
    s_load_dwordx2 s[38:39], s[0:1], 88
    v_and_b32 v100, 63, v0
    v_lshrrev_b32 v104, 6, v0
    v_lshlrev_b32 v96, 4, v100
    v_readfirstlane_b32 s3, v104
    v_lshrrev_b32 v102, 5, v100
    v_and_b32 v101, 0x13, v100
    v_and_b32 v104, 4, v100
    v_lshl_or_b32 v101, v104, 1, v101
    v_bfe_u32 v104, v100, 3, 1
    v_lshl_or_b32 v101, v104, 2, v101
    v_lshrrev_b32 v104, 3, v100
    v_and_b32 v105, 7, v100
    v_bfe_u32 v106, v104, 1, 1
    v_lshlrev_b32 v106, 2, v106
    v_xor_b32 v105, v105, v106
    v_mul_u32_u24 v104, 1152, v104
    v_lshl_add_u32 v97, v105, 4, v104
    v_bfe_u32 v104, v100, 2, 2
    v_lshl_add_u32 v105, v102, 3, v104
    v_lshlrev_b32 v105, 7, v105
    v_bfe_u32 v106, v100, 4, 1
    v_and_b32 v107, 1, v100
    v_lshl_or_b32 v106, v106, 1, v107
    v_bfe_u32 v107, v104, 1, 1
    v_lshlrev_b32 v107, 2, v107
    v_bfe_u32 v108, v100, 1, 1
    v_lshl_add_u32 v105, v108, 3, v105
    s_mul_i32 s24, s3, 20480
    v_add_u32 v105, s24, v105
    v_or_b32 v108, 0, v106
    v_xor_b32 v108, v108, v107
    v_lshl_add_u32 v98, v108, 4, v105
    v_or_b32 v108, 4, v106
    v_xor_b32 v108, v108, v107
    v_lshl_add_u32 v99, v108, 4, v105
    s_waitcnt lgkmcnt(0)
    s_mov_b32 s8, s38
    s_mov_b32 s9, s39
    s_mov_b32 s10, 0x10000000
    s_mov_b32 s11, 0x00020000
    s_mov_b32 s16, s36
    s_mov_b32 s17, s37
    s_mov_b32 s18, 0x480000
    s_mov_b32 s19, 0x00020000
    s_and_b32 s50, s2, 7
    s_lshl_b32 s50, s50, 12
    s_add_u32 s50, s50, 92274688
    v_and_b32 v113, 31, v100
    v_lshlrev_b32 v113, 7, v113
    buffer_load_dword v112, v113, s[8:11], s50 offen sc1
    s_cmp_ge_u32 s31, 252
    s_cbranch_scc1 L_k3_bt
    s_mov_b32 s12, s32
    s_mov_b32 s13, s33
    s_mov_b32 s14, 0x480000
    s_mov_b32 s15, 0x00020000
    s_mov_b32 s30, 0
    s_cmp_ge_u32 s31, 72
    s_cbranch_scc1 L_out_A2
    s_mul_i32 s27, s31, 7282
    s_lshr_b32 s27, s27, 16
    s_mul_i32 s28, s27, 9
    s_sub_u32 s28, s31, s28
    s_mul_i32 s27, s27, 3
    s_add_u32 s20, s27, 0
    s_lshl_b32 s20, s20, 18
    s_lshl_b32 s25, s3, 10
    s_add_u32 s20, s20, s25
    s_add_u32 s20, s20, 50331648
    s_add_u32 s21, s27, 1
    s_lshl_b32 s21, s21, 18
    s_lshl_b32 s25, s3, 10
    s_add_u32 s21, s21, s25
    s_add_u32 s21, s21, 50331648
    s_add_u32 s22, s27, 2
    s_lshl_b32 s22, s22, 18
    s_lshl_b32 s25, s3, 10
    s_add_u32 s22, s22, s25
    s_add_u32 s22, s22, 50331648
    s_mul_i32 s23, s3, 18432
    s_lshl_b32 s25, s28, 7
    s_add_u32 s23, s23, s25
    buffer_load_dwordx4 a[0:3], v96, s[8:11], s20 offen
    buffer_load_dwordx4 a[4:7], v96, s[8:11], s21 offen
    buffer_load_dwordx4 a[8:11], v96, s[8:11], s22 offen
    s_add_u32 m0, s24, 0
    s_add_u32 s20, s20, 4096
    buffer_load_dwordx4 v97, s[12:15], s23 offen lds
    s_add_u32 m0, s24, 1024
    s_add_u32 s25, s23, 9216
    buffer_load_dwordx4 v97, s[12:15], s25 offen lds
    s_add_u32 s21, s21, 4096
    s_add_u32 s22, s22, 4096
    s_add_u32 s23, s23, 73728
    buffer_load_dwordx4 a[12:15], v96, s[8:11], s20 offen
    buffer_load_dwordx4 a[16:19], v96, s[8:11], s21 offen
    buffer_load_dwordx4 a[20:23], v96, s[8:11], s22 offen
    s_add_u32 m0, s24, 2048
    s_add_u32 s20, s20, 4096
    buffer_load_dwordx4 v97, s[12:15], s23 offen lds
    s_add_u32 m0, s24, 3072
    s_add_u32 s25, s23, 9216
    buffer_load_dwordx4 v97, s[12:15], s25 offen lds
    s_add_u32 s21, s21, 4096
    s_add_u32 s22, s22, 4096
    s_add_u32 s23, s23, 73728
    buffer_load_dwordx4 a[24:27], v96, s[8:11], s20 offen
    buffer_load_dwordx4 a[28:31], v96, s[8:11], s21 offen
    buffer_load_dwordx4 a[32:35], v96, s[8:11], s22 offen
    s_add_u32 m0, s24, 4096
    s_add_u32 s20, s20, 4096
    buffer_load_dwordx4 v97, s[12:15], s23 offen lds
    s_add_u32 m0, s24, 5120
    s_add_u32 s25, s23, 9216
    buffer_load_dwordx4 v97, s[12:15], s25 offen lds
    s_add_u32 s21, s21, 4096
    s_add_u32 s22, s22, 4096
    s_add_u32 s23, s23, 73728
    buffer_load_dwordx4 a[36:39], v96, s[8:11], s20 offen
    buffer_load_dwordx4 a[40:43], v96, s[8:11], s21 offen
    buffer_load_dwordx4 a[44:47], v96, s[8:11], s22 offen
    s_add_u32 m0, s24, 6144
    s_add_u32 s20, s20, 4096
    buffer_load_dwordx4 v97, s[12:15], s23 offen lds
    s_add_u32 m0, s24, 7168
    s_add_u32 s25, s23, 9216
    buffer_load_dwordx4 v97, s[12:15], s25 offen lds
    s_add_u32 s21, s21, 4096
    s_add_u32 s22, s22, 4096
    s_add_u32 s23, s23, 73728
    buffer_load_dwordx4 a[48:51], v96, s[8:11], s20 offen
    buffer_load_dwordx4 a[52:55], v96, s[8:11], s21 offen
    buffer_load_dwordx4 a[56:59], v96, s[8:11], s22 offen
    s_add_u32 m0, s24, 8192
    s_add_u32 s20, s20, 4096
    buffer_load_dwordx4 v97, s[12:15], s23 offen lds
    s_add_u32 m0, s24, 9216
    s_add_u32 s25, s23, 9216
    buffer_load_dwordx4 v97, s[12:15], s25 offen lds
    s_add_u32 s21, s21, 4096
    s_add_u32 s22, s22, 4096
    s_add_u32 s23, s23, 73728
    buffer_load_dwordx4 a[60:63], v96, s[8:11], s20 offen
    buffer_load_dwordx4 a[64:67], v96, s[8:11], s21 offen
    buffer_load_dwordx4 a[68:71], v96, s[8:11], s22 offen
    s_add_u32 m0, s24, 10240
    s_add_u32 s20, s20, 4096
    buffer_load_dwordx4 v97, s[12:15], s23 offen lds
    s_add_u32 m0, s24, 11264
    s_add_u32 s25, s23, 9216
    buffer_load_dwordx4 v97, s[12:15], s25 offen lds
    s_add_u32 s21, s21, 4096
    s_add_u32 s22, s22, 4096
    s_add_u32 s23, s23, 73728
    s_waitcnt vmcnt(25)
    ds_read_b64_tr_b16 a[96:97], v98 offset:0
    ds_read_b64_tr_b16 a[98:99], v98 offset:512
    ds_read_b64_tr_b16 a[100:101], v99 offset:0
    ds_read_b64_tr_b16 a[102:103], v99 offset:512
    s_waitcnt vmcnt(20) lgkmcnt(0)
    v_mfma_f32_32x32x16_bf16 v[0:15], a[96:99], a[0:3], 0
    ds_read_b64_tr_b16 a[104:105], v98 offset:2048
    ds_read_b64_tr_b16 a[106:107], v98 offset:2560
    ds_read_b64_tr_b16 a[108:109], v99 offset:2048
    ds_read_b64_tr_b16 a[110:111], v99 offset:2560
    buffer_load_dwordx4 a[72:75], v96, s[8:11], s20 offen
    buffer_load_dwordx4 a[76:79], v96, s[8:11], s21 offen
    buffer_load_dwordx4 a[80:83], v96, s[8:11], s22 offen
    v_mfma_f32_32x32x16_bf16 v[48:63], a[100:103], a[0:3], 0
    s_add_u32 m0, s24, 12288
    s_add_u32 s20, s20, 4096
    buffer_load_dwordx4 v97, s[12:15], s23 offen lds
    v_mfma_f32_32x32x16_bf16 v[16:31], a[96:99], a[4:7], 0
    s_add_u32 m0, s24, 13312
    s_add_u32 s25, s23, 9216
    buffer_load_dwordx4 v97, s[12:15], s25 offen lds
    v_mfma_f32_32x32x16_bf16 v[64:79], a[100:103], a[4:7], 0
    s_add_u32 s21, s21, 4096
    s_add_u32 s22, s22, 4096
    s_add_u32 s23, s23, 73728
    v_mfma_f32_32x32x16_bf16 v[32:47], a[96:99], a[8:11], 0
    v_mfma_f32_32x32x16_bf16 v[80:95], a[100:103], a[8:11], 0
    s_waitcnt vmcnt(20) lgkmcnt(0)
    v_mfma_f32_32x32x16_bf16 v[0:15], a[104:107], a[12:15], v[0:15]
    ds_read_b64_tr_b16 a[96:97], v98 offset:4096
    ds_read_b64_tr_b16 a[98:99], v98 offset:4608
    ds_read_b64_tr_b16 a[100:101], v99 offset:4096
    ds_read_b64_tr_b16 a[102:103], v99 offset:4608
    buffer_load_dwordx4 a[84:87], v96, s[8:11], s20 offen
    buffer_load_dwordx4 a[88:91], v96, s[8:11], s21 offen
    buffer_load_dwordx4 a[92:95], v96, s[8:11], s22 offen
    v_mfma_f32_32x32x16_bf16 v[48:63], a[108:111], a[12:15], v[48:63]
    s_add_u32 m0, s24, 14336
    s_add_u32 s20, s20, 4096
    buffer_load_dwordx4 v97, s[12:15], s23 offen lds
    v_mfma_f32_32x32x16_bf16 v[16:31], a[104:107], a[16:19], v[16:31]
    s_add_u32 m0, s24, 15360
    s_add_u32 s25, s23, 9216
    buffer_load_dwordx4 v97, s[12:15], s25 offen lds
    v_mfma_f32_32x32x16_bf16 v[64:79], a[108:111], a[16:19], v[64:79]
    s_add_u32 s21, s21, 4096
    s_add_u32 s22, s22, 4096
    s_add_u32 s23, s23, 73728
    v_mfma_f32_32x32x16_bf16 v[32:47], a[104:107], a[20:23], v[32:47]
    v_mfma_f32_32x32x16_bf16 v[80:95], a[108:111], a[20:23], v[80:95]
    s_waitcnt vmcnt(20) lgkmcnt(0)
    v_mfma_f32_32x32x16_bf16 v[0:15], a[96:99], a[24:27], v[0:15]
    ds_read_b64_tr_b16 a[104:105], v98 offset:6144
    ds_read_b64_tr_b16 a[106:107], v98 offset:6656
    ds_read_b64_tr_b16 a[108:109], v99 offset:6144
    ds_read_b64_tr_b16 a[110:111], v99 offset:6656
    buffer_load_dwordx4 a[0:3], v96, s[8:11], s20 offen
    buffer_load_dwordx4 a[4:7], v96, s[8:11], s21 offen
    buffer_load_dwordx4 a[8:11], v96, s[8:11], s22 offen
    v_mfma_f32_32x32x16_bf16 v[48:63], a[100:103], a[24:27], v[48:63]
    s_add_u32 m0, s24, 0
    s_add_u32 s20, s20, 4096
    buffer_load_dwordx4 v97, s[12:15], s23 offen lds
    v_mfma_f32_32x32x16_bf16 v[16:31], a[96:99], a[28:31], v[16:31]
    s_add_u32 m0, s24, 1024
    s_add_u32 s25, s23, 9216
    buffer_load_dwordx4 v97, s[12:15], s25 offen lds
    v_mfma_f32_32x32x16_bf16 v[64:79], a[100:103], a[28:31], v[64:79]
    s_add_u32 s21, s21, 4096
    s_add_u32 s22, s22, 4096
    s_add_u32 s23, s23, 73728
    v_mfma_f32_32x32x16_bf16 v[32:47], a[96:99], a[32:35], v[32:47]
    v_mfma_f32_32x32x16_bf16 v[80:95], a[100:103], a[32:35], v[80:95]
    s_waitcnt vmcnt(20) lgkmcnt(0)
    v_mfma_f32_32x32x16_bf16 v[0:15], a[104:107], a[36:39], v[0:15]
    ds_read_b64_tr_b16 a[96:97], v98 offset:8192
    ds_read_b64_tr_b16 a[98:99], v98 offset:8704
    ds_read_b64_tr_b16 a[100:101], v99 offset:8192
    ds_read_b64_tr_b16 a[102:103], v99 offset:8704
    buffer_load_dwordx4 a[12:15], v96, s[8:11], s20 offen
    buffer_load_dwordx4 a[16:19], v96, s[8:11], s21 offen
    buffer_load_dwordx4 a[20:23], v96, s[8:11], s22 offen
    v_mfma_f32_32x32x16_bf16 v[48:63], a[108:111], a[36:39], v[48:63]
    s_add_u32 m0, s24, 2048
    s_add_u32 s20, s20, 4096
    buffer_load_dwordx4 v97, s[12:15], s23 offen lds
    v_mfma_f32_32x32x16_bf16 v[16:31], a[104:107], a[40:43], v[16:31]
    s_add_u32 m0, s24, 3072
    s_add_u32 s25, s23, 9216
    buffer_load_dwordx4 v97, s[12:15], s25 offen lds
    v_mfma_f32_32x32x16_bf16 v[64:79], a[108:111], a[40:43], v[64:79]
    s_add_u32 s21, s21, 4096
    s_add_u32 s22, s22, 4096
    s_add_u32 s23, s23, 73728
    v_mfma_f32_32x32x16_bf16 v[32:47], a[104:107], a[44:47], v[32:47]
    v_mfma_f32_32x32x16_bf16 v[80:95], a[108:111], a[44:47], v[80:95]
    s_waitcnt vmcnt(20) lgkmcnt(0)
    v_mfma_f32_32x32x16_bf16 v[0:15], a[96:99], a[48:51], v[0:15]
    ds_read_b64_tr_b16 a[104:105], v98 offset:10240
    ds_read_b64_tr_b16 a[106:107], v98 offset:10752
    ds_read_b64_tr_b16 a[108:109], v99 offset:10240
    ds_read_b64_tr_b16 a[110:111], v99 offset:10752
    buffer_load_dwordx4 a[24:27], v96, s[8:11], s20 offen
    buffer_load_dwordx4 a[28:31], v96, s[8:11], s21 offen
    buffer_load_dwordx4 a[32:35], v96, s[8:11], s22 offen
    v_mfma_f32_32x32x16_bf16 v[48:63], a[100:103], a[48:51], v[48:63]
    s_add_u32 m0, s24, 4096
    s_add_u32 s20, s20, 4096
    buffer_load_dwordx4 v97, s[12:15], s23 offen lds
    v_mfma_f32_32x32x16_bf16 v[16:31], a[96:99], a[52:55], v[16:31]
    s_add_u32 m0, s24, 5120
    s_add_u32 s25, s23, 9216
    buffer_load_dwordx4 v97, s[12:15], s25 offen lds
    v_mfma_f32_32x32x16_bf16 v[64:79], a[100:103], a[52:55], v[64:79]
    s_add_u32 s21, s21, 4096
    s_add_u32 s22, s22, 4096
    s_add_u32 s23, s23, 73728
    v_mfma_f32_32x32x16_bf16 v[32:47], a[96:99], a[56:59], v[32:47]
    v_mfma_f32_32x32x16_bf16 v[80:95], a[100:103], a[56:59], v[80:95]
    s_waitcnt vmcnt(20) lgkmcnt(0)
    v_mfma_f32_32x32x16_bf16 v[0:15], a[104:107], a[60:63], v[0:15]
    ds_read_b64_tr_b16 a[96:97], v98 offset:12288
    ds_read_b64_tr_b16 a[98:99], v98 offset:12800
    ds_read_b64_tr_b16 a[100:101], v99 offset:12288
    ds_read_b64_tr_b16 a[102:103], v99 offset:12800
    buffer_load_dwordx4 a[36:39], v96, s[8:11], s20 offen
    buffer_load_dwordx4 a[40:43], v96, s[8:11], s21 offen
    buffer_load_dwordx4 a[44:47], v96, s[8:11], s22 offen
    v_mfma_f32_32x32x16_bf16 v[48:63], a[108:111], a[60:63], v[48:63]
    s_add_u32 m0, s24, 6144
    s_add_u32 s20, s20, 4096
    buffer_load_dwordx4 v97, s[12:15], s23 offen lds
    v_mfma_f32_32x32x16_bf16 v[16:31], a[104:107], a[64:67], v[16:31]
    s_add_u32 m0, s24, 7168
    s_add_u32 s25, s23, 9216
    buffer_load_dwordx4 v97, s[12:15], s25 offen lds
    v_mfma_f32_32x32x16_bf16 v[64:79], a[108:111], a[64:67], v[64:79]
    s_add_u32 s21, s21, 4096
    s_add_u32 s22, s22, 4096
    s_add_u32 s23, s23, 73728
    v_mfma_f32_32x32x16_bf16 v[32:47], a[104:107], a[68:71], v[32:47]
    v_mfma_f32_32x32x16_bf16 v[80:95], a[108:111], a[68:71], v[80:95]
    s_waitcnt vmcnt(20) lgkmcnt(0)
    v_mfma_f32_32x32x16_bf16 v[0:15], a[96:99], a[72:75], v[0:15]
    ds_read_b64_tr_b16 a[104:105], v98 offset:14336
    ds_read_b64_tr_b16 a[106:107], v98 offset:14848
    ds_read_b64_tr_b16 a[108:109], v99 offset:14336
    ds_read_b64_tr_b16 a[110:111], v99 offset:14848
    buffer_load_dwordx4 a[48:51], v96, s[8:11], s20 offen
    buffer_load_dwordx4 a[52:55], v96, s[8:11], s21 offen
    buffer_load_dwordx4 a[56:59], v96, s[8:11], s22 offen
    v_mfma_f32_32x32x16_bf16 v[48:63], a[100:103], a[72:75], v[48:63]
    s_add_u32 m0, s24, 8192
    s_add_u32 s20, s20, 4096
    buffer_load_dwordx4 v97, s[12:15], s23 offen lds
    v_mfma_f32_32x32x16_bf16 v[16:31], a[96:99], a[76:79], v[16:31]
    s_add_u32 m0, s24, 9216
    s_add_u32 s25, s23, 9216
    buffer_load_dwordx4 v97, s[12:15], s25 offen lds
    v_mfma_f32_32x32x16_bf16 v[64:79], a[100:103], a[76:79], v[64:79]
    s_add_u32 s21, s21, 4096
    s_add_u32 s22, s22, 4096
    s_add_u32 s23, s23, 73728
    v_mfma_f32_32x32x16_bf16 v[32:47], a[96:99], a[80:83], v[32:47]
    v_mfma_f32_32x32x16_bf16 v[80:95], a[100:103], a[80:83], v[80:95]
    s_waitcnt vmcnt(20) lgkmcnt(0)
    v_mfma_f32_32x32x16_bf16 v[0:15], a[104:107], a[84:87], v[0:15]
    ds_read_b64_tr_b16 a[96:97], v98 offset:0
    ds_read_b64_tr_b16 a[98:99], v98 offset:512
    ds_read_b64_tr_b16 a[100:101], v99 offset:0
    ds_read_b64_tr_b16 a[102:103], v99 offset:512
    buffer_load_dwordx4 a[60:63], v96, s[8:11], s20 offen
    buffer_load_dwordx4 a[64:67], v96, s[8:11], s21 offen
    buffer_load_dwordx4 a[68:71], v96, s[8:11], s22 offen
    v_mfma_f32_32x32x16_bf16 v[48:63], a[108:111], a[84:87], v[48:63]
    s_add_u32 m0, s24, 10240
    s_add_u32 s20, s20, 4096
    buffer_load_dwordx4 v97, s[12:15], s23 offen lds
    v_mfma_f32_32x32x16_bf16 v[16:31], a[104:107], a[88:91], v[16:31]
    s_add_u32 m0, s24, 11264
    s_add_u32 s25, s23, 9216
    buffer_load_dwordx4 v97, s[12:15], s25 offen lds
    v_mfma_f32_32x32x16_bf16 v[64:79], a[108:111], a[88:91], v[64:79]
    s_add_u32 s21, s21, 4096
    s_add_u32 s22, s22, 4096
    s_add_u32 s23, s23, 73728
    v_mfma_f32_32x32x16_bf16 v[32:47], a[104:107], a[92:95], v[32:47]
    v_mfma_f32_32x32x16_bf16 v[80:95], a[108:111], a[92:95], v[80:95]
    s_mov_b32 s26, 6
.p2align 6
L_O_6:
    s_waitcnt vmcnt(20) lgkmcnt(0)
    v_mfma_f32_32x32x16_bf16 v[0:15], a[96:99], a[0:3], v[0:15]
    ds_read_b64_tr_b16 a[104:105], v98 offset:2048
    ds_read_b64_tr_b16 a[106:107], v98 offset:2560
    ds_read_b64_tr_b16 a[108:109], v99 offset:2048
    ds_read_b64_tr_b16 a[110:111], v99 offset:2560
    buffer_load_dwordx4 a[72:75], v96, s[8:11], s20 offen
    buffer_load_dwordx4 a[76:79], v96, s[8:11], s21 offen
    buffer_load_dwordx4 a[80:83], v96, s[8:11], s22 offen
    v_mfma_f32_32x32x16_bf16 v[48:63], a[100:103], a[0:3], v[48:63]
    s_add_u32 m0, s24, 12288
    s_add_u32 s20, s20, 4096
    buffer_load_dwordx4 v97, s[12:15], s23 offen lds
    v_mfma_f32_32x32x16_bf16 v[16:31], a[96:99], a[4:7], v[16:31]
    s_add_u32 m0, s24, 13312
    s_add_u32 s25, s23, 9216
    buffer_load_dwordx4 v97, s[12:15], s25 offen lds
    v_mfma_f32_32x32x16_bf16 v[64:79], a[100:103], a[4:7], v[64:79]
    s_add_u32 s21, s21, 4096
    s_add_u32 s22, s22, 4096
    s_add_u32 s23, s23, 73728
    v_mfma_f32_32x32x16_bf16 v[32:47], a[96:99], a[8:11], v[32:47]
    v_mfma_f32_32x32x16_bf16 v[80:95], a[100:103], a[8:11], v[80:95]
    s_waitcnt vmcnt(20) lgkmcnt(0)
    v_mfma_f32_32x32x16_bf16 v[0:15], a[104:107], a[12:15], v[0:15]
    ds_read_b64_tr_b16 a[96:97], v98 offset:4096
    ds_read_b64_tr_b16 a[98:99], v98 offset:4608
    ds_read_b64_tr_b16 a[100:101], v99 offset:4096
    ds_read_b64_tr_b16 a[102:103], v99 offset:4608
    buffer_load_dwordx4 a[84:87], v96, s[8:11], s20 offen
    buffer_load_dwordx4 a[88:91], v96, s[8:11], s21 offen
    buffer_load_dwordx4 a[92:95], v96, s[8:11], s22 offen
    v_mfma_f32_32x32x16_bf16 v[48:63], a[108:111], a[12:15], v[48:63]
    s_add_u32 m0, s24, 14336
    s_add_u32 s20, s20, 4096
    buffer_load_dwordx4 v97, s[12:15], s23 offen lds
    v_mfma_f32_32x32x16_bf16 v[16:31], a[104:107], a[16:19], v[16:31]
    s_add_u32 m0, s24, 15360
    s_add_u32 s25, s23, 9216
    buffer_load_dwordx4 v97, s[12:15], s25 offen lds
    v_mfma_f32_32x32x16_bf16 v[64:79], a[108:111], a[16:19], v[64:79]
    s_add_u32 s21, s21, 4096
    s_add_u32 s22, s22, 4096
    s_add_u32 s23, s23, 73728
    v_mfma_f32_32x32x16_bf16 v[32:47], a[104:107], a[20:23], v[32:47]
    v_mfma_f32_32x32x16_bf16 v[80:95], a[108:111], a[20:23], v[80:95]
    s_waitcnt vmcnt(20) lgkmcnt(0)
    v_mfma_f32_32x32x16_bf16 v[0:15], a[96:99], a[24:27], v[0:15]
    ds_read_b64_tr_b16 a[104:105], v98 offset:6144
    ds_read_b64_tr_b16 a[106:107], v98 offset:6656
    ds_read_b64_tr_b16 a[108:109], v99 offset:6144
    ds_read_b64_tr_b16 a[110:111], v99 offset:6656
    buffer_load_dwordx4 a[0:3], v96, s[8:11], s20 offen
    buffer_load_dwordx4 a[4:7], v96, s[8:11], s21 offen
    buffer_load_dwordx4 a[8:11], v96, s[8:11], s22 offen
    v_mfma_f32_32x32x16_bf16 v[48:63], a[100:103], a[24:27], v[48:63]
    s_add_u32 m0, s24, 0
    s_add_u32 s20, s20, 4096
    buffer_load_dwordx4 v97, s[12:15], s23 offen lds
    v_mfma_f32_32x32x16_bf16 v[16:31], a[96:99], a[28:31], v[16:31]
    s_add_u32 m0, s24, 1024
    s_add_u32 s25, s23, 9216
    buffer_load_dwordx4 v97, s[12:15], s25 offen lds
    v_mfma_f32_32x32x16_bf16 v[64:79], a[100:103], a[28:31], v[64:79]
    s_add_u32 s21, s21, 4096
    s_add_u32 s22, s22, 4096
    s_add_u32 s23, s23, 73728
    v_mfma_f32_32x32x16_bf16 v[32:47], a[96:99], a[32:35], v[32:47]
    v_mfma_f32_32x32x16_bf16 v[80:95], a[100:103], a[32:35], v[80:95]
    s_waitcnt vmcnt(20) lgkmcnt(0)
    v_mfma_f32_32x32x16_bf16 v[0:15], a[104:107], a[36:39], v[0:15]
    ds_read_b64_tr_b16 a[96:97], v98 offset:8192
    ds_read_b64_tr_b16 a[98:99], v98 offset:8704
    ds_read_b64_tr_b16 a[100:101], v99 offset:8192
    ds_read_b64_tr_b16 a[102:103], v99 offset:8704
    buffer_load_dwordx4 a[12:15], v96, s[8:11], s20 offen
    buffer_load_dwordx4 a[16:19], v96, s[8:11], s21 offen
    buffer_load_dwordx4 a[20:23], v96, s[8:11], s22 offen
    v_mfma_f32_32x32x16_bf16 v[48:63], a[108:111], a[36:39], v[48:63]
    s_add_u32 m0, s24, 2048
    s_add_u32 s20, s20, 4096
    buffer_load_dwordx4 v97, s[12:15], s23 offen lds
    v_mfma_f32_32x32x16_bf16 v[16:31], a[104:107], a[40:43], v[16:31]
    s_add_u32 m0, s24, 3072
    s_add_u32 s25, s23, 9216
    buffer_load_dwordx4 v97, s[12:15], s25 offen lds
    v_mfma_f32_32x32x16_bf16 v[64:79], a[108:111], a[40:43], v[64:79]
    s_add_u32 s21, s21, 4096
    s_add_u32 s22, s22, 4096
    s_add_u32 s23, s23, 73728
    v_mfma_f32_32x32x16_bf16 v[32:47], a[104:107], a[44:47], v[32:47]
    v_mfma_f32_32x32x16_bf16 v[80:95], a[108:111], a[44:47], v[80:95]
    s_waitcnt vmcnt(20) lgkmcnt(0)
    v_mfma_f32_32x32x16_bf16 v[0:15], a[96:99], a[48:51], v[0:15]
    ds_read_b64_tr_b16 a[104:105], v98 offset:10240
    ds_read_b64_tr_b16 a[106:107], v98 offset:10752
    ds_read_b64_tr_b16 a[108:109], v99 offset:10240
    ds_read_b64_tr_b16 a[110:111], v99 offset:10752
    buffer_load_dwordx4 a[24:27], v96, s[8:11], s20 offen
    buffer_load_dwordx4 a[28:31], v96, s[8:11], s21 offen
    buffer_load_dwordx4 a[32:35], v96, s[8:11], s22 offen
    v_mfma_f32_32x32x16_bf16 v[48:63], a[100:103], a[48:51], v[48:63]
    s_add_u32 m0, s24, 4096
    s_add_u32 s20, s20, 4096
    buffer_load_dwordx4 v97, s[12:15], s23 offen lds
    v_mfma_f32_32x32x16_bf16 v[16:31], a[96:99], a[52:55], v[16:31]
    s_add_u32 m0, s24, 5120
    s_add_u32 s25, s23, 9216
    buffer_load_dwordx4 v97, s[12:15], s25 offen lds
    v_mfma_f32_32x32x16_bf16 v[64:79], a[100:103], a[52:55], v[64:79]
    s_add_u32 s21, s21, 4096
    s_add_u32 s22, s22, 4096
    s_add_u32 s23, s23, 73728
    v_mfma_f32_32x32x16_bf16 v[32:47], a[96:99], a[56:59], v[32:47]
    v_mfma_f32_32x32x16_bf16 v[80:95], a[100:103], a[56:59], v[80:95]
    s_waitcnt vmcnt(20) lgkmcnt(0)
    v_mfma_f32_32x32x16_bf16 v[0:15], a[104:107], a[60:63], v[0:15]
    ds_read_b64_tr_b16 a[96:97], v98 offset:12288
    ds_read_b64_tr_b16 a[98:99], v98 offset:12800
    ds_read_b64_tr_b16 a[100:101], v99 offset:12288
    ds_read_b64_tr_b16 a[102:103], v99 offset:12800
    buffer_load_dwordx4 a[36:39], v96, s[8:11], s20 offen
    buffer_load_dwordx4 a[40:43], v96, s[8:11], s21 offen
    buffer_load_dwordx4 a[44:47], v96, s[8:11], s22 offen
    v_mfma_f32_32x32x16_bf16 v[48:63], a[108:111], a[60:63], v[48:63]
    s_add_u32 m0, s24, 6144
    s_add_u32 s20, s20, 4096
    buffer_load_dwordx4 v97, s[12:15], s23 offen lds
    v_mfma_f32_32x32x16_bf16 v[16:31], a[104:107], a[64:67], v[16:31]
    s_add_u32 m0, s24, 7168
    s_add_u32 s25, s23, 9216
    buffer_load_dwordx4 v97, s[12:15], s25 offen lds
    v_mfma_f32_32x32x16_bf16 v[64:79], a[108:111], a[64:67], v[64:79]
    s_add_u32 s21, s21, 4096
    s_add_u32 s22, s22, 4096
    s_add_u32 s23, s23, 73728
    v_mfma_f32_32x32x16_bf16 v[32:47], a[104:107], a[68:71], v[32:47]
    v_mfma_f32_32x32x16_bf16 v[80:95], a[108:111], a[68:71], v[80:95]
    s_waitcnt vmcnt(20) lgkmcnt(0)
    v_mfma_f32_32x32x16_bf16 v[0:15], a[96:99], a[72:75], v[0:15]
    ds_read_b64_tr_b16 a[104:105], v98 offset:14336
    ds_read_b64_tr_b16 a[106:107], v98 offset:14848
    ds_read_b64_tr_b16 a[108:109], v99 offset:14336
    ds_read_b64_tr_b16 a[110:111], v99 offset:14848
    buffer_load_dwordx4 a[48:51], v96, s[8:11], s20 offen
    buffer_load_dwordx4 a[52:55], v96, s[8:11], s21 offen
    buffer_load_dwordx4 a[56:59], v96, s[8:11], s22 offen
    v_mfma_f32_32x32x16_bf16 v[48:63], a[100:103], a[72:75], v[48:63]
    s_add_u32 m0, s24, 8192
    s_add_u32 s20, s20, 4096
    buffer_load_dwordx4 v97, s[12:15], s23 offen lds
    v_mfma_f32_32x32x16_bf16 v[16:31], a[96:99], a[76:79], v[16:31]
    s_add_u32 m0, s24, 9216
    s_add_u32 s25, s23, 9216
    buffer_load_dwordx4 v97, s[12:15], s25 offen lds
    v_mfma_f32_32x32x16_bf16 v[64:79], a[100:103], a[76:79], v[64:79]
    s_add_u32 s21, s21, 4096
    s_add_u32 s22, s22, 4096
    s_add_u32 s23, s23, 73728
    v_mfma_f32_32x32x16_bf16 v[32:47], a[96:99], a[80:83], v[32:47]
    v_mfma_f32_32x32x16_bf16 v[80:95], a[100:103], a[80:83], v[80:95]
    s_waitcnt vmcnt(20) lgkmcnt(0)
    v_mfma_f32_32x32x16_bf16 v[0:15], a[104:107], a[84:87], v[0:15]
    ds_read_b64_tr_b16 a[96:97], v98 offset:0
    ds_read_b64_tr_b16 a[98:99], v98 offset:512
    ds_read_b64_tr_b16 a[100:101], v99 offset:0
    ds_read_b64_tr_b16 a[102:103], v99 offset:512
    buffer_load_dwordx4 a[60:63], v96, s[8:11], s20 offen
    buffer_load_dwordx4 a[64:67], v96, s[8:11], s21 offen
    buffer_load_dwordx4 a[68:71], v96, s[8:11], s22 offen
    v_mfma_f32_32x32x16_bf16 v[48:63], a[108:111], a[84:87], v[48:63]
    s_add_u32 m0, s24, 10240
    s_add_u32 s20, s20, 4096
    buffer_load_dwordx4 v97, s[12:15], s23 offen lds
    v_mfma_f32_32x32x16_bf16 v[16:31], a[104:107], a[88:91], v[16:31]
    s_add_u32 m0, s24, 11264
    s_add_u32 s25, s23, 9216
    buffer_load_dwordx4 v97, s[12:15], s25 offen lds
    v_mfma_f32_32x32x16_bf16 v[64:79], a[108:111], a[88:91], v[64:79]
    s_add_u32 s21, s21, 4096
    s_add_u32 s22, s22, 4096
    s_add_u32 s23, s23, 73728
    v_mfma_f32_32x32x16_bf16 v[32:47], a[104:107], a[92:95], v[32:47]
    v_mfma_f32_32x32x16_bf16 v[80:95], a[108:111], a[92:95], v[80:95]
    s_sub_u32 s26, s26, 1
    s_cmp_lg_u32 s26, 0
    s_cbranch_scc1 L_O_6
    s_waitcnt vmcnt(20) lgkmcnt(0)
    v_mfma_f32_32x32x16_bf16 v[0:15], a[96:99], a[0:3], v[0:15]
    ds_read_b64_tr_b16 a[104:105], v98 offset:2048
    ds_read_b64_tr_b16 a[106:107], v98 offset:2560
    ds_read_b64_tr_b16 a[108:109], v99 offset:2048
    ds_read_b64_tr_b16 a[110:111], v99 offset:2560
    buffer_load_dwordx4 a[72:75], v96, s[8:11], s20 offen
    buffer_load_dwordx4 a[76:79], v96, s[8:11], s21 offen
    buffer_load_dwordx4 a[80:83], v96, s[8:11], s22 offen
    v_mfma_f32_32x32x16_bf16 v[48:63], a[100:103], a[0:3], v[48:63]
    s_add_u32 m0, s24, 12288
    s_add_u32 s20, s20, 4096
    buffer_load_dwordx4 v97, s[12:15], s23 offen lds
    v_mfma_f32_32x32x16_bf16 v[16:31], a[96:99], a[4:7], v[16:31]
    s_add_u32 m0, s24, 13312
    s_add_u32 s25, s23, 9216
    buffer_load_dwordx4 v97, s[12:15], s25 offen lds
    v_mfma_f32_32x32x16_bf16 v[64:79], a[100:103], a[4:7], v[64:79]
    s_add_u32 s21, s21, 4096
    s_add_u32 s22, s22, 4096
    s_add_u32 s23, s23, 73728
    v_mfma_f32_32x32x16_bf16 v[32:47], a[96:99], a[8:11], v[32:47]
    v_mfma_f32_32x32x16_bf16 v[80:95], a[100:103], a[8:11], v[80:95]
    s_waitcnt vmcnt(20) lgkmcnt(0)
    v_mfma_f32_32x32x16_bf16 v[0:15], a[104:107], a[12:15], v[0:15]
    ds_read_b64_tr_b16 a[96:97], v98 offset:4096
    ds_read_b64_tr_b16 a[98:99], v98 offset:4608
    ds_read_b64_tr_b16 a[100:101], v99 offset:4096
    ds_read_b64_tr_b16 a[102:103], v99 offset:4608
    buffer_load_dwordx4 a[84:87], v96, s[8:11], s20 offen
    buffer_load_dwordx4 a[88:91], v96, s[8:11], s21 offen
    buffer_load_dwordx4 a[92:95], v96, s[8:11], s22 offen
    v_mfma_f32_32x32x16_bf16 v[48:63], a[108:111], a[12:15], v[48:63]
    s_add_u32 m0, s24, 14336
    s_add_u32 s20, s20, 4096
    buffer_load_dwordx4 v97, s[12:15], s23 offen lds
    v_mfma_f32_32x32x16_bf16 v[16:31], a[104:107], a[16:19], v[16:31]
    s_add_u32 m0, s24, 15360
    s_add_u32 s25, s23, 9216
    buffer_load_dwordx4 v97, s[12:15], s25 offen lds
    v_mfma_f32_32x32x16_bf16 v[64:79], a[108:111], a[16:19], v[64:79]
    s_add_u32 s21, s21, 4096
    s_add_u32 s22, s22, 4096
    s_add_u32 s23, s23, 73728
    v_mfma_f32_32x32x16_bf16 v[32:47], a[104:107], a[20:23], v[32:47]
    v_mfma_f32_32x32x16_bf16 v[80:95], a[108:111], a[20:23], v[80:95]
    s_waitcnt vmcnt(20) lgkmcnt(0)
    v_mfma_f32_32x32x16_bf16 v[0:15], a[96:99], a[24:27], v[0:15]
    ds_read_b64_tr_b16 a[104:105], v98 offset:6144
    ds_read_b64_tr_b16 a[106:107], v98 offset:6656
    ds_read_b64_tr_b16 a[108:109], v99 offset:6144
    ds_read_b64_tr_b16 a[110:111], v99 offset:6656
    v_mfma_f32_32x32x16_bf16 v[48:63], a[100:103], a[24:27], v[48:63]
    v_mfma_f32_32x32x16_bf16 v[16:31], a[96:99], a[28:31], v[16:31]
    v_mfma_f32_32x32x16_bf16 v[64:79], a[100:103], a[28:31], v[64:79]
    v_mfma_f32_32x32x16_bf16 v[32:47], a[96:99], a[32:35], v[32:47]
    v_mfma_f32_32x32x16_bf16 v[80:95], a[100:103], a[32:35], v[80:95]
    s_waitcnt vmcnt(15) lgkmcnt(0)
    v_mfma_f32_32x32x16_bf16 v[0:15], a[104:107], a[36:39], v[0:15]
    ds_read_b64_tr_b16 a[96:97], v98 offset:8192
    ds_read_b64_tr_b16 a[98:99], v98 offset:8704
    ds_read_b64_tr_b16 a[100:101], v99 offset:8192
    ds_read_b64_tr_b16 a[102:103], v99 offset:8704
    v_mfma_f32_32x32x16_bf16 v[48:63], a[108:111], a[36:39], v[48:63]
    v_mfma_f32_32x32x16_bf16 v[16:31], a[104:107], a[40:43], v[16:31]
    v_mfma_f32_32x32x16_bf16 v[64:79], a[108:111], a[40:43], v[64:79]
    v_mfma_f32_32x32x16_bf16 v[32:47], a[104:107], a[44:47], v[32:47]
    v_mfma_f32_32x32x16_bf16 v[80:95], a[108:111], a[44:47], v[80:95]
    s_waitcnt vmcnt(10) lgkmcnt(0)
    v_mfma_f32_32x32x16_bf16 v[0:15], a[96:99], a[48:51], v[0:15]
    ds_read_b64_tr_b16 a[104:105], v98 offset:10240
    ds_read_b64_tr_b16 a[106:107], v98 offset:10752
    ds_read_b64_tr_b16 a[108:109], v99 offset:10240
    ds_read_b64_tr_b16 a[110:111], v99 offset:10752
    v_mfma_f32_32x32x16_bf16 v[48:63], a[100:103], a[48:51], v[48:63]
    v_mfma_f32_32x32x16_bf16 v[16:31], a[96:99], a[52:55], v[16:31]
    v_mfma_f32_32x32x16_bf16 v[64:79], a[100:103], a[52:55], v[64:79]
    v_mfma_f32_32x32x16_bf16 v[32:47], a[96:99], a[56:59], v[32:47]
    v_mfma_f32_32x32x16_bf16 v[80:95], a[100:103], a[56:59], v[80:95]
    s_waitcnt vmcnt(5) lgkmcnt(0)
    v_mfma_f32_32x32x16_bf16 v[0:15], a[104:107], a[60:63], v[0:15]
    ds_read_b64_tr_b16 a[96:97], v98 offset:12288
    ds_read_b64_tr_b16 a[98:99], v98 offset:12800
    ds_read_b64_tr_b16 a[100:101], v99 offset:12288
    ds_read_b64_tr_b16 a[102:103], v99 offset:12800
    v_mfma_f32_32x32x16_bf16 v[48:63], a[108:111], a[60:63], v[48:63]
    v_mfma_f32_32x32x16_bf16 v[16:31], a[104:107], a[64:67], v[16:31]
    v_mfma_f32_32x32x16_bf16 v[64:79], a[108:111], a[64:67], v[64:79]
    v_mfma_f32_32x32x16_bf16 v[32:47], a[104:107], a[68:71], v[32:47]
    v_mfma_f32_32x32x16_bf16 v[80:95], a[108:111], a[68:71], v[80:95]
    s_waitcnt vmcnt(0) lgkmcnt(0)
    v_mfma_f32_32x32x16_bf16 v[0:15], a[96:99], a[72:75], v[0:15]
    ds_read_b64_tr_b16 a[104:105], v98 offset:14336
    ds_read_b64_tr_b16 a[106:107], v98 offset:14848
    ds_read_b64_tr_b16 a[108:109], v99 offset:14336
    ds_read_b64_tr_b16 a[110:111], v99 offset:14848
    v_mfma_f32_32x32x16_bf16 v[48:63], a[100:103], a[72:75], v[48:63]
    v_mfma_f32_32x32x16_bf16 v[16:31], a[96:99], a[76:79], v[16:31]
    v_mfma_f32_32x32x16_bf16 v[64:79], a[100:103], a[76:79], v[64:79]
    v_mfma_f32_32x32x16_bf16 v[32:47], a[96:99], a[80:83], v[32:47]
    v_mfma_f32_32x32x16_bf16 v[80:95], a[100:103], a[80:83], v[80:95]
    s_waitcnt lgkmcnt(0)
    v_mfma_f32_32x32x16_bf16 v[0:15], a[104:107], a[84:87], v[0:15]
    v_mfma_f32_32x32x16_bf16 v[48:63], a[108:111], a[84:87], v[48:63]
    v_mfma_f32_32x32x16_bf16 v[16:31], a[104:107], a[88:91], v[16:31]
    v_mfma_f32_32x32x16_bf16 v[64:79], a[108:111], a[88:91], v[64:79]
    v_mfma_f32_32x32x16_bf16 v[32:47], a[104:107], a[92:95], v[32:47]
    v_mfma_f32_32x32x16_bf16 v[80:95], a[108:111], a[92:95], v[80:95]
    s_nop 7
    s_nop 7
    v_mul_u32_u24 v105, 2304, v101
    v_lshl_add_u32 v105, v102, 4, v105
    v_add_u32 v104, s24, v96
    s_cmp_eq_u32 s3, 1
    s_cbranch_scc1 L_rw_8
    s_cmp_eq_u32 s3, 2
    s_cbranch_scc1 L_rw_9
    s_cmp_eq_u32 s3, 3
    s_cbranch_scc1 L_rw_10
    ds_write_b128 v104, v[16:19] offset:0
    ds_write_b128 v104, v[20:23] offset:1024
    ds_write_b128 v104, v[24:27] offset:2048
    ds_write_b128 v104, v[28:31] offset:3072
    ds_write_b128 v104, v[32:35] offset:4096
    ds_write_b128 v104, v[36:39] offset:5120
    ds_write_b128 v104, v[40:43] offset:6144
    ds_write_b128 v104, v[44:47] offset:7168
    ds_write_b128 v104, v[48:51] offset:8192
    ds_write_b128 v104, v[52:55] offset:9216
    ds_write_b128 v104, v[56:59] offset:10240
    ds_write_b128 v104, v[60:63] offset:11264
    ds_write_b128 v104, v[80:83] offset:12288
    ds_write_b128 v104, v[84:87] offset:13312
    ds_write_b128 v104, v[88:91] offset:14336
    ds_write_b128 v104, v[92:95] offset:15360
    s_waitcnt lgkmcnt(0)
    s_barrier
    v_mov_b32 v106, v96
    v_add_u32 v107, 0x10000, v96
    ds_read_b128 v[16:19], v106 offset:20480
    ds_read_b128 v[20:23], v106 offset:21504
    ds_read_b128 v[24:27], v106 offset:22528
    ds_read_b128 v[28:31], v106 offset:23552
    ds_read_b128 v[32:35], v106 offset:40960
    ds_read_b128 v[36:39], v106 offset:41984
    ds_read_b128 v[40:43], v106 offset:43008
    ds_read_b128 v[44:47], v106 offset:44032
    ds_read_b128 v[48:51], v106 offset:61440
    ds_read_b128 v[52:55], v106 offset:62464
    ds_read_b128 v[56:59], v106 offset:63488
    ds_read_b128 v[60:63], v106 offset:64512
    s_add_u32 s25, s27, 0
    s_mul_i32 s25, s25, 73728
    s_lshl_b32 s29, s28, 7
    s_add_u32 s25, s25, s29
    s_add_u32 s25, s25, s30
    s_waitcnt lgkmcnt(0)
    v_pk_add_f32 v[0:1], v[0:1], v[16:17]
    v_pk_add_f32 v[32:33], v[32:33], v[48:49]
    v_pk_add_f32 v[2:3], v[2:3], v[18:19]
    v_pk_add_f32 v[34:35], v[34:35], v[50:51]
    v_pk_add_f32 v[4:5], v[4:5], v[20:21]
    v_pk_add_f32 v[36:37], v[36:37], v[52:53]
    v_pk_add_f32 v[6:7], v[6:7], v[22:23]
    v_pk_add_f32 v[38:39], v[38:39], v[54:55]
    v_pk_add_f32 v[8:9], v[8:9], v[24:25]
    v_pk_add_f32 v[40:41], v[40:41], v[56:57]
    v_pk_add_f32 v[10:11], v[10:11], v[26:27]
    v_pk_add_f32 v[42:43], v[42:43], v[58:59]
    v_pk_add_f32 v[12:13], v[12:13], v[28:29]
    v_pk_add_f32 v[44:45], v[44:45], v[60:61]
    v_pk_add_f32 v[14:15], v[14:15], v[30:31]
    v_pk_add_f32 v[46:47], v[46:47], v[62:63]
    v_pk_add_f32 v[0:1], v[0:1], v[32:33]
    v_pk_add_f32 v[2:3], v[2:3], v[34:35]
    v_pk_add_f32 v[4:5], v[4:5], v[36:37]
    v_pk_add_f32 v[6:7], v[6:7], v[38:39]
    v_pk_add_f32 v[8:9], v[8:9], v[40:41]
    v_pk_add_f32 v[10:11], v[10:11], v[42:43]
    v_pk_add_f32 v[12:13], v[12:13], v[44:45]
    v_pk_add_f32 v[14:15], v[14:15], v[46:47]
    v_cvt_pk_bf16_f32 v0, v0, v1
    v_cvt_pk_bf16_f32 v1, v2, v3
    v_cvt_pk_bf16_f32 v2, v4, v5
    v_cvt_pk_bf16_f32 v3, v6, v7
    v_cvt_pk_bf16_f32 v4, v8, v9
    v_cvt_pk_bf16_f32 v5, v10, v11
    v_cvt_pk_bf16_f32 v6, v12, v13
    v_cvt_pk_bf16_f32 v7, v14, v15
    buffer_store_dwordx4 v[0:3], v105, s[16:19], s25 offen
    buffer_store_dwordx4 v[4:7], v105, s[16:19], s25 offen offset:32
    v_mov_b32 v106, v96
    v_add_u32 v107, 0x10000, v96
    ds_read_b128 v[16:19], v106 offset:32768
    ds_read_b128 v[20:23], v106 offset:33792
    ds_read_b128 v[24:27], v106 offset:34816
    ds_read_b128 v[28:31], v106 offset:35840
    ds_read_b128 v[32:35], v106 offset:53248
    ds_read_b128 v[36:39], v106 offset:54272
    ds_read_b128 v[40:43], v106 offset:55296
    ds_read_b128 v[44:47], v106 offset:56320
    ds_read_b128 v[48:51], v107 offset:8192
    ds_read_b128 v[52:55], v107 offset:9216
    ds_read_b128 v[56:59], v107 offset:10240
    ds_read_b128 v[60:63], v107 offset:11264
    s_add_u32 s25, s27, 1
    s_mul_i32 s25, s25, 73728
    s_lshl_b32 s29, s28, 7
    s_add_u32 s25, s25, s29
    s_add_u32 s25, s25, s30
    s_add_u32 s25, s25, 64
    s_waitcnt lgkmcnt(0)
    v_pk_add_f32 v[64:65], v[64:65], v[16:17]
    v_pk_add_f32 v[32:33], v[32:33], v[48:49]
    v_pk_add_f32 v[66:67], v[66:67], v[18:19]
    v_pk_add_f32 v[34:35], v[34:35], v[50:51]
    v_pk_add_f32 v[68:69], v[68:69], v[20:21]
    v_pk_add_f32 v[36:37], v[36:37], v[52:53]
    v_pk_add_f32 v[70:71], v[70:71], v[22:23]
    v_pk_add_f32 v[38:39], v[38:39], v[54:55]
    v_pk_add_f32 v[72:73], v[72:73], v[24:25]
    v_pk_add_f32 v[40:41], v[40:41], v[56:57]
    v_pk_add_f32 v[74:75], v[74:75], v[26:27]
    v_pk_add_f32 v[42:43], v[42:43], v[58:59]
    v_pk_add_f32 v[76:77], v[76:77], v[28:29]
    v_pk_add_f32 v[44:45], v[44:45], v[60:61]
    v_pk_add_f32 v[78:79], v[78:79], v[30:31]
    v_pk_add_f32 v[46:47], v[46:47], v[62:63]
    v_pk_add_f32 v[64:65], v[64:65], v[32:33]
    v_pk_add_f32 v[66:67], v[66:67], v[34:35]
    v_pk_add_f32 v[68:69], v[68:69], v[36:37]
    v_pk_add_f32 v[70:71], v[70:71], v[38:39]
    v_pk_add_f32 v[72:73], v[72:73], v[40:41]
    v_pk_add_f32 v[74:75], v[74:75], v[42:43]
    v_pk_add_f32 v[76:77], v[76:77], v[44:45]
    v_pk_add_f32 v[78:79], v[78:79], v[46:47]
    v_cvt_pk_bf16_f32 v64, v64, v65
    v_cvt_pk_bf16_f32 v65, v66, v67
    v_cvt_pk_bf16_f32 v66, v68, v69
    v_cvt_pk_bf16_f32 v67, v70, v71
    v_cvt_pk_bf16_f32 v68, v72, v73
    v_cvt_pk_bf16_f32 v69, v74, v75
    v_cvt_pk_bf16_f32 v70, v76, v77
    v_cvt_pk_bf16_f32 v71, v78, v79
    buffer_store_dwordx4 v[64:67], v105, s[16:19], s25 offen
    buffer_store_dwordx4 v[68:71], v105, s[16:19], s25 offen offset:32
    s_branch L_rj_11
L_rw_8:
    ds_write_b128 v104, v[0:3] offset:0
    ds_write_b128 v104, v[4:7] offset:1024
    ds_write_b128 v104, v[8:11] offset:2048
    ds_write_b128 v104, v[12:15] offset:3072
    ds_write_b128 v104, v[32:35] offset:4096
    ds_write_b128 v104, v[36:39] offset:5120
    ds_write_b128 v104, v[40:43] offset:6144
    ds_write_b128 v104, v[44:47] offset:7168
    ds_write_b128 v104, v[48:51] offset:8192
    ds_write_b128 v104, v[52:55] offset:9216
    ds_write_b128 v104, v[56:59] offset:10240
    ds_write_b128 v104, v[60:63] offset:11264
    ds_write_b128 v104, v[64:67] offset:12288
    ds_write_b128 v104, v[68:71] offset:13312
    ds_write_b128 v104, v[72:75] offset:14336
    ds_write_b128 v104, v[76:79] offset:15360
    s_waitcnt lgkmcnt(0)
    s_barrier
    v_mov_b32 v106, v96
    v_add_u32 v107, 0x10000, v96
    ds_read_b128 v[0:3], v106 offset:0
    ds_read_b128 v[4:7], v106 offset:1024
    ds_read_b128 v[8:11], v106 offset:2048
    ds_read_b128 v[12:15], v106 offset:3072
    ds_read_b128 v[32:35], v106 offset:45056
    ds_read_b128 v[36:39], v106 offset:46080
    ds_read_b128 v[40:43], v106 offset:47104
    ds_read_b128 v[44:47], v106 offset:48128
    ds_read_b128 v[48:51], v107 offset:0
    ds_read_b128 v[52:55], v107 offset:1024
    ds_read_b128 v[56:59], v107 offset:2048
    ds_read_b128 v[60:63], v107 offset:3072
    s_add_u32 s25, s27, 1
    s_mul_i32 s25, s25, 73728
    s_lshl_b32 s29, s28, 7
    s_add_u32 s25, s25, s29
    s_add_u32 s25, s25, s30
    s_waitcnt lgkmcnt(0)
    v_pk_add_f32 v[16:17], v[16:17], v[0:1]
    v_pk_add_f32 v[32:33], v[32:33], v[48:49]
    v_pk_add_f32 v[18:19], v[18:19], v[2:3]
    v_pk_add_f32 v[34:35], v[34:35], v[50:51]
    v_pk_add_f32 v[20:21], v[20:21], v[4:5]
    v_pk_add_f32 v[36:37], v[36:37], v[52:53]
    v_pk_add_f32 v[22:23], v[22:23], v[6:7]
    v_pk_add_f32 v[38:39], v[38:39], v[54:55]
    v_pk_add_f32 v[24:25], v[24:25], v[8:9]
    v_pk_add_f32 v[40:41], v[40:41], v[56:57]
    v_pk_add_f32 v[26:27], v[26:27], v[10:11]
    v_pk_add_f32 v[42:43], v[42:43], v[58:59]
    v_pk_add_f32 v[28:29], v[28:29], v[12:13]
    v_pk_add_f32 v[44:45], v[44:45], v[60:61]
    v_pk_add_f32 v[30:31], v[30:31], v[14:15]
    v_pk_add_f32 v[46:47], v[46:47], v[62:63]
    v_pk_add_f32 v[16:17], v[16:17], v[32:33]
    v_pk_add_f32 v[18:19], v[18:19], v[34:35]
    v_pk_add_f32 v[20:21], v[20:21], v[36:37]
    v_pk_add_f32 v[22:23], v[22:23], v[38:39]
    v_pk_add_f32 v[24:25], v[24:25], v[40:41]
    v_pk_add_f32 v[26:27], v[26:27], v[42:43]
    v_pk_add_f32 v[28:29], v[28:29], v[44:45]
    v_pk_add_f32 v[30:31], v[30:31], v[46:47]
    v_cvt_pk_bf16_f32 v16, v16, v17
    v_cvt_pk_bf16_f32 v17, v18, v19
    v_cvt_pk_bf16_f32 v18, v20, v21
    v_cvt_pk_bf16_f32 v19, v22, v23
    v_cvt_pk_bf16_f32 v20, v24, v25
    v_cvt_pk_bf16_f32 v21, v26, v27
    v_cvt_pk_bf16_f32 v22, v28, v29
    v_cvt_pk_bf16_f32 v23, v30, v31
    buffer_store_dwordx4 v[16:19], v105, s[16:19], s25 offen
    buffer_store_dwordx4 v[20:23], v105, s[16:19], s25 offen offset:32
    v_mov_b32 v106, v96
    v_add_u32 v107, 0x10000, v96
    ds_read_b128 v[0:3], v106 offset:12288
    ds_read_b128 v[4:7], v106 offset:13312
    ds_read_b128 v[8:11], v106 offset:14336
    ds_read_b128 v[12:15], v106 offset:15360
    ds_read_b128 v[32:35], v106 offset:57344
    ds_read_b128 v[36:39], v106 offset:58368
    ds_read_b128 v[40:43], v106 offset:59392
    ds_read_b128 v[44:47], v106 offset:60416
    ds_read_b128 v[48:51], v107 offset:12288
    ds_read_b128 v[52:55], v107 offset:13312
    ds_read_b128 v[56:59], v107 offset:14336
    ds_read_b128 v[60:63], v107 offset:15360
    s_add_u32 s25, s27, 2
    s_mul_i32 s25, s25, 73728
    s_lshl_b32 s29, s28, 7
    s_add_u32 s25, s25, s29
    s_add_u32 s25, s25, s30
    s_add_u32 s25, s25, 64
    s_waitcnt lgkmcnt(0)
    v_pk_add_f32 v[80:81], v[80:81], v[0:1]
    v_pk_add_f32 v[32:33], v[32:33], v[48:49]
    v_pk_add_f32 v[82:83], v[82:83], v[2:3]
    v_pk_add_f32 v[34:35], v[34:35], v[50:51]
    v_pk_add_f32 v[84:85], v[84:85], v[4:5]
    v_pk_add_f32 v[36:37], v[36:37], v[52:53]
    v_pk_add_f32 v[86:87], v[86:87], v[6:7]
    v_pk_add_f32 v[38:39], v[38:39], v[54:55]
    v_pk_add_f32 v[88:89], v[88:89], v[8:9]
    v_pk_add_f32 v[40:41], v[40:41], v[56:57]
    v_pk_add_f32 v[90:91], v[90:91], v[10:11]
    v_pk_add_f32 v[42:43], v[42:43], v[58:59]
    v_pk_add_f32 v[92:93], v[92:93], v[12:13]
    v_pk_add_f32 v[44:45], v[44:45], v[60:61]
    v_pk_add_f32 v[94:95], v[94:95], v[14:15]
    v_pk_add_f32 v[46:47], v[46:47], v[62:63]
    v_pk_add_f32 v[80:81], v[80:81], v[32:33]
    v_pk_add_f32 v[82:83], v[82:83], v[34:35]
    v_pk_add_f32 v[84:85], v[84:85], v[36:37]
    v_pk_add_f32 v[86:87], v[86:87], v[38:39]
    v_pk_add_f32 v[88:89], v[88:89], v[40:41]
    v_pk_add_f32 v[90:91], v[90:91], v[42:43]
    v_pk_add_f32 v[92:93], v[92:93], v[44:45]
    v_pk_add_f32 v[94:95], v[94:95], v[46:47]
    v_cvt_pk_bf16_f32 v80, v80, v81
    v_cvt_pk_bf16_f32 v81, v82, v83
    v_cvt_pk_bf16_f32 v82, v84, v85
    v_cvt_pk_bf16_f32 v83, v86, v87
    v_cvt_pk_bf16_f32 v84, v88, v89
    v_cvt_pk_bf16_f32 v85, v90, v91
    v_cvt_pk_bf16_f32 v86, v92, v93
    v_cvt_pk_bf16_f32 v87, v94, v95
    buffer_store_dwordx4 v[80:83], v105, s[16:19], s25 offen
    buffer_store_dwordx4 v[84:87], v105, s[16:19], s25 offen offset:32
    s_branch L_rj_11
L_rw_9:
    ds_write_b128 v104, v[0:3] offset:0
    ds_write_b128 v104, v[4:7] offset:1024
    ds_write_b128 v104, v[8:11] offset:2048
    ds_write_b128 v104, v[12:15] offset:3072
    ds_write_b128 v104, v[16:19] offset:4096
    ds_write_b128 v104, v[20:23] offset:5120
    ds_write_b128 v104, v[24:27] offset:6144
    ds_write_b128 v104, v[28:31] offset:7168
    ds_write_b128 v104, v[48:51] offset:8192
    ds_write_b128 v104, v[52:55] offset:9216
    ds_write_b128 v104, v[56:59] offset:10240
    ds_write_b128 v104, v[60:63] offset:11264
    ds_write_b128 v104, v[64:67] offset:12288
    ds_write_b128 v104, v[68:71] offset:13312
    ds_write_b128 v104, v[72:75] offset:14336
    ds_write_b128 v104, v[76:79] offset:15360
    ds_write_b128 v104, v[80:83] offset:16384
    ds_write_b128 v104, v[84:87] offset:17408
    ds_write_b128 v104, v[88:91] offset:18432
    ds_write_b128 v104, v[92:95] offset:19456
    s_waitcnt lgkmcnt(0)
    s_barrier
    v_mov_b32 v106, v96
    v_add_u32 v107, 0x10000, v96
    ds_read_b128 v[0:3], v106 offset:4096
    ds_read_b128 v[4:7], v106 offset:5120
    ds_read_b128 v[8:11], v106 offset:6144
    ds_read_b128 v[12:15], v106 offset:7168
    ds_read_b128 v[16:19], v106 offset:24576
    ds_read_b128 v[20:23], v106 offset:25600
    ds_read_b128 v[24:27], v106 offset:26624
    ds_read_b128 v[28:31], v106 offset:27648
    ds_read_b128 v[48:51], v107 offset:4096
    ds_read_b128 v[52:55], v107 offset:5120
    ds_read_b128 v[56:59], v107 offset:6144
    ds_read_b128 v[60:63], v107 offset:7168
    s_add_u32 s25, s27, 2
    s_mul_i32 s25, s25, 73728
    s_lshl_b32 s29, s28, 7
    s_add_u32 s25, s25, s29
    s_add_u32 s25, s25, s30
    s_waitcnt lgkmcnt(0)
    v_pk_add_f32 v[32:33], v[32:33], v[0:1]
    v_pk_add_f32 v[16:17], v[16:17], v[48:49]
    v_pk_add_f32 v[34:35], v[34:35], v[2:3]
    v_pk_add_f32 v[18:19], v[18:19], v[50:51]
    v_pk_add_f32 v[36:37], v[36:37], v[4:5]
    v_pk_add_f32 v[20:21], v[20:21], v[52:53]
    v_pk_add_f32 v[38:39], v[38:39], v[6:7]
    v_pk_add_f32 v[22:23], v[22:23], v[54:55]
    v_pk_add_f32 v[40:41], v[40:41], v[8:9]
    v_pk_add_f32 v[24:25], v[24:25], v[56:57]
    v_pk_add_f32 v[42:43], v[42:43], v[10:11]
    v_pk_add_f32 v[26:27], v[26:27], v[58:59]
    v_pk_add_f32 v[44:45], v[44:45], v[12:13]
    v_pk_add_f32 v[28:29], v[28:29], v[60:61]
    v_pk_add_f32 v[46:47], v[46:47], v[14:15]
    v_pk_add_f32 v[30:31], v[30:31], v[62:63]
    v_pk_add_f32 v[32:33], v[32:33], v[16:17]
    v_pk_add_f32 v[34:35], v[34:35], v[18:19]
    v_pk_add_f32 v[36:37], v[36:37], v[20:21]
    v_pk_add_f32 v[38:39], v[38:39], v[22:23]
    v_pk_add_f32 v[40:41], v[40:41], v[24:25]
    v_pk_add_f32 v[42:43], v[42:43], v[26:27]
    v_pk_add_f32 v[44:45], v[44:45], v[28:29]
    v_pk_add_f32 v[46:47], v[46:47], v[30:31]
    v_cvt_pk_bf16_f32 v32, v32, v33
    v_cvt_pk_bf16_f32 v33, v34, v35
    v_cvt_pk_bf16_f32 v34, v36, v37
    v_cvt_pk_bf16_f32 v35, v38, v39
    v_cvt_pk_bf16_f32 v36, v40, v41
    v_cvt_pk_bf16_f32 v37, v42, v43
    v_cvt_pk_bf16_f32 v38, v44, v45
    v_cvt_pk_bf16_f32 v39, v46, v47
    buffer_store_dwordx4 v[32:35], v105, s[16:19], s25 offen
    buffer_store_dwordx4 v[36:39], v105, s[16:19], s25 offen offset:32
    s_branch L_rj_11
L_rw_10:
    ds_write_b128 v104, v[0:3] offset:0
    ds_write_b128 v104, v[4:7] offset:1024
    ds_write_b128 v104, v[8:11] offset:2048
    ds_write_b128 v104, v[12:15] offset:3072
    ds_write_b128 v104, v[16:19] offset:4096
    ds_write_b128 v104, v[20:23] offset:5120
    ds_write_b128 v104, v[24:27] offset:6144
    ds_write_b128 v104, v[28:31] offset:7168
    ds_write_b128 v104, v[32:35] offset:8192
    ds_write_b128 v104, v[36:39] offset:9216
    ds_write_b128 v104, v[40:43] offset:10240
    ds_write_b128 v104, v[44:47] offset:11264
    ds_write_b128 v104, v[64:67] offset:12288
    ds_write_b128 v104, v[68:71] offset:13312
    ds_write_b128 v104, v[72:75] offset:14336
    ds_write_b128 v104, v[76:79] offset:15360
    ds_write_b128 v104, v[80:83] offset:16384
    ds_write_b128 v104, v[84:87] offset:17408
    ds_write_b128 v104, v[88:91] offset:18432
    ds_write_b128 v104, v[92:95] offset:19456
    s_waitcnt lgkmcnt(0)
    s_barrier
    v_mov_b32 v106, v96
    v_add_u32 v107, 0x10000, v96
    ds_read_b128 v[0:3], v106 offset:8192
    ds_read_b128 v[4:7], v106 offset:9216
    ds_read_b128 v[8:11], v106 offset:10240
    ds_read_b128 v[12:15], v106 offset:11264
    ds_read_b128 v[16:19], v106 offset:28672
    ds_read_b128 v[20:23], v106 offset:29696
    ds_read_b128 v[24:27], v106 offset:30720
    ds_read_b128 v[28:31], v106 offset:31744
    ds_read_b128 v[32:35], v106 offset:49152
    ds_read_b128 v[36:39], v106 offset:50176
    ds_read_b128 v[40:43], v106 offset:51200
    ds_read_b128 v[44:47], v106 offset:52224
    s_add_u32 s25, s27, 0
    s_mul_i32 s25, s25, 73728
    s_lshl_b32 s29, s28, 7
    s_add_u32 s25, s25, s29
    s_add_u32 s25, s25, s30
    s_add_u32 s25, s25, 64
    s_waitcnt lgkmcnt(0)
    v_pk_add_f32 v[48:49], v[48:49], v[0:1]
    v_pk_add_f32 v[16:17], v[16:17], v[32:33]
    v_pk_add_f32 v[50:51], v[50:51], v[2:3]
    v_pk_add_f32 v[18:19], v[18:19], v[34:35]
    v_pk_add_f32 v[52:53], v[52:53], v[4:5]
    v_pk_add_f32 v[20:21], v[20:21], v[36:37]
    v_pk_add_f32 v[54:55], v[54:55], v[6:7]
    v_pk_add_f32 v[22:23], v[22:23], v[38:39]
    v_pk_add_f32 v[56:57], v[56:57], v[8:9]
    v_pk_add_f32 v[24:25], v[24:25], v[40:41]
    v_pk_add_f32 v[58:59], v[58:59], v[10:11]
    v_pk_add_f32 v[26:27], v[26:27], v[42:43]
    v_pk_add_f32 v[60:61], v[60:61], v[12:13]
    v_pk_add_f32 v[28:29], v[28:29], v[44:45]
    v_pk_add_f32 v[62:63], v[62:63], v[14:15]
    v_pk_add_f32 v[30:31], v[30:31], v[46:47]
    v_pk_add_f32 v[48:49], v[48:49], v[16:17]
    v_pk_add_f32 v[50:51], v[50:51], v[18:19]
    v_pk_add_f32 v[52:53], v[52:53], v[20:21]
    v_pk_add_f32 v[54:55], v[54:55], v[22:23]
    v_pk_add_f32 v[56:57], v[56:57], v[24:25]
    v_pk_add_f32 v[58:59], v[58:59], v[26:27]
    v_pk_add_f32 v[60:61], v[60:61], v[28:29]
    v_pk_add_f32 v[62:63], v[62:63], v[30:31]
    v_cvt_pk_bf16_f32 v48, v48, v49
    v_cvt_pk_bf16_f32 v49, v50, v51
    v_cvt_pk_bf16_f32 v50, v52, v53
    v_cvt_pk_bf16_f32 v51, v54, v55
    v_cvt_pk_bf16_f32 v52, v56, v57
    v_cvt_pk_bf16_f32 v53, v58, v59
    v_cvt_pk_bf16_f32 v54, v60, v61
    v_cvt_pk_bf16_f32 v55, v62, v63
    buffer_store_dwordx4 v[48:51], v105, s[16:19], s25 offen
    buffer_store_dwordx4 v[52:55], v105, s[16:19], s25 offen offset:32
    s_branch L_rj_11
L_rj_11:
    s_branch L_k3_bt
L_out_A2:
    s_sub_u32 s40, s31, 72
    s_mul_i32 s27, s40, 7282
    s_lshr_b32 s27, s27, 16
    s_mul_i32 s28, s27, 9
    s_sub_u32 s28, s40, s28
    s_lshl_b32 s27, s27, 1
    s_add_u32 s27, s27, 24
    s_add_u32 s20, s27, 0
    s_lshl_b32 s20, s20, 18
    s_lshl_b32 s25, s3, 10
    s_add_u32 s20, s20, s25
    s_add_u32 s20, s20, 50331648
    s_add_u32 s21, s27, 1
    s_lshl_b32 s21, s21, 18
    s_lshl_b32 s25, s3, 10
    s_add_u32 s21, s21, s25
    s_add_u32 s21, s21, 50331648
    s_mul_i32 s23, s3, 18432
    s_lshl_b32 s25, s28, 7
    s_add_u32 s23, s23, s25
    buffer_load_dwordx4 a[0:3], v96, s[8:11], s20 offen
    buffer_load_dwordx4 a[4:7], v96, s[8:11], s21 offen
    s_add_u32 m0, s24, 0
    s_add_u32 s20, s20, 4096
    buffer_load_dwordx4 v97, s[12:15], s23 offen lds
    s_add_u32 m0, s24, 1024
    s_add_u32 s25, s23, 9216
    buffer_load_dwordx4 v97, s[12:15], s25 offen lds
    s_add_u32 s21, s21, 4096
    s_add_u32 s23, s23, 73728
    buffer_load_dwordx4 a[8:11], v96, s[8:11], s20 offen
    buffer_load_dwordx4 a[12:15], v96, s[8:11], s21 offen
    s_add_u32 m0, s24, 2048
    s_add_u32 s20, s20, 4096
    buffer_load_dwordx4 v97, s[12:15], s23 offen lds
    s_add_u32 m0, s24, 3072
    s_add_u32 s25, s23, 9216
    buffer_load_dwordx4 v97, s[12:15], s25 offen lds
    s_add_u32 s21, s21, 4096
    s_add_u32 s23, s23, 73728
    buffer_load_dwordx4 a[16:19], v96, s[8:11], s20 offen
    buffer_load_dwordx4 a[20:23], v96, s[8:11], s21 offen
    s_add_u32 m0, s24, 4096
    s_add_u32 s20, s20, 4096
    buffer_load_dwordx4 v97, s[12:15], s23 offen lds
    s_add_u32 m0, s24, 5120
    s_add_u32 s25, s23, 9216
    buffer_load_dwordx4 v97, s[12:15], s25 offen lds
    s_add_u32 s21, s21, 4096
    s_add_u32 s23, s23, 73728
    buffer_load_dwordx4 a[24:27], v96, s[8:11], s20 offen
    buffer_load_dwordx4 a[28:31], v96, s[8:11], s21 offen
    s_add_u32 m0, s24, 6144
    s_add_u32 s20, s20, 4096
    buffer_load_dwordx4 v97, s[12:15], s23 offen lds
    s_add_u32 m0, s24, 7168
    s_add_u32 s25, s23, 9216
    buffer_load_dwordx4 v97, s[12:15], s25 offen lds
    s_add_u32 s21, s21, 4096
    s_add_u32 s23, s23, 73728
    buffer_load_dwordx4 a[32:35], v96, s[8:11], s20 offen
    buffer_load_dwordx4 a[36:39], v96, s[8:11], s21 offen
    s_add_u32 m0, s24, 8192
    s_add_u32 s20, s20, 4096
    buffer_load_dwordx4 v97, s[12:15], s23 offen lds
    s_add_u32 m0, s24, 9216
    s_add_u32 s25, s23, 9216
    buffer_load_dwordx4 v97, s[12:15], s25 offen lds
    s_add_u32 s21, s21, 4096
    s_add_u32 s23, s23, 73728
    buffer_load_dwordx4 a[40:43], v96, s[8:11], s20 offen
    buffer_load_dwordx4 a[44:47], v96, s[8:11], s21 offen
    s_add_u32 m0, s24, 10240
    s_add_u32 s20, s20, 4096
    buffer_load_dwordx4 v97, s[12:15], s23 offen lds
    s_add_u32 m0, s24, 11264
    s_add_u32 s25, s23, 9216
    buffer_load_dwordx4 v97, s[12:15], s25 offen lds
    s_add_u32 s21, s21, 4096
    s_add_u32 s23, s23, 73728
    buffer_load_dwordx4 a[48:51], v96, s[8:11], s20 offen
    buffer_load_dwordx4 a[52:55], v96, s[8:11], s21 offen
    s_add_u32 m0, s24, 12288
    s_add_u32 s20, s20, 4096
    buffer_load_dwordx4 v97, s[12:15], s23 offen lds
    s_add_u32 m0, s24, 13312
    s_add_u32 s25, s23, 9216
    buffer_load_dwordx4 v97, s[12:15], s25 offen lds
    s_add_u32 s21, s21, 4096
    s_add_u32 s23, s23, 73728
    buffer_load_dwordx4 a[56:59], v96, s[8:11], s20 offen
    buffer_load_dwordx4 a[60:63], v96, s[8:11], s21 offen
    s_add_u32 m0, s24, 14336
    s_add_u32 s20, s20, 4096
    buffer_load_dwordx4 v97, s[12:15], s23 offen lds
    s_add_u32 m0, s24, 15360
    s_add_u32 s25, s23, 9216
    buffer_load_dwordx4 v97, s[12:15], s25 offen lds
    s_add_u32 s21, s21, 4096
    s_add_u32 s23, s23, 73728
    s_waitcnt vmcnt(28)
    ds_read_b64_tr_b16 a[96:97], v98 offset:0
    ds_read_b64_tr_b16 a[98:99], v98 offset:512
    ds_read_b64_tr_b16 a[100:101], v99 offset:0
    ds_read_b64_tr_b16 a[102:103], v99 offset:512
    s_waitcnt vmcnt(24) lgkmcnt(0)
    v_mfma_f32_32x32x16_bf16 v[0:15], a[96:99], a[0:3], 0
    ds_read_b64_tr_b16 a[104:105], v98 offset:2048
    ds_read_b64_tr_b16 a[106:107], v98 offset:2560
    ds_read_b64_tr_b16 a[108:109], v99 offset:2048
    ds_read_b64_tr_b16 a[110:111], v99 offset:2560
    buffer_load_dwordx4 a[64:67], v96, s[8:11], s20 offen
    buffer_load_dwordx4 a[68:71], v96, s[8:11], s21 offen
    s_add_u32 m0, s24, 16384
    s_add_u32 s20, s20, 4096
    v_mfma_f32_32x32x16_bf16 v[32:47], a[100:103], a[0:3], 0
    buffer_load_dwordx4 v97, s[12:15], s23 offen lds
    s_add_u32 m0, s24, 17408
    s_add_u32 s25, s23, 9216
    buffer_load_dwordx4 v97, s[12:15], s25 offen lds
    v_mfma_f32_32x32x16_bf16 v[16:31], a[96:99], a[4:7], 0
    s_add_u32 s21, s21, 4096
    s_add_u32 s23, s23, 73728
    v_mfma_f32_32x32x16_bf16 v[48:63], a[100:103], a[4:7], 0
    s_waitcnt vmcnt(24) lgkmcnt(0)
    v_mfma_f32_32x32x16_bf16 v[0:15], a[104:107], a[8:11], v[0:15]
    ds_read_b64_tr_b16 a[96:97], v98 offset:4096
    ds_read_b64_tr_b16 a[98:99], v98 offset:4608
    ds_read_b64_tr_b16 a[100:101], v99 offset:4096
    ds_read_b64_tr_b16 a[102:103], v99 offset:4608
    buffer_load_dwordx4 a[72:75], v96, s[8:11], s20 offen
    buffer_load_dwordx4 a[76:79], v96, s[8:11], s21 offen
    s_add_u32 m0, s24, 18432
    s_add_u32 s20, s20, 4096
    v_mfma_f32_32x32x16_bf16 v[32:47], a[108:111], a[8:11], v[32:47]
    buffer_load_dwordx4 v97, s[12:15], s23 offen lds
    s_add_u32 m0, s24, 19456
    s_add_u32 s25, s23, 9216
    buffer_load_dwordx4 v97, s[12:15], s25 offen lds
    v_mfma_f32_32x32x16_bf16 v[16:31], a[104:107], a[12:15], v[16:31]
    s_add_u32 s21, s21, 4096
    s_add_u32 s23, s23, 73728
    v_mfma_f32_32x32x16_bf16 v[48:63], a[108:111], a[12:15], v[48:63]
    s_waitcnt vmcnt(24) lgkmcnt(0)
    v_mfma_f32_32x32x16_bf16 v[0:15], a[96:99], a[16:19], v[0:15]
    ds_read_b64_tr_b16 a[104:105], v98 offset:6144
    ds_read_b64_tr_b16 a[106:107], v98 offset:6656
    ds_read_b64_tr_b16 a[108:109], v99 offset:6144
    ds_read_b64_tr_b16 a[110:111], v99 offset:6656
    buffer_load_dwordx4 a[0:3], v96, s[8:11], s20 offen
    buffer_load_dwordx4 a[4:7], v96, s[8:11], s21 offen
    s_add_u32 m0, s24, 0
    s_add_u32 s20, s20, 4096
    v_mfma_f32_32x32x16_bf16 v[32:47], a[100:103], a[16:19], v[32:47]
    buffer_load_dwordx4 v97, s[12:15], s23 offen lds
    s_add_u32 m0, s24, 1024
    s_add_u32 s25, s23, 9216
    buffer_load_dwordx4 v97, s[12:15], s25 offen lds
    v_mfma_f32_32x32x16_bf16 v[16:31], a[96:99], a[20:23], v[16:31]
    s_add_u32 s21, s21, 4096
    s_add_u32 s23, s23, 73728
    v_mfma_f32_32x32x16_bf16 v[48:63], a[100:103], a[20:23], v[48:63]
    s_waitcnt vmcnt(24) lgkmcnt(0)
    v_mfma_f32_32x32x16_bf16 v[0:15], a[104:107], a[24:27], v[0:15]
    ds_read_b64_tr_b16 a[96:97], v98 offset:8192
    ds_read_b64_tr_b16 a[98:99], v98 offset:8704
    ds_read_b64_tr_b16 a[100:101], v99 offset:8192
    ds_read_b64_tr_b16 a[102:103], v99 offset:8704
    buffer_load_dwordx4 a[8:11], v96, s[8:11], s20 offen
    buffer_load_dwordx4 a[12:15], v96, s[8:11], s21 offen
    s_add_u32 m0, s24, 2048
    s_add_u32 s20, s20, 4096
    v_mfma_f32_32x32x16_bf16 v[32:47], a[108:111], a[24:27], v[32:47]
    buffer_load_dwordx4 v97, s[12:15], s23 offen lds
    s_add_u32 m0, s24, 3072
    s_add_u32 s25, s23, 9216
    buffer_load_dwordx4 v97, s[12:15], s25 offen lds
    v_mfma_f32_32x32x16_bf16 v[16:31], a[104:107], a[28:31], v[16:31]
    s_add_u32 s21, s21, 4096
    s_add_u32 s23, s23, 73728
    v_mfma_f32_32x32x16_bf16 v[48:63], a[108:111], a[28:31], v[48:63]
    s_waitcnt vmcnt(24) lgkmcnt(0)
    v_mfma_f32_32x32x16_bf16 v[0:15], a[96:99], a[32:35], v[0:15]
    ds_read_b64_tr_b16 a[104:105], v98 offset:10240
    ds_read_b64_tr_b16 a[106:107], v98 offset:10752
    ds_read_b64_tr_b16 a[108:109], v99 offset:10240
    ds_read_b64_tr_b16 a[110:111], v99 offset:10752
    buffer_load_dwordx4 a[16:19], v96, s[8:11], s20 offen
    buffer_load_dwordx4 a[20:23], v96, s[8:11], s21 offen
    s_add_u32 m0, s24, 4096
    s_add_u32 s20, s20, 4096
    v_mfma_f32_32x32x16_bf16 v[32:47], a[100:103], a[32:35], v[32:47]
    buffer_load_dwordx4 v97, s[12:15], s23 offen lds
    s_add_u32 m0, s24, 5120
    s_add_u32 s25, s23, 9216
    buffer_load_dwordx4 v97, s[12:15], s25 offen lds
    v_mfma_f32_32x32x16_bf16 v[16:31], a[96:99], a[36:39], v[16:31]
    s_add_u32 s21, s21, 4096
    s_add_u32 s23, s23, 73728
    v_mfma_f32_32x32x16_bf16 v[48:63], a[100:103], a[36:39], v[48:63]
    s_waitcnt vmcnt(24) lgkmcnt(0)
    v_mfma_f32_32x32x16_bf16 v[0:15], a[104:107], a[40:43], v[0:15]
    ds_read_b64_tr_b16 a[96:97], v98 offset:12288
    ds_read_b64_tr_b16 a[98:99], v98 offset:12800
    ds_read_b64_tr_b16 a[100:101], v99 offset:12288
    ds_read_b64_tr_b16 a[102:103], v99 offset:12800
    buffer_load_dwordx4 a[24:27], v96, s[8:11], s20 offen
    buffer_load_dwordx4 a[28:31], v96, s[8:11], s21 offen
    s_add_u32 m0, s24, 6144
    s_add_u32 s20, s20, 4096
    v_mfma_f32_32x32x16_bf16 v[32:47], a[108:111], a[40:43], v[32:47]
    buffer_load_dwordx4 v97, s[12:15], s23 offen lds
    s_add_u32 m0, s24, 7168
    s_add_u32 s25, s23, 9216
    buffer_load_dwordx4 v97, s[12:15], s25 offen lds
    v_mfma_f32_32x32x16_bf16 v[16:31], a[104:107], a[44:47], v[16:31]
    s_add_u32 s21, s21, 4096
    s_add_u32 s23, s23, 73728
    v_mfma_f32_32x32x16_bf16 v[48:63], a[108:111], a[44:47], v[48:63]
    s_waitcnt vmcnt(24) lgkmcnt(0)
    v_mfma_f32_32x32x16_bf16 v[0:15], a[96:99], a[48:51], v[0:15]
    ds_read_b64_tr_b16 a[104:105], v98 offset:14336
    ds_read_b64_tr_b16 a[106:107], v98 offset:14848
    ds_read_b64_tr_b16 a[108:109], v99 offset:14336
    ds_read_b64_tr_b16 a[110:111], v99 offset:14848
    buffer_load_dwordx4 a[32:35], v96, s[8:11], s20 offen
    buffer_load_dwordx4 a[36:39], v96, s[8:11], s21 offen
    s_add_u32 m0, s24, 8192
    s_add_u32 s20, s20, 4096
    v_mfma_f32_32x32x16_bf16 v[32:47], a[100:103], a[48:51], v[32:47]
    buffer_load_dwordx4 v97, s[12:15], s23 offen lds
    s_add_u32 m0, s24, 9216
    s_add_u32 s25, s23, 9216
    buffer_load_dwordx4 v97, s[12:15], s25 offen lds
    v_mfma_f32_32x32x16_bf16 v[16:31], a[96:99], a[52:55], v[16:31]
    s_add_u32 s21, s21, 4096
    s_add_u32 s23, s23, 73728
    v_mfma_f32_32x32x16_bf16 v[48:63], a[100:103], a[52:55], v[48:63]
    s_waitcnt vmcnt(24) lgkmcnt(0)
    v_mfma_f32_32x32x16_bf16 v[0:15], a[104:107], a[56:59], v[0:15]
    ds_read_b64_tr_b16 a[96:97], v98 offset:16384
    ds_read_b64_tr_b16 a[98:99], v98 offset:16896
    ds_read_b64_tr_b16 a[100:101], v99 offset:16384
    ds_read_b64_tr_b16 a[102:103], v99 offset:16896
    buffer_load_dwordx4 a[40:43], v96, s[8:11], s20 offen
    buffer_load_dwordx4 a[44:47], v96, s[8:11], s21 offen
    s_add_u32 m0, s24, 10240
    s_add_u32 s20, s20, 4096
    v_mfma_f32_32x32x16_bf16 v[32:47], a[108:111], a[56:59], v[32:47]
    buffer_load_dwordx4 v97, s[12:15], s23 offen lds
    s_add_u32 m0, s24, 11264
    s_add_u32 s25, s23, 9216
    buffer_load_dwordx4 v97, s[12:15], s25 offen lds
    v_mfma_f32_32x32x16_bf16 v[16:31], a[104:107], a[60:63], v[16:31]
    s_add_u32 s21, s21, 4096
    s_add_u32 s23, s23, 73728
    v_mfma_f32_32x32x16_bf16 v[48:63], a[108:111], a[60:63], v[48:63]
    s_waitcnt vmcnt(24) lgkmcnt(0)
    v_mfma_f32_32x32x16_bf16 v[0:15], a[96:99], a[64:67], v[0:15]
    ds_read_b64_tr_b16 a[104:105], v98 offset:18432
    ds_read_b64_tr_b16 a[106:107], v98 offset:18944
    ds_read_b64_tr_b16 a[108:109], v99 offset:18432
    ds_read_b64_tr_b16 a[110:111], v99 offset:18944
    buffer_load_dwordx4 a[48:51], v96, s[8:11], s20 offen
    buffer_load_dwordx4 a[52:55], v96, s[8:11], s21 offen
    s_add_u32 m0, s24, 12288
    s_add_u32 s20, s20, 4096
    v_mfma_f32_32x32x16_bf16 v[32:47], a[100:103], a[64:67], v[32:47]
    buffer_load_dwordx4 v97, s[12:15], s23 offen lds
    s_add_u32 m0, s24, 13312
    s_add_u32 s25, s23, 9216
    buffer_load_dwordx4 v97, s[12:15], s25 offen lds
    v_mfma_f32_32x32x16_bf16 v[16:31], a[96:99], a[68:71], v[16:31]
    s_add_u32 s21, s21, 4096
    s_add_u32 s23, s23, 73728
    v_mfma_f32_32x32x16_bf16 v[48:63], a[100:103], a[68:71], v[48:63]
    s_waitcnt vmcnt(24) lgkmcnt(0)
    v_mfma_f32_32x32x16_bf16 v[0:15], a[104:107], a[72:75], v[0:15]
    ds_read_b64_tr_b16 a[96:97], v98 offset:0
    ds_read_b64_tr_b16 a[98:99], v98 offset:512
    ds_read_b64_tr_b16 a[100:101], v99 offset:0
    ds_read_b64_tr_b16 a[102:103], v99 offset:512
    buffer_load_dwordx4 a[56:59], v96, s[8:11], s20 offen
    buffer_load_dwordx4 a[60:63], v96, s[8:11], s21 offen
    s_add_u32 m0, s24, 14336
    s_add_u32 s20, s20, 4096
    v_mfma_f32_32x32x16_bf16 v[32:47], a[108:111], a[72:75], v[32:47]
    buffer_load_dwordx4 v97, s[12:15], s23 offen lds
    s_add_u32 m0, s24, 15360
    s_add_u32 s25, s23, 9216
    buffer_load_dwordx4 v97, s[12:15], s25 offen lds
    v_mfma_f32_32x32x16_bf16 v[16:31], a[104:107], a[76:79], v[16:31]
    s_add_u32 s21, s21, 4096
    s_add_u32 s23, s23, 73728
    v_mfma_f32_32x32x16_bf16 v[48:63], a[108:111], a[76:79], v[48:63]
    s_mov_b32 s26, 4
.p2align 6
L_O_12:
    s_waitcnt vmcnt(24) lgkmcnt(0)
    v_mfma_f32_32x32x16_bf16 v[0:15], a[96:99], a[0:3], v[0:15]
    ds_read_b64_tr_b16 a[104:105], v98 offset:2048
    ds_read_b64_tr_b16 a[106:107], v98 offset:2560
    ds_read_b64_tr_b16 a[108:109], v99 offset:2048
    ds_read_b64_tr_b16 a[110:111], v99 offset:2560
    buffer_load_dwordx4 a[64:67], v96, s[8:11], s20 offen
    buffer_load_dwordx4 a[68:71], v96, s[8:11], s21 offen
    s_add_u32 m0, s24, 16384
    s_add_u32 s20, s20, 4096
    v_mfma_f32_32x32x16_bf16 v[32:47], a[100:103], a[0:3], v[32:47]
    buffer_load_dwordx4 v97, s[12:15], s23 offen lds
    s_add_u32 m0, s24, 17408
    s_add_u32 s25, s23, 9216
    buffer_load_dwordx4 v97, s[12:15], s25 offen lds
    v_mfma_f32_32x32x16_bf16 v[16:31], a[96:99], a[4:7], v[16:31]
    s_add_u32 s21, s21, 4096
    s_add_u32 s23, s23, 73728
    v_mfma_f32_32x32x16_bf16 v[48:63], a[100:103], a[4:7], v[48:63]
    s_waitcnt vmcnt(24) lgkmcnt(0)
    v_mfma_f32_32x32x16_bf16 v[0:15], a[104:107], a[8:11], v[0:15]
    ds_read_b64_tr_b16 a[96:97], v98 offset:4096
    ds_read_b64_tr_b16 a[98:99], v98 offset:4608
    ds_read_b64_tr_b16 a[100:101], v99 offset:4096
    ds_read_b64_tr_b16 a[102:103], v99 offset:4608
    buffer_load_dwordx4 a[72:75], v96, s[8:11], s20 offen
    buffer_load_dwordx4 a[76:79], v96, s[8:11], s21 offen
    s_add_u32 m0, s24, 18432
    s_add_u32 s20, s20, 4096
    v_mfma_f32_32x32x16_bf16 v[32:47], a[108:111], a[8:11], v[32:47]
    buffer_load_dwordx4 v97, s[12:15], s23 offen lds
    s_add_u32 m0, s24, 19456
    s_add_u32 s25, s23, 9216
    buffer_load_dwordx4 v97, s[12:15], s25 offen lds
    v_mfma_f32_32x32x16_bf16 v[16:31], a[104:107], a[12:15], v[16:31]
    s_add_u32 s21, s21, 4096
    s_add_u32 s23, s23, 73728
    v_mfma_f32_32x32x16_bf16 v[48:63], a[108:111], a[12:15], v[48:63]
    s_waitcnt vmcnt(24) lgkmcnt(0)
    v_mfma_f32_32x32x16_bf16 v[0:15], a[96:99], a[16:19], v[0:15]
    ds_read_b64_tr_b16 a[104:105], v98 offset:6144
    ds_read_b64_tr_b16 a[106:107], v98 offset:6656
    ds_read_b64_tr_b16 a[108:109], v99 offset:6144
    ds_read_b64_tr_b16 a[110:111], v99 offset:6656
    buffer_load_dwordx4 a[0:3], v96, s[8:11], s20 offen
    buffer_load_dwordx4 a[4:7], v96, s[8:11], s21 offen
    s_add_u32 m0, s24, 0
    s_add_u32 s20, s20, 4096
    v_mfma_f32_32x32x16_bf16 v[32:47], a[100:103], a[16:19], v[32:47]
    buffer_load_dwordx4 v97, s[12:15], s23 offen lds
    s_add_u32 m0, s24, 1024
    s_add_u32 s25, s23, 9216
    buffer_load_dwordx4 v97, s[12:15], s25 offen lds
    v_mfma_f32_32x32x16_bf16 v[16:31], a[96:99], a[20:23], v[16:31]
    s_add_u32 s21, s21, 4096
    s_add_u32 s23, s23, 73728
    v_mfma_f32_32x32x16_bf16 v[48:63], a[100:103], a[20:23], v[48:63]
    s_waitcnt vmcnt(24) lgkmcnt(0)
    v_mfma_f32_32x32x16_bf16 v[0:15], a[104:107], a[24:27], v[0:15]
    ds_read_b64_tr_b16 a[96:97], v98 offset:8192
    ds_read_b64_tr_b16 a[98:99], v98 offset:8704
    ds_read_b64_tr_b16 a[100:101], v99 offset:8192
    ds_read_b64_tr_b16 a[102:103], v99 offset:8704
    buffer_load_dwordx4 a[8:11], v96, s[8:11], s20 offen
    buffer_load_dwordx4 a[12:15], v96, s[8:11], s21 offen
    s_add_u32 m0, s24, 2048
    s_add_u32 s20, s20, 4096
    v_mfma_f32_32x32x16_bf16 v[32:47], a[108:111], a[24:27], v[32:47]
    buffer_load_dwordx4 v97, s[12:15], s23 offen lds
    s_add_u32 m0, s24, 3072
    s_add_u32 s25, s23, 9216
    buffer_load_dwordx4 v97, s[12:15], s25 offen lds
    v_mfma_f32_32x32x16_bf16 v[16:31], a[104:107], a[28:31], v[16:31]
    s_add_u32 s21, s21, 4096
    s_add_u32 s23, s23, 73728
    v_mfma_f32_32x32x16_bf16 v[48:63], a[108:111], a[28:31], v[48:63]
    s_waitcnt vmcnt(24) lgkmcnt(0)
    v_mfma_f32_32x32x16_bf16 v[0:15], a[96:99], a[32:35], v[0:15]
    ds_read_b64_tr_b16 a[104:105], v98 offset:10240
    ds_read_b64_tr_b16 a[106:107], v98 offset:10752
    ds_read_b64_tr_b16 a[108:109], v99 offset:10240
    ds_read_b64_tr_b16 a[110:111], v99 offset:10752
    buffer_load_dwordx4 a[16:19], v96, s[8:11], s20 offen
    buffer_load_dwordx4 a[20:23], v96, s[8:11], s21 offen
    s_add_u32 m0, s24, 4096
    s_add_u32 s20, s20, 4096
    v_mfma_f32_32x32x16_bf16 v[32:47], a[100:103], a[32:35], v[32:47]
    buffer_load_dwordx4 v97, s[12:15], s23 offen lds
    s_add_u32 m0, s24, 5120
    s_add_u32 s25, s23, 9216
    buffer_load_dwordx4 v97, s[12:15], s25 offen lds
    v_mfma_f32_32x32x16_bf16 v[16:31], a[96:99], a[36:39], v[16:31]
    s_add_u32 s21, s21, 4096
    s_add_u32 s23, s23, 73728
    v_mfma_f32_32x32x16_bf16 v[48:63], a[100:103], a[36:39], v[48:63]
    s_waitcnt vmcnt(24) lgkmcnt(0)
    v_mfma_f32_32x32x16_bf16 v[0:15], a[104:107], a[40:43], v[0:15]
    ds_read_b64_tr_b16 a[96:97], v98 offset:12288
    ds_read_b64_tr_b16 a[98:99], v98 offset:12800
    ds_read_b64_tr_b16 a[100:101], v99 offset:12288
    ds_read_b64_tr_b16 a[102:103], v99 offset:12800
    buffer_load_dwordx4 a[24:27], v96, s[8:11], s20 offen
    buffer_load_dwordx4 a[28:31], v96, s[8:11], s21 offen
    s_add_u32 m0, s24, 6144
    s_add_u32 s20, s20, 4096
    v_mfma_f32_32x32x16_bf16 v[32:47], a[108:111], a[40:43], v[32:47]
    buffer_load_dwordx4 v97, s[12:15], s23 offen lds
    s_add_u32 m0, s24, 7168
    s_add_u32 s25, s23, 9216
    buffer_load_dwordx4 v97, s[12:15], s25 offen lds
    v_mfma_f32_32x32x16_bf16 v[16:31], a[104:107], a[44:47], v[16:31]
    s_add_u32 s21, s21, 4096
    s_add_u32 s23, s23, 73728
    v_mfma_f32_32x32x16_bf16 v[48:63], a[108:111], a[44:47], v[48:63]
    s_waitcnt vmcnt(24) lgkmcnt(0)
    v_mfma_f32_32x32x16_bf16 v[0:15], a[96:99], a[48:51], v[0:15]
    ds_read_b64_tr_b16 a[104:105], v98 offset:14336
    ds_read_b64_tr_b16 a[106:107], v98 offset:14848
    ds_read_b64_tr_b16 a[108:109], v99 offset:14336
    ds_read_b64_tr_b16 a[110:111], v99 offset:14848
    buffer_load_dwordx4 a[32:35], v96, s[8:11], s20 offen
    buffer_load_dwordx4 a[36:39], v96, s[8:11], s21 offen
    s_add_u32 m0, s24, 8192
    s_add_u32 s20, s20, 4096
    v_mfma_f32_32x32x16_bf16 v[32:47], a[100:103], a[48:51], v[32:47]
    buffer_load_dwordx4 v97, s[12:15], s23 offen lds
    s_add_u32 m0, s24, 9216
    s_add_u32 s25, s23, 9216
    buffer_load_dwordx4 v97, s[12:15], s25 offen lds
    v_mfma_f32_32x32x16_bf16 v[16:31], a[96:99], a[52:55], v[16:31]
    s_add_u32 s21, s21, 4096
    s_add_u32 s23, s23, 73728
    v_mfma_f32_32x32x16_bf16 v[48:63], a[100:103], a[52:55], v[48:63]
    s_waitcnt vmcnt(24) lgkmcnt(0)
    v_mfma_f32_32x32x16_bf16 v[0:15], a[104:107], a[56:59], v[0:15]
    ds_read_b64_tr_b16 a[96:97], v98 offset:16384
    ds_read_b64_tr_b16 a[98:99], v98 offset:16896
    ds_read_b64_tr_b16 a[100:101], v99 offset:16384
    ds_read_b64_tr_b16 a[102:103], v99 offset:16896
    buffer_load_dwordx4 a[40:43], v96, s[8:11], s20 offen
    buffer_load_dwordx4 a[44:47], v96, s[8:11], s21 offen
    s_add_u32 m0, s24, 10240
    s_add_u32 s20, s20, 4096
    v_mfma_f32_32x32x16_bf16 v[32:47], a[108:111], a[56:59], v[32:47]
    buffer_load_dwordx4 v97, s[12:15], s23 offen lds
    s_add_u32 m0, s24, 11264
    s_add_u32 s25, s23, 9216
    buffer_load_dwordx4 v97, s[12:15], s25 offen lds
    v_mfma_f32_32x32x16_bf16 v[16:31], a[104:107], a[60:63], v[16:31]
    s_add_u32 s21, s21, 4096
    s_add_u32 s23, s23, 73728
    v_mfma_f32_32x32x16_bf16 v[48:63], a[108:111], a[60:63], v[48:63]
    s_waitcnt vmcnt(24) lgkmcnt(0)
    v_mfma_f32_32x32x16_bf16 v[0:15], a[96:99], a[64:67], v[0:15]
    ds_read_b64_tr_b16 a[104:105], v98 offset:18432
    ds_read_b64_tr_b16 a[106:107], v98 offset:18944
    ds_read_b64_tr_b16 a[108:109], v99 offset:18432
    ds_read_b64_tr_b16 a[110:111], v99 offset:18944
    buffer_load_dwordx4 a[48:51], v96, s[8:11], s20 offen
    buffer_load_dwordx4 a[52:55], v96, s[8:11], s21 offen
    s_add_u32 m0, s24, 12288
    s_add_u32 s20, s20, 4096
    v_mfma_f32_32x32x16_bf16 v[32:47], a[100:103], a[64:67], v[32:47]
    buffer_load_dwordx4 v97, s[12:15], s23 offen lds
    s_add_u32 m0, s24, 13312
    s_add_u32 s25, s23, 9216
    buffer_load_dwordx4 v97, s[12:15], s25 offen lds
    v_mfma_f32_32x32x16_bf16 v[16:31], a[96:99], a[68:71], v[16:31]
    s_add_u32 s21, s21, 4096
    s_add_u32 s23, s23, 73728
    v_mfma_f32_32x32x16_bf16 v[48:63], a[100:103], a[68:71], v[48:63]
    s_waitcnt vmcnt(24) lgkmcnt(0)
    v_mfma_f32_32x32x16_bf16 v[0:15], a[104:107], a[72:75], v[0:15]
    ds_read_b64_tr_b16 a[96:97], v98 offset:0
    ds_read_b64_tr_b16 a[98:99], v98 offset:512
    ds_read_b64_tr_b16 a[100:101], v99 offset:0
    ds_read_b64_tr_b16 a[102:103], v99 offset:512
    buffer_load_dwordx4 a[56:59], v96, s[8:11], s20 offen
    buffer_load_dwordx4 a[60:63], v96, s[8:11], s21 offen
    s_add_u32 m0, s24, 14336
    s_add_u32 s20, s20, 4096
    v_mfma_f32_32x32x16_bf16 v[32:47], a[108:111], a[72:75], v[32:47]
    buffer_load_dwordx4 v97, s[12:15], s23 offen lds
    s_add_u32 m0, s24, 15360
    s_add_u32 s25, s23, 9216
    buffer_load_dwordx4 v97, s[12:15], s25 offen lds
    v_mfma_f32_32x32x16_bf16 v[16:31], a[104:107], a[76:79], v[16:31]
    s_add_u32 s21, s21, 4096
    s_add_u32 s23, s23, 73728
    v_mfma_f32_32x32x16_bf16 v[48:63], a[108:111], a[76:79], v[48:63]
    s_sub_u32 s26, s26, 1
    s_cmp_lg_u32 s26, 0
    s_cbranch_scc1 L_O_12
    s_waitcnt vmcnt(24) lgkmcnt(0)
    v_mfma_f32_32x32x16_bf16 v[0:15], a[96:99], a[0:3], v[0:15]
    ds_read_b64_tr_b16 a[104:105], v98 offset:2048
    ds_read_b64_tr_b16 a[106:107], v98 offset:2560
    ds_read_b64_tr_b16 a[108:109], v99 offset:2048
    ds_read_b64_tr_b16 a[110:111], v99 offset:2560
    buffer_load_dwordx4 a[64:67], v96, s[8:11], s20 offen
    buffer_load_dwordx4 a[68:71], v96, s[8:11], s21 offen
    s_add_u32 m0, s24, 16384
    s_add_u32 s20, s20, 4096
    v_mfma_f32_32x32x16_bf16 v[32:47], a[100:103], a[0:3], v[32:47]
    buffer_load_dwordx4 v97, s[12:15], s23 offen lds
    s_add_u32 m0, s24, 17408
    s_add_u32 s25, s23, 9216
    buffer_load_dwordx4 v97, s[12:15], s25 offen lds
    v_mfma_f32_32x32x16_bf16 v[16:31], a[96:99], a[4:7], v[16:31]
    s_add_u32 s21, s21, 4096
    s_add_u32 s23, s23, 73728
    v_mfma_f32_32x32x16_bf16 v[48:63], a[100:103], a[4:7], v[48:63]
    s_waitcnt vmcnt(24) lgkmcnt(0)
    v_mfma_f32_32x32x16_bf16 v[0:15], a[104:107], a[8:11], v[0:15]
    ds_read_b64_tr_b16 a[96:97], v98 offset:4096
    ds_read_b64_tr_b16 a[98:99], v98 offset:4608
    ds_read_b64_tr_b16 a[100:101], v99 offset:4096
    ds_read_b64_tr_b16 a[102:103], v99 offset:4608
    buffer_load_dwordx4 a[72:75], v96, s[8:11], s20 offen
    buffer_load_dwordx4 a[76:79], v96, s[8:11], s21 offen
    s_add_u32 m0, s24, 18432
    s_add_u32 s20, s20, 4096
    v_mfma_f32_32x32x16_bf16 v[32:47], a[108:111], a[8:11], v[32:47]
    buffer_load_dwordx4 v97, s[12:15], s23 offen lds
    s_add_u32 m0, s24, 19456
    s_add_u32 s25, s23, 9216
    buffer_load_dwordx4 v97, s[12:15], s25 offen lds
    v_mfma_f32_32x32x16_bf16 v[16:31], a[104:107], a[12:15], v[16:31]
    s_add_u32 s21, s21, 4096
    s_add_u32 s23, s23, 73728
    v_mfma_f32_32x32x16_bf16 v[48:63], a[108:111], a[12:15], v[48:63]
    s_waitcnt vmcnt(24) lgkmcnt(0)
    v_mfma_f32_32x32x16_bf16 v[0:15], a[96:99], a[16:19], v[0:15]
    ds_read_b64_tr_b16 a[104:105], v98 offset:6144
    ds_read_b64_tr_b16 a[106:107], v98 offset:6656
    ds_read_b64_tr_b16 a[108:109], v99 offset:6144
    ds_read_b64_tr_b16 a[110:111], v99 offset:6656
    buffer_load_dwordx4 a[0:3], v96, s[8:11], s20 offen
    buffer_load_dwordx4 a[4:7], v96, s[8:11], s21 offen
    s_add_u32 m0, s24, 0
    s_add_u32 s20, s20, 4096
    v_mfma_f32_32x32x16_bf16 v[32:47], a[100:103], a[16:19], v[32:47]
    buffer_load_dwordx4 v97, s[12:15], s23 offen lds
    s_add_u32 m0, s24, 1024
    s_add_u32 s25, s23, 9216
    buffer_load_dwordx4 v97, s[12:15], s25 offen lds
    v_mfma_f32_32x32x16_bf16 v[16:31], a[96:99], a[20:23], v[16:31]
    s_add_u32 s21, s21, 4096
    s_add_u32 s23, s23, 73728
    v_mfma_f32_32x32x16_bf16 v[48:63], a[100:103], a[20:23], v[48:63]
    s_waitcnt vmcnt(24) lgkmcnt(0)
    v_mfma_f32_32x32x16_bf16 v[0:15], a[104:107], a[24:27], v[0:15]
    ds_read_b64_tr_b16 a[96:97], v98 offset:8192
    ds_read_b64_tr_b16 a[98:99], v98 offset:8704
    ds_read_b64_tr_b16 a[100:101], v99 offset:8192
    ds_read_b64_tr_b16 a[102:103], v99 offset:8704
    buffer_load_dwordx4 a[8:11], v96, s[8:11], s20 offen
    buffer_load_dwordx4 a[12:15], v96, s[8:11], s21 offen
    s_add_u32 m0, s24, 2048
    s_add_u32 s20, s20, 4096
    v_mfma_f32_32x32x16_bf16 v[32:47], a[108:111], a[24:27], v[32:47]
    buffer_load_dwordx4 v97, s[12:15], s23 offen lds
    s_add_u32 m0, s24, 3072
    s_add_u32 s25, s23, 9216
    buffer_load_dwordx4 v97, s[12:15], s25 offen lds
    v_mfma_f32_32x32x16_bf16 v[16:31], a[104:107], a[28:31], v[16:31]
    s_add_u32 s21, s21, 4096
    s_add_u32 s23, s23, 73728
    v_mfma_f32_32x32x16_bf16 v[48:63], a[108:111], a[28:31], v[48:63]
    s_waitcnt vmcnt(24) lgkmcnt(0)
    v_mfma_f32_32x32x16_bf16 v[0:15], a[96:99], a[32:35], v[0:15]
    ds_read_b64_tr_b16 a[104:105], v98 offset:10240
    ds_read_b64_tr_b16 a[106:107], v98 offset:10752
    ds_read_b64_tr_b16 a[108:109], v99 offset:10240
    ds_read_b64_tr_b16 a[110:111], v99 offset:10752
    buffer_load_dwordx4 a[16:19], v96, s[8:11], s20 offen
    buffer_load_dwordx4 a[20:23], v96, s[8:11], s21 offen
    s_add_u32 m0, s24, 4096
    s_add_u32 s20, s20, 4096
    v_mfma_f32_32x32x16_bf16 v[32:47], a[100:103], a[32:35], v[32:47]
    buffer_load_dwordx4 v97, s[12:15], s23 offen lds
    s_add_u32 m0, s24, 5120
    s_add_u32 s25, s23, 9216
    buffer_load_dwordx4 v97, s[12:15], s25 offen lds
    v_mfma_f32_32x32x16_bf16 v[16:31], a[96:99], a[36:39], v[16:31]
    s_add_u32 s21, s21, 4096
    s_add_u32 s23, s23, 73728
    v_mfma_f32_32x32x16_bf16 v[48:63], a[100:103], a[36:39], v[48:63]
    s_waitcnt vmcnt(24) lgkmcnt(0)
    v_mfma_f32_32x32x16_bf16 v[0:15], a[104:107], a[40:43], v[0:15]
    ds_read_b64_tr_b16 a[96:97], v98 offset:12288
    ds_read_b64_tr_b16 a[98:99], v98 offset:12800
    ds_read_b64_tr_b16 a[100:101], v99 offset:12288
    ds_read_b64_tr_b16 a[102:103], v99 offset:12800
    buffer_load_dwordx4 a[24:27], v96, s[8:11], s20 offen
    buffer_load_dwordx4 a[28:31], v96, s[8:11], s21 offen
    s_add_u32 m0, s24, 6144
    s_add_u32 s20, s20, 4096
    v_mfma_f32_32x32x16_bf16 v[32:47], a[108:111], a[40:43], v[32:47]
    buffer_load_dwordx4 v97, s[12:15], s23 offen lds
    s_add_u32 m0, s24, 7168
    s_add_u32 s25, s23, 9216
    buffer_load_dwordx4 v97, s[12:15], s25 offen lds
    v_mfma_f32_32x32x16_bf16 v[16:31], a[104:107], a[44:47], v[16:31]
    s_add_u32 s21, s21, 4096
    s_add_u32 s23, s23, 73728
    v_mfma_f32_32x32x16_bf16 v[48:63], a[108:111], a[44:47], v[48:63]
    s_waitcnt vmcnt(24) lgkmcnt(0)
    v_mfma_f32_32x32x16_bf16 v[0:15], a[96:99], a[48:51], v[0:15]
    ds_read_b64_tr_b16 a[104:105], v98 offset:14336
    ds_read_b64_tr_b16 a[106:107], v98 offset:14848
    ds_read_b64_tr_b16 a[108:109], v99 offset:14336
    ds_read_b64_tr_b16 a[110:111], v99 offset:14848
    v_mfma_f32_32x32x16_bf16 v[32:47], a[100:103], a[48:51], v[32:47]
    v_mfma_f32_32x32x16_bf16 v[16:31], a[96:99], a[52:55], v[16:31]
    v_mfma_f32_32x32x16_bf16 v[48:63], a[100:103], a[52:55], v[48:63]
    s_waitcnt vmcnt(20) lgkmcnt(0)
    v_mfma_f32_32x32x16_bf16 v[0:15], a[104:107], a[56:59], v[0:15]
    ds_read_b64_tr_b16 a[96:97], v98 offset:16384
    ds_read_b64_tr_b16 a[98:99], v98 offset:16896
    ds_read_b64_tr_b16 a[100:101], v99 offset:16384
    ds_read_b64_tr_b16 a[102:103], v99 offset:16896
    v_mfma_f32_32x32x16_bf16 v[32:47], a[108:111], a[56:59], v[32:47]
    v_mfma_f32_32x32x16_bf16 v[16:31], a[104:107], a[60:63], v[16:31]
    v_mfma_f32_32x32x16_bf16 v[48:63], a[108:111], a[60:63], v[48:63]
    s_waitcnt vmcnt(16) lgkmcnt(0)
    v_mfma_f32_32x32x16_bf16 v[0:15], a[96:99], a[64:67], v[0:15]
    ds_read_b64_tr_b16 a[104:105], v98 offset:18432
    ds_read_b64_tr_b16 a[106:107], v98 offset:18944
    ds_read_b64_tr_b16 a[108:109], v99 offset:18432
    ds_read_b64_tr_b16 a[110:111], v99 offset:18944
    v_mfma_f32_32x32x16_bf16 v[32:47], a[100:103], a[64:67], v[32:47]
    v_mfma_f32_32x32x16_bf16 v[16:31], a[96:99], a[68:71], v[16:31]
    v_mfma_f32_32x32x16_bf16 v[48:63], a[100:103], a[68:71], v[48:63]
    s_waitcnt vmcnt(12) lgkmcnt(0)
    v_mfma_f32_32x32x16_bf16 v[0:15], a[104:107], a[72:75], v[0:15]
    ds_read_b64_tr_b16 a[96:97], v98 offset:0
    ds_read_b64_tr_b16 a[98:99], v98 offset:512
    ds_read_b64_tr_b16 a[100:101], v99 offset:0
    ds_read_b64_tr_b16 a[102:103], v99 offset:512
    v_mfma_f32_32x32x16_bf16 v[32:47], a[108:111], a[72:75], v[32:47]
    v_mfma_f32_32x32x16_bf16 v[16:31], a[104:107], a[76:79], v[16:31]
    v_mfma_f32_32x32x16_bf16 v[48:63], a[108:111], a[76:79], v[48:63]
    s_waitcnt vmcnt(8) lgkmcnt(0)
    v_mfma_f32_32x32x16_bf16 v[0:15], a[96:99], a[0:3], v[0:15]
    ds_read_b64_tr_b16 a[104:105], v98 offset:2048
    ds_read_b64_tr_b16 a[106:107], v98 offset:2560
    ds_read_b64_tr_b16 a[108:109], v99 offset:2048
    ds_read_b64_tr_b16 a[110:111], v99 offset:2560
    v_mfma_f32_32x32x16_bf16 v[32:47], a[100:103], a[0:3], v[32:47]
    v_mfma_f32_32x32x16_bf16 v[16:31], a[96:99], a[4:7], v[16:31]
    v_mfma_f32_32x32x16_bf16 v[48:63], a[100:103], a[4:7], v[48:63]
    s_waitcnt vmcnt(4) lgkmcnt(0)
    v_mfma_f32_32x32x16_bf16 v[0:15], a[104:107], a[8:11], v[0:15]
    ds_read_b64_tr_b16 a[96:97], v98 offset:4096
    ds_read_b64_tr_b16 a[98:99], v98 offset:4608
    ds_read_b64_tr_b16 a[100:101], v99 offset:4096
    ds_read_b64_tr_b16 a[102:103], v99 offset:4608
    v_mfma_f32_32x32x16_bf16 v[32:47], a[108:111], a[8:11], v[32:47]
    v_mfma_f32_32x32x16_bf16 v[16:31], a[104:107], a[12:15], v[16:31]
    v_mfma_f32_32x32x16_bf16 v[48:63], a[108:111], a[12:15], v[48:63]
    s_waitcnt vmcnt(0) lgkmcnt(0)
    v_mfma_f32_32x32x16_bf16 v[0:15], a[96:99], a[16:19], v[0:15]
    ds_read_b64_tr_b16 a[104:105], v98 offset:6144
    ds_read_b64_tr_b16 a[106:107], v98 offset:6656
    ds_read_b64_tr_b16 a[108:109], v99 offset:6144
    ds_read_b64_tr_b16 a[110:111], v99 offset:6656
    v_mfma_f32_32x32x16_bf16 v[32:47], a[100:103], a[16:19], v[32:47]
    v_mfma_f32_32x32x16_bf16 v[16:31], a[96:99], a[20:23], v[16:31]
    v_mfma_f32_32x32x16_bf16 v[48:63], a[100:103], a[20:23], v[48:63]
    s_waitcnt lgkmcnt(0)
    v_mfma_f32_32x32x16_bf16 v[0:15], a[104:107], a[24:27], v[0:15]
    v_mfma_f32_32x32x16_bf16 v[32:47], a[108:111], a[24:27], v[32:47]
    v_mfma_f32_32x32x16_bf16 v[16:31], a[104:107], a[28:31], v[16:31]
    v_mfma_f32_32x32x16_bf16 v[48:63], a[108:111], a[28:31], v[48:63]
    s_nop 7
    s_nop 7
    v_mul_u32_u24 v105, 2304, v101
    v_lshl_add_u32 v105, v102, 4, v105
    v_add_u32 v104, s24, v96
    s_cmp_eq_u32 s3, 1
    s_cbranch_scc1 L_rw_14
    s_cmp_eq_u32 s3, 2
    s_cbranch_scc1 L_rw_15
    s_cmp_eq_u32 s3, 3
    s_cbranch_scc1 L_rw_16
    ds_write_b128 v104, v[16:19] offset:0
    ds_write_b128 v104, v[20:23] offset:1024
    ds_write_b128 v104, v[24:27] offset:2048
    ds_write_b128 v104, v[28:31] offset:3072
    ds_write_b128 v104, v[32:35] offset:4096
    ds_write_b128 v104, v[36:39] offset:5120
    ds_write_b128 v104, v[40:43] offset:6144
    ds_write_b128 v104, v[44:47] offset:7168
    ds_write_b128 v104, v[48:51] offset:8192
    ds_write_b128 v104, v[52:55] offset:9216
    ds_write_b128 v104, v[56:59] offset:10240
    ds_write_b128 v104, v[60:63] offset:11264
    s_waitcnt lgkmcnt(0)
    s_barrier
    v_mov_b32 v106, v96
    v_add_u32 v107, 0x10000, v96
    ds_read_b128 v[16:19], v106 offset:20480
    ds_read_b128 v[20:23], v106 offset:21504
    ds_read_b128 v[24:27], v106 offset:22528
    ds_read_b128 v[28:31], v106 offset:23552
    ds_read_b128 v[32:35], v106 offset:40960
    ds_read_b128 v[36:39], v106 offset:41984
    ds_read_b128 v[40:43], v106 offset:43008
    ds_read_b128 v[44:47], v106 offset:44032
    ds_read_b128 v[48:51], v106 offset:61440
    ds_read_b128 v[52:55], v106 offset:62464
    ds_read_b128 v[56:59], v106 offset:63488
    ds_read_b128 v[60:63], v106 offset:64512
    s_add_u32 s25, s27, 0
    s_mul_i32 s25, s25, 73728
    s_lshl_b32 s29, s28, 7
    s_add_u32 s25, s25, s29
    s_add_u32 s25, s25, s30
    s_waitcnt lgkmcnt(0)
    v_pk_add_f32 v[0:1], v[0:1], v[16:17]
    v_pk_add_f32 v[32:33], v[32:33], v[48:49]
    v_pk_add_f32 v[2:3], v[2:3], v[18:19]
    v_pk_add_f32 v[34:35], v[34:35], v[50:51]
    v_pk_add_f32 v[4:5], v[4:5], v[20:21]
    v_pk_add_f32 v[36:37], v[36:37], v[52:53]
    v_pk_add_f32 v[6:7], v[6:7], v[22:23]
    v_pk_add_f32 v[38:39], v[38:39], v[54:55]
    v_pk_add_f32 v[8:9], v[8:9], v[24:25]
    v_pk_add_f32 v[40:41], v[40:41], v[56:57]
    v_pk_add_f32 v[10:11], v[10:11], v[26:27]
    v_pk_add_f32 v[42:43], v[42:43], v[58:59]
    v_pk_add_f32 v[12:13], v[12:13], v[28:29]
    v_pk_add_f32 v[44:45], v[44:45], v[60:61]
    v_pk_add_f32 v[14:15], v[14:15], v[30:31]
    v_pk_add_f32 v[46:47], v[46:47], v[62:63]
    v_pk_add_f32 v[0:1], v[0:1], v[32:33]
    v_pk_add_f32 v[2:3], v[2:3], v[34:35]
    v_pk_add_f32 v[4:5], v[4:5], v[36:37]
    v_pk_add_f32 v[6:7], v[6:7], v[38:39]
    v_pk_add_f32 v[8:9], v[8:9], v[40:41]
    v_pk_add_f32 v[10:11], v[10:11], v[42:43]
    v_pk_add_f32 v[12:13], v[12:13], v[44:45]
    v_pk_add_f32 v[14:15], v[14:15], v[46:47]
    v_cvt_pk_bf16_f32 v0, v0, v1
    v_cvt_pk_bf16_f32 v1, v2, v3
    v_cvt_pk_bf16_f32 v2, v4, v5
    v_cvt_pk_bf16_f32 v3, v6, v7
    v_cvt_pk_bf16_f32 v4, v8, v9
    v_cvt_pk_bf16_f32 v5, v10, v11
    v_cvt_pk_bf16_f32 v6, v12, v13
    v_cvt_pk_bf16_f32 v7, v14, v15
    buffer_store_dwordx4 v[0:3], v105, s[16:19], s25 offen
    buffer_store_dwordx4 v[4:7], v105, s[16:19], s25 offen offset:32
    s_branch L_rj_17
L_rw_14:
    ds_write_b128 v104, v[0:3] offset:0
    ds_write_b128 v104, v[4:7] offset:1024
    ds_write_b128 v104, v[8:11] offset:2048
    ds_write_b128 v104, v[12:15] offset:3072
    ds_write_b128 v104, v[32:35] offset:4096
    ds_write_b128 v104, v[36:39] offset:5120
    ds_write_b128 v104, v[40:43] offset:6144
    ds_write_b128 v104, v[44:47] offset:7168
    ds_write_b128 v104, v[48:51] offset:8192
    ds_write_b128 v104, v[52:55] offset:9216
    ds_write_b128 v104, v[56:59] offset:10240
    ds_write_b128 v104, v[60:63] offset:11264
    s_waitcnt lgkmcnt(0)
    s_barrier
    v_mov_b32 v106, v96
    v_add_u32 v107, 0x10000, v96
    ds_read_b128 v[0:3], v106 offset:0
    ds_read_b128 v[4:7], v106 offset:1024
    ds_read_b128 v[8:11], v106 offset:2048
    ds_read_b128 v[12:15], v106 offset:3072
    ds_read_b128 v[32:35], v106 offset:45056
    ds_read_b128 v[36:39], v106 offset:46080
    ds_read_b128 v[40:43], v106 offset:47104
    ds_read_b128 v[44:47], v106 offset:48128
    ds_read_b128 v[48:51], v107 offset:0
    ds_read_b128 v[52:55], v107 offset:1024
    ds_read_b128 v[56:59], v107 offset:2048
    ds_read_b128 v[60:63], v107 offset:3072
    s_add_u32 s25, s27, 1
    s_mul_i32 s25, s25, 73728
    s_lshl_b32 s29, s28, 7
    s_add_u32 s25, s25, s29
    s_add_u32 s25, s25, s30
    s_waitcnt lgkmcnt(0)
    v_pk_add_f32 v[16:17], v[16:17], v[0:1]
    v_pk_add_f32 v[32:33], v[32:33], v[48:49]
    v_pk_add_f32 v[18:19], v[18:19], v[2:3]
    v_pk_add_f32 v[34:35], v[34:35], v[50:51]
    v_pk_add_f32 v[20:21], v[20:21], v[4:5]
    v_pk_add_f32 v[36:37], v[36:37], v[52:53]
    v_pk_add_f32 v[22:23], v[22:23], v[6:7]
    v_pk_add_f32 v[38:39], v[38:39], v[54:55]
    v_pk_add_f32 v[24:25], v[24:25], v[8:9]
    v_pk_add_f32 v[40:41], v[40:41], v[56:57]
    v_pk_add_f32 v[26:27], v[26:27], v[10:11]
    v_pk_add_f32 v[42:43], v[42:43], v[58:59]
    v_pk_add_f32 v[28:29], v[28:29], v[12:13]
    v_pk_add_f32 v[44:45], v[44:45], v[60:61]
    v_pk_add_f32 v[30:31], v[30:31], v[14:15]
    v_pk_add_f32 v[46:47], v[46:47], v[62:63]
    v_pk_add_f32 v[16:17], v[16:17], v[32:33]
    v_pk_add_f32 v[18:19], v[18:19], v[34:35]
    v_pk_add_f32 v[20:21], v[20:21], v[36:37]
    v_pk_add_f32 v[22:23], v[22:23], v[38:39]
    v_pk_add_f32 v[24:25], v[24:25], v[40:41]
    v_pk_add_f32 v[26:27], v[26:27], v[42:43]
    v_pk_add_f32 v[28:29], v[28:29], v[44:45]
    v_pk_add_f32 v[30:31], v[30:31], v[46:47]
    v_cvt_pk_bf16_f32 v16, v16, v17
    v_cvt_pk_bf16_f32 v17, v18, v19
    v_cvt_pk_bf16_f32 v18, v20, v21
    v_cvt_pk_bf16_f32 v19, v22, v23
    v_cvt_pk_bf16_f32 v20, v24, v25
    v_cvt_pk_bf16_f32 v21, v26, v27
    v_cvt_pk_bf16_f32 v22, v28, v29
    v_cvt_pk_bf16_f32 v23, v30, v31
    buffer_store_dwordx4 v[16:19], v105, s[16:19], s25 offen
    buffer_store_dwordx4 v[20:23], v105, s[16:19], s25 offen offset:32
    s_branch L_rj_17
L_rw_15:
    ds_write_b128 v104, v[0:3] offset:0
    ds_write_b128 v104, v[4:7] offset:1024
    ds_write_b128 v104, v[8:11] offset:2048
    ds_write_b128 v104, v[12:15] offset:3072
    ds_write_b128 v104, v[16:19] offset:4096
    ds_write_b128 v104, v[20:23] offset:5120
    ds_write_b128 v104, v[24:27] offset:6144
    ds_write_b128 v104, v[28:31] offset:7168
    ds_write_b128 v104, v[48:51] offset:8192
    ds_write_b128 v104, v[52:55] offset:9216
    ds_write_b128 v104, v[56:59] offset:10240
    ds_write_b128 v104, v[60:63] offset:11264
    s_waitcnt lgkmcnt(0)
    s_barrier
    v_mov_b32 v106, v96
    v_add_u32 v107, 0x10000, v96
    ds_read_b128 v[0:3], v106 offset:4096
    ds_read_b128 v[4:7], v106 offset:5120
    ds_read_b128 v[8:11], v106 offset:6144
    ds_read_b128 v[12:15], v106 offset:7168
    ds_read_b128 v[16:19], v106 offset:24576
    ds_read_b128 v[20:23], v106 offset:25600
    ds_read_b128 v[24:27], v106 offset:26624
    ds_read_b128 v[28:31], v106 offset:27648
    ds_read_b128 v[48:51], v107 offset:4096
    ds_read_b128 v[52:55], v107 offset:5120
    ds_read_b128 v[56:59], v107 offset:6144
    ds_read_b128 v[60:63], v107 offset:7168
    s_add_u32 s25, s27, 0
    s_mul_i32 s25, s25, 73728
    s_lshl_b32 s29, s28, 7
    s_add_u32 s25, s25, s29
    s_add_u32 s25, s25, s30
    s_add_u32 s25, s25, 64
    s_waitcnt lgkmcnt(0)
    v_pk_add_f32 v[32:33], v[32:33], v[0:1]
    v_pk_add_f32 v[16:17], v[16:17], v[48:49]
    v_pk_add_f32 v[34:35], v[34:35], v[2:3]
    v_pk_add_f32 v[18:19], v[18:19], v[50:51]
    v_pk_add_f32 v[36:37], v[36:37], v[4:5]
    v_pk_add_f32 v[20:21], v[20:21], v[52:53]
    v_pk_add_f32 v[38:39], v[38:39], v[6:7]
    v_pk_add_f32 v[22:23], v[22:23], v[54:55]
    v_pk_add_f32 v[40:41], v[40:41], v[8:9]
    v_pk_add_f32 v[24:25], v[24:25], v[56:57]
    v_pk_add_f32 v[42:43], v[42:43], v[10:11]
    v_pk_add_f32 v[26:27], v[26:27], v[58:59]
    v_pk_add_f32 v[44:45], v[44:45], v[12:13]
    v_pk_add_f32 v[28:29], v[28:29], v[60:61]
    v_pk_add_f32 v[46:47], v[46:47], v[14:15]
    v_pk_add_f32 v[30:31], v[30:31], v[62:63]
    v_pk_add_f32 v[32:33], v[32:33], v[16:17]
    v_pk_add_f32 v[34:35], v[34:35], v[18:19]
    v_pk_add_f32 v[36:37], v[36:37], v[20:21]
    v_pk_add_f32 v[38:39], v[38:39], v[22:23]
    v_pk_add_f32 v[40:41], v[40:41], v[24:25]
    v_pk_add_f32 v[42:43], v[42:43], v[26:27]
    v_pk_add_f32 v[44:45], v[44:45], v[28:29]
    v_pk_add_f32 v[46:47], v[46:47], v[30:31]
    v_cvt_pk_bf16_f32 v32, v32, v33
    v_cvt_pk_bf16_f32 v33, v34, v35
    v_cvt_pk_bf16_f32 v34, v36, v37
    v_cvt_pk_bf16_f32 v35, v38, v39
    v_cvt_pk_bf16_f32 v36, v40, v41
    v_cvt_pk_bf16_f32 v37, v42, v43
    v_cvt_pk_bf16_f32 v38, v44, v45
    v_cvt_pk_bf16_f32 v39, v46, v47
    buffer_store_dwordx4 v[32:35], v105, s[16:19], s25 offen
    buffer_store_dwordx4 v[36:39], v105, s[16:19], s25 offen offset:32
    s_branch L_rj_17
L_rw_16:
    ds_write_b128 v104, v[0:3] offset:0
    ds_write_b128 v104, v[4:7] offset:1024
    ds_write_b128 v104, v[8:11] offset:2048
    ds_write_b128 v104, v[12:15] offset:3072
    ds_write_b128 v104, v[16:19] offset:4096
    ds_write_b128 v104, v[20:23] offset:5120
    ds_write_b128 v104, v[24:27] offset:6144
    ds_write_b128 v104, v[28:31] offset:7168
    ds_write_b128 v104, v[32:35] offset:8192
    ds_write_b128 v104, v[36:39] offset:9216
    ds_write_b128 v104, v[40:43] offset:10240
    ds_write_b128 v104, v[44:47] offset:11264
    s_waitcnt lgkmcnt(0)
    s_barrier
    v_mov_b32 v106, v96
    v_add_u32 v107, 0x10000, v96
    ds_read_b128 v[0:3], v106 offset:8192
    ds_read_b128 v[4:7], v106 offset:9216
    ds_read_b128 v[8:11], v106 offset:10240
    ds_read_b128 v[12:15], v106 offset:11264
    ds_read_b128 v[16:19], v106 offset:28672
    ds_read_b128 v[20:23], v106 offset:29696
    ds_read_b128 v[24:27], v106 offset:30720
    ds_read_b128 v[28:31], v106 offset:31744
    ds_read_b128 v[32:35], v106 offset:49152
    ds_read_b128 v[36:39], v106 offset:50176
    ds_read_b128 v[40:43], v106 offset:51200
    ds_read_b128 v[44:47], v106 offset:52224
    s_add_u32 s25, s27, 1
    s_mul_i32 s25, s25, 73728
    s_lshl_b32 s29, s28, 7
    s_add_u32 s25, s25, s29
    s_add_u32 s25, s25, s30
    s_add_u32 s25, s25, 64
    s_waitcnt lgkmcnt(0)
    v_pk_add_f32 v[48:49], v[48:49], v[0:1]
    v_pk_add_f32 v[16:17], v[16:17], v[32:33]
    v_pk_add_f32 v[50:51], v[50:51], v[2:3]
    v_pk_add_f32 v[18:19], v[18:19], v[34:35]
    v_pk_add_f32 v[52:53], v[52:53], v[4:5]
    v_pk_add_f32 v[20:21], v[20:21], v[36:37]
    v_pk_add_f32 v[54:55], v[54:55], v[6:7]
    v_pk_add_f32 v[22:23], v[22:23], v[38:39]
    v_pk_add_f32 v[56:57], v[56:57], v[8:9]
    v_pk_add_f32 v[24:25], v[24:25], v[40:41]
    v_pk_add_f32 v[58:59], v[58:59], v[10:11]
    v_pk_add_f32 v[26:27], v[26:27], v[42:43]
    v_pk_add_f32 v[60:61], v[60:61], v[12:13]
    v_pk_add_f32 v[28:29], v[28:29], v[44:45]
    v_pk_add_f32 v[62:63], v[62:63], v[14:15]
    v_pk_add_f32 v[30:31], v[30:31], v[46:47]
    v_pk_add_f32 v[48:49], v[48:49], v[16:17]
    v_pk_add_f32 v[50:51], v[50:51], v[18:19]
    v_pk_add_f32 v[52:53], v[52:53], v[20:21]
    v_pk_add_f32 v[54:55], v[54:55], v[22:23]
    v_pk_add_f32 v[56:57], v[56:57], v[24:25]
    v_pk_add_f32 v[58:59], v[58:59], v[26:27]
    v_pk_add_f32 v[60:61], v[60:61], v[28:29]
    v_pk_add_f32 v[62:63], v[62:63], v[30:31]
    v_cvt_pk_bf16_f32 v48, v48, v49
    v_cvt_pk_bf16_f32 v49, v50, v51
    v_cvt_pk_bf16_f32 v50, v52, v53
    v_cvt_pk_bf16_f32 v51, v54, v55
    v_cvt_pk_bf16_f32 v52, v56, v57
    v_cvt_pk_bf16_f32 v53, v58, v59
    v_cvt_pk_bf16_f32 v54, v60, v61
    v_cvt_pk_bf16_f32 v55, v62, v63
    buffer_store_dwordx4 v[48:51], v105, s[16:19], s25 offen
    buffer_store_dwordx4 v[52:55], v105, s[16:19], s25 offen offset:32
    s_branch L_rj_17
L_rj_17:
    s_branch L_k3_bt
L_k3_bt:
    s_barrier
    s_mov_b32 s12, s34
    s_mov_b32 s13, s35
    s_mov_b32 s14, 0xa2000
    s_mov_b32 s15, 0x00020000
    s_mov_b32 s30, 1152
    s_and_b32 s27, s2, 7
    s_lshl_b32 s27, s27, 2
    s_bfe_u32 s25, s2, 0x20003
    s_add_u32 s27, s27, s25
    s_lshl_b32 s27, s27, 1
    s_mov_b32 s28, s52
    s_add_u32 s20, s27, 0
    s_mul_i32 s20, s20, 49152
    s_lshl_b32 s25, s3, 10
    s_add_u32 s20, s20, s25
    s_add_u32 s20, s20, 79691776
    s_add_u32 s21, s27, 1
    s_mul_i32 s21, s21, 49152
    s_lshl_b32 s25, s3, 10
    s_add_u32 s21, s21, s25
    s_add_u32 s21, s21, 79691776
    s_lshl_b32 s25, s3, 1
    s_add_u32 s25, s25, 0
    s_mul_i32 s29, s25, 171
    s_lshr_b32 s29, s29, 9
    s_mul_i32 s29, s29, 6
    s_lshl_b32 s25, s25, 3
    s_sub_u32 s25, s25, s29
    s_mul_i32 s25, s25, 1152
    s_lshl_b32 s29, s28, 7
    s_add_u32 s44, s25, s29
    s_lshl_b32 s25, s3, 1
    s_add_u32 s25, s25, 1
    s_mul_i32 s29, s25, 171
    s_lshr_b32 s29, s29, 9
    s_mul_i32 s29, s29, 6
    s_lshl_b32 s25, s25, 3
    s_sub_u32 s25, s25, s29
    s_mul_i32 s25, s25, 1152
    s_lshl_b32 s29, s28, 7
    s_add_u32 s45, s25, s29
    s_lshl_b32 s25, s3, 1
    s_add_u32 s25, s25, 8
    s_mul_i32 s29, s25, 171
    s_lshr_b32 s29, s29, 9
    s_mul_i32 s29, s29, 6
    s_lshl_b32 s25, s25, 3
    s_sub_u32 s25, s25, s29
    s_mul_i32 s25, s25, 1152
    s_lshl_b32 s29, s28, 7
    s_add_u32 s46, s25, s29
    s_lshl_b32 s25, s3, 1
    s_add_u32 s25, s25, 9
    s_mul_i32 s29, s25, 171
    s_lshr_b32 s29, s29, 9
    s_mul_i32 s29, s29, 6
    s_lshl_b32 s25, s25, 3
    s_sub_u32 s25, s25, s29
    s_mul_i32 s25, s25, 1152
    s_lshl_b32 s29, s28, 7
    s_add_u32 s47, s25, s29
    s_lshl_b32 s25, s3, 1
    s_add_u32 s25, s25, 16
    s_mul_i32 s29, s25, 171
    s_lshr_b32 s29, s29, 9
    s_mul_i32 s29, s29, 6
    s_lshl_b32 s25, s25, 3
    s_sub_u32 s25, s25, s29
    s_mul_i32 s25, s25, 1152
    s_lshl_b32 s29, s28, 7
    s_add_u32 s48, s25, s29
    s_lshl_b32 s25, s3, 1
    s_add_u32 s25, s25, 17
    s_mul_i32 s29, s25, 171
    s_lshr_b32 s29, s29, 9
    s_mul_i32 s29, s29, 6
    s_lshl_b32 s25, s25, 3
    s_sub_u32 s25, s25, s29
    s_mul_i32 s25, s25, 1152
    s_lshl_b32 s29, s28, 7
    s_add_u32 s49, s25, s29
    s_add_u32 m0, s24, 0
    s_add_u32 s25, s44, 0
    buffer_load_dwordx4 v97, s[12:15], s25 offen lds
    s_add_u32 m0, s24, 1024
    s_add_u32 s25, s45, 0
    buffer_load_dwordx4 v97, s[12:15], s25 offen lds
    s_add_u32 m0, s24, 2048
    s_add_u32 s25, s46, 0
    buffer_load_dwordx4 v97, s[12:15], s25 offen lds
    s_add_u32 m0, s24, 3072
    s_add_u32 s25, s47, 0
    buffer_load_dwordx4 v97, s[12:15], s25 offen lds
    s_add_u32 m0, s24, 4096
    s_add_u32 s25, s48, 0
    buffer_load_dwordx4 v97, s[12:15], s25 offen lds
    s_add_u32 m0, s24, 5120
    s_add_u32 s25, s49, 0
    buffer_load_dwordx4 v97, s[12:15], s25 offen lds
    s_add_u32 m0, s24, 6144
    s_add_u32 s25, s44, 165888
    buffer_load_dwordx4 v97, s[12:15], s25 offen lds
    s_add_u32 m0, s24, 7168
    s_add_u32 s25, s45, 165888
    buffer_load_dwordx4 v97, s[12:15], s25 offen lds
    s_add_u32 m0, s24, 8192
    s_add_u32 s25, s46, 165888
    buffer_load_dwordx4 v97, s[12:15], s25 offen lds
    s_add_u32 m0, s24, 9216
    s_add_u32 s25, s47, 165888
    buffer_load_dwordx4 v97, s[12:15], s25 offen lds
    s_add_u32 m0, s24, 10240
    s_add_u32 s25, s48, 165888
    buffer_load_dwordx4 v97, s[12:15], s25 offen lds
    s_add_u32 m0, s24, 11264
    s_add_u32 s25, s49, 165888
    buffer_load_dwordx4 v97, s[12:15], s25 offen lds
    s_add_u32 m0, s24, 12288
    s_add_u32 s25, s44, 331776
    buffer_load_dwordx4 v97, s[12:15], s25 offen lds
    s_add_u32 m0, s24, 13312
    s_add_u32 s25, s45, 331776
    buffer_load_dwordx4 v97, s[12:15], s25 offen lds
    s_add_u32 m0, s24, 14336
    s_add_u32 s25, s46, 331776
    buffer_load_dwordx4 v97, s[12:15], s25 offen lds
    s_add_u32 m0, s24, 15360
    s_add_u32 s25, s47, 331776
    buffer_load_dwordx4 v97, s[12:15], s25 offen lds
    s_add_u32 m0, s24, 16384
    s_add_u32 s25, s48, 331776
    buffer_load_dwordx4 v97, s[12:15], s25 offen lds
    s_add_u32 m0, s24, 17408
    s_add_u32 s25, s49, 331776
    buffer_load_dwordx4 v97, s[12:15], s25 offen lds
    s_add_u32 m0, s24, 18432
    s_add_u32 s25, s44, 497664
    buffer_load_dwordx4 v97, s[12:15], s25 offen lds
    s_add_u32 m0, s24, 19456
    s_add_u32 s25, s45, 497664
    buffer_load_dwordx4 v97, s[12:15], s25 offen lds
    s_cmp_lg_u32 s3, 0
    s_cbranch_scc1 L_polld_19
    s_mov_b32 s51, 0
L_poll_18:
    buffer_load_dword v114, v113, s[8:11], s50 offen sc1
    s_waitcnt vmcnt(0)
    v_cmp_eq_u32 vcc, v114, v112
    s_nop 3
    s_cmp_eq_u64 vcc, 0
    s_cbranch_scc1 L_polld_19
    s_add_u32 s51, s51, 1
    s_cmp_ge_u32 s51, 2000
    s_cbranch_scc1 L_polld_19
    s_sleep 8
    s_branch L_poll_18
L_polld_19:
    s_barrier
    buffer_load_dwordx4 a[0:3], v96, s[8:11], s20 offen
    buffer_load_dwordx4 a[4:7], v96, s[8:11], s21 offen
    s_add_u32 s20, s20, 4096
    s_add_u32 s21, s21, 4096
    buffer_load_dwordx4 a[8:11], v96, s[8:11], s20 offen
    buffer_load_dwordx4 a[12:15], v96, s[8:11], s21 offen
    s_add_u32 s20, s20, 4096
    s_add_u32 s21, s21, 4096
    buffer_load_dwordx4 a[16:19], v96, s[8:11], s20 offen
    buffer_load_dwordx4 a[20:23], v96, s[8:11], s21 offen
    s_add_u32 s20, s20, 4096
    s_add_u32 s21, s21, 4096
    buffer_load_dwordx4 a[24:27], v96, s[8:11], s20 offen
    buffer_load_dwordx4 a[28:31], v96, s[8:11], s21 offen
    s_add_u32 s20, s20, 4096
    s_add_u32 s21, s21, 4096
    buffer_load_dwordx4 a[32:35], v96, s[8:11], s20 offen
    buffer_load_dwordx4 a[36:39], v96, s[8:11], s21 offen
    s_add_u32 s20, s20, 4096
    s_add_u32 s21, s21, 4096
    buffer_load_dwordx4 a[40:43], v96, s[8:11], s20 offen
    buffer_load_dwordx4 a[44:47], v96, s[8:11], s21 offen
    s_add_u32 s20, s20, 4096
    s_add_u32 s21, s21, 4096
    buffer_load_dwordx4 a[48:51], v96, s[8:11], s20 offen
    buffer_load_dwordx4 a[52:55], v96, s[8:11], s21 offen
    s_add_u32 s20, s20, 4096
    s_add_u32 s21, s21, 4096
    buffer_load_dwordx4 a[56:59], v96, s[8:11], s20 offen
    buffer_load_dwordx4 a[60:63], v96, s[8:11], s21 offen
    s_add_u32 s20, s20, 4096
    s_add_u32 s21, s21, 4096
    buffer_load_dwordx4 a[64:67], v96, s[8:11], s20 offen
    buffer_load_dwordx4 a[68:71], v96, s[8:11], s21 offen
    s_add_u32 s20, s20, 4096
    s_add_u32 s21, s21, 4096
    buffer_load_dwordx4 a[72:75], v96, s[8:11], s20 offen
    buffer_load_dwordx4 a[76:79], v96, s[8:11], s21 offen
    s_add_u32 s20, s20, 4096
    s_add_u32 s21, s21, 4096
    s_waitcnt vmcnt(18)
    ds_read_b64_tr_b16 a[96:97], v98 offset:0
    ds_read_b64_tr_b16 a[98:99], v98 offset:512
    ds_read_b64_tr_b16 a[100:101], v99 offset:0
    ds_read_b64_tr_b16 a[102:103], v99 offset:512
    s_waitcnt vmcnt(16) lgkmcnt(0)
    v_mfma_f32_32x32x16_bf16 v[0:15], a[96:99], a[0:3], 0
    ds_read_b64_tr_b16 a[104:105], v98 offset:2048
    ds_read_b64_tr_b16 a[106:107], v98 offset:2560
    ds_read_b64_tr_b16 a[108:109], v99 offset:2048
    ds_read_b64_tr_b16 a[110:111], v99 offset:2560
    v_mfma_f32_32x32x16_bf16 v[32:47], a[100:103], a[0:3], 0
    v_mfma_f32_32x32x16_bf16 v[16:31], a[96:99], a[4:7], 0
    v_mfma_f32_32x32x16_bf16 v[48:63], a[100:103], a[4:7], 0
    s_add_u32 m0, s24, 0
    s_add_u32 s25, s46, 497664
    buffer_load_dwordx4 v97, s[12:15], s25 offen lds
    s_add_u32 m0, s24, 1024
    s_add_u32 s25, s47, 497664
    buffer_load_dwordx4 v97, s[12:15], s25 offen lds
    buffer_load_dwordx4 a[0:3], v96, s[8:11], s20 offen
    buffer_load_dwordx4 a[4:7], v96, s[8:11], s21 offen
    s_add_u32 s20, s20, 4096
    s_add_u32 s21, s21, 4096
    s_waitcnt vmcnt(18) lgkmcnt(0)
    v_mfma_f32_32x32x16_bf16 v[0:15], a[104:107], a[8:11], v[0:15]
    ds_read_b64_tr_b16 a[96:97], v98 offset:4096
    ds_read_b64_tr_b16 a[98:99], v98 offset:4608
    ds_read_b64_tr_b16 a[100:101], v99 offset:4096
    ds_read_b64_tr_b16 a[102:103], v99 offset:4608
    v_mfma_f32_32x32x16_bf16 v[32:47], a[108:111], a[8:11], v[32:47]
    v_mfma_f32_32x32x16_bf16 v[16:31], a[104:107], a[12:15], v[16:31]
    v_mfma_f32_32x32x16_bf16 v[48:63], a[108:111], a[12:15], v[48:63]
    s_add_u32 m0, s24, 2048
    s_add_u32 s25, s48, 497664
    buffer_load_dwordx4 v97, s[12:15], s25 offen lds
    s_add_u32 m0, s24, 3072
    s_add_u32 s25, s49, 497664
    buffer_load_dwordx4 v97, s[12:15], s25 offen lds
    buffer_load_dwordx4 a[8:11], v96, s[8:11], s20 offen
    buffer_load_dwordx4 a[12:15], v96, s[8:11], s21 offen
    s_add_u32 s20, s20, 4096
    s_add_u32 s21, s21, 4096
    s_waitcnt vmcnt(20) lgkmcnt(0)
    v_mfma_f32_32x32x16_bf16 v[0:15], a[96:99], a[16:19], v[0:15]
    ds_read_b64_tr_b16 a[104:105], v98 offset:6144
    ds_read_b64_tr_b16 a[106:107], v98 offset:6656
    ds_read_b64_tr_b16 a[108:109], v99 offset:6144
    ds_read_b64_tr_b16 a[110:111], v99 offset:6656
    v_mfma_f32_32x32x16_bf16 v[32:47], a[100:103], a[16:19], v[32:47]
    v_mfma_f32_32x32x16_bf16 v[16:31], a[96:99], a[20:23], v[16:31]
    v_mfma_f32_32x32x16_bf16 v[48:63], a[100:103], a[20:23], v[48:63]
    s_waitcnt vmcnt(18) lgkmcnt(0)
    v_mfma_f32_32x32x16_bf16 v[0:15], a[104:107], a[24:27], v[0:15]
    ds_read_b64_tr_b16 a[96:97], v98 offset:8192
    ds_read_b64_tr_b16 a[98:99], v98 offset:8704
    ds_read_b64_tr_b16 a[100:101], v99 offset:8192
    ds_read_b64_tr_b16 a[102:103], v99 offset:8704
    v_mfma_f32_32x32x16_bf16 v[32:47], a[108:111], a[24:27], v[32:47]
    v_mfma_f32_32x32x16_bf16 v[16:31], a[104:107], a[28:31], v[16:31]
    v_mfma_f32_32x32x16_bf16 v[48:63], a[108:111], a[28:31], v[48:63]
    s_waitcnt vmcnt(16) lgkmcnt(0)
    v_mfma_f32_32x32x16_bf16 v[0:15], a[96:99], a[32:35], v[0:15]
    ds_read_b64_tr_b16 a[104:105], v98 offset:10240
    ds_read_b64_tr_b16 a[106:107], v98 offset:10752
    ds_read_b64_tr_b16 a[108:109], v99 offset:10240
    ds_read_b64_tr_b16 a[110:111], v99 offset:10752
    v_mfma_f32_32x32x16_bf16 v[32:47], a[100:103], a[32:35], v[32:47]
    v_mfma_f32_32x32x16_bf16 v[16:31], a[96:99], a[36:39], v[16:31]
    v_mfma_f32_32x32x16_bf16 v[48:63], a[100:103], a[36:39], v[48:63]
    s_waitcnt vmcnt(14) lgkmcnt(0)
    v_mfma_f32_32x32x16_bf16 v[0:15], a[104:107], a[40:43], v[0:15]
    ds_read_b64_tr_b16 a[96:97], v98 offset:12288
    ds_read_b64_tr_b16 a[98:99], v98 offset:12800
    ds_read_b64_tr_b16 a[100:101], v99 offset:12288
    ds_read_b64_tr_b16 a[102:103], v99 offset:12800
    v_mfma_f32_32x32x16_bf16 v[32:47], a[108:111], a[40:43], v[32:47]
    v_mfma_f32_32x32x16_bf16 v[16:31], a[104:107], a[44:47], v[16:31]
    v_mfma_f32_32x32x16_bf16 v[48:63], a[108:111], a[44:47], v[48:63]
    s_waitcnt vmcnt(12) lgkmcnt(0)
    v_mfma_f32_32x32x16_bf16 v[0:15], a[96:99], a[48:51], v[0:15]
    ds_read_b64_tr_b16 a[104:105], v98 offset:14336
    ds_read_b64_tr_b16 a[106:107], v98 offset:14848
    ds_read_b64_tr_b16 a[108:109], v99 offset:14336
    ds_read_b64_tr_b16 a[110:111], v99 offset:14848
    v_mfma_f32_32x32x16_bf16 v[32:47], a[100:103], a[48:51], v[32:47]
    v_mfma_f32_32x32x16_bf16 v[16:31], a[96:99], a[52:55], v[16:31]
    v_mfma_f32_32x32x16_bf16 v[48:63], a[100:103], a[52:55], v[48:63]
    s_waitcnt vmcnt(10) lgkmcnt(0)
    v_mfma_f32_32x32x16_bf16 v[0:15], a[104:107], a[56:59], v[0:15]
    ds_read_b64_tr_b16 a[96:97], v98 offset:16384
    ds_read_b64_tr_b16 a[98:99], v98 offset:16896
    ds_read_b64_tr_b16 a[100:101], v99 offset:16384
    ds_read_b64_tr_b16 a[102:103], v99 offset:16896
    v_mfma_f32_32x32x16_bf16 v[32:47], a[108:111], a[56:59], v[32:47]
    v_mfma_f32_32x32x16_bf16 v[16:31], a[104:107], a[60:63], v[16:31]
    v_mfma_f32_32x32x16_bf16 v[48:63], a[108:111], a[60:63], v[48:63]
    s_waitcnt vmcnt(8) lgkmcnt(0)
    v_mfma_f32_32x32x16_bf16 v[0:15], a[96:99], a[64:67], v[0:15]
    ds_read_b64_tr_b16 a[104:105], v98 offset:18432
    ds_read_b64_tr_b16 a[106:107], v98 offset:18944
    ds_read_b64_tr_b16 a[108:109], v99 offset:18432
    ds_read_b64_tr_b16 a[110:111], v99 offset:18944
    v_mfma_f32_32x32x16_bf16 v[32:47], a[100:103], a[64:67], v[32:47]
    v_mfma_f32_32x32x16_bf16 v[16:31], a[96:99], a[68:71], v[16:31]
    v_mfma_f32_32x32x16_bf16 v[48:63], a[100:103], a[68:71], v[48:63]
    s_waitcnt vmcnt(4) lgkmcnt(0)
    v_mfma_f32_32x32x16_bf16 v[0:15], a[104:107], a[72:75], v[0:15]
    ds_read_b64_tr_b16 a[96:97], v98 offset:0
    ds_read_b64_tr_b16 a[98:99], v98 offset:512
    ds_read_b64_tr_b16 a[100:101], v99 offset:0
    ds_read_b64_tr_b16 a[102:103], v99 offset:512
    v_mfma_f32_32x32x16_bf16 v[32:47], a[108:111], a[72:75], v[32:47]
    v_mfma_f32_32x32x16_bf16 v[16:31], a[104:107], a[76:79], v[16:31]
    v_mfma_f32_32x32x16_bf16 v[48:63], a[108:111], a[76:79], v[48:63]
    s_waitcnt vmcnt(0) lgkmcnt(0)
    v_mfma_f32_32x32x16_bf16 v[0:15], a[96:99], a[0:3], v[0:15]
    ds_read_b64_tr_b16 a[104:105], v98 offset:2048
    ds_read_b64_tr_b16 a[106:107], v98 offset:2560
    ds_read_b64_tr_b16 a[108:109], v99 offset:2048
    ds_read_b64_tr_b16 a[110:111], v99 offset:2560
    v_mfma_f32_32x32x16_bf16 v[32:47], a[100:103], a[0:3], v[32:47]
    v_mfma_f32_32x32x16_bf16 v[16:31], a[96:99], a[4:7], v[16:31]
    v_mfma_f32_32x32x16_bf16 v[48:63], a[100:103], a[4:7], v[48:63]
    s_waitcnt lgkmcnt(0)
    v_mfma_f32_32x32x16_bf16 v[0:15], a[104:107], a[8:11], v[0:15]
    v_mfma_f32_32x32x16_bf16 v[32:47], a[108:111], a[8:11], v[32:47]
    v_mfma_f32_32x32x16_bf16 v[16:31], a[104:107], a[12:15], v[16:31]
    v_mfma_f32_32x32x16_bf16 v[48:63], a[108:111], a[12:15], v[48:63]
    s_nop 7
    s_nop 7
    v_mul_u32_u24 v105, 2304, v101
    v_lshl_add_u32 v105, v102, 4, v105
    v_add_u32 v104, s24, v96
    s_cmp_eq_u32 s3, 1
    s_cbranch_scc1 L_rw_21
    s_cmp_eq_u32 s3, 2
    s_cbranch_scc1 L_rw_22
    s_cmp_eq_u32 s3, 3
    s_cbranch_scc1 L_rw_23
    ds_write_b128 v104, v[16:19] offset:0
    ds_write_b128 v104, v[20:23] offset:1024
    ds_write_b128 v104, v[24:27] offset:2048
    ds_write_b128 v104, v[28:31] offset:3072
    ds_write_b128 v104, v[32:35] offset:4096
    ds_write_b128 v104, v[36:39] offset:5120
    ds_write_b128 v104, v[40:43] offset:6144
    ds_write_b128 v104, v[44:47] offset:7168
    ds_write_b128 v104, v[48:51] offset:8192
    ds_write_b128 v104, v[52:55] offset:9216
    ds_write_b128 v104, v[56:59] offset:10240
    ds_write_b128 v104, v[60:63] offset:11264
    s_waitcnt lgkmcnt(0)
    s_barrier
    v_mov_b32 v106, v96
    v_add_u32 v107, 0x10000, v96
    ds_read_b128 v[16:19], v106 offset:20480
    ds_read_b128 v[20:23], v106 offset:21504
    ds_read_b128 v[24:27], v106 offset:22528
    ds_read_b128 v[28:31], v106 offset:23552
    ds_read_b128 v[32:35], v106 offset:40960
    ds_read_b128 v[36:39], v106 offset:41984
    ds_read_b128 v[40:43], v106 offset:43008
    ds_read_b128 v[44:47], v106 offset:44032
    ds_read_b128 v[48:51], v106 offset:61440
    ds_read_b128 v[52:55], v106 offset:62464
    ds_read_b128 v[56:59], v106 offset:63488
    ds_read_b128 v[60:63], v106 offset:64512
    s_add_u32 s25, s27, 0
    s_mul_i32 s25, s25, 73728
    s_lshl_b32 s29, s28, 7
    s_add_u32 s25, s25, s29
    s_add_u32 s25, s25, s30
    s_waitcnt lgkmcnt(0)
    v_pk_add_f32 v[0:1], v[0:1], v[16:17]
    v_pk_add_f32 v[32:33], v[32:33], v[48:49]
    v_pk_add_f32 v[2:3], v[2:3], v[18:19]
    v_pk_add_f32 v[34:35], v[34:35], v[50:51]
    v_pk_add_f32 v[4:5], v[4:5], v[20:21]
    v_pk_add_f32 v[36:37], v[36:37], v[52:53]
    v_pk_add_f32 v[6:7], v[6:7], v[22:23]
    v_pk_add_f32 v[38:39], v[38:39], v[54:55]
    v_pk_add_f32 v[8:9], v[8:9], v[24:25]
    v_pk_add_f32 v[40:41], v[40:41], v[56:57]
    v_pk_add_f32 v[10:11], v[10:11], v[26:27]
    v_pk_add_f32 v[42:43], v[42:43], v[58:59]
    v_pk_add_f32 v[12:13], v[12:13], v[28:29]
    v_pk_add_f32 v[44:45], v[44:45], v[60:61]
    v_pk_add_f32 v[14:15], v[14:15], v[30:31]
    v_pk_add_f32 v[46:47], v[46:47], v[62:63]
    v_pk_add_f32 v[0:1], v[0:1], v[32:33]
    v_pk_add_f32 v[2:3], v[2:3], v[34:35]
    v_pk_add_f32 v[4:5], v[4:5], v[36:37]
    v_pk_add_f32 v[6:7], v[6:7], v[38:39]
    v_pk_add_f32 v[8:9], v[8:9], v[40:41]
    v_pk_add_f32 v[10:11], v[10:11], v[42:43]
    v_pk_add_f32 v[12:13], v[12:13], v[44:45]
    v_pk_add_f32 v[14:15], v[14:15], v[46:47]
    v_cvt_pk_bf16_f32 v0, v0, v1
    v_cvt_pk_bf16_f32 v1, v2, v3
    v_cvt_pk_bf16_f32 v2, v4, v5
    v_cvt_pk_bf16_f32 v3, v6, v7
    v_cvt_pk_bf16_f32 v4, v8, v9
    v_cvt_pk_bf16_f32 v5, v10, v11
    v_cvt_pk_bf16_f32 v6, v12, v13
    v_cvt_pk_bf16_f32 v7, v14, v15
    buffer_store_dwordx4 v[0:3], v105, s[16:19], s25 offen
    buffer_store_dwordx4 v[4:7], v105, s[16:19], s25 offen offset:32
    s_branch L_rj_24
L_rw_21:
    ds_write_b128 v104, v[0:3] offset:0
    ds_write_b128 v104, v[4:7] offset:1024
    ds_write_b128 v104, v[8:11] offset:2048
    ds_write_b128 v104, v[12:15] offset:3072
    ds_write_b128 v104, v[32:35] offset:4096
    ds_write_b128 v104, v[36:39] offset:5120
    ds_write_b128 v104, v[40:43] offset:6144
    ds_write_b128 v104, v[44:47] offset:7168
    ds_write_b128 v104, v[48:51] offset:8192
    ds_write_b128 v104, v[52:55] offset:9216
    ds_write_b128 v104, v[56:59] offset:10240
    ds_write_b128 v104, v[60:63] offset:11264
    s_waitcnt lgkmcnt(0)
    s_barrier
    v_mov_b32 v106, v96
    v_add_u32 v107, 0x10000, v96
    ds_read_b128 v[0:3], v106 offset:0
    ds_read_b128 v[4:7], v106 offset:1024
    ds_read_b128 v[8:11], v106 offset:2048
    ds_read_b128 v[12:15], v106 offset:3072
    ds_read_b128 v[32:35], v106 offset:45056
    ds_read_b128 v[36:39], v106 offset:46080
    ds_read_b128 v[40:43], v106 offset:47104
    ds_read_b128 v[44:47], v106 offset:48128
    ds_read_b128 v[48:51], v107 offset:0
    ds_read_b128 v[52:55], v107 offset:1024
    ds_read_b128 v[56:59], v107 offset:2048
    ds_read_b128 v[60:63], v107 offset:3072
    s_add_u32 s25, s27, 1
    s_mul_i32 s25, s25, 73728
    s_lshl_b32 s29, s28, 7
    s_add_u32 s25, s25, s29
    s_add_u32 s25, s25, s30
    s_waitcnt lgkmcnt(0)
    v_pk_add_f32 v[16:17], v[16:17], v[0:1]
    v_pk_add_f32 v[32:33], v[32:33], v[48:49]
    v_pk_add_f32 v[18:19], v[18:19], v[2:3]
    v_pk_add_f32 v[34:35], v[34:35], v[50:51]
    v_pk_add_f32 v[20:21], v[20:21], v[4:5]
    v_pk_add_f32 v[36:37], v[36:37], v[52:53]
    v_pk_add_f32 v[22:23], v[22:23], v[6:7]
    v_pk_add_f32 v[38:39], v[38:39], v[54:55]
    v_pk_add_f32 v[24:25], v[24:25], v[8:9]
    v_pk_add_f32 v[40:41], v[40:41], v[56:57]
    v_pk_add_f32 v[26:27], v[26:27], v[10:11]
    v_pk_add_f32 v[42:43], v[42:43], v[58:59]
    v_pk_add_f32 v[28:29], v[28:29], v[12:13]
    v_pk_add_f32 v[44:45], v[44:45], v[60:61]
    v_pk_add_f32 v[30:31], v[30:31], v[14:15]
    v_pk_add_f32 v[46:47], v[46:47], v[62:63]
    v_pk_add_f32 v[16:17], v[16:17], v[32:33]
    v_pk_add_f32 v[18:19], v[18:19], v[34:35]
    v_pk_add_f32 v[20:21], v[20:21], v[36:37]
    v_pk_add_f32 v[22:23], v[22:23], v[38:39]
    v_pk_add_f32 v[24:25], v[24:25], v[40:41]
    v_pk_add_f32 v[26:27], v[26:27], v[42:43]
    v_pk_add_f32 v[28:29], v[28:29], v[44:45]
    v_pk_add_f32 v[30:31], v[30:31], v[46:47]
    v_cvt_pk_bf16_f32 v16, v16, v17
    v_cvt_pk_bf16_f32 v17, v18, v19
    v_cvt_pk_bf16_f32 v18, v20, v21
    v_cvt_pk_bf16_f32 v19, v22, v23
    v_cvt_pk_bf16_f32 v20, v24, v25
    v_cvt_pk_bf16_f32 v21, v26, v27
    v_cvt_pk_bf16_f32 v22, v28, v29
    v_cvt_pk_bf16_f32 v23, v30, v31
    buffer_store_dwordx4 v[16:19], v105, s[16:19], s25 offen
    buffer_store_dwordx4 v[20:23], v105, s[16:19], s25 offen offset:32
    s_branch L_rj_24
L_rw_22:
    ds_write_b128 v104, v[0:3] offset:0
    ds_write_b128 v104, v[4:7] offset:1024
    ds_write_b128 v104, v[8:11] offset:2048
    ds_write_b128 v104, v[12:15] offset:3072
    ds_write_b128 v104, v[16:19] offset:4096
    ds_write_b128 v104, v[20:23] offset:5120
    ds_write_b128 v104, v[24:27] offset:6144
    ds_write_b128 v104, v[28:31] offset:7168
    ds_write_b128 v104, v[48:51] offset:8192
    ds_write_b128 v104, v[52:55] offset:9216
    ds_write_b128 v104, v[56:59] offset:10240
    ds_write_b128 v104, v[60:63] offset:11264
    s_waitcnt lgkmcnt(0)
    s_barrier
    v_mov_b32 v106, v96
    v_add_u32 v107, 0x10000, v96
    ds_read_b128 v[0:3], v106 offset:4096
    ds_read_b128 v[4:7], v106 offset:5120
    ds_read_b128 v[8:11], v106 offset:6144
    ds_read_b128 v[12:15], v106 offset:7168
    ds_read_b128 v[16:19], v106 offset:24576
    ds_read_b128 v[20:23], v106 offset:25600
    ds_read_b128 v[24:27], v106 offset:26624
    ds_read_b128 v[28:31], v106 offset:27648
    ds_read_b128 v[48:51], v107 offset:4096
    ds_read_b128 v[52:55], v107 offset:5120
    ds_read_b128 v[56:59], v107 offset:6144
    ds_read_b128 v[60:63], v107 offset:7168
    s_add_u32 s25, s27, 0
    s_mul_i32 s25, s25, 73728
    s_lshl_b32 s29, s28, 7
    s_add_u32 s25, s25, s29
    s_add_u32 s25, s25, s30
    s_add_u32 s25, s25, 64
    s_waitcnt lgkmcnt(0)
    v_pk_add_f32 v[32:33], v[32:33], v[0:1]
    v_pk_add_f32 v[16:17], v[16:17], v[48:49]
    v_pk_add_f32 v[34:35], v[34:35], v[2:3]
    v_pk_add_f32 v[18:19], v[18:19], v[50:51]
    v_pk_add_f32 v[36:37], v[36:37], v[4:5]
    v_pk_add_f32 v[20:21], v[20:21], v[52:53]
    v_pk_add_f32 v[38:39], v[38:39], v[6:7]
    v_pk_add_f32 v[22:23], v[22:23], v[54:55]
    v_pk_add_f32 v[40:41], v[40:41], v[8:9]
    v_pk_add_f32 v[24:25], v[24:25], v[56:57]
    v_pk_add_f32 v[42:43], v[42:43], v[10:11]
    v_pk_add_f32 v[26:27], v[26:27], v[58:59]
    v_pk_add_f32 v[44:45], v[44:45], v[12:13]
    v_pk_add_f32 v[28:29], v[28:29], v[60:61]
    v_pk_add_f32 v[46:47], v[46:47], v[14:15]
    v_pk_add_f32 v[30:31], v[30:31], v[62:63]
    v_pk_add_f32 v[32:33], v[32:33], v[16:17]
    v_pk_add_f32 v[34:35], v[34:35], v[18:19]
    v_pk_add_f32 v[36:37], v[36:37], v[20:21]
    v_pk_add_f32 v[38:39], v[38:39], v[22:23]
    v_pk_add_f32 v[40:41], v[40:41], v[24:25]
    v_pk_add_f32 v[42:43], v[42:43], v[26:27]
    v_pk_add_f32 v[44:45], v[44:45], v[28:29]
    v_pk_add_f32 v[46:47], v[46:47], v[30:31]
    v_cvt_pk_bf16_f32 v32, v32, v33
    v_cvt_pk_bf16_f32 v33, v34, v35
    v_cvt_pk_bf16_f32 v34, v36, v37
    v_cvt_pk_bf16_f32 v35, v38, v39
    v_cvt_pk_bf16_f32 v36, v40, v41
    v_cvt_pk_bf16_f32 v37, v42, v43
    v_cvt_pk_bf16_f32 v38, v44, v45
    v_cvt_pk_bf16_f32 v39, v46, v47
    buffer_store_dwordx4 v[32:35], v105, s[16:19], s25 offen
    buffer_store_dwordx4 v[36:39], v105, s[16:19], s25 offen offset:32
    s_branch L_rj_24
L_rw_23:
    ds_write_b128 v104, v[0:3] offset:0
    ds_write_b128 v104, v[4:7] offset:1024
    ds_write_b128 v104, v[8:11] offset:2048
    ds_write_b128 v104, v[12:15] offset:3072
    ds_write_b128 v104, v[16:19] offset:4096
    ds_write_b128 v104, v[20:23] offset:5120
    ds_write_b128 v104, v[24:27] offset:6144
    ds_write_b128 v104, v[28:31] offset:7168
    ds_write_b128 v104, v[32:35] offset:8192
    ds_write_b128 v104, v[36:39] offset:9216
    ds_write_b128 v104, v[40:43] offset:10240
    ds_write_b128 v104, v[44:47] offset:11264
    s_waitcnt lgkmcnt(0)
    s_barrier
    v_mov_b32 v106, v96
    v_add_u32 v107, 0x10000, v96
    ds_read_b128 v[0:3], v106 offset:8192
    ds_read_b128 v[4:7], v106 offset:9216
    ds_read_b128 v[8:11], v106 offset:10240
    ds_read_b128 v[12:15], v106 offset:11264
    ds_read_b128 v[16:19], v106 offset:28672
    ds_read_b128 v[20:23], v106 offset:29696
    ds_read_b128 v[24:27], v106 offset:30720
    ds_read_b128 v[28:31], v106 offset:31744
    ds_read_b128 v[32:35], v106 offset:49152
    ds_read_b128 v[36:39], v106 offset:50176
    ds_read_b128 v[40:43], v106 offset:51200
    ds_read_b128 v[44:47], v106 offset:52224
    s_add_u32 s25, s27, 1
    s_mul_i32 s25, s25, 73728
    s_lshl_b32 s29, s28, 7
    s_add_u32 s25, s25, s29
    s_add_u32 s25, s25, s30
    s_add_u32 s25, s25, 64
    s_waitcnt lgkmcnt(0)
    v_pk_add_f32 v[48:49], v[48:49], v[0:1]
    v_pk_add_f32 v[16:17], v[16:17], v[32:33]
    v_pk_add_f32 v[50:51], v[50:51], v[2:3]
    v_pk_add_f32 v[18:19], v[18:19], v[34:35]
    v_pk_add_f32 v[52:53], v[52:53], v[4:5]
    v_pk_add_f32 v[20:21], v[20:21], v[36:37]
    v_pk_add_f32 v[54:55], v[54:55], v[6:7]
    v_pk_add_f32 v[22:23], v[22:23], v[38:39]
    v_pk_add_f32 v[56:57], v[56:57], v[8:9]
    v_pk_add_f32 v[24:25], v[24:25], v[40:41]
    v_pk_add_f32 v[58:59], v[58:59], v[10:11]
    v_pk_add_f32 v[26:27], v[26:27], v[42:43]
    v_pk_add_f32 v[60:61], v[60:61], v[12:13]
    v_pk_add_f32 v[28:29], v[28:29], v[44:45]
    v_pk_add_f32 v[62:63], v[62:63], v[14:15]
    v_pk_add_f32 v[30:31], v[30:31], v[46:47]
    v_pk_add_f32 v[48:49], v[48:49], v[16:17]
    v_pk_add_f32 v[50:51], v[50:51], v[18:19]
    v_pk_add_f32 v[52:53], v[52:53], v[20:21]
    v_pk_add_f32 v[54:55], v[54:55], v[22:23]
    v_pk_add_f32 v[56:57], v[56:57], v[24:25]
    v_pk_add_f32 v[58:59], v[58:59], v[26:27]
    v_pk_add_f32 v[60:61], v[60:61], v[28:29]
    v_pk_add_f32 v[62:63], v[62:63], v[30:31]
    v_cvt_pk_bf16_f32 v48, v48, v49
    v_cvt_pk_bf16_f32 v49, v50, v51
    v_cvt_pk_bf16_f32 v50, v52, v53
    v_cvt_pk_bf16_f32 v51, v54, v55
    v_cvt_pk_bf16_f32 v52, v56, v57
    v_cvt_pk_bf16_f32 v53, v58, v59
    v_cvt_pk_bf16_f32 v54, v60, v61
    v_cvt_pk_bf16_f32 v55, v62, v63
    buffer_store_dwordx4 v[48:51], v105, s[16:19], s25 offen
    buffer_store_dwordx4 v[52:55], v105, s[16:19], s25 offen offset:32
    s_branch L_rj_24
L_rj_24:
L_k3_done:
    s_waitcnt vmcnt(0)
L_k3_exit:
    s_endpgm
L_text_end:
.section .rodata,"a"
.p2align 6
.amdhsa_kernel main_kernel
  .amdhsa_next_free_vgpr 512
  .amdhsa_next_free_sgpr 102
  .amdhsa_accum_offset 256
  .amdhsa_group_segment_fixed_size 0
  .amdhsa_kernarg_size 96
  .amdhsa_user_sgpr_count 2
  .amdhsa_user_sgpr_kernarg_segment_ptr 1
  .amdhsa_system_sgpr_workgroup_id_x 1
.end_amdhsa_kernel
.section .rodata,"a"
.p2align 6
.amdhsa_kernel k3_kernel
  .amdhsa_next_free_vgpr 256
  .amdhsa_next_free_sgpr 102
  .amdhsa_accum_offset 128
  .amdhsa_group_segment_fixed_size 0
  .amdhsa_kernarg_size 96
  .amdhsa_user_sgpr_count 2
  .amdhsa_user_sgpr_kernarg_segment_ptr 1
  .amdhsa_system_sgpr_workgroup_id_x 1
.end_amdhsa_kernel
```
